```python
import torch

def _softmax(x, axis=-1):
    return torch.softmax(x, dim=axis)
def _gelu(x):
    return torch.nn.functional.gelu(x, approximate="tanh")
def _silu(x):
    return torch.nn.functional.silu(x)
def _sigmoid(x):
    return torch.sigmoid(x)
def _layernorm(x, axis=-1, eps=1e-5):
    m = x.mean(dim=axis, keepdim=True)
    v = x.var(dim=axis, keepdim=True, unbiased=False)
    return (x - m) / torch.sqrt(v + eps)
def _scatter_add(tgt, idx, src, axis=0):
    return tgt.clone().index_add_(axis, idx, src)
def _segment_sum(src, seg, n):
    out = torch.zeros((n,) + src.shape[1:], dtype=src.dtype)
    return out.index_add_(0, seg, src)
def _pad(x, pw):
    flat = tuple(v for pair in reversed(pw) for v in pair)
    return torch.nn.functional.pad(x, flat)

kernel_name = 'recurrent_scan__gqa_block_cached__mixer_s_mlp__prompt'

def setup_inputs():

    _w = (lambda a: (lambda t: t.to(torch.bfloat16) if t.is_floating_point() else t)(torch.as_tensor(a)))
    def _A_setup():
        B, Sq, D = 1, 2048, 576
        Hq, Hkv, Sk, Dh = 32, 16, 2048, 128
        assert Hq % Hkv == 0, (Hq, Hkv)
        return {
            "x": _w((lambda *s: torch.randn(*s, dtype=torch.bfloat16) * 0.05)(B, Sq, D)),
            "k_cache": _w((lambda *s: torch.randn(*s, dtype=torch.bfloat16) * 0.8)(B, Hkv, Sk, Dh)),
            "v_cache": _w((lambda *s: torch.randn(*s, dtype=torch.bfloat16) * 0.8)(B, Hkv, Sk, Dh)),
            "wq": _w((lambda *s: torch.randn(*s, dtype=torch.bfloat16) * 0.8)(D, Hq * Dh) * (D ** -0.5)),
            "wo": _w((lambda *s: torch.randn(*s, dtype=torch.bfloat16) * 0.8)(Hq * Dh, D) * ((Hq * Dh) ** -0.5)),
        }
    _A_in = _A_setup()

    def _B_setup():
        B, S, D, F = 1, 2048, 576, 4608
        return {
            "x":  _w((lambda *s: torch.randn(*s, dtype=torch.bfloat16) * 0.05)(B, S, D)),
            "w1": _w((lambda *s: torch.randn(*s, dtype=torch.bfloat16) * 3.2)(D, D) * (D ** -0.5)),
            "w2": _w((lambda *s: torch.randn(*s, dtype=torch.bfloat16) * 3.2)(D, D) * (D ** -0.5)),
            "w3": _w((lambda *s: torch.randn(*s, dtype=torch.bfloat16) * 3.2)(D, F) * (D ** -0.5)),
            "w4": _w((lambda *s: torch.randn(*s, dtype=torch.bfloat16) * 1.6)(F, D) * (F ** -0.5)),
        }
    _B_in = _B_setup()

    return {
        "A_x": _A_in["x"],
        "A_k_cache": _A_in["k_cache"],
        "A_v_cache": _A_in["v_cache"],
        "A_wq": _A_in["wq"],
        "A_wo": _A_in["wo"],
        "B_x": _B_in["x"],
        "B_w1": _B_in["w1"],
        "B_w2": _B_in["w2"],
        "B_w3": _B_in["w3"],
        "B_w4": _B_in["w4"],
    }

def reference(A_x, A_k_cache, A_v_cache, A_wq, A_wo, B_x, B_w1, B_w2, B_w3, B_w4):
    def _A_ref(x, k_cache, v_cache, wq, wo):
        B, Sq, D = x.shape
        Hq, Dh = 32, 128
        Hkv = k_cache.shape[1]
        rep = Hq // Hkv
        q = (lambda x, *d: x.permute(*d))((x @ wq).reshape(B, Sq, Hq, Dh), 0, 2, 1, 3)
        k = (lambda x, n, axis: torch.repeat_interleave(x, n, dim=axis))(k_cache, rep, axis=1)
        v = (lambda x, n, axis: torch.repeat_interleave(x, n, dim=axis))(v_cache, rep, axis=1)
        scores = torch.einsum("bhqd,bhkd->bhqk", q, k) * (Dh ** -0.5)
        p = _softmax(scores, axis=-1)
        o = torch.einsum("bhqk,bhkd->bhqd", p, v)
        return (lambda x, *d: x.permute(*d))(o, 0, 2, 1, 3).reshape(B, Sq, Hq * Dh) @ wo

    def _B_ref(x, w1, w2, w3, w4):
        B, S, D = x.shape
        h = _gelu(_layernorm(x, axis=-1) @ w1)
        c = D // 4
        g0 = _pad(h[:, :, 0*c:1*c], ((0, 0), (1, 0), (0, 0)))[:, :S, :]
        g1 = _pad(h[:, :, 1*c:2*c], ((0, 0), (0, 1), (0, 0)))[:, 1:, :]
        g2 = _pad(h[:, :, 2*c:3*c], ((0, 0), (2, 0), (0, 0)))[:, :S, :]
        g3 = _pad(h[:, :, 3*c:   ], ((0, 0), (0, 2), (0, 0)))[:, 2:, :]
        hs = torch.concatenate([g0, g1, g2, g3], axis=-1) @ w2
        x1 = x + hs
        h2 = _gelu(_layernorm(x1, axis=-1) @ w3) @ w4
        return x1 + h2

    x = A_x
    xn = _layernorm(x, axis=-1)
    s = _A_ref(xn, A_k_cache, A_v_cache, A_wq, A_wo)
    g = _silu(_B_ref(xn, B_w1, B_w2, B_w3, B_w4))
    return x + s * g
```

```asm
; @launch grid=(256,1,1) block=(256,1,1) lds=131136
.amdgcn_target "amdgcn-amd-amdhsa--gfx950"
.text
.globl recurrent_scan__gqa_block_cached__mixer_s_mlp__prompt_kernel
.p2align 8
.type recurrent_scan__gqa_block_cached__mixer_s_mlp__prompt_kernel,@function
recurrent_scan__gqa_block_cached__mixer_s_mlp__prompt_kernel:
s_cmp_lt_u32 s2, 256
s_cbranch_scc1 M_go
s_endpgm
M_go:
s_load_dwordx2 s[62:63], s[0:1], 0
s_load_dwordx2 s[64:65], s[0:1], 48
s_load_dwordx2 s[70:71], s[0:1], 96
s_load_dwordx2 s[66:67], s[0:1], 88
s_load_dwordx2 s[68:69], s[0:1], 56
v_and_b32 v255, 63, v0
v_and_b32 v254, 15, v255
v_lshrrev_b32 v253, 4, v255
s_getpc_b64 s[20:21]
M_pc_a:
s_sub_u32 s20, s20, M_pc_a-recurrent_scan__gqa_block_cached__mixer_s_mlp__prompt_kernel
s_subb_u32 s21, s21, 0
s_mov_b32 s22, K3_end-recurrent_scan__gqa_block_cached__mixer_s_mlp__prompt_kernel
s_mov_b32 s23, 0x20000
s_lshr_b32 s24, s2, 3
s_lshl_b32 s24, s24, 2
v_lshrrev_b32 v251, 6, v0
v_add_u32 v251, s24, v251
s_mov_b32 s24, (K3_end-recurrent_scan__gqa_block_cached__mixer_s_mlp__prompt_kernel+16383)/16384
v_mul_lo_u32 v251, s24, v251
v_add_u32 v251, v251, v255
v_lshlrev_b32 v251, 7, v251
v_cmp_gt_u32 vcc, s24, v255
v_mov_b32 v250, 0x70000000
s_nop 0
v_cndmask_b32 v251, v250, v251
buffer_load_dword v249, v251, s[20:23], 0 offen
s_cmp_ge_u32 s2, 192
s_cbranch_scc1 M_cs
v_lshrrev_b32 v4, 6, v0
s_nop 0
v_readfirstlane_b32 s40, v4
s_nop 3
v_and_b32 v1, 63, v0
v_and_b32 v2, 15, v1
v_lshrrev_b32 v3, 4, v1
s_and_b32 s96, s2, 7
s_lshl_b32 s96, s96, 2
s_bfe_u32 s60, s2, 0x20003
s_add_u32 s96, s96, s60
s_lshr_b32 s97, s2, 5
s_lshl_b32 s100, s96, 6
s_lshl_b32 s60, s40, 4
s_add_u32 s100, s100, s60
v_lshlrev_b32 v12, 4, v1
v_add_u32 v12, 0, v12
s_mov_b32 s60, 0x1555556
v_mul_hi_u32 v13, s60, v12
v_mul_u32_u24 v14, 192, v13
v_sub_u32 v14, v12, v14
v_bfe_u32 v15, v13, 3, 1
v_lshlrev_b32 v15, 5, v15
v_xor_b32 v14, v14, v15
v_mul_u32_u24 v13, 1152, v13
v_add_u32 v13, v13, v14
v_subrev_u32 v4, 0, v13
v_lshlrev_b32 v12, 4, v1
v_add_u32 v12, 1024, v12
s_mov_b32 s60, 0x1555556
v_mul_hi_u32 v13, s60, v12
v_mul_u32_u24 v14, 192, v13
v_sub_u32 v14, v12, v14
v_bfe_u32 v15, v13, 3, 1
v_lshlrev_b32 v15, 5, v15
v_xor_b32 v14, v14, v15
v_mul_u32_u24 v13, 1152, v13
v_add_u32 v13, v13, v14
v_subrev_u32 v5, 1024, v13
v_lshlrev_b32 v12, 4, v1
v_add_u32 v12, 2048, v12
s_mov_b32 s60, 0x1555556
v_mul_hi_u32 v13, s60, v12
v_mul_u32_u24 v14, 192, v13
v_sub_u32 v14, v12, v14
v_bfe_u32 v15, v13, 3, 1
v_lshlrev_b32 v15, 5, v15
v_xor_b32 v14, v14, v15
v_mul_u32_u24 v13, 1152, v13
v_add_u32 v13, v13, v14
v_subrev_u32 v6, 2048, v13
s_mul_i32 s98, s40, 18432
s_mul_i32 s60, s97, 192
s_add_u32 s98, s98, s60
s_mul_i32 s99, s40, 3072
v_lshrrev_b32 v12, 2, v2
v_lshl_add_u32 v12, v3, 3, v12
v_mul_u32_u24 v12, 192, v12
v_and_b32 v13, 3, v2
v_lshl_add_u32 v12, v13, 3, v12
v_and_b32 v13, 1, v3
v_lshlrev_b32 v13, 5, v13
v_add_u32 v8, v12, v13
v_sub_u32 v9, v12, v13
v_add_u32 v10, 61440, v8
v_add_u32 v11, 61440, v9
v_mul_u32_u24 v12, 1152, v2
v_lshl_add_u32 v12, v3, 4, v12
s_mul_i32 s101, s100, 1152
s_waitcnt lgkmcnt(0)
s_mov_b32 s4, s62
s_mov_b32 s5, s63
s_mov_b32 s6, 0x240000
s_mov_b32 s7, 0x20000
s_mov_b32 s8, s64
s_mov_b32 s9, s65
s_mov_b32 s10, 0xa2000
s_mov_b32 s11, 0x20000
s_bfe_u32 s60, s2, 0x20003
s_add_u32 s60, s60, s97
s_add_u32 s61, s60, 0
s_mul_hi_u32 s53, s61, 0x55555556
s_mul_i32 s53, s53, 3
s_sub_u32 s53, s61, s53
s_mul_i32 s47, s53, 221184
s_add_u32 s47, s47, s98
s_mul_i32 s50, s53, 384
s_add_u32 s50, s50, s101
s_add_u32 s61, s60, 1
s_mul_hi_u32 s54, s61, 0x55555556
s_mul_i32 s54, s54, 3
s_sub_u32 s54, s61, s54
s_mul_i32 s48, s54, 221184
s_add_u32 s48, s48, s98
s_mul_i32 s51, s54, 384
s_add_u32 s51, s51, s101
s_add_u32 s61, s60, 2
s_mul_hi_u32 s55, s61, 0x55555556
s_mul_i32 s55, s55, 3
s_sub_u32 s55, s61, s55
s_mul_i32 s49, s55, 221184
s_add_u32 s49, s49, s98
s_mul_i32 s52, s55, 384
s_add_u32 s52, s52, s101
s_add_u32 m0, s99, 0
s_add_u32 s61, s47, 0
buffer_load_dwordx4 v4, s[8:11], s61 offen lds
buffer_load_dwordx4 v5, s[8:11], s61 offen offset:1024 lds
buffer_load_dwordx4 v6, s[8:11], s61 offen offset:2048 lds
buffer_load_dwordx4 a[0:3], v12, s[4:7], s50 offen
buffer_load_dwordx4 a[4:7], v12, s[4:7], s50 offen offset:64
s_add_u32 m0, s99, 12288
s_add_u32 s61, s47, 73728
buffer_load_dwordx4 v4, s[8:11], s61 offen lds
buffer_load_dwordx4 v5, s[8:11], s61 offen offset:1024 lds
buffer_load_dwordx4 v6, s[8:11], s61 offen offset:2048 lds
buffer_load_dwordx4 a[8:11], v12, s[4:7], s50 offen offset:128
buffer_load_dwordx4 a[12:15], v12, s[4:7], s50 offen offset:192
s_add_u32 m0, s99, 24576
s_add_u32 s61, s47, 147456
buffer_load_dwordx4 v4, s[8:11], s61 offen lds
buffer_load_dwordx4 v5, s[8:11], s61 offen offset:1024 lds
buffer_load_dwordx4 v6, s[8:11], s61 offen offset:2048 lds
buffer_load_dwordx4 a[16:19], v12, s[4:7], s50 offen offset:256
buffer_load_dwordx4 a[20:23], v12, s[4:7], s50 offen offset:320
s_add_u32 s12, s70, 0x80000
s_addc_u32 s13, s71, 0
s_mov_b32 s14, 0x240000
s_mov_b32 s15, 0x20000
s_mov_b32 s36, s70
s_mov_b32 s37, s71
s_mov_b32 s38, 0x80000
s_mov_b32 s39, 0x20000
s_add_u32 s16, s70, 0x4000000
s_addc_u32 s17, s71, 0
s_mov_b32 s18, 0x240000
s_mov_b32 s19, 0x20000
s_add_u32 s72, s70, 0x70000
s_addc_u32 s73, s71, 0
s_mov_b32 s74, 0x5000
s_mov_b32 s75, 0x20000
s_mov_b32 s76, s66
s_mov_b32 s77, s67
s_mov_b32 s78, 0x100
s_mov_b32 s79, 0x20000
s_mov_b32 s20, s68
s_mov_b32 s21, s69
s_mov_b32 s22, 0xa2000
s_mov_b32 s23, 0x20000
s_lshr_b32 s60, s2, 3
s_lshl_b32 s60, s60, 2
s_add_u32 s60, s60, s40
s_mul_i32 s60, s60, 6912
v_lshlrev_b32 v13, 7, v1
v_cmp_gt_u32 vcc, 54, v1
v_mov_b32 v14, 0x70000000
s_nop 0
v_cndmask_b32 v13, v14, v13
v_mov_b32 v121, v13
s_mov_b32 s57, s60
v_mov_b32 v14, 0x3f803f80
v_mov_b32 v92, v14
v_mov_b32 v93, v14
v_mov_b32 v94, v14
v_mov_b32 v95, v14
v_mov_b32 v40, 0
v_mov_b32 v41, 0
v_mov_b32 v42, 0
v_mov_b32 v43, 0
v_mov_b32 v44, 0
v_mov_b32 v45, 0
v_mov_b32 v46, 0
v_mov_b32 v47, 0
v_mov_b32 v48, 0
v_mov_b32 v49, 0
v_mov_b32 v50, 0
v_mov_b32 v51, 0
v_mov_b32 v52, 0
v_mov_b32 v53, 0
v_mov_b32 v54, 0
v_mov_b32 v55, 0
v_mov_b32 v56, 0
v_mov_b32 v57, 0
v_mov_b32 v58, 0
v_mov_b32 v59, 0
v_mov_b32 v60, 0
v_mov_b32 v61, 0
v_mov_b32 v62, 0
v_mov_b32 v63, 0
v_lshrrev_b32 v252, 5, v255
v_add_u32 v252, 0, v252
v_and_b32 v251, 3, v252
v_bfe_u32 v250, v252, 3, 1
v_lshl_or_b32 v251, v250, 2, v251
v_lshlrev_b32 v251, 1, v251
v_and_b32 v250, 31, v255
v_xor_b32 v251, v251, v250
v_lshlrev_b32 v251, 4, v251
v_lshl_add_u32 v251, v252, 13, v251
v_subrev_u32 v208, 0, v251
v_lshrrev_b32 v252, 5, v255
v_add_u32 v252, 2, v252
v_and_b32 v251, 3, v252
v_bfe_u32 v250, v252, 3, 1
v_lshl_or_b32 v251, v250, 2, v251
v_lshlrev_b32 v251, 1, v251
v_and_b32 v250, 31, v255
v_xor_b32 v251, v251, v250
v_lshlrev_b32 v251, 4, v251
v_lshl_add_u32 v251, v252, 13, v251
v_subrev_u32 v209, 1024, v251
v_lshrrev_b32 v252, 5, v255
v_add_u32 v252, 4, v252
v_and_b32 v251, 3, v252
v_bfe_u32 v250, v252, 3, 1
v_lshl_or_b32 v251, v250, 2, v251
v_lshlrev_b32 v251, 1, v251
v_and_b32 v250, 31, v255
v_xor_b32 v251, v251, v250
v_lshlrev_b32 v251, 4, v251
v_lshl_add_u32 v251, v252, 13, v251
v_subrev_u32 v210, 2048, v251
v_lshrrev_b32 v252, 5, v255
v_add_u32 v252, 6, v252
v_and_b32 v251, 3, v252
v_bfe_u32 v250, v252, 3, 1
v_lshl_or_b32 v251, v250, 2, v251
v_lshlrev_b32 v251, 1, v251
v_and_b32 v250, 31, v255
v_xor_b32 v251, v251, v250
v_lshlrev_b32 v251, 4, v251
v_lshl_add_u32 v251, v252, 13, v251
v_subrev_u32 v211, 3072, v251
v_lshrrev_b32 v252, 5, v255
v_add_u32 v252, 8, v252
v_and_b32 v251, 3, v252
v_bfe_u32 v250, v252, 3, 1
v_lshl_or_b32 v251, v250, 2, v251
v_lshlrev_b32 v251, 1, v251
v_and_b32 v250, 31, v255
v_xor_b32 v251, v251, v250
v_lshlrev_b32 v251, 4, v251
v_lshl_add_u32 v251, v252, 13, v251
v_subrev_u32 v212, 0, v251
v_lshrrev_b32 v252, 5, v255
v_add_u32 v252, 10, v252
v_and_b32 v251, 3, v252
v_bfe_u32 v250, v252, 3, 1
v_lshl_or_b32 v251, v250, 2, v251
v_lshlrev_b32 v251, 1, v251
v_and_b32 v250, 31, v255
v_xor_b32 v251, v251, v250
v_lshlrev_b32 v251, 4, v251
v_lshl_add_u32 v251, v252, 13, v251
v_subrev_u32 v213, 1024, v251
v_lshrrev_b32 v252, 5, v255
v_add_u32 v252, 12, v252
v_and_b32 v251, 3, v252
v_bfe_u32 v250, v252, 3, 1
v_lshl_or_b32 v251, v250, 2, v251
v_lshlrev_b32 v251, 1, v251
v_and_b32 v250, 31, v255
v_xor_b32 v251, v251, v250
v_lshlrev_b32 v251, 4, v251
v_lshl_add_u32 v251, v252, 13, v251
v_subrev_u32 v214, 2048, v251
v_lshrrev_b32 v252, 5, v255
v_add_u32 v252, 14, v252
v_and_b32 v251, 3, v252
v_bfe_u32 v250, v252, 3, 1
v_lshl_or_b32 v251, v250, 2, v251
v_lshlrev_b32 v251, 1, v251
v_and_b32 v250, 31, v255
v_xor_b32 v251, v251, v250
v_lshlrev_b32 v251, 4, v251
v_lshl_add_u32 v251, v252, 13, v251
v_subrev_u32 v215, 3072, v251
v_lshlrev_b32 v252, 4, v255
v_add_u32 v220, 0, v252
v_lshlrev_b32 v252, 4, v255
v_add_u32 v221, 18432, v252
v_lshrrev_b32 v252, 2, v254
v_and_b32 v251, 1, v253
v_lshl_or_b32 v251, v251, 2, v252
v_lshl_add_u32 v252, v253, 3, v252
v_lshlrev_b32 v252, 9, v252
v_and_b32 v250, 3, v254
v_lshl_add_u32 v252, v250, 3, v252
v_xor_b32 v250, 0, v251
v_lshl_add_u32 v128, v250, 5, v252
v_add_u32 v136, 0x10000, v128
v_xor_b32 v250, 1, v251
v_lshl_add_u32 v129, v250, 5, v252
v_add_u32 v137, 0x10000, v129
v_xor_b32 v250, 2, v251
v_lshl_add_u32 v130, v250, 5, v252
v_add_u32 v138, 0x10000, v130
v_xor_b32 v250, 3, v251
v_lshl_add_u32 v131, v250, 5, v252
v_add_u32 v139, 0x10000, v131
v_xor_b32 v250, 4, v251
v_lshl_add_u32 v132, v250, 5, v252
v_add_u32 v140, 0x10000, v132
v_xor_b32 v250, 5, v251
v_lshl_add_u32 v133, v250, 5, v252
v_add_u32 v141, 0x10000, v133
v_xor_b32 v250, 6, v251
v_lshl_add_u32 v134, v250, 5, v252
v_add_u32 v142, 0x10000, v134
v_xor_b32 v250, 7, v251
v_lshl_add_u32 v135, v250, 5, v252
v_add_u32 v143, 0x10000, v135
v_lshlrev_b32 v222, 3, v254
v_lshlrev_b32 v223, 4, v253
v_lshlrev_b32 v252, 4, v255
v_add_u32 v252, 0, v252
s_mov_b32 s56, 0xe38e39
v_mul_hi_u32 v251, s56, v252
v_mul_u32_u24 v250, 288, v251
v_sub_u32 v250, v252, v250
v_mul_u32_u24 v251, 9216, v251
v_add_u32 v251, v251, v250
v_subrev_u32 v230, 0, v251
v_lshlrev_b32 v252, 4, v255
v_add_u32 v252, 1024, v252
s_mov_b32 s56, 0xe38e39
v_mul_hi_u32 v251, s56, v252
v_mul_u32_u24 v250, 288, v251
v_sub_u32 v250, v252, v250
v_mul_u32_u24 v251, 9216, v251
v_add_u32 v251, v251, v250
v_subrev_u32 v231, 1024, v251
v_lshlrev_b32 v252, 4, v255
v_add_u32 v252, 2048, v252
s_mov_b32 s56, 0xe38e39
v_mul_hi_u32 v251, s56, v252
v_mul_u32_u24 v250, 288, v251
v_sub_u32 v250, v252, v250
v_mul_u32_u24 v251, 9216, v251
v_add_u32 v251, v251, v250
v_subrev_u32 v232, 2048, v251
v_lshlrev_b32 v252, 4, v255
v_add_u32 v252, 3072, v252
s_mov_b32 s56, 0xe38e39
v_mul_hi_u32 v251, s56, v252
v_mul_u32_u24 v250, 288, v251
v_sub_u32 v250, v252, v250
v_mul_u32_u24 v251, 9216, v251
v_add_u32 v251, v251, v250
v_subrev_u32 v233, 3072, v251
v_lshlrev_b32 v252, 4, v255
v_add_u32 v252, 4096, v252
s_mov_b32 s56, 0xe38e39
v_mul_hi_u32 v251, s56, v252
v_mul_u32_u24 v250, 288, v251
v_sub_u32 v250, v252, v250
v_mul_u32_u24 v251, 9216, v251
v_add_u32 v251, v251, v250
v_subrev_u32 v234, 0, v251
v_cmp_gt_u32 vcc, 32, v255
v_mov_b32 v252, 0x70000000
s_nop 0
v_cndmask_b32 v234, v252, v234
v_lshlrev_b32 v252, 4, v255
v_add_u32 v235, 0, v252
v_lshlrev_b32 v252, 4, v255
v_add_u32 v236, 18432, v252
v_lshlrev_b32 v252, 4, v255
v_add_u32 v237, 36864, v252
v_lshlrev_b32 v252, 4, v255
v_add_u32 v238, 55296, v252
v_lshrrev_b32 v252, 2, v254
v_lshl_add_u32 v252, v253, 2, v252
v_mul_u32_u24 v252, 288, v252
v_and_b32 v251, 3, v254
v_lshl_add_u32 v239, v251, 3, v252
v_add_u32 v240, 0x10000, v239
v_lshrrev_b32 v252, 4, v255
v_and_b32 v251, 15, v255
v_add_u32 v250, 0, v252
v_xor_b32 v250, v250, v251
v_lshlrev_b32 v250, 4, v250
v_lshl_add_u32 v224, v252, 8, v250
v_add_u32 v250, 4, v252
v_xor_b32 v250, v250, v251
v_lshlrev_b32 v250, 4, v250
v_lshl_add_u32 v225, v252, 8, v250
v_add_u32 v250, 8, v252
v_xor_b32 v250, v250, v251
v_lshlrev_b32 v250, 4, v250
v_lshl_add_u32 v226, v252, 8, v250
v_add_u32 v250, 12, v252
v_xor_b32 v250, v250, v251
v_lshlrev_b32 v250, 4, v250
v_lshl_add_u32 v227, v252, 8, v250
v_add_u32 v250, 0, v252
v_lshlrev_b32 v250, 1, v250
v_xor_b32 v250, v250, v251
v_lshlrev_b32 v250, 4, v250
v_lshl_add_u32 v228, v252, 8, v250
v_add_u32 v250, 4, v252
v_lshlrev_b32 v250, 1, v250
v_xor_b32 v250, v250, v251
v_lshlrev_b32 v250, 4, v250
v_lshl_add_u32 v229, v252, 8, v250
v_add_u32 v118, s100, v2
v_add_u32 v252, 4294967295, v118
v_lshlrev_b32 v251, 6, v252
v_lshl_add_u32 v251, v3, 4, v251
v_mov_b32 v250, 2048
v_cmp_gt_u32 vcc, v250, v252
v_mov_b32 v250, 0x70000000
s_nop 0
v_cndmask_b32 v112, v250, v251
v_add_u32 v252, 1, v118
v_lshlrev_b32 v251, 6, v252
v_lshl_add_u32 v251, v3, 4, v251
v_mov_b32 v250, 2048
v_cmp_gt_u32 vcc, v250, v252
v_mov_b32 v250, 0x70000000
s_nop 0
v_cndmask_b32 v114, v250, v251
v_add_u32 v252, 4294967294, v118
v_lshlrev_b32 v251, 6, v252
v_lshl_add_u32 v251, v3, 4, v251
v_mov_b32 v250, 2048
v_cmp_gt_u32 vcc, v250, v252
v_mov_b32 v250, 0x70000000
s_nop 0
v_cndmask_b32 v115, v250, v251
v_add_u32 v252, 2, v118
v_lshlrev_b32 v251, 6, v252
v_lshl_add_u32 v251, v3, 4, v251
v_mov_b32 v250, 2048
v_cmp_gt_u32 vcc, v250, v252
v_mov_b32 v250, 0x70000000
s_nop 0
v_cndmask_b32 v117, v250, v251
v_cmp_gt_u32 vcc, 2, v3
s_nop 1
v_cndmask_b32 v113, v114, v112
v_cndmask_b32 v116, v117, v115
s_add_u32 m0, s99, 36864
s_add_u32 s61, s48, 0
buffer_load_dwordx4 v4, s[8:11], s61 offen lds
buffer_load_dwordx4 v5, s[8:11], s61 offen offset:1024 lds
buffer_load_dwordx4 v6, s[8:11], s61 offen offset:2048 lds
buffer_load_dwordx4 a[24:27], v12, s[4:7], s51 offen
buffer_load_dwordx4 a[28:31], v12, s[4:7], s51 offen offset:64
s_add_u32 m0, s99, 49152
s_add_u32 s61, s48, 73728
buffer_load_dwordx4 v4, s[8:11], s61 offen lds
buffer_load_dwordx4 v5, s[8:11], s61 offen offset:1024 lds
buffer_load_dwordx4 v6, s[8:11], s61 offen offset:2048 lds
buffer_load_dwordx4 a[32:35], v12, s[4:7], s51 offen offset:128
buffer_load_dwordx4 a[36:39], v12, s[4:7], s51 offen offset:192
s_add_u32 m0, s99, 61440
s_add_u32 s61, s48, 147456
buffer_load_dwordx4 v4, s[8:11], s61 offen lds
buffer_load_dwordx4 v5, s[8:11], s61 offen offset:1024 lds
buffer_load_dwordx4 v6, s[8:11], s61 offen offset:2048 lds
buffer_load_dwordx4 a[40:43], v12, s[4:7], s51 offen offset:256
buffer_load_dwordx4 a[44:47], v12, s[4:7], s51 offen offset:320
s_waitcnt vmcnt(15)
s_barrier
ds_read_b64_tr_b16 a[72:73], v8
ds_read_b64_tr_b16 a[74:75], v8 offset:768
ds_read_b64_tr_b16 a[76:77], v9 offset:32
ds_read_b64_tr_b16 a[78:79], v9 offset:800
ds_read_b64_tr_b16 a[80:81], v8 offset:64
ds_read_b64_tr_b16 a[82:83], v8 offset:832
ds_read_b64_tr_b16 a[84:85], v9 offset:96
ds_read_b64_tr_b16 a[86:87], v9 offset:864
ds_read_b64_tr_b16 a[88:89], v8 offset:128
ds_read_b64_tr_b16 a[90:91], v8 offset:896
ds_read_b64_tr_b16 a[92:93], v9 offset:160
ds_read_b64_tr_b16 a[94:95], v9 offset:928
s_waitcnt lgkmcnt(0)
v_mfma_f32_16x16x32_bf16 v[16:19], a[72:75], a[0:3], 0
ds_read_b64_tr_b16 a[96:97], v8 offset:6144
ds_read_b64_tr_b16 a[98:99], v8 offset:6912
s_add_u32 m0, s99, 73728
s_add_u32 s61, s49, 0
buffer_load_dwordx4 v4, s[8:11], s61 offen lds
v_mfma_f32_16x16x32_bf16 v[20:23], a[76:79], a[0:3], 0
ds_read_b64_tr_b16 a[100:101], v9 offset:6176
ds_read_b64_tr_b16 a[102:103], v9 offset:6944
buffer_load_dwordx4 v5, s[8:11], s61 offen offset:1024 lds
v_mfma_f32_16x16x32_bf16 v[24:27], a[80:83], a[0:3], 0
ds_read_b64_tr_b16 a[104:105], v8 offset:6208
ds_read_b64_tr_b16 a[106:107], v8 offset:6976
buffer_load_dwordx4 v6, s[8:11], s61 offen offset:2048 lds
v_mfma_f32_16x16x32_bf16 v[28:31], a[84:87], a[0:3], 0
ds_read_b64_tr_b16 a[108:109], v9 offset:6240
ds_read_b64_tr_b16 a[110:111], v9 offset:7008
v_mfma_f32_16x16x32_bf16 v[32:35], a[88:91], a[0:3], 0
ds_read_b64_tr_b16 a[112:113], v8 offset:6272
ds_read_b64_tr_b16 a[114:115], v8 offset:7040
v_mfma_f32_16x16x32_bf16 v[36:39], a[92:95], a[0:3], 0
ds_read_b64_tr_b16 a[116:117], v9 offset:6304
ds_read_b64_tr_b16 a[118:119], v9 offset:7072
v_mfma_f32_16x16x32_bf16 v[64:67], v[92:95], a[0:3], 0
v_mfma_f32_16x16x32_bf16 v[68:71], a[0:3], a[0:3], 0
s_cmp_lg_u32 s40, 0
s_cbranch_scc1 K1_nocs0
v_mfma_f32_16x16x32_bf16 v[40:43], a[72:75], v[92:95], v[40:43]
v_mfma_f32_16x16x32_bf16 v[44:47], a[76:79], v[92:95], v[44:47]
v_mfma_f32_16x16x32_bf16 v[48:51], a[80:83], v[92:95], v[48:51]
v_mfma_f32_16x16x32_bf16 v[52:55], a[84:87], v[92:95], v[52:55]
v_mfma_f32_16x16x32_bf16 v[56:59], a[88:91], v[92:95], v[56:59]
v_mfma_f32_16x16x32_bf16 v[60:63], a[92:95], v[92:95], v[60:63]
K1_nocs0:
s_nop 0
s_waitcnt lgkmcnt(0)
v_mfma_f32_16x16x32_bf16 v[16:19], a[96:99], a[4:7], v[16:19]
ds_read_b64_tr_b16 a[120:121], v8 offset:12288
ds_read_b64_tr_b16 a[122:123], v8 offset:13056
buffer_load_dwordx4 a[48:51], v12, s[4:7], s52 offen
v_mfma_f32_16x16x32_bf16 v[20:23], a[100:103], a[4:7], v[20:23]
ds_read_b64_tr_b16 a[124:125], v9 offset:12320
ds_read_b64_tr_b16 a[126:127], v9 offset:13088
buffer_load_dwordx4 a[52:55], v12, s[4:7], s52 offen offset:64
v_mfma_f32_16x16x32_bf16 v[24:27], a[104:107], a[4:7], v[24:27]
ds_read_b64_tr_b16 a[128:129], v8 offset:12352
ds_read_b64_tr_b16 a[130:131], v8 offset:13120
s_add_u32 m0, s99, 86016
s_add_u32 s61, s49, 73728
buffer_load_dwordx4 v4, s[8:11], s61 offen lds
v_mfma_f32_16x16x32_bf16 v[28:31], a[108:111], a[4:7], v[28:31]
ds_read_b64_tr_b16 a[132:133], v9 offset:12384
ds_read_b64_tr_b16 a[134:135], v9 offset:13152
v_mfma_f32_16x16x32_bf16 v[32:35], a[112:115], a[4:7], v[32:35]
ds_read_b64_tr_b16 a[136:137], v8 offset:12416
ds_read_b64_tr_b16 a[138:139], v8 offset:13184
v_mfma_f32_16x16x32_bf16 v[36:39], a[116:119], a[4:7], v[36:39]
ds_read_b64_tr_b16 a[140:141], v9 offset:12448
ds_read_b64_tr_b16 a[142:143], v9 offset:13216
v_mfma_f32_16x16x32_bf16 v[64:67], v[92:95], a[4:7], v[64:67]
v_mfma_f32_16x16x32_bf16 v[68:71], a[4:7], a[4:7], v[68:71]
s_cmp_lg_u32 s40, 1
s_cbranch_scc1 K1_nocs1
v_mfma_f32_16x16x32_bf16 v[40:43], a[96:99], v[92:95], v[40:43]
v_mfma_f32_16x16x32_bf16 v[44:47], a[100:103], v[92:95], v[44:47]
v_mfma_f32_16x16x32_bf16 v[48:51], a[104:107], v[92:95], v[48:51]
v_mfma_f32_16x16x32_bf16 v[52:55], a[108:111], v[92:95], v[52:55]
v_mfma_f32_16x16x32_bf16 v[56:59], a[112:115], v[92:95], v[56:59]
v_mfma_f32_16x16x32_bf16 v[60:63], a[116:119], v[92:95], v[60:63]
K1_nocs1:
s_nop 0
s_waitcnt lgkmcnt(0)
v_mfma_f32_16x16x32_bf16 v[16:19], a[120:123], a[8:11], v[16:19]
ds_read_b64_tr_b16 a[72:73], v8 offset:18432
ds_read_b64_tr_b16 a[74:75], v8 offset:19200
buffer_load_dwordx4 v5, s[8:11], s61 offen offset:1024 lds
v_mfma_f32_16x16x32_bf16 v[20:23], a[124:127], a[8:11], v[20:23]
ds_read_b64_tr_b16 a[76:77], v9 offset:18464
ds_read_b64_tr_b16 a[78:79], v9 offset:19232
buffer_load_dwordx4 v6, s[8:11], s61 offen offset:2048 lds
v_mfma_f32_16x16x32_bf16 v[24:27], a[128:131], a[8:11], v[24:27]
ds_read_b64_tr_b16 a[80:81], v8 offset:18496
ds_read_b64_tr_b16 a[82:83], v8 offset:19264
buffer_load_dwordx4 a[56:59], v12, s[4:7], s52 offen offset:128
v_mfma_f32_16x16x32_bf16 v[28:31], a[132:135], a[8:11], v[28:31]
ds_read_b64_tr_b16 a[84:85], v9 offset:18528
ds_read_b64_tr_b16 a[86:87], v9 offset:19296
v_mfma_f32_16x16x32_bf16 v[32:35], a[136:139], a[8:11], v[32:35]
ds_read_b64_tr_b16 a[88:89], v8 offset:18560
ds_read_b64_tr_b16 a[90:91], v8 offset:19328
v_mfma_f32_16x16x32_bf16 v[36:39], a[140:143], a[8:11], v[36:39]
ds_read_b64_tr_b16 a[92:93], v9 offset:18592
ds_read_b64_tr_b16 a[94:95], v9 offset:19360
v_mfma_f32_16x16x32_bf16 v[64:67], v[92:95], a[8:11], v[64:67]
v_mfma_f32_16x16x32_bf16 v[68:71], a[8:11], a[8:11], v[68:71]
s_cmp_lg_u32 s40, 2
s_cbranch_scc1 K1_nocs2
v_mfma_f32_16x16x32_bf16 v[40:43], a[120:123], v[92:95], v[40:43]
v_mfma_f32_16x16x32_bf16 v[44:47], a[124:127], v[92:95], v[44:47]
v_mfma_f32_16x16x32_bf16 v[48:51], a[128:131], v[92:95], v[48:51]
v_mfma_f32_16x16x32_bf16 v[52:55], a[132:135], v[92:95], v[52:55]
v_mfma_f32_16x16x32_bf16 v[56:59], a[136:139], v[92:95], v[56:59]
v_mfma_f32_16x16x32_bf16 v[60:63], a[140:143], v[92:95], v[60:63]
K1_nocs2:
s_nop 0
s_waitcnt lgkmcnt(0)
v_mfma_f32_16x16x32_bf16 v[16:19], a[72:75], a[12:15], v[16:19]
ds_read_b64_tr_b16 a[96:97], v8 offset:24576
ds_read_b64_tr_b16 a[98:99], v8 offset:25344
buffer_load_dwordx4 a[60:63], v12, s[4:7], s52 offen offset:192
v_mfma_f32_16x16x32_bf16 v[20:23], a[76:79], a[12:15], v[20:23]
ds_read_b64_tr_b16 a[100:101], v9 offset:24608
ds_read_b64_tr_b16 a[102:103], v9 offset:25376
s_add_u32 m0, s99, 98304
s_add_u32 s61, s49, 147456
buffer_load_dwordx4 v4, s[8:11], s61 offen lds
v_mfma_f32_16x16x32_bf16 v[24:27], a[80:83], a[12:15], v[24:27]
ds_read_b64_tr_b16 a[104:105], v8 offset:24640
ds_read_b64_tr_b16 a[106:107], v8 offset:25408
buffer_load_dwordx4 v5, s[8:11], s61 offen offset:1024 lds
v_mfma_f32_16x16x32_bf16 v[28:31], a[84:87], a[12:15], v[28:31]
ds_read_b64_tr_b16 a[108:109], v9 offset:24672
ds_read_b64_tr_b16 a[110:111], v9 offset:25440
v_mfma_f32_16x16x32_bf16 v[32:35], a[88:91], a[12:15], v[32:35]
ds_read_b64_tr_b16 a[112:113], v8 offset:24704
ds_read_b64_tr_b16 a[114:115], v8 offset:25472
v_mfma_f32_16x16x32_bf16 v[36:39], a[92:95], a[12:15], v[36:39]
ds_read_b64_tr_b16 a[116:117], v9 offset:24736
ds_read_b64_tr_b16 a[118:119], v9 offset:25504
v_mfma_f32_16x16x32_bf16 v[64:67], v[92:95], a[12:15], v[64:67]
v_mfma_f32_16x16x32_bf16 v[68:71], a[12:15], a[12:15], v[68:71]
s_cmp_lg_u32 s40, 3
s_cbranch_scc1 K1_nocs3
v_mfma_f32_16x16x32_bf16 v[40:43], a[72:75], v[92:95], v[40:43]
v_mfma_f32_16x16x32_bf16 v[44:47], a[76:79], v[92:95], v[44:47]
v_mfma_f32_16x16x32_bf16 v[48:51], a[80:83], v[92:95], v[48:51]
v_mfma_f32_16x16x32_bf16 v[52:55], a[84:87], v[92:95], v[52:55]
v_mfma_f32_16x16x32_bf16 v[56:59], a[88:91], v[92:95], v[56:59]
v_mfma_f32_16x16x32_bf16 v[60:63], a[92:95], v[92:95], v[60:63]
K1_nocs3:
s_nop 0
s_waitcnt lgkmcnt(0)
v_mfma_f32_16x16x32_bf16 v[16:19], a[96:99], a[16:19], v[16:19]
ds_read_b64_tr_b16 a[120:121], v8 offset:30720
ds_read_b64_tr_b16 a[122:123], v8 offset:31488
buffer_load_dwordx4 v6, s[8:11], s61 offen offset:2048 lds
v_mfma_f32_16x16x32_bf16 v[20:23], a[100:103], a[16:19], v[20:23]
ds_read_b64_tr_b16 a[124:125], v9 offset:30752
ds_read_b64_tr_b16 a[126:127], v9 offset:31520
buffer_load_dwordx4 a[64:67], v12, s[4:7], s52 offen offset:256
v_mfma_f32_16x16x32_bf16 v[24:27], a[104:107], a[16:19], v[24:27]
ds_read_b64_tr_b16 a[128:129], v8 offset:30784
ds_read_b64_tr_b16 a[130:131], v8 offset:31552
buffer_load_dwordx4 a[68:71], v12, s[4:7], s52 offen offset:320
v_mfma_f32_16x16x32_bf16 v[28:31], a[108:111], a[16:19], v[28:31]
ds_read_b64_tr_b16 a[132:133], v9 offset:30816
ds_read_b64_tr_b16 a[134:135], v9 offset:31584
v_mfma_f32_16x16x32_bf16 v[32:35], a[112:115], a[16:19], v[32:35]
ds_read_b64_tr_b16 a[136:137], v8 offset:30848
ds_read_b64_tr_b16 a[138:139], v8 offset:31616
v_mfma_f32_16x16x32_bf16 v[36:39], a[116:119], a[16:19], v[36:39]
ds_read_b64_tr_b16 a[140:141], v9 offset:30880
ds_read_b64_tr_b16 a[142:143], v9 offset:31648
v_mfma_f32_16x16x32_bf16 v[64:67], v[92:95], a[16:19], v[64:67]
v_mfma_f32_16x16x32_bf16 v[68:71], a[16:19], a[16:19], v[68:71]
s_cmp_lg_u32 s40, 0
s_cbranch_scc1 K1_nocs4
v_mfma_f32_16x16x32_bf16 v[40:43], a[96:99], v[92:95], v[40:43]
v_mfma_f32_16x16x32_bf16 v[44:47], a[100:103], v[92:95], v[44:47]
v_mfma_f32_16x16x32_bf16 v[48:51], a[104:107], v[92:95], v[48:51]
v_mfma_f32_16x16x32_bf16 v[52:55], a[108:111], v[92:95], v[52:55]
v_mfma_f32_16x16x32_bf16 v[56:59], a[112:115], v[92:95], v[56:59]
v_mfma_f32_16x16x32_bf16 v[60:63], a[116:119], v[92:95], v[60:63]
K1_nocs4:
s_nop 0
s_waitcnt lgkmcnt(0)
v_mfma_f32_16x16x32_bf16 v[16:19], a[120:123], a[20:23], v[16:19]
v_mfma_f32_16x16x32_bf16 v[20:23], a[124:127], a[20:23], v[20:23]
v_mfma_f32_16x16x32_bf16 v[24:27], a[128:131], a[20:23], v[24:27]
v_mfma_f32_16x16x32_bf16 v[28:31], a[132:135], a[20:23], v[28:31]
v_mfma_f32_16x16x32_bf16 v[32:35], a[136:139], a[20:23], v[32:35]
v_mfma_f32_16x16x32_bf16 v[36:39], a[140:143], a[20:23], v[36:39]
v_mfma_f32_16x16x32_bf16 v[64:67], v[92:95], a[20:23], v[64:67]
v_mfma_f32_16x16x32_bf16 v[68:71], a[20:23], a[20:23], v[68:71]
s_cmp_lg_u32 s40, 1
s_cbranch_scc1 K1_nocs5
v_mfma_f32_16x16x32_bf16 v[40:43], a[120:123], v[92:95], v[40:43]
v_mfma_f32_16x16x32_bf16 v[44:47], a[124:127], v[92:95], v[44:47]
v_mfma_f32_16x16x32_bf16 v[48:51], a[128:131], v[92:95], v[48:51]
v_mfma_f32_16x16x32_bf16 v[52:55], a[132:135], v[92:95], v[52:55]
v_mfma_f32_16x16x32_bf16 v[56:59], a[136:139], v[92:95], v[56:59]
v_mfma_f32_16x16x32_bf16 v[60:63], a[140:143], v[92:95], v[60:63]
K1_nocs5:
s_nop 0
s_waitcnt vmcnt(15)
s_barrier
ds_read_b64_tr_b16 a[72:73], v8 offset:36864
ds_read_b64_tr_b16 a[74:75], v8 offset:37632
ds_read_b64_tr_b16 a[76:77], v9 offset:36896
ds_read_b64_tr_b16 a[78:79], v9 offset:37664
ds_read_b64_tr_b16 a[80:81], v8 offset:36928
ds_read_b64_tr_b16 a[82:83], v8 offset:37696
ds_read_b64_tr_b16 a[84:85], v9 offset:36960
ds_read_b64_tr_b16 a[86:87], v9 offset:37728
ds_read_b64_tr_b16 a[88:89], v8 offset:36992
ds_read_b64_tr_b16 a[90:91], v8 offset:37760
ds_read_b64_tr_b16 a[92:93], v9 offset:37024
ds_read_b64_tr_b16 a[94:95], v9 offset:37792
s_waitcnt lgkmcnt(0)
v_mfma_f32_16x16x32_bf16 v[16:19], a[72:75], a[24:27], v[16:19]
ds_read_b64_tr_b16 a[96:97], v8 offset:43008
ds_read_b64_tr_b16 a[98:99], v8 offset:43776
buffer_load_dword v15, v121, s[20:23], s57 offen
v_mfma_f32_16x16x32_bf16 v[20:23], a[76:79], a[24:27], v[20:23]
ds_read_b64_tr_b16 a[100:101], v9 offset:43040
ds_read_b64_tr_b16 a[102:103], v9 offset:43808
v_mfma_f32_16x16x32_bf16 v[24:27], a[80:83], a[24:27], v[24:27]
ds_read_b64_tr_b16 a[104:105], v8 offset:43072
ds_read_b64_tr_b16 a[106:107], v8 offset:43840
v_mfma_f32_16x16x32_bf16 v[28:31], a[84:87], a[24:27], v[28:31]
ds_read_b64_tr_b16 a[108:109], v9 offset:43104
ds_read_b64_tr_b16 a[110:111], v9 offset:43872
v_mfma_f32_16x16x32_bf16 v[32:35], a[88:91], a[24:27], v[32:35]
ds_read_b64_tr_b16 a[112:113], v8 offset:43136
ds_read_b64_tr_b16 a[114:115], v8 offset:43904
v_mfma_f32_16x16x32_bf16 v[36:39], a[92:95], a[24:27], v[36:39]
ds_read_b64_tr_b16 a[116:117], v9 offset:43168
ds_read_b64_tr_b16 a[118:119], v9 offset:43936
v_mfma_f32_16x16x32_bf16 v[64:67], v[92:95], a[24:27], v[64:67]
v_mfma_f32_16x16x32_bf16 v[68:71], a[24:27], a[24:27], v[68:71]
s_cmp_lg_u32 s40, 2
s_cbranch_scc1 K1_nocs6
v_mfma_f32_16x16x32_bf16 v[40:43], a[72:75], v[92:95], v[40:43]
v_mfma_f32_16x16x32_bf16 v[44:47], a[76:79], v[92:95], v[44:47]
v_mfma_f32_16x16x32_bf16 v[48:51], a[80:83], v[92:95], v[48:51]
v_mfma_f32_16x16x32_bf16 v[52:55], a[84:87], v[92:95], v[52:55]
v_mfma_f32_16x16x32_bf16 v[56:59], a[88:91], v[92:95], v[56:59]
v_mfma_f32_16x16x32_bf16 v[60:63], a[92:95], v[92:95], v[60:63]
K1_nocs6:
s_nop 0
s_waitcnt lgkmcnt(0)
v_mfma_f32_16x16x32_bf16 v[16:19], a[96:99], a[28:31], v[16:19]
ds_read_b64_tr_b16 a[120:121], v8 offset:49152
ds_read_b64_tr_b16 a[122:123], v8 offset:49920
v_mfma_f32_16x16x32_bf16 v[20:23], a[100:103], a[28:31], v[20:23]
ds_read_b64_tr_b16 a[124:125], v9 offset:49184
ds_read_b64_tr_b16 a[126:127], v9 offset:49952
v_mfma_f32_16x16x32_bf16 v[24:27], a[104:107], a[28:31], v[24:27]
ds_read_b64_tr_b16 a[128:129], v8 offset:49216
ds_read_b64_tr_b16 a[130:131], v8 offset:49984
v_mfma_f32_16x16x32_bf16 v[28:31], a[108:111], a[28:31], v[28:31]
ds_read_b64_tr_b16 a[132:133], v9 offset:49248
ds_read_b64_tr_b16 a[134:135], v9 offset:50016
v_mfma_f32_16x16x32_bf16 v[32:35], a[112:115], a[28:31], v[32:35]
ds_read_b64_tr_b16 a[136:137], v8 offset:49280
ds_read_b64_tr_b16 a[138:139], v8 offset:50048
v_mfma_f32_16x16x32_bf16 v[36:39], a[116:119], a[28:31], v[36:39]
ds_read_b64_tr_b16 a[140:141], v9 offset:49312
ds_read_b64_tr_b16 a[142:143], v9 offset:50080
v_mfma_f32_16x16x32_bf16 v[64:67], v[92:95], a[28:31], v[64:67]
v_mfma_f32_16x16x32_bf16 v[68:71], a[28:31], a[28:31], v[68:71]
s_cmp_lg_u32 s40, 3
s_cbranch_scc1 K1_nocs7
v_mfma_f32_16x16x32_bf16 v[40:43], a[96:99], v[92:95], v[40:43]
v_mfma_f32_16x16x32_bf16 v[44:47], a[100:103], v[92:95], v[44:47]
v_mfma_f32_16x16x32_bf16 v[48:51], a[104:107], v[92:95], v[48:51]
v_mfma_f32_16x16x32_bf16 v[52:55], a[108:111], v[92:95], v[52:55]
v_mfma_f32_16x16x32_bf16 v[56:59], a[112:115], v[92:95], v[56:59]
v_mfma_f32_16x16x32_bf16 v[60:63], a[116:119], v[92:95], v[60:63]
K1_nocs7:
s_nop 0
s_waitcnt lgkmcnt(0)
v_mfma_f32_16x16x32_bf16 v[16:19], a[120:123], a[32:35], v[16:19]
ds_read_b64_tr_b16 a[72:73], v8 offset:55296
ds_read_b64_tr_b16 a[74:75], v8 offset:56064
v_mfma_f32_16x16x32_bf16 v[20:23], a[124:127], a[32:35], v[20:23]
ds_read_b64_tr_b16 a[76:77], v9 offset:55328
ds_read_b64_tr_b16 a[78:79], v9 offset:56096
v_mfma_f32_16x16x32_bf16 v[24:27], a[128:131], a[32:35], v[24:27]
ds_read_b64_tr_b16 a[80:81], v8 offset:55360
ds_read_b64_tr_b16 a[82:83], v8 offset:56128
v_mfma_f32_16x16x32_bf16 v[28:31], a[132:135], a[32:35], v[28:31]
ds_read_b64_tr_b16 a[84:85], v9 offset:55392
ds_read_b64_tr_b16 a[86:87], v9 offset:56160
v_mfma_f32_16x16x32_bf16 v[32:35], a[136:139], a[32:35], v[32:35]
ds_read_b64_tr_b16 a[88:89], v8 offset:55424
ds_read_b64_tr_b16 a[90:91], v8 offset:56192
v_mfma_f32_16x16x32_bf16 v[36:39], a[140:143], a[32:35], v[36:39]
ds_read_b64_tr_b16 a[92:93], v9 offset:55456
ds_read_b64_tr_b16 a[94:95], v9 offset:56224
v_mfma_f32_16x16x32_bf16 v[64:67], v[92:95], a[32:35], v[64:67]
v_mfma_f32_16x16x32_bf16 v[68:71], a[32:35], a[32:35], v[68:71]
s_cmp_lg_u32 s40, 0
s_cbranch_scc1 K1_nocs8
v_mfma_f32_16x16x32_bf16 v[40:43], a[120:123], v[92:95], v[40:43]
v_mfma_f32_16x16x32_bf16 v[44:47], a[124:127], v[92:95], v[44:47]
v_mfma_f32_16x16x32_bf16 v[48:51], a[128:131], v[92:95], v[48:51]
v_mfma_f32_16x16x32_bf16 v[52:55], a[132:135], v[92:95], v[52:55]
v_mfma_f32_16x16x32_bf16 v[56:59], a[136:139], v[92:95], v[56:59]
v_mfma_f32_16x16x32_bf16 v[60:63], a[140:143], v[92:95], v[60:63]
K1_nocs8:
s_nop 0
s_waitcnt lgkmcnt(0)
v_mfma_f32_16x16x32_bf16 v[16:19], a[72:75], a[36:39], v[16:19]
ds_read_b64_tr_b16 a[96:97], v10
ds_read_b64_tr_b16 a[98:99], v10 offset:768
v_mfma_f32_16x16x32_bf16 v[20:23], a[76:79], a[36:39], v[20:23]
ds_read_b64_tr_b16 a[100:101], v11 offset:32
ds_read_b64_tr_b16 a[102:103], v11 offset:800
v_mfma_f32_16x16x32_bf16 v[24:27], a[80:83], a[36:39], v[24:27]
ds_read_b64_tr_b16 a[104:105], v10 offset:64
ds_read_b64_tr_b16 a[106:107], v10 offset:832
v_mfma_f32_16x16x32_bf16 v[28:31], a[84:87], a[36:39], v[28:31]
ds_read_b64_tr_b16 a[108:109], v11 offset:96
ds_read_b64_tr_b16 a[110:111], v11 offset:864
v_mfma_f32_16x16x32_bf16 v[32:35], a[88:91], a[36:39], v[32:35]
ds_read_b64_tr_b16 a[112:113], v10 offset:128
ds_read_b64_tr_b16 a[114:115], v10 offset:896
v_mfma_f32_16x16x32_bf16 v[36:39], a[92:95], a[36:39], v[36:39]
ds_read_b64_tr_b16 a[116:117], v11 offset:160
ds_read_b64_tr_b16 a[118:119], v11 offset:928
v_mfma_f32_16x16x32_bf16 v[64:67], v[92:95], a[36:39], v[64:67]
v_mfma_f32_16x16x32_bf16 v[68:71], a[36:39], a[36:39], v[68:71]
s_cmp_lg_u32 s40, 1
s_cbranch_scc1 K1_nocs9
v_mfma_f32_16x16x32_bf16 v[40:43], a[72:75], v[92:95], v[40:43]
v_mfma_f32_16x16x32_bf16 v[44:47], a[76:79], v[92:95], v[44:47]
v_mfma_f32_16x16x32_bf16 v[48:51], a[80:83], v[92:95], v[48:51]
v_mfma_f32_16x16x32_bf16 v[52:55], a[84:87], v[92:95], v[52:55]
v_mfma_f32_16x16x32_bf16 v[56:59], a[88:91], v[92:95], v[56:59]
v_mfma_f32_16x16x32_bf16 v[60:63], a[92:95], v[92:95], v[60:63]
K1_nocs9:
s_nop 0
s_waitcnt lgkmcnt(0)
v_mfma_f32_16x16x32_bf16 v[16:19], a[96:99], a[40:43], v[16:19]
ds_read_b64_tr_b16 a[120:121], v10 offset:6144
ds_read_b64_tr_b16 a[122:123], v10 offset:6912
v_mfma_f32_16x16x32_bf16 v[20:23], a[100:103], a[40:43], v[20:23]
ds_read_b64_tr_b16 a[124:125], v11 offset:6176
ds_read_b64_tr_b16 a[126:127], v11 offset:6944
v_mfma_f32_16x16x32_bf16 v[24:27], a[104:107], a[40:43], v[24:27]
ds_read_b64_tr_b16 a[128:129], v10 offset:6208
ds_read_b64_tr_b16 a[130:131], v10 offset:6976
v_mfma_f32_16x16x32_bf16 v[28:31], a[108:111], a[40:43], v[28:31]
ds_read_b64_tr_b16 a[132:133], v11 offset:6240
ds_read_b64_tr_b16 a[134:135], v11 offset:7008
v_mfma_f32_16x16x32_bf16 v[32:35], a[112:115], a[40:43], v[32:35]
ds_read_b64_tr_b16 a[136:137], v10 offset:6272
ds_read_b64_tr_b16 a[138:139], v10 offset:7040
v_mfma_f32_16x16x32_bf16 v[36:39], a[116:119], a[40:43], v[36:39]
ds_read_b64_tr_b16 a[140:141], v11 offset:6304
ds_read_b64_tr_b16 a[142:143], v11 offset:7072
v_mfma_f32_16x16x32_bf16 v[64:67], v[92:95], a[40:43], v[64:67]
v_mfma_f32_16x16x32_bf16 v[68:71], a[40:43], a[40:43], v[68:71]
s_cmp_lg_u32 s40, 2
s_cbranch_scc1 K1_nocs10
v_mfma_f32_16x16x32_bf16 v[40:43], a[96:99], v[92:95], v[40:43]
v_mfma_f32_16x16x32_bf16 v[44:47], a[100:103], v[92:95], v[44:47]
v_mfma_f32_16x16x32_bf16 v[48:51], a[104:107], v[92:95], v[48:51]
v_mfma_f32_16x16x32_bf16 v[52:55], a[108:111], v[92:95], v[52:55]
v_mfma_f32_16x16x32_bf16 v[56:59], a[112:115], v[92:95], v[56:59]
v_mfma_f32_16x16x32_bf16 v[60:63], a[116:119], v[92:95], v[60:63]
K1_nocs10:
s_nop 0
s_waitcnt lgkmcnt(0)
v_mfma_f32_16x16x32_bf16 v[16:19], a[120:123], a[44:47], v[16:19]
v_mfma_f32_16x16x32_bf16 v[20:23], a[124:127], a[44:47], v[20:23]
v_mfma_f32_16x16x32_bf16 v[24:27], a[128:131], a[44:47], v[24:27]
v_mfma_f32_16x16x32_bf16 v[28:31], a[132:135], a[44:47], v[28:31]
v_mfma_f32_16x16x32_bf16 v[32:35], a[136:139], a[44:47], v[32:35]
v_mfma_f32_16x16x32_bf16 v[36:39], a[140:143], a[44:47], v[36:39]
v_mfma_f32_16x16x32_bf16 v[64:67], v[92:95], a[44:47], v[64:67]
v_mfma_f32_16x16x32_bf16 v[68:71], a[44:47], a[44:47], v[68:71]
s_cmp_lg_u32 s40, 3
s_cbranch_scc1 K1_nocs11
v_mfma_f32_16x16x32_bf16 v[40:43], a[120:123], v[92:95], v[40:43]
v_mfma_f32_16x16x32_bf16 v[44:47], a[124:127], v[92:95], v[44:47]
v_mfma_f32_16x16x32_bf16 v[48:51], a[128:131], v[92:95], v[48:51]
v_mfma_f32_16x16x32_bf16 v[52:55], a[132:135], v[92:95], v[52:55]
v_mfma_f32_16x16x32_bf16 v[56:59], a[136:139], v[92:95], v[56:59]
v_mfma_f32_16x16x32_bf16 v[60:63], a[140:143], v[92:95], v[60:63]
K1_nocs11:
s_nop 0
s_waitcnt vmcnt(1)
s_barrier
ds_read_b64_tr_b16 a[72:73], v10 offset:12288
ds_read_b64_tr_b16 a[74:75], v10 offset:13056
ds_read_b64_tr_b16 a[76:77], v11 offset:12320
ds_read_b64_tr_b16 a[78:79], v11 offset:13088
ds_read_b64_tr_b16 a[80:81], v10 offset:12352
ds_read_b64_tr_b16 a[82:83], v10 offset:13120
ds_read_b64_tr_b16 a[84:85], v11 offset:12384
ds_read_b64_tr_b16 a[86:87], v11 offset:13152
ds_read_b64_tr_b16 a[88:89], v10 offset:12416
ds_read_b64_tr_b16 a[90:91], v10 offset:13184
ds_read_b64_tr_b16 a[92:93], v11 offset:12448
ds_read_b64_tr_b16 a[94:95], v11 offset:13216
s_waitcnt lgkmcnt(0)
v_mfma_f32_16x16x32_bf16 v[16:19], a[72:75], a[48:51], v[16:19]
ds_read_b64_tr_b16 a[96:97], v10 offset:18432
ds_read_b64_tr_b16 a[98:99], v10 offset:19200
s_lshr_b32 s58, s100, 4
s_mul_i32 s58, s58, 18432
s_mul_i32 s59, s53, 6144
s_add_u32 s58, s58, s59
v_lshlrev_b32 v13, 4, v1
s_cmp_ge_u32 s97, 3
s_cbranch_scc1 K1_xfb
buffer_store_dwordx4 a[0:3], v13, s[16:19], s58 offen sc1
buffer_store_dwordx4 a[4:7], v13, s[16:19], s58 offen offset:1024 sc1
buffer_store_dwordx4 a[8:11], v13, s[16:19], s58 offen offset:2048 sc1
s_branch K1_xfd
K1_xfb:
s_add_u32 s58, s58, 3072
buffer_store_dwordx4 a[12:15], v13, s[16:19], s58 offen sc1
buffer_store_dwordx4 a[16:19], v13, s[16:19], s58 offen offset:1024 sc1
buffer_store_dwordx4 a[20:23], v13, s[16:19], s58 offen offset:2048 sc1
K1_xfd:
v_mfma_f32_16x16x32_bf16 v[20:23], a[76:79], a[48:51], v[20:23]
ds_read_b64_tr_b16 a[100:101], v11 offset:18464
ds_read_b64_tr_b16 a[102:103], v11 offset:19232
v_mfma_f32_16x16x32_bf16 v[24:27], a[80:83], a[48:51], v[24:27]
ds_read_b64_tr_b16 a[104:105], v10 offset:18496
ds_read_b64_tr_b16 a[106:107], v10 offset:19264
v_mfma_f32_16x16x32_bf16 v[28:31], a[84:87], a[48:51], v[28:31]
ds_read_b64_tr_b16 a[108:109], v11 offset:18528
ds_read_b64_tr_b16 a[110:111], v11 offset:19296
v_mfma_f32_16x16x32_bf16 v[32:35], a[88:91], a[48:51], v[32:35]
ds_read_b64_tr_b16 a[112:113], v10 offset:18560
ds_read_b64_tr_b16 a[114:115], v10 offset:19328
v_mfma_f32_16x16x32_bf16 v[36:39], a[92:95], a[48:51], v[36:39]
ds_read_b64_tr_b16 a[116:117], v11 offset:18592
ds_read_b64_tr_b16 a[118:119], v11 offset:19360
v_mfma_f32_16x16x32_bf16 v[64:67], v[92:95], a[48:51], v[64:67]
v_mfma_f32_16x16x32_bf16 v[68:71], a[48:51], a[48:51], v[68:71]
s_cmp_lg_u32 s40, 0
s_cbranch_scc1 K1_nocs12
v_mfma_f32_16x16x32_bf16 v[40:43], a[72:75], v[92:95], v[40:43]
v_mfma_f32_16x16x32_bf16 v[44:47], a[76:79], v[92:95], v[44:47]
v_mfma_f32_16x16x32_bf16 v[48:51], a[80:83], v[92:95], v[48:51]
v_mfma_f32_16x16x32_bf16 v[52:55], a[84:87], v[92:95], v[52:55]
v_mfma_f32_16x16x32_bf16 v[56:59], a[88:91], v[92:95], v[56:59]
v_mfma_f32_16x16x32_bf16 v[60:63], a[92:95], v[92:95], v[60:63]
K1_nocs12:
s_nop 0
s_waitcnt lgkmcnt(0)
v_mfma_f32_16x16x32_bf16 v[16:19], a[96:99], a[52:55], v[16:19]
ds_read_b64_tr_b16 a[120:121], v10 offset:24576
ds_read_b64_tr_b16 a[122:123], v10 offset:25344
v_mfma_f32_16x16x32_bf16 v[20:23], a[100:103], a[52:55], v[20:23]
ds_read_b64_tr_b16 a[124:125], v11 offset:24608
ds_read_b64_tr_b16 a[126:127], v11 offset:25376
v_mfma_f32_16x16x32_bf16 v[24:27], a[104:107], a[52:55], v[24:27]
ds_read_b64_tr_b16 a[128:129], v10 offset:24640
ds_read_b64_tr_b16 a[130:131], v10 offset:25408
v_mfma_f32_16x16x32_bf16 v[28:31], a[108:111], a[52:55], v[28:31]
ds_read_b64_tr_b16 a[132:133], v11 offset:24672
ds_read_b64_tr_b16 a[134:135], v11 offset:25440
v_mfma_f32_16x16x32_bf16 v[32:35], a[112:115], a[52:55], v[32:35]
ds_read_b64_tr_b16 a[136:137], v10 offset:24704
ds_read_b64_tr_b16 a[138:139], v10 offset:25472
v_mfma_f32_16x16x32_bf16 v[36:39], a[116:119], a[52:55], v[36:39]
ds_read_b64_tr_b16 a[140:141], v11 offset:24736
ds_read_b64_tr_b16 a[142:143], v11 offset:25504
v_mfma_f32_16x16x32_bf16 v[64:67], v[92:95], a[52:55], v[64:67]
v_mfma_f32_16x16x32_bf16 v[68:71], a[52:55], a[52:55], v[68:71]
s_cmp_lg_u32 s40, 1
s_cbranch_scc1 K1_nocs13
v_mfma_f32_16x16x32_bf16 v[40:43], a[96:99], v[92:95], v[40:43]
v_mfma_f32_16x16x32_bf16 v[44:47], a[100:103], v[92:95], v[44:47]
v_mfma_f32_16x16x32_bf16 v[48:51], a[104:107], v[92:95], v[48:51]
v_mfma_f32_16x16x32_bf16 v[52:55], a[108:111], v[92:95], v[52:55]
v_mfma_f32_16x16x32_bf16 v[56:59], a[112:115], v[92:95], v[56:59]
v_mfma_f32_16x16x32_bf16 v[60:63], a[116:119], v[92:95], v[60:63]
K1_nocs13:
s_nop 0
s_waitcnt lgkmcnt(0)
v_mfma_f32_16x16x32_bf16 v[16:19], a[120:123], a[56:59], v[16:19]
ds_read_b64_tr_b16 a[72:73], v10 offset:30720
ds_read_b64_tr_b16 a[74:75], v10 offset:31488
v_mfma_f32_16x16x32_bf16 v[20:23], a[124:127], a[56:59], v[20:23]
ds_read_b64_tr_b16 a[76:77], v11 offset:30752
ds_read_b64_tr_b16 a[78:79], v11 offset:31520
v_mfma_f32_16x16x32_bf16 v[24:27], a[128:131], a[56:59], v[24:27]
ds_read_b64_tr_b16 a[80:81], v10 offset:30784
ds_read_b64_tr_b16 a[82:83], v10 offset:31552
v_mfma_f32_16x16x32_bf16 v[28:31], a[132:135], a[56:59], v[28:31]
ds_read_b64_tr_b16 a[84:85], v11 offset:30816
ds_read_b64_tr_b16 a[86:87], v11 offset:31584
v_mfma_f32_16x16x32_bf16 v[32:35], a[136:139], a[56:59], v[32:35]
ds_read_b64_tr_b16 a[88:89], v10 offset:30848
ds_read_b64_tr_b16 a[90:91], v10 offset:31616
v_mfma_f32_16x16x32_bf16 v[36:39], a[140:143], a[56:59], v[36:39]
ds_read_b64_tr_b16 a[92:93], v11 offset:30880
ds_read_b64_tr_b16 a[94:95], v11 offset:31648
v_mfma_f32_16x16x32_bf16 v[64:67], v[92:95], a[56:59], v[64:67]
v_mfma_f32_16x16x32_bf16 v[68:71], a[56:59], a[56:59], v[68:71]
s_cmp_lg_u32 s40, 2
s_cbranch_scc1 K1_nocs14
v_mfma_f32_16x16x32_bf16 v[40:43], a[120:123], v[92:95], v[40:43]
v_mfma_f32_16x16x32_bf16 v[44:47], a[124:127], v[92:95], v[44:47]
v_mfma_f32_16x16x32_bf16 v[48:51], a[128:131], v[92:95], v[48:51]
v_mfma_f32_16x16x32_bf16 v[52:55], a[132:135], v[92:95], v[52:55]
v_mfma_f32_16x16x32_bf16 v[56:59], a[136:139], v[92:95], v[56:59]
v_mfma_f32_16x16x32_bf16 v[60:63], a[140:143], v[92:95], v[60:63]
K1_nocs14:
s_nop 0
s_waitcnt lgkmcnt(0)
v_mfma_f32_16x16x32_bf16 v[16:19], a[72:75], a[60:63], v[16:19]
ds_read_b64_tr_b16 a[96:97], v10 offset:36864
ds_read_b64_tr_b16 a[98:99], v10 offset:37632
v_mfma_f32_16x16x32_bf16 v[20:23], a[76:79], a[60:63], v[20:23]
ds_read_b64_tr_b16 a[100:101], v11 offset:36896
ds_read_b64_tr_b16 a[102:103], v11 offset:37664
v_mfma_f32_16x16x32_bf16 v[24:27], a[80:83], a[60:63], v[24:27]
ds_read_b64_tr_b16 a[104:105], v10 offset:36928
ds_read_b64_tr_b16 a[106:107], v10 offset:37696
v_mfma_f32_16x16x32_bf16 v[28:31], a[84:87], a[60:63], v[28:31]
ds_read_b64_tr_b16 a[108:109], v11 offset:36960
ds_read_b64_tr_b16 a[110:111], v11 offset:37728
v_mfma_f32_16x16x32_bf16 v[32:35], a[88:91], a[60:63], v[32:35]
ds_read_b64_tr_b16 a[112:113], v10 offset:36992
ds_read_b64_tr_b16 a[114:115], v10 offset:37760
v_mfma_f32_16x16x32_bf16 v[36:39], a[92:95], a[60:63], v[36:39]
ds_read_b64_tr_b16 a[116:117], v11 offset:37024
ds_read_b64_tr_b16 a[118:119], v11 offset:37792
v_mfma_f32_16x16x32_bf16 v[64:67], v[92:95], a[60:63], v[64:67]
v_mfma_f32_16x16x32_bf16 v[68:71], a[60:63], a[60:63], v[68:71]
s_cmp_lg_u32 s40, 3
s_cbranch_scc1 K1_nocs15
v_mfma_f32_16x16x32_bf16 v[40:43], a[72:75], v[92:95], v[40:43]
v_mfma_f32_16x16x32_bf16 v[44:47], a[76:79], v[92:95], v[44:47]
v_mfma_f32_16x16x32_bf16 v[48:51], a[80:83], v[92:95], v[48:51]
v_mfma_f32_16x16x32_bf16 v[52:55], a[84:87], v[92:95], v[52:55]
v_mfma_f32_16x16x32_bf16 v[56:59], a[88:91], v[92:95], v[56:59]
v_mfma_f32_16x16x32_bf16 v[60:63], a[92:95], v[92:95], v[60:63]
K1_nocs15:
s_nop 0
s_waitcnt lgkmcnt(0)
v_mfma_f32_16x16x32_bf16 v[16:19], a[96:99], a[64:67], v[16:19]
ds_read_b64_tr_b16 a[120:121], v10 offset:43008
ds_read_b64_tr_b16 a[122:123], v10 offset:43776
v_mfma_f32_16x16x32_bf16 v[20:23], a[100:103], a[64:67], v[20:23]
ds_read_b64_tr_b16 a[124:125], v11 offset:43040
ds_read_b64_tr_b16 a[126:127], v11 offset:43808
v_mfma_f32_16x16x32_bf16 v[24:27], a[104:107], a[64:67], v[24:27]
ds_read_b64_tr_b16 a[128:129], v10 offset:43072
ds_read_b64_tr_b16 a[130:131], v10 offset:43840
v_mfma_f32_16x16x32_bf16 v[28:31], a[108:111], a[64:67], v[28:31]
ds_read_b64_tr_b16 a[132:133], v11 offset:43104
ds_read_b64_tr_b16 a[134:135], v11 offset:43872
v_mfma_f32_16x16x32_bf16 v[32:35], a[112:115], a[64:67], v[32:35]
ds_read_b64_tr_b16 a[136:137], v10 offset:43136
ds_read_b64_tr_b16 a[138:139], v10 offset:43904
v_mfma_f32_16x16x32_bf16 v[36:39], a[116:119], a[64:67], v[36:39]
ds_read_b64_tr_b16 a[140:141], v11 offset:43168
ds_read_b64_tr_b16 a[142:143], v11 offset:43936
v_mfma_f32_16x16x32_bf16 v[64:67], v[92:95], a[64:67], v[64:67]
v_mfma_f32_16x16x32_bf16 v[68:71], a[64:67], a[64:67], v[68:71]
s_cmp_lg_u32 s40, 0
s_cbranch_scc1 K1_nocs16
v_mfma_f32_16x16x32_bf16 v[40:43], a[96:99], v[92:95], v[40:43]
v_mfma_f32_16x16x32_bf16 v[44:47], a[100:103], v[92:95], v[44:47]
v_mfma_f32_16x16x32_bf16 v[48:51], a[104:107], v[92:95], v[48:51]
v_mfma_f32_16x16x32_bf16 v[52:55], a[108:111], v[92:95], v[52:55]
v_mfma_f32_16x16x32_bf16 v[56:59], a[112:115], v[92:95], v[56:59]
v_mfma_f32_16x16x32_bf16 v[60:63], a[116:119], v[92:95], v[60:63]
K1_nocs16:
s_nop 0
s_waitcnt lgkmcnt(0)
v_mfma_f32_16x16x32_bf16 v[16:19], a[120:123], a[68:71], v[16:19]
v_mfma_f32_16x16x32_bf16 v[20:23], a[124:127], a[68:71], v[20:23]
v_mfma_f32_16x16x32_bf16 v[24:27], a[128:131], a[68:71], v[24:27]
v_mfma_f32_16x16x32_bf16 v[28:31], a[132:135], a[68:71], v[28:31]
v_mfma_f32_16x16x32_bf16 v[32:35], a[136:139], a[68:71], v[32:35]
v_mfma_f32_16x16x32_bf16 v[36:39], a[140:143], a[68:71], v[36:39]
v_mfma_f32_16x16x32_bf16 v[64:67], v[92:95], a[68:71], v[64:67]
v_mfma_f32_16x16x32_bf16 v[68:71], a[68:71], a[68:71], v[68:71]
s_cmp_lg_u32 s40, 1
s_cbranch_scc1 K1_nocs17
v_mfma_f32_16x16x32_bf16 v[40:43], a[120:123], v[92:95], v[40:43]
v_mfma_f32_16x16x32_bf16 v[44:47], a[124:127], v[92:95], v[44:47]
v_mfma_f32_16x16x32_bf16 v[48:51], a[128:131], v[92:95], v[48:51]
v_mfma_f32_16x16x32_bf16 v[52:55], a[132:135], v[92:95], v[52:55]
v_mfma_f32_16x16x32_bf16 v[56:59], a[136:139], v[92:95], v[56:59]
v_mfma_f32_16x16x32_bf16 v[60:63], a[140:143], v[92:95], v[60:63]
K1_nocs17:
s_nop 0
s_nop 7
v_lshlrev_b32 v12, 4, v3
s_mul_i32 s60, s40, 384
s_add_u32 s60, s60, 110592
v_add_u32 v7, s60, v12
v_cmp_eq_u32 vcc, 0, v2
s_nop 3
s_and_saveexec_b64 s[56:57], vcc
ds_write_b128 v7, v[40:43]
ds_write_b128 v7, v[44:47] offset:64
ds_write_b128 v7, v[48:51] offset:128
ds_write_b128 v7, v[52:55] offset:192
ds_write_b128 v7, v[56:59] offset:256
ds_write_b128 v7, v[60:63] offset:320
s_mov_b64 exec, s[56:57]
s_waitcnt lgkmcnt(0)
s_barrier
v_mov_b32 v246, 0
buffer_load_dword v247, v246, s[76:79], 0 offen sc1
v_add_u32 v7, 110592, v12
ds_read_b128 v[40:43], v7
ds_read_b128 v[72:75], v7 offset:384
ds_read_b128 v[76:79], v7 offset:768
ds_read_b128 v[80:83], v7 offset:1152
ds_read_b128 v[44:47], v7 offset:64
ds_read_b128 v[84:87], v7 offset:448
ds_read_b128 v[88:91], v7 offset:832
ds_read_b128 v[92:95], v7 offset:1216
ds_read_b128 v[48:51], v7 offset:128
ds_read_b128 v[96:99], v7 offset:512
ds_read_b128 v[100:103], v7 offset:896
ds_read_b128 v[104:107], v7 offset:1280
s_waitcnt lgkmcnt(0)
v_pk_add_f32 v[40:41], v[40:41], v[72:73]
v_pk_add_f32 v[42:43], v[42:43], v[74:75]
v_pk_add_f32 v[40:41], v[40:41], v[76:77]
v_pk_add_f32 v[42:43], v[42:43], v[78:79]
v_pk_add_f32 v[40:41], v[40:41], v[80:81]
v_pk_add_f32 v[42:43], v[42:43], v[82:83]
v_pk_add_f32 v[44:45], v[44:45], v[84:85]
v_pk_add_f32 v[46:47], v[46:47], v[86:87]
v_pk_add_f32 v[44:45], v[44:45], v[88:89]
v_pk_add_f32 v[46:47], v[46:47], v[90:91]
v_pk_add_f32 v[44:45], v[44:45], v[92:93]
v_pk_add_f32 v[46:47], v[46:47], v[94:95]
v_pk_add_f32 v[48:49], v[48:49], v[96:97]
v_pk_add_f32 v[50:51], v[50:51], v[98:99]
v_pk_add_f32 v[48:49], v[48:49], v[100:101]
v_pk_add_f32 v[50:51], v[50:51], v[102:103]
v_pk_add_f32 v[48:49], v[48:49], v[104:105]
v_pk_add_f32 v[50:51], v[50:51], v[106:107]
ds_read_b128 v[52:55], v7 offset:192
ds_read_b128 v[72:75], v7 offset:576
ds_read_b128 v[76:79], v7 offset:960
ds_read_b128 v[80:83], v7 offset:1344
ds_read_b128 v[56:59], v7 offset:256
ds_read_b128 v[84:87], v7 offset:640
ds_read_b128 v[88:91], v7 offset:1024
ds_read_b128 v[92:95], v7 offset:1408
ds_read_b128 v[60:63], v7 offset:320
ds_read_b128 v[96:99], v7 offset:704
ds_read_b128 v[100:103], v7 offset:1088
ds_read_b128 v[104:107], v7 offset:1472
s_waitcnt lgkmcnt(0)
v_pk_add_f32 v[52:53], v[52:53], v[72:73]
v_pk_add_f32 v[54:55], v[54:55], v[74:75]
v_pk_add_f32 v[52:53], v[52:53], v[76:77]
v_pk_add_f32 v[54:55], v[54:55], v[78:79]
v_pk_add_f32 v[52:53], v[52:53], v[80:81]
v_pk_add_f32 v[54:55], v[54:55], v[82:83]
v_pk_add_f32 v[56:57], v[56:57], v[84:85]
v_pk_add_f32 v[58:59], v[58:59], v[86:87]
v_pk_add_f32 v[56:57], v[56:57], v[88:89]
v_pk_add_f32 v[58:59], v[58:59], v[90:91]
v_pk_add_f32 v[56:57], v[56:57], v[92:93]
v_pk_add_f32 v[58:59], v[58:59], v[94:95]
v_pk_add_f32 v[60:61], v[60:61], v[96:97]
v_pk_add_f32 v[62:63], v[62:63], v[98:99]
v_pk_add_f32 v[60:61], v[60:61], v[100:101]
v_pk_add_f32 v[62:63], v[62:63], v[102:103]
v_pk_add_f32 v[60:61], v[60:61], v[104:105]
v_pk_add_f32 v[62:63], v[62:63], v[106:107]
v_and_b32 v12, 3, v1
v_lshrrev_b32 v13, 2, v2
v_lshl_add_u32 v13, v13, 4, v2
v_lshlrev_b32 v13, 2, v13
v_cmp_eq_u32 vcc, 1, v12
s_nop 1
v_cndmask_b32 v68, v68, v69
v_cmp_eq_u32 vcc, 2, v12
s_nop 1
v_cndmask_b32 v68, v68, v70
v_cmp_eq_u32 vcc, 3, v12
s_nop 1
v_cndmask_b32 v68, v68, v71
ds_bpermute_b32 v68, v13, v68
s_waitcnt lgkmcnt(0)
v_mul_f32 v72, 0x3ae38e39, v64
v_mul_f32 v68, 0x3ae38e39, v68
v_fma_f32 v68, -v72, v72, v68
v_max_f32 v68, 0, v68
v_add_f32 v69, 0x3727c5ac, v68
v_rsq_f32 v73, v69
s_nop 0
v_mul_f32 v69, v73, v73
v_mul_f32 v69, v68, v69
v_add_f32 v69, 0x3727c5ac, v69
v_rsq_f32 v69, v69
s_nop 0
v_mul_f32 v69, v73, v69
v_rcp_f32 v79, v69
v_mul_f32 v71, v69, v69
v_mul_f32 v71, v71, v69
v_mul_f32 v78, 0xbdd2d3e8, v71
v_mul_f32 v77, 0xc0135761, v69
v_mov_b32 v76, v72
v_and_b32 v7, 1, v3
v_lshlrev_b32 v7, 5, v7
v_lshrrev_b32 v13, 1, v3
v_lshl_add_u32 v7, v13, 4, v7
v_lshl_add_u32 v7, v2, 6, v7
s_mul_i32 s60, s97, 393216
s_lshl_b32 s61, s100, 6
s_add_u32 s60, s60, s61
s_mov_b32 s8, s68
s_mov_b32 s9, s69
s_mov_b32 s10, 0xa2000
s_mov_b32 s11, 0x20000
v_pk_fma_f32 v[16:17], v[76:77], v[40:41], v[16:17] op_sel_hi:[0,1,1] neg_lo:[1,0,0] neg_hi:[1,0,0]
v_pk_fma_f32 v[18:19], v[76:77], v[42:43], v[18:19] op_sel_hi:[0,1,1] neg_lo:[1,0,0] neg_hi:[1,0,0]
v_pk_fma_f32 v[20:21], v[76:77], v[44:45], v[20:21] op_sel_hi:[0,1,1] neg_lo:[1,0,0] neg_hi:[1,0,0]
v_pk_fma_f32 v[22:23], v[76:77], v[46:47], v[22:23] op_sel_hi:[0,1,1] neg_lo:[1,0,0] neg_hi:[1,0,0]
v_pk_fma_f32 v[24:25], v[76:77], v[48:49], v[24:25] op_sel_hi:[0,1,1] neg_lo:[1,0,0] neg_hi:[1,0,0]
v_pk_fma_f32 v[26:27], v[76:77], v[50:51], v[26:27] op_sel_hi:[0,1,1] neg_lo:[1,0,0] neg_hi:[1,0,0]
v_pk_fma_f32 v[28:29], v[76:77], v[52:53], v[28:29] op_sel_hi:[0,1,1] neg_lo:[1,0,0] neg_hi:[1,0,0]
v_pk_fma_f32 v[30:31], v[76:77], v[54:55], v[30:31] op_sel_hi:[0,1,1] neg_lo:[1,0,0] neg_hi:[1,0,0]
v_pk_fma_f32 v[32:33], v[76:77], v[56:57], v[32:33] op_sel_hi:[0,1,1] neg_lo:[1,0,0] neg_hi:[1,0,0]
v_pk_fma_f32 v[34:35], v[76:77], v[58:59], v[34:35] op_sel_hi:[0,1,1] neg_lo:[1,0,0] neg_hi:[1,0,0]
v_pk_fma_f32 v[36:37], v[76:77], v[60:61], v[36:37] op_sel_hi:[0,1,1] neg_lo:[1,0,0] neg_hi:[1,0,0]
v_pk_fma_f32 v[38:39], v[76:77], v[62:63], v[38:39] op_sel_hi:[0,1,1] neg_lo:[1,0,0] neg_hi:[1,0,0]
v_pk_mul_f32 v[80:81], v[16:17], v[16:17]
v_pk_mul_f32 v[82:83], v[18:19], v[18:19]
v_pk_mul_f32 v[84:85], v[20:21], v[20:21]
v_pk_mul_f32 v[86:87], v[22:23], v[22:23]
v_pk_mul_f32 v[88:89], v[24:25], v[24:25]
v_pk_mul_f32 v[90:91], v[26:27], v[26:27]
v_pk_mul_f32 v[92:93], v[28:29], v[28:29]
v_pk_mul_f32 v[94:95], v[30:31], v[30:31]
v_pk_mul_f32 v[96:97], v[32:33], v[32:33]
v_pk_mul_f32 v[98:99], v[34:35], v[34:35]
v_pk_mul_f32 v[100:101], v[36:37], v[36:37]
v_pk_mul_f32 v[102:103], v[38:39], v[38:39]
v_pk_fma_f32 v[80:81], v[80:81], v[78:79], v[76:77] op_sel:[0,0,1] op_sel_hi:[1,0,1]
v_pk_fma_f32 v[82:83], v[82:83], v[78:79], v[76:77] op_sel:[0,0,1] op_sel_hi:[1,0,1]
v_pk_fma_f32 v[84:85], v[84:85], v[78:79], v[76:77] op_sel:[0,0,1] op_sel_hi:[1,0,1]
v_pk_fma_f32 v[86:87], v[86:87], v[78:79], v[76:77] op_sel:[0,0,1] op_sel_hi:[1,0,1]
v_pk_fma_f32 v[88:89], v[88:89], v[78:79], v[76:77] op_sel:[0,0,1] op_sel_hi:[1,0,1]
v_pk_fma_f32 v[90:91], v[90:91], v[78:79], v[76:77] op_sel:[0,0,1] op_sel_hi:[1,0,1]
v_pk_fma_f32 v[92:93], v[92:93], v[78:79], v[76:77] op_sel:[0,0,1] op_sel_hi:[1,0,1]
v_pk_fma_f32 v[94:95], v[94:95], v[78:79], v[76:77] op_sel:[0,0,1] op_sel_hi:[1,0,1]
v_pk_fma_f32 v[96:97], v[96:97], v[78:79], v[76:77] op_sel:[0,0,1] op_sel_hi:[1,0,1]
v_pk_fma_f32 v[98:99], v[98:99], v[78:79], v[76:77] op_sel:[0,0,1] op_sel_hi:[1,0,1]
v_pk_fma_f32 v[100:101], v[100:101], v[78:79], v[76:77] op_sel:[0,0,1] op_sel_hi:[1,0,1]
v_pk_fma_f32 v[102:103], v[102:103], v[78:79], v[76:77] op_sel:[0,0,1] op_sel_hi:[1,0,1]
v_pk_mul_f32 v[80:81], v[16:17], v[80:81]
v_pk_mul_f32 v[82:83], v[18:19], v[82:83]
v_pk_mul_f32 v[84:85], v[20:21], v[84:85]
v_pk_mul_f32 v[86:87], v[22:23], v[86:87]
v_pk_mul_f32 v[88:89], v[24:25], v[88:89]
v_pk_mul_f32 v[90:91], v[26:27], v[90:91]
v_pk_mul_f32 v[92:93], v[28:29], v[92:93]
v_pk_mul_f32 v[94:95], v[30:31], v[94:95]
v_pk_mul_f32 v[96:97], v[32:33], v[96:97]
v_pk_mul_f32 v[98:99], v[34:35], v[98:99]
v_pk_mul_f32 v[100:101], v[36:37], v[100:101]
v_pk_mul_f32 v[102:103], v[38:39], v[102:103]
v_exp_f32 v80, v80
v_exp_f32 v81, v81
v_exp_f32 v82, v82
v_exp_f32 v83, v83
v_exp_f32 v84, v84
v_exp_f32 v85, v85
v_exp_f32 v86, v86
v_exp_f32 v87, v87
v_exp_f32 v88, v88
v_exp_f32 v89, v89
v_exp_f32 v90, v90
v_exp_f32 v91, v91
v_exp_f32 v92, v92
v_exp_f32 v93, v93
v_exp_f32 v94, v94
v_exp_f32 v95, v95
v_exp_f32 v96, v96
v_exp_f32 v97, v97
v_exp_f32 v98, v98
v_exp_f32 v99, v99
v_exp_f32 v100, v100
v_exp_f32 v101, v101
v_exp_f32 v102, v102
v_exp_f32 v103, v103
v_pk_fma_f32 v[80:81], v[80:81], v[78:79], v[78:79] op_sel:[0,1,1]
v_pk_fma_f32 v[82:83], v[82:83], v[78:79], v[78:79] op_sel:[0,1,1]
v_pk_fma_f32 v[84:85], v[84:85], v[78:79], v[78:79] op_sel:[0,1,1]
v_pk_fma_f32 v[86:87], v[86:87], v[78:79], v[78:79] op_sel:[0,1,1]
v_pk_fma_f32 v[88:89], v[88:89], v[78:79], v[78:79] op_sel:[0,1,1]
v_pk_fma_f32 v[90:91], v[90:91], v[78:79], v[78:79] op_sel:[0,1,1]
v_pk_fma_f32 v[92:93], v[92:93], v[78:79], v[78:79] op_sel:[0,1,1]
v_pk_fma_f32 v[94:95], v[94:95], v[78:79], v[78:79] op_sel:[0,1,1]
v_pk_fma_f32 v[96:97], v[96:97], v[78:79], v[78:79] op_sel:[0,1,1]
v_pk_fma_f32 v[98:99], v[98:99], v[78:79], v[78:79] op_sel:[0,1,1]
v_pk_fma_f32 v[100:101], v[100:101], v[78:79], v[78:79] op_sel:[0,1,1]
v_pk_fma_f32 v[102:103], v[102:103], v[78:79], v[78:79] op_sel:[0,1,1]
v_rcp_f32 v80, v80
v_rcp_f32 v81, v81
v_rcp_f32 v82, v82
v_rcp_f32 v83, v83
v_rcp_f32 v84, v84
v_rcp_f32 v85, v85
v_rcp_f32 v86, v86
v_rcp_f32 v87, v87
v_rcp_f32 v88, v88
v_rcp_f32 v89, v89
v_rcp_f32 v90, v90
v_rcp_f32 v91, v91
v_rcp_f32 v92, v92
v_rcp_f32 v93, v93
v_rcp_f32 v94, v94
v_rcp_f32 v95, v95
v_rcp_f32 v96, v96
v_rcp_f32 v97, v97
v_rcp_f32 v98, v98
v_rcp_f32 v99, v99
v_rcp_f32 v100, v100
v_rcp_f32 v101, v101
v_rcp_f32 v102, v102
v_rcp_f32 v103, v103
v_pk_mul_f32 v[16:17], v[16:17], v[80:81]
v_pk_mul_f32 v[18:19], v[18:19], v[82:83]
v_pk_mul_f32 v[20:21], v[20:21], v[84:85]
v_pk_mul_f32 v[22:23], v[22:23], v[86:87]
v_pk_mul_f32 v[24:25], v[24:25], v[88:89]
v_pk_mul_f32 v[26:27], v[26:27], v[90:91]
v_pk_mul_f32 v[28:29], v[28:29], v[92:93]
v_pk_mul_f32 v[30:31], v[30:31], v[94:95]
v_pk_mul_f32 v[32:33], v[32:33], v[96:97]
v_pk_mul_f32 v[34:35], v[34:35], v[98:99]
v_pk_mul_f32 v[36:37], v[36:37], v[100:101]
v_pk_mul_f32 v[38:39], v[38:39], v[102:103]
v_cvt_pk_bf16_f32 v16, v16, v17
v_cvt_pk_bf16_f32 v17, v18, v19
v_cvt_pk_bf16_f32 v18, v20, v21
v_cvt_pk_bf16_f32 v19, v22, v23
s_nop 1
v_permlane16_swap_b32 v16, v18
v_permlane16_swap_b32 v17, v19
buffer_store_dwordx4 v[16:19], v7, s[12:15], s60 offen sc1
s_add_u32 s60, s60, 131072
v_cvt_pk_bf16_f32 v24, v24, v25
v_cvt_pk_bf16_f32 v25, v26, v27
v_cvt_pk_bf16_f32 v26, v28, v29
v_cvt_pk_bf16_f32 v27, v30, v31
s_nop 1
v_permlane16_swap_b32 v24, v26
v_permlane16_swap_b32 v25, v27
buffer_store_dwordx4 v[24:27], v7, s[12:15], s60 offen sc1
s_add_u32 s60, s60, 131072
v_cvt_pk_bf16_f32 v32, v32, v33
v_cvt_pk_bf16_f32 v33, v34, v35
v_cvt_pk_bf16_f32 v34, v36, v37
v_cvt_pk_bf16_f32 v35, v38, v39
s_nop 1
v_permlane16_swap_b32 v32, v34
v_permlane16_swap_b32 v33, v35
buffer_store_dwordx4 v[32:35], v7, s[12:15], s60 offen sc1
s_add_u32 s60, s60, 131072
s_cmp_lg_u32 s97, 0
s_cbranch_scc1 K1_nost
v_cmp_gt_u32 vcc, 16, v1
s_nop 3
s_and_saveexec_b64 s[56:57], vcc
v_lshlrev_b32 v13, 3, v2
s_lshl_b32 s60, s100, 3
buffer_store_dwordx2 v[72:73], v13, s[36:39], s60 offen sc1
s_mov_b64 exec, s[56:57]
K1_nost:
s_waitcnt vmcnt(0)
s_barrier
v_mov_b32 v246, 0
v_mov_b32 v248, 1
s_cmp_lg_u32 s40, 0
s_cbranch_scc1 L_lk_i1
s_mov_b32 s58, 0
L_lc_i1:
v_and_b32 v252, 0xffff, v247
v_cmp_ge_u32 vcc, v252, v248
s_nop 3
s_cmp_eq_u64 vcc, -1
s_cbranch_scc1 L_lk_i1
s_add_u32 s58, s58, 1
s_cmp_ge_u32 s58, 65536
s_cbranch_scc1 L_lk_i1
s_sleep 2
buffer_load_dword v247, v246, s[76:79], 0 offen sc1
s_waitcnt vmcnt(0)
s_branch L_lc_i1
L_lk_i1:
s_lshl_b32 s60, s96, 7
s_cmp_lg_u32 s40, 0
s_cbranch_scc1 L_nosig_h
s_mov_b64 exec, 1
v_mov_b32 v252, 1
v_mov_b32 v251, 0
s_nop 0
buffer_atomic_add v252, v251, s[72:75], s60 offen
s_mov_b64 exec, -1
L_nosig_h:
s_load_dwordx2 s[64:65], s[0:1], 64
s_load_dwordx2 s[66:67], s[0:1], 24
s_load_dwordx2 s[68:69], s[0:1], 8
s_load_dwordx2 s[62:63], s[0:1], 16
v_min_u32 v12, 2, v255
v_add_u32 v12, s96, v12
v_subrev_u32 v12, 1, v12
v_max_i32 v12, 0, v12
v_min_u32 v12, 31, v12
v_lshlrev_b32 v246, 7, v12
v_mov_b32 v248, 6
s_add_u32 m0, s99, 0
s_add_u32 s59, s98, 0
buffer_load_dwordx4 v4, s[8:11], s59 offen lds
buffer_load_dwordx4 v5, s[8:11], s59 offen offset:1024 lds
buffer_load_dwordx4 v6, s[8:11], s59 offen offset:2048 lds
s_add_u32 m0, s99, 12288
s_add_u32 s59, s98, 73728
buffer_load_dwordx4 v4, s[8:11], s59 offen lds
buffer_load_dwordx4 v5, s[8:11], s59 offen offset:1024 lds
buffer_load_dwordx4 v6, s[8:11], s59 offen offset:2048 lds
s_add_u32 m0, s99, 24576
s_add_u32 s59, s98, 147456
buffer_load_dwordx4 v4, s[8:11], s59 offen lds
buffer_load_dwordx4 v5, s[8:11], s59 offen offset:1024 lds
buffer_load_dwordx4 v6, s[8:11], s59 offen offset:2048 lds
s_add_u32 m0, s99, 36864
s_add_u32 s59, s98, 221184
buffer_load_dwordx4 v4, s[8:11], s59 offen lds
buffer_load_dwordx4 v5, s[8:11], s59 offen offset:1024 lds
buffer_load_dwordx4 v6, s[8:11], s59 offen offset:2048 lds
s_add_u32 m0, s99, 49152
s_add_u32 s59, s98, 294912
buffer_load_dwordx4 v4, s[8:11], s59 offen lds
buffer_load_dwordx4 v5, s[8:11], s59 offen offset:1024 lds
buffer_load_dwordx4 v6, s[8:11], s59 offen offset:2048 lds
s_add_u32 m0, s99, 61440
s_add_u32 s59, s98, 368640
buffer_load_dwordx4 v4, s[8:11], s59 offen lds
buffer_load_dwordx4 v5, s[8:11], s59 offen offset:1024 lds
buffer_load_dwordx4 v6, s[8:11], s59 offen offset:2048 lds
s_add_u32 m0, s99, 73728
s_add_u32 s59, s98, 442368
buffer_load_dwordx4 v4, s[8:11], s59 offen lds
buffer_load_dwordx4 v5, s[8:11], s59 offen offset:1024 lds
buffer_load_dwordx4 v6, s[8:11], s59 offen offset:2048 lds
s_add_u32 m0, s99, 86016
s_add_u32 s59, s98, 516096
buffer_load_dwordx4 v4, s[8:11], s59 offen lds
buffer_load_dwordx4 v5, s[8:11], s59 offen offset:1024 lds
buffer_load_dwordx4 v6, s[8:11], s59 offen offset:2048 lds
s_add_u32 m0, s99, 98304
s_add_u32 s59, s98, 589824
buffer_load_dwordx4 v4, s[8:11], s59 offen lds
buffer_load_dwordx4 v5, s[8:11], s59 offen offset:1024 lds
buffer_load_dwordx4 v6, s[8:11], s59 offen offset:2048 lds
buffer_load_dword v247, v246, s[72:75], 0 offen sc1
v_mov_b32 v14, v118
v_mul_u32_u24 v12, 1152, v14
v_lshl_add_u32 v12, v3, 3, v12
s_mul_i32 s60, s97, 192
buffer_load_dwordx2 v[48:49], v12, s[4:7], s60 offen
buffer_load_dwordx2 v[50:51], v12, s[4:7], s60 offen offset:32
buffer_load_dwordx2 v[52:53], v12, s[4:7], s60 offen offset:64
buffer_load_dwordx2 v[54:55], v12, s[4:7], s60 offen offset:96
buffer_load_dwordx2 v[56:57], v12, s[4:7], s60 offen offset:128
buffer_load_dwordx2 v[58:59], v12, s[4:7], s60 offen offset:160
s_and_b32 s56, s2, 7
s_lshl_b32 s41, s56, 1
s_bfe_u32 s57, s2, 0x10003
s_add_u32 s41, s41, s57
s_lshr_b32 s42, s2, 4
s_lshl_b32 s43, s56, 2
s_bfe_u32 s57, s2, 0x20003
s_add_u32 s43, s43, s57
s_lshr_b32 s44, s2, 5
s_mul_i32 s53, s40, 5120
s_lshl_b32 s54, s40, 13
s_lshl_b32 s55, s40, 12
s_mul_i32 s49, s40, 131072
s_lshl_b32 s56, s41, 9
s_add_u32 s49, s49, s56
s_lshl_b32 s56, s42, 3
s_lshl_b32 s57, s40, 1
s_add_u32 s56, s56, s57
s_mul_i32 s50, s56, 18432
s_mul_i32 s47, s40, 147456
s_mul_i32 s56, s43, 288
s_add_u32 s47, s47, s56
s_lshl_b32 s56, s44, 4
s_lshl_b32 s57, s40, 2
s_add_u32 s56, s56, s57
s_mul_i32 s48, s56, 18432
s_lshl_b32 s51, s41, 19
s_add_u32 s51, s51, s55
s_mov_b32 s52, s51
s_waitcnt lgkmcnt(0)
s_mov_b32 s4, s64
s_mov_b32 s5, s65
s_mov_b32 s6, 0x510000
s_mov_b32 s7, 0x20000
s_mov_b32 s20, s68
s_mov_b32 s21, s69
s_mov_b32 s22, 0x800000
s_mov_b32 s23, 0x20000
s_mov_b32 s24, s62
s_mov_b32 s25, s63
s_mov_b32 s26, 0x800000
s_mov_b32 s27, 0x20000
s_add_u32 s28, s70, 0x600000
s_addc_u32 s29, s71, 0
s_mov_b32 s30, 0x1200000
s_mov_b32 s31, 0x20000
s_add_u32 s16, s70, 0x300000
s_addc_u32 s17, s71, 0
s_mov_b32 s18, 0x240000
s_mov_b32 s19, 0x20000
s_waitcnt vmcnt(6)
s_cmp_lg_u32 s40, 0
s_cbranch_scc1 L_lk_h
s_mov_b32 s58, 0
L_lc_h:
v_and_b32 v252, 0xffff, v247
v_cmp_ge_u32 vcc, v252, v248
s_nop 3
s_cmp_eq_u64 vcc, -1
s_cbranch_scc1 L_lk_h
s_add_u32 s58, s58, 1
s_cmp_ge_u32 s58, 65536
s_cbranch_scc1 L_lk_h
s_sleep 2
buffer_load_dword v247, v246, s[72:75], 0 offen sc1
s_waitcnt vmcnt(0)
s_branch L_lc_h
L_lk_h:
s_barrier
s_mov_b32 s60, 0
buffer_load_dwordx4 a[0:3], v112, s[12:15], s60 offen sc1
s_mov_b32 s60, 131072
buffer_load_dwordx4 a[4:7], v112, s[12:15], s60 offen sc1
s_mov_b32 s60, 262144
buffer_load_dwordx4 a[8:11], v112, s[12:15], s60 offen sc1
s_mov_b32 s60, 393216
buffer_load_dwordx4 a[12:15], v112, s[12:15], s60 offen sc1
s_mov_b32 s60, 524288
buffer_load_dwordx4 a[16:19], v113, s[12:15], s60 offen sc1
s_mov_b32 s60, 655360
buffer_load_dwordx4 a[20:23], v114, s[12:15], s60 offen sc1
s_mov_b32 s60, 786432
buffer_load_dwordx4 a[24:27], v114, s[12:15], s60 offen sc1
s_mov_b32 s60, 917504
buffer_load_dwordx4 a[28:31], v114, s[12:15], s60 offen sc1
s_mov_b32 s60, 1048576
buffer_load_dwordx4 a[32:35], v114, s[12:15], s60 offen sc1
s_mov_b32 s60, 1179648
buffer_load_dwordx4 a[36:39], v115, s[12:15], s60 offen sc1
s_mov_b32 s60, 1310720
buffer_load_dwordx4 a[40:43], v115, s[12:15], s60 offen sc1
s_mov_b32 s60, 1441792
buffer_load_dwordx4 a[44:47], v115, s[12:15], s60 offen sc1
s_mov_b32 s60, 1572864
buffer_load_dwordx4 a[48:51], v115, s[12:15], s60 offen sc1
s_mov_b32 s60, 1703936
buffer_load_dwordx4 a[52:55], v116, s[12:15], s60 offen sc1
s_mov_b32 s60, 1835008
buffer_load_dwordx4 a[56:59], v117, s[12:15], s60 offen sc1
s_mov_b32 s60, 1966080
buffer_load_dwordx4 a[60:63], v117, s[12:15], s60 offen sc1
s_mov_b32 s60, 2097152
buffer_load_dwordx4 a[64:67], v117, s[12:15], s60 offen sc1
s_mov_b32 s60, 2228224
buffer_load_dwordx4 a[68:71], v117, s[12:15], s60 offen sc1
v_lshlrev_b32 v12, 3, v14
buffer_load_dwordx2 v[60:61], v12, s[36:39], 0 offen sc1
s_lshl_b32 s56, s42, 1
v_min_u32 v252, 1, v255
v_add_u32 v252, s56, v252
s_add_u32 s57, s41, 32
v_mov_b32 v251, s57
v_cmp_gt_u32 vcc, 2, v255
s_nop 1
v_cndmask_b32 v252, v251, v252
v_lshlrev_b32 v246, 7, v252
v_mov_b32 v252, 6
v_mov_b32 v251, 2
v_cndmask_b32 v248, v251, v252
buffer_load_dword v247, v246, s[72:75], 0 offen sc1
s_waitcnt vmcnt(14)
s_barrier
ds_read_b64_tr_b16 a[72:73], v8
ds_read_b64_tr_b16 a[74:75], v8 offset:768
ds_read_b64_tr_b16 a[76:77], v9 offset:32
ds_read_b64_tr_b16 a[78:79], v9 offset:800
ds_read_b64_tr_b16 a[80:81], v8 offset:64
ds_read_b64_tr_b16 a[82:83], v8 offset:832
ds_read_b64_tr_b16 a[84:85], v9 offset:96
ds_read_b64_tr_b16 a[86:87], v9 offset:864
ds_read_b64_tr_b16 a[88:89], v8 offset:128
ds_read_b64_tr_b16 a[90:91], v8 offset:896
ds_read_b64_tr_b16 a[92:93], v9 offset:160
ds_read_b64_tr_b16 a[94:95], v9 offset:928
s_waitcnt lgkmcnt(0)
v_mfma_f32_16x16x32_bf16 v[16:19], a[72:75], a[0:3], 0
ds_read_b64_tr_b16 a[96:97], v8 offset:6144
ds_read_b64_tr_b16 a[98:99], v8 offset:6912
v_mfma_f32_16x16x32_bf16 v[20:23], a[76:79], a[0:3], 0
ds_read_b64_tr_b16 a[100:101], v9 offset:6176
ds_read_b64_tr_b16 a[102:103], v9 offset:6944
v_mfma_f32_16x16x32_bf16 v[24:27], a[80:83], a[0:3], 0
ds_read_b64_tr_b16 a[104:105], v8 offset:6208
ds_read_b64_tr_b16 a[106:107], v8 offset:6976
v_mfma_f32_16x16x32_bf16 v[28:31], a[84:87], a[0:3], 0
ds_read_b64_tr_b16 a[108:109], v9 offset:6240
ds_read_b64_tr_b16 a[110:111], v9 offset:7008
v_mfma_f32_16x16x32_bf16 v[32:35], a[88:91], a[0:3], 0
ds_read_b64_tr_b16 a[112:113], v8 offset:6272
ds_read_b64_tr_b16 a[114:115], v8 offset:7040
v_mfma_f32_16x16x32_bf16 v[36:39], a[92:95], a[0:3], 0
ds_read_b64_tr_b16 a[116:117], v9 offset:6304
ds_read_b64_tr_b16 a[118:119], v9 offset:7072
s_waitcnt lgkmcnt(0)
v_mfma_f32_16x16x32_bf16 v[16:19], a[96:99], a[4:7], v[16:19]
ds_read_b64_tr_b16 a[120:121], v8 offset:12288
ds_read_b64_tr_b16 a[122:123], v8 offset:13056
v_mfma_f32_16x16x32_bf16 v[20:23], a[100:103], a[4:7], v[20:23]
ds_read_b64_tr_b16 a[124:125], v9 offset:12320
ds_read_b64_tr_b16 a[126:127], v9 offset:13088
v_mfma_f32_16x16x32_bf16 v[24:27], a[104:107], a[4:7], v[24:27]
ds_read_b64_tr_b16 a[128:129], v8 offset:12352
ds_read_b64_tr_b16 a[130:131], v8 offset:13120
v_mfma_f32_16x16x32_bf16 v[28:31], a[108:111], a[4:7], v[28:31]
ds_read_b64_tr_b16 a[132:133], v9 offset:12384
ds_read_b64_tr_b16 a[134:135], v9 offset:13152
v_mfma_f32_16x16x32_bf16 v[32:35], a[112:115], a[4:7], v[32:35]
ds_read_b64_tr_b16 a[136:137], v8 offset:12416
ds_read_b64_tr_b16 a[138:139], v8 offset:13184
v_mfma_f32_16x16x32_bf16 v[36:39], a[116:119], a[4:7], v[36:39]
ds_read_b64_tr_b16 a[140:141], v9 offset:12448
ds_read_b64_tr_b16 a[142:143], v9 offset:13216
s_waitcnt lgkmcnt(0)
v_mfma_f32_16x16x32_bf16 v[16:19], a[120:123], a[8:11], v[16:19]
ds_read_b64_tr_b16 a[72:73], v8 offset:18432
ds_read_b64_tr_b16 a[74:75], v8 offset:19200
v_mfma_f32_16x16x32_bf16 v[20:23], a[124:127], a[8:11], v[20:23]
ds_read_b64_tr_b16 a[76:77], v9 offset:18464
ds_read_b64_tr_b16 a[78:79], v9 offset:19232
v_mfma_f32_16x16x32_bf16 v[24:27], a[128:131], a[8:11], v[24:27]
ds_read_b64_tr_b16 a[80:81], v8 offset:18496
ds_read_b64_tr_b16 a[82:83], v8 offset:19264
v_mfma_f32_16x16x32_bf16 v[28:31], a[132:135], a[8:11], v[28:31]
ds_read_b64_tr_b16 a[84:85], v9 offset:18528
ds_read_b64_tr_b16 a[86:87], v9 offset:19296
v_mfma_f32_16x16x32_bf16 v[32:35], a[136:139], a[8:11], v[32:35]
ds_read_b64_tr_b16 a[88:89], v8 offset:18560
ds_read_b64_tr_b16 a[90:91], v8 offset:19328
v_mfma_f32_16x16x32_bf16 v[36:39], a[140:143], a[8:11], v[36:39]
ds_read_b64_tr_b16 a[92:93], v9 offset:18592
ds_read_b64_tr_b16 a[94:95], v9 offset:19360
s_waitcnt lgkmcnt(0)
v_mfma_f32_16x16x32_bf16 v[16:19], a[72:75], a[12:15], v[16:19]
ds_read_b64_tr_b16 a[96:97], v8 offset:24576
ds_read_b64_tr_b16 a[98:99], v8 offset:25344
v_mfma_f32_16x16x32_bf16 v[20:23], a[76:79], a[12:15], v[20:23]
ds_read_b64_tr_b16 a[100:101], v9 offset:24608
ds_read_b64_tr_b16 a[102:103], v9 offset:25376
v_mfma_f32_16x16x32_bf16 v[24:27], a[80:83], a[12:15], v[24:27]
ds_read_b64_tr_b16 a[104:105], v8 offset:24640
ds_read_b64_tr_b16 a[106:107], v8 offset:25408
v_mfma_f32_16x16x32_bf16 v[28:31], a[84:87], a[12:15], v[28:31]
ds_read_b64_tr_b16 a[108:109], v9 offset:24672
ds_read_b64_tr_b16 a[110:111], v9 offset:25440
v_mfma_f32_16x16x32_bf16 v[32:35], a[88:91], a[12:15], v[32:35]
ds_read_b64_tr_b16 a[112:113], v8 offset:24704
ds_read_b64_tr_b16 a[114:115], v8 offset:25472
v_mfma_f32_16x16x32_bf16 v[36:39], a[92:95], a[12:15], v[36:39]
ds_read_b64_tr_b16 a[116:117], v9 offset:24736
ds_read_b64_tr_b16 a[118:119], v9 offset:25504
s_waitcnt lgkmcnt(0)
v_mfma_f32_16x16x32_bf16 v[16:19], a[96:99], a[16:19], v[16:19]
ds_read_b64_tr_b16 a[120:121], v8 offset:30720
ds_read_b64_tr_b16 a[122:123], v8 offset:31488
v_mfma_f32_16x16x32_bf16 v[20:23], a[100:103], a[16:19], v[20:23]
ds_read_b64_tr_b16 a[124:125], v9 offset:30752
ds_read_b64_tr_b16 a[126:127], v9 offset:31520
v_mfma_f32_16x16x32_bf16 v[24:27], a[104:107], a[16:19], v[24:27]
ds_read_b64_tr_b16 a[128:129], v8 offset:30784
ds_read_b64_tr_b16 a[130:131], v8 offset:31552
v_mfma_f32_16x16x32_bf16 v[28:31], a[108:111], a[16:19], v[28:31]
ds_read_b64_tr_b16 a[132:133], v9 offset:30816
ds_read_b64_tr_b16 a[134:135], v9 offset:31584
v_mfma_f32_16x16x32_bf16 v[32:35], a[112:115], a[16:19], v[32:35]
ds_read_b64_tr_b16 a[136:137], v8 offset:30848
ds_read_b64_tr_b16 a[138:139], v8 offset:31616
v_mfma_f32_16x16x32_bf16 v[36:39], a[116:119], a[16:19], v[36:39]
ds_read_b64_tr_b16 a[140:141], v9 offset:30880
ds_read_b64_tr_b16 a[142:143], v9 offset:31648
s_waitcnt lgkmcnt(0)
v_mfma_f32_16x16x32_bf16 v[16:19], a[120:123], a[20:23], v[16:19]
v_mfma_f32_16x16x32_bf16 v[20:23], a[124:127], a[20:23], v[20:23]
v_mfma_f32_16x16x32_bf16 v[24:27], a[128:131], a[20:23], v[24:27]
v_mfma_f32_16x16x32_bf16 v[28:31], a[132:135], a[20:23], v[28:31]
v_mfma_f32_16x16x32_bf16 v[32:35], a[136:139], a[20:23], v[32:35]
v_mfma_f32_16x16x32_bf16 v[36:39], a[140:143], a[20:23], v[36:39]
s_waitcnt vmcnt(8)
s_barrier
ds_read_b64_tr_b16 a[72:73], v8 offset:36864
ds_read_b64_tr_b16 a[74:75], v8 offset:37632
ds_read_b64_tr_b16 a[76:77], v9 offset:36896
ds_read_b64_tr_b16 a[78:79], v9 offset:37664
ds_read_b64_tr_b16 a[80:81], v8 offset:36928
ds_read_b64_tr_b16 a[82:83], v8 offset:37696
ds_read_b64_tr_b16 a[84:85], v9 offset:36960
ds_read_b64_tr_b16 a[86:87], v9 offset:37728
ds_read_b64_tr_b16 a[88:89], v8 offset:36992
ds_read_b64_tr_b16 a[90:91], v8 offset:37760
ds_read_b64_tr_b16 a[92:93], v9 offset:37024
ds_read_b64_tr_b16 a[94:95], v9 offset:37792
s_waitcnt lgkmcnt(0)
v_mfma_f32_16x16x32_bf16 v[16:19], a[72:75], a[24:27], v[16:19]
ds_read_b64_tr_b16 a[96:97], v8 offset:43008
ds_read_b64_tr_b16 a[98:99], v8 offset:43776
v_mfma_f32_16x16x32_bf16 v[20:23], a[76:79], a[24:27], v[20:23]
ds_read_b64_tr_b16 a[100:101], v9 offset:43040
ds_read_b64_tr_b16 a[102:103], v9 offset:43808
v_mfma_f32_16x16x32_bf16 v[24:27], a[80:83], a[24:27], v[24:27]
ds_read_b64_tr_b16 a[104:105], v8 offset:43072
ds_read_b64_tr_b16 a[106:107], v8 offset:43840
v_mfma_f32_16x16x32_bf16 v[28:31], a[84:87], a[24:27], v[28:31]
ds_read_b64_tr_b16 a[108:109], v9 offset:43104
ds_read_b64_tr_b16 a[110:111], v9 offset:43872
v_mfma_f32_16x16x32_bf16 v[32:35], a[88:91], a[24:27], v[32:35]
ds_read_b64_tr_b16 a[112:113], v8 offset:43136
ds_read_b64_tr_b16 a[114:115], v8 offset:43904
v_mfma_f32_16x16x32_bf16 v[36:39], a[92:95], a[24:27], v[36:39]
ds_read_b64_tr_b16 a[116:117], v9 offset:43168
ds_read_b64_tr_b16 a[118:119], v9 offset:43936
s_waitcnt lgkmcnt(0)
v_mfma_f32_16x16x32_bf16 v[16:19], a[96:99], a[28:31], v[16:19]
ds_read_b64_tr_b16 a[120:121], v8 offset:49152
ds_read_b64_tr_b16 a[122:123], v8 offset:49920
v_mfma_f32_16x16x32_bf16 v[20:23], a[100:103], a[28:31], v[20:23]
ds_read_b64_tr_b16 a[124:125], v9 offset:49184
ds_read_b64_tr_b16 a[126:127], v9 offset:49952
v_mfma_f32_16x16x32_bf16 v[24:27], a[104:107], a[28:31], v[24:27]
ds_read_b64_tr_b16 a[128:129], v8 offset:49216
ds_read_b64_tr_b16 a[130:131], v8 offset:49984
v_mfma_f32_16x16x32_bf16 v[28:31], a[108:111], a[28:31], v[28:31]
ds_read_b64_tr_b16 a[132:133], v9 offset:49248
ds_read_b64_tr_b16 a[134:135], v9 offset:50016
v_mfma_f32_16x16x32_bf16 v[32:35], a[112:115], a[28:31], v[32:35]
ds_read_b64_tr_b16 a[136:137], v8 offset:49280
ds_read_b64_tr_b16 a[138:139], v8 offset:50048
v_mfma_f32_16x16x32_bf16 v[36:39], a[116:119], a[28:31], v[36:39]
ds_read_b64_tr_b16 a[140:141], v9 offset:49312
ds_read_b64_tr_b16 a[142:143], v9 offset:50080
s_waitcnt lgkmcnt(0)
v_mfma_f32_16x16x32_bf16 v[16:19], a[120:123], a[32:35], v[16:19]
ds_read_b64_tr_b16 a[72:73], v8 offset:55296
ds_read_b64_tr_b16 a[74:75], v8 offset:56064
v_mfma_f32_16x16x32_bf16 v[20:23], a[124:127], a[32:35], v[20:23]
ds_read_b64_tr_b16 a[76:77], v9 offset:55328
ds_read_b64_tr_b16 a[78:79], v9 offset:56096
v_mfma_f32_16x16x32_bf16 v[24:27], a[128:131], a[32:35], v[24:27]
ds_read_b64_tr_b16 a[80:81], v8 offset:55360
ds_read_b64_tr_b16 a[82:83], v8 offset:56128
v_mfma_f32_16x16x32_bf16 v[28:31], a[132:135], a[32:35], v[28:31]
ds_read_b64_tr_b16 a[84:85], v9 offset:55392
ds_read_b64_tr_b16 a[86:87], v9 offset:56160
v_mfma_f32_16x16x32_bf16 v[32:35], a[136:139], a[32:35], v[32:35]
ds_read_b64_tr_b16 a[88:89], v8 offset:55424
ds_read_b64_tr_b16 a[90:91], v8 offset:56192
v_mfma_f32_16x16x32_bf16 v[36:39], a[140:143], a[32:35], v[36:39]
ds_read_b64_tr_b16 a[92:93], v9 offset:55456
ds_read_b64_tr_b16 a[94:95], v9 offset:56224
s_waitcnt lgkmcnt(0)
v_mfma_f32_16x16x32_bf16 v[16:19], a[72:75], a[36:39], v[16:19]
ds_read_b64_tr_b16 a[96:97], v10
ds_read_b64_tr_b16 a[98:99], v10 offset:768
v_mfma_f32_16x16x32_bf16 v[20:23], a[76:79], a[36:39], v[20:23]
ds_read_b64_tr_b16 a[100:101], v11 offset:32
ds_read_b64_tr_b16 a[102:103], v11 offset:800
v_mfma_f32_16x16x32_bf16 v[24:27], a[80:83], a[36:39], v[24:27]
ds_read_b64_tr_b16 a[104:105], v10 offset:64
ds_read_b64_tr_b16 a[106:107], v10 offset:832
v_mfma_f32_16x16x32_bf16 v[28:31], a[84:87], a[36:39], v[28:31]
ds_read_b64_tr_b16 a[108:109], v11 offset:96
ds_read_b64_tr_b16 a[110:111], v11 offset:864
v_mfma_f32_16x16x32_bf16 v[32:35], a[88:91], a[36:39], v[32:35]
ds_read_b64_tr_b16 a[112:113], v10 offset:128
ds_read_b64_tr_b16 a[114:115], v10 offset:896
v_mfma_f32_16x16x32_bf16 v[36:39], a[92:95], a[36:39], v[36:39]
ds_read_b64_tr_b16 a[116:117], v11 offset:160
ds_read_b64_tr_b16 a[118:119], v11 offset:928
s_waitcnt lgkmcnt(0)
v_mfma_f32_16x16x32_bf16 v[16:19], a[96:99], a[40:43], v[16:19]
ds_read_b64_tr_b16 a[120:121], v10 offset:6144
ds_read_b64_tr_b16 a[122:123], v10 offset:6912
v_mfma_f32_16x16x32_bf16 v[20:23], a[100:103], a[40:43], v[20:23]
ds_read_b64_tr_b16 a[124:125], v11 offset:6176
ds_read_b64_tr_b16 a[126:127], v11 offset:6944
v_mfma_f32_16x16x32_bf16 v[24:27], a[104:107], a[40:43], v[24:27]
ds_read_b64_tr_b16 a[128:129], v10 offset:6208
ds_read_b64_tr_b16 a[130:131], v10 offset:6976
v_mfma_f32_16x16x32_bf16 v[28:31], a[108:111], a[40:43], v[28:31]
ds_read_b64_tr_b16 a[132:133], v11 offset:6240
ds_read_b64_tr_b16 a[134:135], v11 offset:7008
v_mfma_f32_16x16x32_bf16 v[32:35], a[112:115], a[40:43], v[32:35]
ds_read_b64_tr_b16 a[136:137], v10 offset:6272
ds_read_b64_tr_b16 a[138:139], v10 offset:7040
v_mfma_f32_16x16x32_bf16 v[36:39], a[116:119], a[40:43], v[36:39]
ds_read_b64_tr_b16 a[140:141], v11 offset:6304
ds_read_b64_tr_b16 a[142:143], v11 offset:7072
s_waitcnt lgkmcnt(0)
v_mfma_f32_16x16x32_bf16 v[16:19], a[120:123], a[44:47], v[16:19]
v_mfma_f32_16x16x32_bf16 v[20:23], a[124:127], a[44:47], v[20:23]
v_mfma_f32_16x16x32_bf16 v[24:27], a[128:131], a[44:47], v[24:27]
v_mfma_f32_16x16x32_bf16 v[28:31], a[132:135], a[44:47], v[28:31]
v_mfma_f32_16x16x32_bf16 v[32:35], a[136:139], a[44:47], v[32:35]
v_mfma_f32_16x16x32_bf16 v[36:39], a[140:143], a[44:47], v[36:39]
s_waitcnt vmcnt(2)
s_barrier
ds_read_b64_tr_b16 a[72:73], v10 offset:12288
ds_read_b64_tr_b16 a[74:75], v10 offset:13056
ds_read_b64_tr_b16 a[76:77], v11 offset:12320
ds_read_b64_tr_b16 a[78:79], v11 offset:13088
ds_read_b64_tr_b16 a[80:81], v10 offset:12352
ds_read_b64_tr_b16 a[82:83], v10 offset:13120
ds_read_b64_tr_b16 a[84:85], v11 offset:12384
ds_read_b64_tr_b16 a[86:87], v11 offset:13152
ds_read_b64_tr_b16 a[88:89], v10 offset:12416
ds_read_b64_tr_b16 a[90:91], v10 offset:13184
ds_read_b64_tr_b16 a[92:93], v11 offset:12448
ds_read_b64_tr_b16 a[94:95], v11 offset:13216
s_waitcnt lgkmcnt(0)
v_mfma_f32_16x16x32_bf16 v[16:19], a[72:75], a[48:51], v[16:19]
ds_read_b64_tr_b16 a[96:97], v10 offset:18432
ds_read_b64_tr_b16 a[98:99], v10 offset:19200
v_mfma_f32_16x16x32_bf16 v[20:23], a[76:79], a[48:51], v[20:23]
ds_read_b64_tr_b16 a[100:101], v11 offset:18464
ds_read_b64_tr_b16 a[102:103], v11 offset:19232
v_mfma_f32_16x16x32_bf16 v[24:27], a[80:83], a[48:51], v[24:27]
ds_read_b64_tr_b16 a[104:105], v10 offset:18496
ds_read_b64_tr_b16 a[106:107], v10 offset:19264
v_mfma_f32_16x16x32_bf16 v[28:31], a[84:87], a[48:51], v[28:31]
ds_read_b64_tr_b16 a[108:109], v11 offset:18528
ds_read_b64_tr_b16 a[110:111], v11 offset:19296
v_mfma_f32_16x16x32_bf16 v[32:35], a[88:91], a[48:51], v[32:35]
ds_read_b64_tr_b16 a[112:113], v10 offset:18560
ds_read_b64_tr_b16 a[114:115], v10 offset:19328
v_mfma_f32_16x16x32_bf16 v[36:39], a[92:95], a[48:51], v[36:39]
ds_read_b64_tr_b16 a[116:117], v11 offset:18592
ds_read_b64_tr_b16 a[118:119], v11 offset:19360
s_waitcnt lgkmcnt(0)
v_mfma_f32_16x16x32_bf16 v[16:19], a[96:99], a[52:55], v[16:19]
ds_read_b64_tr_b16 a[120:121], v10 offset:24576
ds_read_b64_tr_b16 a[122:123], v10 offset:25344
v_mfma_f32_16x16x32_bf16 v[20:23], a[100:103], a[52:55], v[20:23]
ds_read_b64_tr_b16 a[124:125], v11 offset:24608
ds_read_b64_tr_b16 a[126:127], v11 offset:25376
v_mfma_f32_16x16x32_bf16 v[24:27], a[104:107], a[52:55], v[24:27]
ds_read_b64_tr_b16 a[128:129], v10 offset:24640
ds_read_b64_tr_b16 a[130:131], v10 offset:25408
v_mfma_f32_16x16x32_bf16 v[28:31], a[108:111], a[52:55], v[28:31]
ds_read_b64_tr_b16 a[132:133], v11 offset:24672
ds_read_b64_tr_b16 a[134:135], v11 offset:25440
v_mfma_f32_16x16x32_bf16 v[32:35], a[112:115], a[52:55], v[32:35]
ds_read_b64_tr_b16 a[136:137], v10 offset:24704
ds_read_b64_tr_b16 a[138:139], v10 offset:25472
v_mfma_f32_16x16x32_bf16 v[36:39], a[116:119], a[52:55], v[36:39]
ds_read_b64_tr_b16 a[140:141], v11 offset:24736
ds_read_b64_tr_b16 a[142:143], v11 offset:25504
s_waitcnt lgkmcnt(0)
v_mfma_f32_16x16x32_bf16 v[16:19], a[120:123], a[56:59], v[16:19]
ds_read_b64_tr_b16 a[72:73], v10 offset:30720
ds_read_b64_tr_b16 a[74:75], v10 offset:31488
v_mfma_f32_16x16x32_bf16 v[20:23], a[124:127], a[56:59], v[20:23]
ds_read_b64_tr_b16 a[76:77], v11 offset:30752
ds_read_b64_tr_b16 a[78:79], v11 offset:31520
v_mfma_f32_16x16x32_bf16 v[24:27], a[128:131], a[56:59], v[24:27]
ds_read_b64_tr_b16 a[80:81], v10 offset:30784
ds_read_b64_tr_b16 a[82:83], v10 offset:31552
v_mfma_f32_16x16x32_bf16 v[28:31], a[132:135], a[56:59], v[28:31]
ds_read_b64_tr_b16 a[84:85], v11 offset:30816
ds_read_b64_tr_b16 a[86:87], v11 offset:31584
v_mfma_f32_16x16x32_bf16 v[32:35], a[136:139], a[56:59], v[32:35]
ds_read_b64_tr_b16 a[88:89], v10 offset:30848
ds_read_b64_tr_b16 a[90:91], v10 offset:31616
v_mfma_f32_16x16x32_bf16 v[36:39], a[140:143], a[56:59], v[36:39]
ds_read_b64_tr_b16 a[92:93], v11 offset:30880
ds_read_b64_tr_b16 a[94:95], v11 offset:31648
s_waitcnt lgkmcnt(0)
v_mfma_f32_16x16x32_bf16 v[16:19], a[72:75], a[60:63], v[16:19]
ds_read_b64_tr_b16 a[96:97], v10 offset:36864
ds_read_b64_tr_b16 a[98:99], v10 offset:37632
v_mfma_f32_16x16x32_bf16 v[20:23], a[76:79], a[60:63], v[20:23]
ds_read_b64_tr_b16 a[100:101], v11 offset:36896
ds_read_b64_tr_b16 a[102:103], v11 offset:37664
v_mfma_f32_16x16x32_bf16 v[24:27], a[80:83], a[60:63], v[24:27]
ds_read_b64_tr_b16 a[104:105], v10 offset:36928
ds_read_b64_tr_b16 a[106:107], v10 offset:37696
v_mfma_f32_16x16x32_bf16 v[28:31], a[84:87], a[60:63], v[28:31]
ds_read_b64_tr_b16 a[108:109], v11 offset:36960
ds_read_b64_tr_b16 a[110:111], v11 offset:37728
v_mfma_f32_16x16x32_bf16 v[32:35], a[88:91], a[60:63], v[32:35]
ds_read_b64_tr_b16 a[112:113], v10 offset:36992
ds_read_b64_tr_b16 a[114:115], v10 offset:37760
v_mfma_f32_16x16x32_bf16 v[36:39], a[92:95], a[60:63], v[36:39]
ds_read_b64_tr_b16 a[116:117], v11 offset:37024
ds_read_b64_tr_b16 a[118:119], v11 offset:37792
s_waitcnt lgkmcnt(0)
v_mfma_f32_16x16x32_bf16 v[16:19], a[96:99], a[64:67], v[16:19]
ds_read_b64_tr_b16 a[120:121], v10 offset:43008
ds_read_b64_tr_b16 a[122:123], v10 offset:43776
v_mfma_f32_16x16x32_bf16 v[20:23], a[100:103], a[64:67], v[20:23]
ds_read_b64_tr_b16 a[124:125], v11 offset:43040
ds_read_b64_tr_b16 a[126:127], v11 offset:43808
v_mfma_f32_16x16x32_bf16 v[24:27], a[104:107], a[64:67], v[24:27]
ds_read_b64_tr_b16 a[128:129], v10 offset:43072
ds_read_b64_tr_b16 a[130:131], v10 offset:43840
v_mfma_f32_16x16x32_bf16 v[28:31], a[108:111], a[64:67], v[28:31]
ds_read_b64_tr_b16 a[132:133], v11 offset:43104
ds_read_b64_tr_b16 a[134:135], v11 offset:43872
v_mfma_f32_16x16x32_bf16 v[32:35], a[112:115], a[64:67], v[32:35]
ds_read_b64_tr_b16 a[136:137], v10 offset:43136
ds_read_b64_tr_b16 a[138:139], v10 offset:43904
v_mfma_f32_16x16x32_bf16 v[36:39], a[116:119], a[64:67], v[36:39]
ds_read_b64_tr_b16 a[140:141], v11 offset:43168
ds_read_b64_tr_b16 a[142:143], v11 offset:43936
s_waitcnt lgkmcnt(0)
v_mfma_f32_16x16x32_bf16 v[16:19], a[120:123], a[68:71], v[16:19]
v_mfma_f32_16x16x32_bf16 v[20:23], a[124:127], a[68:71], v[20:23]
v_mfma_f32_16x16x32_bf16 v[24:27], a[128:131], a[68:71], v[24:27]
v_mfma_f32_16x16x32_bf16 v[28:31], a[132:135], a[68:71], v[28:31]
v_mfma_f32_16x16x32_bf16 v[32:35], a[136:139], a[68:71], v[32:35]
v_mfma_f32_16x16x32_bf16 v[36:39], a[140:143], a[68:71], v[36:39]
s_nop 7
s_barrier
s_waitcnt vmcnt(0)
s_cmp_lg_u32 s40, 0
s_cbranch_scc1 L_lk_q1
s_mov_b32 s58, 0
L_lc_q1:
v_and_b32 v252, 0xffff, v247
v_cmp_ge_u32 vcc, v252, v248
s_nop 3
s_cmp_eq_u64 vcc, -1
s_cbranch_scc1 L_lk_q1
s_add_u32 s58, s58, 1
s_cmp_ge_u32 s58, 65536
s_cbranch_scc1 L_lk_q1
s_sleep 4
buffer_load_dword v247, v246, s[72:75], 0 offen sc1
s_waitcnt vmcnt(0)
s_branch L_lc_q1
L_lk_q1:
s_barrier
s_waitcnt vmcnt(1)
s_mov_b32 s8, s66
s_mov_b32 s9, s67
s_mov_b32 s10, 0x480000
s_mov_b32 s11, 0x20000
s_add_u32 s12, s70, 0x4000000
s_addc_u32 s13, s71, 0
s_mov_b32 s14, 0x240000
s_mov_b32 s15, 0x20000
s_add_u32 m0, s54, 0x0
s_nop 0
buffer_load_dwordx4 v208, s[8:11], s49 offen lds
v_mov_b32 v62, 0
v_mov_b32 v63, 0
v_lshlrev_b32 v64, 16, v48
v_and_b32 v65, 0xffff0000, v48
v_lshlrev_b32 v66, 16, v49
v_and_b32 v67, 0xffff0000, v49
v_pk_add_f32 v[64:65], v[64:65], v[60:61] op_sel_hi:[1,0] neg_lo:[0,1] neg_hi:[0,1]
v_pk_add_f32 v[66:67], v[66:67], v[60:61] op_sel_hi:[1,0] neg_lo:[0,1] neg_hi:[0,1]
buffer_load_dwordx4 v209, s[8:11], s49 offen offset:1024 lds
v_pk_mul_f32 v[64:65], v[64:65], v[60:61] op_sel:[0,1]
v_pk_mul_f32 v[66:67], v[66:67], v[60:61] op_sel:[0,1]
v_cvt_pk_bf16_f32 v68, v64, v65
v_cvt_pk_bf16_f32 v69, v66, v67
v_cvt_pk_bf16_f32 v70, v16, v17
v_cvt_pk_bf16_f32 v71, v18, v19
v_lshlrev_b32 v64, 16, v68
v_and_b32 v65, 0xffff0000, v68
buffer_load_dwordx4 v210, s[8:11], s49 offen offset:2048 lds
v_lshlrev_b32 v66, 16, v69
v_and_b32 v67, 0xffff0000, v69
v_lshlrev_b32 v16, 16, v70
v_and_b32 v17, 0xffff0000, v70
v_lshlrev_b32 v18, 16, v71
v_and_b32 v19, 0xffff0000, v71
v_pk_add_f32 v[64:65], v[64:65], v[16:17]
v_pk_add_f32 v[66:67], v[66:67], v[18:19]
buffer_load_dwordx4 v211, s[8:11], s49 offen offset:3072 lds
v_cvt_pk_bf16_f32 v72, v64, v65
v_cvt_pk_bf16_f32 v73, v66, v67
v_lshlrev_b32 v64, 16, v72
v_and_b32 v65, 0xffff0000, v72
v_lshlrev_b32 v66, 16, v73
v_and_b32 v67, 0xffff0000, v73
v_add_f32 v62, v62, v64
v_fmac_f32 v63, v64, v64
s_add_u32 m0, s54, 0x1000
s_nop 0
buffer_load_dwordx4 v212, s[8:11], s49 offen lds
v_add_f32 v62, v62, v65
v_fmac_f32 v63, v65, v65
v_add_f32 v62, v62, v66
v_fmac_f32 v63, v66, v66
v_add_f32 v62, v62, v67
v_fmac_f32 v63, v67, v67
v_lshlrev_b32 v64, 16, v50
buffer_load_dwordx4 v213, s[8:11], s49 offen offset:1024 lds
v_and_b32 v65, 0xffff0000, v50
v_lshlrev_b32 v66, 16, v51
v_and_b32 v67, 0xffff0000, v51
v_pk_add_f32 v[64:65], v[64:65], v[60:61] op_sel_hi:[1,0] neg_lo:[0,1] neg_hi:[0,1]
v_pk_add_f32 v[66:67], v[66:67], v[60:61] op_sel_hi:[1,0] neg_lo:[0,1] neg_hi:[0,1]
v_pk_mul_f32 v[64:65], v[64:65], v[60:61] op_sel:[0,1]
v_pk_mul_f32 v[66:67], v[66:67], v[60:61] op_sel:[0,1]
v_cvt_pk_bf16_f32 v68, v64, v65
buffer_load_dwordx4 v214, s[8:11], s49 offen offset:2048 lds
v_cvt_pk_bf16_f32 v69, v66, v67
v_cvt_pk_bf16_f32 v70, v20, v21
v_cvt_pk_bf16_f32 v71, v22, v23
v_lshlrev_b32 v64, 16, v68
v_and_b32 v65, 0xffff0000, v68
v_lshlrev_b32 v66, 16, v69
v_and_b32 v67, 0xffff0000, v69
v_lshlrev_b32 v20, 16, v70
buffer_load_dwordx4 v215, s[8:11], s49 offen offset:3072 lds
v_and_b32 v21, 0xffff0000, v70
v_lshlrev_b32 v22, 16, v71
v_and_b32 v23, 0xffff0000, v71
v_pk_add_f32 v[64:65], v[64:65], v[20:21]
v_pk_add_f32 v[66:67], v[66:67], v[22:23]
v_cvt_pk_bf16_f32 v74, v64, v65
v_cvt_pk_bf16_f32 v75, v66, v67
v_lshlrev_b32 v64, 16, v74
s_add_u32 s49, s49, 524288
buffer_load_dwordx4 a[0:3], v220, s[12:15], s50 offen sc1
v_and_b32 v65, 0xffff0000, v74
v_lshlrev_b32 v66, 16, v75
v_and_b32 v67, 0xffff0000, v75
v_add_f32 v62, v62, v64
v_fmac_f32 v63, v64, v64
v_add_f32 v62, v62, v65
v_fmac_f32 v63, v65, v65
v_add_f32 v62, v62, v66
buffer_load_dwordx4 a[4:7], v221, s[12:15], s50 offen sc1
v_fmac_f32 v63, v66, v66
v_add_f32 v62, v62, v67
v_fmac_f32 v63, v67, v67
v_lshlrev_b32 v64, 16, v52
v_and_b32 v65, 0xffff0000, v52
v_lshlrev_b32 v66, 16, v53
v_and_b32 v67, 0xffff0000, v53
buffer_load_dwordx4 a[8:11], v220, s[12:15], s50 offen offset:1024 sc1
v_pk_add_f32 v[64:65], v[64:65], v[60:61] op_sel_hi:[1,0] neg_lo:[0,1] neg_hi:[0,1]
v_pk_add_f32 v[66:67], v[66:67], v[60:61] op_sel_hi:[1,0] neg_lo:[0,1] neg_hi:[0,1]
v_pk_mul_f32 v[64:65], v[64:65], v[60:61] op_sel:[0,1]
v_pk_mul_f32 v[66:67], v[66:67], v[60:61] op_sel:[0,1]
v_cvt_pk_bf16_f32 v68, v64, v65
v_cvt_pk_bf16_f32 v69, v66, v67
v_cvt_pk_bf16_f32 v70, v24, v25
v_cvt_pk_bf16_f32 v71, v26, v27
buffer_load_dwordx4 a[12:15], v221, s[12:15], s50 offen offset:1024 sc1
v_lshlrev_b32 v64, 16, v68
v_and_b32 v65, 0xffff0000, v68
v_lshlrev_b32 v66, 16, v69
v_and_b32 v67, 0xffff0000, v69
v_lshlrev_b32 v24, 16, v70
v_and_b32 v25, 0xffff0000, v70
v_lshlrev_b32 v26, 16, v71
v_and_b32 v27, 0xffff0000, v71
buffer_load_dwordx4 a[16:19], v220, s[12:15], s50 offen offset:2048 sc1
v_pk_add_f32 v[64:65], v[64:65], v[24:25]
v_pk_add_f32 v[66:67], v[66:67], v[26:27]
v_cvt_pk_bf16_f32 v76, v64, v65
v_cvt_pk_bf16_f32 v77, v66, v67
v_lshlrev_b32 v64, 16, v76
v_and_b32 v65, 0xffff0000, v76
v_lshlrev_b32 v66, 16, v77
v_and_b32 v67, 0xffff0000, v77
buffer_load_dwordx4 a[20:23], v221, s[12:15], s50 offen offset:2048 sc1
v_add_f32 v62, v62, v64
v_fmac_f32 v63, v64, v64
v_add_f32 v62, v62, v65
v_fmac_f32 v63, v65, v65
v_add_f32 v62, v62, v66
v_fmac_f32 v63, v66, v66
v_add_f32 v62, v62, v67
buffer_load_dwordx4 a[24:27], v220, s[12:15], s50 offen offset:3072 sc1
v_fmac_f32 v63, v67, v67
v_lshlrev_b32 v64, 16, v54
v_and_b32 v65, 0xffff0000, v54
v_lshlrev_b32 v66, 16, v55
v_and_b32 v67, 0xffff0000, v55
v_pk_add_f32 v[64:65], v[64:65], v[60:61] op_sel_hi:[1,0] neg_lo:[0,1] neg_hi:[0,1]
v_pk_add_f32 v[66:67], v[66:67], v[60:61] op_sel_hi:[1,0] neg_lo:[0,1] neg_hi:[0,1]
v_pk_mul_f32 v[64:65], v[64:65], v[60:61] op_sel:[0,1]
buffer_load_dwordx4 a[28:31], v221, s[12:15], s50 offen offset:3072 sc1
v_pk_mul_f32 v[66:67], v[66:67], v[60:61] op_sel:[0,1]
v_cvt_pk_bf16_f32 v68, v64, v65
v_cvt_pk_bf16_f32 v69, v66, v67
v_cvt_pk_bf16_f32 v70, v28, v29
v_cvt_pk_bf16_f32 v71, v30, v31
v_lshlrev_b32 v64, 16, v68
v_and_b32 v65, 0xffff0000, v68
v_lshlrev_b32 v66, 16, v69
s_add_u32 m0, s54, 0x8000
s_nop 0
buffer_load_dwordx4 v208, s[8:11], s49 offen lds
v_and_b32 v67, 0xffff0000, v69
v_lshlrev_b32 v28, 16, v70
v_and_b32 v29, 0xffff0000, v70
v_lshlrev_b32 v30, 16, v71
v_and_b32 v31, 0xffff0000, v71
v_pk_add_f32 v[64:65], v[64:65], v[28:29]
v_pk_add_f32 v[66:67], v[66:67], v[30:31]
v_cvt_pk_bf16_f32 v78, v64, v65
buffer_load_dwordx4 v209, s[8:11], s49 offen offset:1024 lds
v_cvt_pk_bf16_f32 v79, v66, v67
v_lshlrev_b32 v64, 16, v78
v_and_b32 v65, 0xffff0000, v78
v_lshlrev_b32 v66, 16, v79
v_and_b32 v67, 0xffff0000, v79
v_add_f32 v62, v62, v64
v_fmac_f32 v63, v64, v64
v_add_f32 v62, v62, v65
buffer_load_dwordx4 v210, s[8:11], s49 offen offset:2048 lds
v_fmac_f32 v63, v65, v65
v_add_f32 v62, v62, v66
v_fmac_f32 v63, v66, v66
v_add_f32 v62, v62, v67
v_fmac_f32 v63, v67, v67
v_lshlrev_b32 v64, 16, v56
v_and_b32 v65, 0xffff0000, v56
buffer_load_dwordx4 v211, s[8:11], s49 offen offset:3072 lds
v_lshlrev_b32 v66, 16, v57
v_and_b32 v67, 0xffff0000, v57
v_pk_add_f32 v[64:65], v[64:65], v[60:61] op_sel_hi:[1,0] neg_lo:[0,1] neg_hi:[0,1]
v_pk_add_f32 v[66:67], v[66:67], v[60:61] op_sel_hi:[1,0] neg_lo:[0,1] neg_hi:[0,1]
v_pk_mul_f32 v[64:65], v[64:65], v[60:61] op_sel:[0,1]
v_pk_mul_f32 v[66:67], v[66:67], v[60:61] op_sel:[0,1]
v_cvt_pk_bf16_f32 v68, v64, v65
v_cvt_pk_bf16_f32 v69, v66, v67
s_add_u32 m0, s54, 0x9000
s_nop 0
buffer_load_dwordx4 v212, s[8:11], s49 offen lds
v_cvt_pk_bf16_f32 v70, v32, v33
v_cvt_pk_bf16_f32 v71, v34, v35
v_lshlrev_b32 v64, 16, v68
v_and_b32 v65, 0xffff0000, v68
v_lshlrev_b32 v66, 16, v69
v_and_b32 v67, 0xffff0000, v69
v_lshlrev_b32 v32, 16, v70
v_and_b32 v33, 0xffff0000, v70
buffer_load_dwordx4 v213, s[8:11], s49 offen offset:1024 lds
v_lshlrev_b32 v34, 16, v71
v_and_b32 v35, 0xffff0000, v71
v_pk_add_f32 v[64:65], v[64:65], v[32:33]
v_pk_add_f32 v[66:67], v[66:67], v[34:35]
v_cvt_pk_bf16_f32 v80, v64, v65
v_cvt_pk_bf16_f32 v81, v66, v67
v_lshlrev_b32 v64, 16, v80
v_and_b32 v65, 0xffff0000, v80
buffer_load_dwordx4 v214, s[8:11], s49 offen offset:2048 lds
v_lshlrev_b32 v66, 16, v81
v_and_b32 v67, 0xffff0000, v81
v_add_f32 v62, v62, v64
v_fmac_f32 v63, v64, v64
v_add_f32 v62, v62, v65
v_fmac_f32 v63, v65, v65
v_add_f32 v62, v62, v66
v_fmac_f32 v63, v66, v66
buffer_load_dwordx4 v215, s[8:11], s49 offen offset:3072 lds
v_add_f32 v62, v62, v67
v_fmac_f32 v63, v67, v67
v_lshlrev_b32 v64, 16, v58
v_and_b32 v65, 0xffff0000, v58
v_lshlrev_b32 v66, 16, v59
v_and_b32 v67, 0xffff0000, v59
v_pk_add_f32 v[64:65], v[64:65], v[60:61] op_sel_hi:[1,0] neg_lo:[0,1] neg_hi:[0,1]
s_add_u32 s49, s49, 524288
s_add_u32 s50, s50, 4096
buffer_load_dwordx4 a[32:35], v220, s[12:15], s50 offen sc1
v_pk_add_f32 v[66:67], v[66:67], v[60:61] op_sel_hi:[1,0] neg_lo:[0,1] neg_hi:[0,1]
v_pk_mul_f32 v[64:65], v[64:65], v[60:61] op_sel:[0,1]
v_pk_mul_f32 v[66:67], v[66:67], v[60:61] op_sel:[0,1]
v_cvt_pk_bf16_f32 v68, v64, v65
v_cvt_pk_bf16_f32 v69, v66, v67
v_cvt_pk_bf16_f32 v70, v36, v37
v_cvt_pk_bf16_f32 v71, v38, v39
v_lshlrev_b32 v64, 16, v68
buffer_load_dwordx4 a[36:39], v221, s[12:15], s50 offen sc1
v_and_b32 v65, 0xffff0000, v68
v_lshlrev_b32 v66, 16, v69
v_and_b32 v67, 0xffff0000, v69
v_lshlrev_b32 v36, 16, v70
v_and_b32 v37, 0xffff0000, v70
v_lshlrev_b32 v38, 16, v71
v_and_b32 v39, 0xffff0000, v71
v_pk_add_f32 v[64:65], v[64:65], v[36:37]
buffer_load_dwordx4 a[40:43], v220, s[12:15], s50 offen offset:1024 sc1
v_pk_add_f32 v[66:67], v[66:67], v[38:39]
v_cvt_pk_bf16_f32 v82, v64, v65
v_cvt_pk_bf16_f32 v83, v66, v67
v_lshlrev_b32 v64, 16, v82
v_and_b32 v65, 0xffff0000, v82
v_lshlrev_b32 v66, 16, v83
v_and_b32 v67, 0xffff0000, v83
v_add_f32 v62, v62, v64
buffer_load_dwordx4 a[44:47], v221, s[12:15], s50 offen offset:1024 sc1
v_fmac_f32 v63, v64, v64
v_add_f32 v62, v62, v65
v_fmac_f32 v63, v65, v65
v_add_f32 v62, v62, v66
v_fmac_f32 v63, v66, v66
v_add_f32 v62, v62, v67
v_fmac_f32 v63, v67, v67
s_lshr_b32 s60, s100, 4
s_mul_i32 s60, s60, 18
s_mul_i32 s61, s97, 3
s_add_u32 s60, s60, s61
s_lshl_b32 s60, s60, 10
v_lshlrev_b32 v12, 4, v1
buffer_store_dwordx4 v[72:75], v12, s[16:19], s60 offen sc1
buffer_store_dwordx4 v[76:79], v12, s[16:19], s60 offen offset:1024 sc1
buffer_store_dwordx4 v[80:83], v12, s[16:19], s60 offen offset:2048 sc1
v_mov_b32 v64, v62
s_nop 1
v_permlane32_swap_b32 v64, v62
s_nop 1
v_add_f32 v62, v62, v64
v_mov_b32 v64, v62
s_nop 1
v_permlane16_swap_b32 v64, v62
s_nop 1
v_add_f32 v62, v62, v64
v_mov_b32 v64, v63
s_nop 1
v_permlane32_swap_b32 v64, v63
s_nop 1
v_add_f32 v63, v63, v64
v_mov_b32 v64, v63
s_nop 1
v_permlane16_swap_b32 v64, v63
s_nop 1
v_add_f32 v63, v63, v64
s_lshl_b32 s60, s97, 14
s_add_u32 s60, s60, 0x20000
v_cmp_gt_u32 vcc, 16, v1
s_nop 3
s_and_saveexec_b64 s[56:57], vcc
v_lshlrev_b32 v13, 3, v14
buffer_store_dwordx2 v[62:63], v13, s[36:39], s60 offen sc1
s_mov_b64 exec, s[56:57]
s_lshr_b32 s62, s96, 2
s_add_u32 s62, s62, 80
s_lshl_b32 s62, s62, 7
s_branch M_q
M_cs:
s_waitcnt lgkmcnt(0)
s_load_dwordx2 s[62:63], s[0:1], 24
s_load_dwordx2 s[64:65], s[0:1], 64
v_lshrrev_b32 v252, 6, v0
s_nop 0
v_readfirstlane_b32 s40, v252
s_nop 3
s_waitcnt lgkmcnt(0)
s_mov_b32 s36, s70
s_mov_b32 s37, s71
s_mov_b32 s38, 0x80000
s_mov_b32 s39, 0x20000
s_add_u32 s72, s70, 0x70000
s_addc_u32 s73, s71, 0
s_mov_b32 s74, 0x5000
s_mov_b32 s75, 0x20000
s_mov_b32 s76, s66
s_mov_b32 s77, s67
s_mov_b32 s78, 0x100
s_mov_b32 s79, 0x20000
s_cmp_lg_u32 s2, 255
s_cbranch_scc1 M_nozero
v_mov_b32 v4, 0
v_mov_b32 v5, 0
v_mov_b32 v6, 0
v_mov_b32 v7, 0
v_lshlrev_b32 v8, 4, v0
s_mov_b32 s56, 0
buffer_store_dwordx4 v[4:7], v8, s[72:75], s56 offen sc1
s_mov_b32 s56, 4096
buffer_store_dwordx4 v[4:7], v8, s[72:75], s56 offen sc1
s_mov_b32 s56, 8192
buffer_store_dwordx4 v[4:7], v8, s[72:75], s56 offen sc1
s_mov_b32 s56, 12288
buffer_store_dwordx4 v[4:7], v8, s[72:75], s56 offen sc1
s_mov_b32 s56, 16384
buffer_store_dwordx4 v[4:7], v8, s[72:75], s56 offen sc1
s_waitcnt vmcnt(0)
s_barrier
s_mov_b32 s56, 0
s_cmp_lg_u32 s40, 0
s_cbranch_scc1 L_nosig_ini
s_mov_b64 exec, 1
v_mov_b32 v252, 1
v_mov_b32 v251, 0
s_nop 0
buffer_atomic_add v252, v251, s[76:79], s56 offen
s_mov_b64 exec, -1
L_nosig_ini:
M_nozero:
v_lshrrev_b32 v252, 5, v255
v_add_u32 v252, 0, v252
v_and_b32 v251, 3, v252
v_bfe_u32 v250, v252, 3, 1
v_lshl_or_b32 v251, v250, 2, v251
v_lshlrev_b32 v251, 1, v251
v_and_b32 v250, 31, v255
v_xor_b32 v251, v251, v250
v_lshlrev_b32 v251, 4, v251
v_lshl_add_u32 v251, v252, 13, v251
v_subrev_u32 v208, 0, v251
v_lshrrev_b32 v252, 5, v255
v_add_u32 v252, 2, v252
v_and_b32 v251, 3, v252
v_bfe_u32 v250, v252, 3, 1
v_lshl_or_b32 v251, v250, 2, v251
v_lshlrev_b32 v251, 1, v251
v_and_b32 v250, 31, v255
v_xor_b32 v251, v251, v250
v_lshlrev_b32 v251, 4, v251
v_lshl_add_u32 v251, v252, 13, v251
v_subrev_u32 v209, 1024, v251
v_lshrrev_b32 v252, 5, v255
v_add_u32 v252, 4, v252
v_and_b32 v251, 3, v252
v_bfe_u32 v250, v252, 3, 1
v_lshl_or_b32 v251, v250, 2, v251
v_lshlrev_b32 v251, 1, v251
v_and_b32 v250, 31, v255
v_xor_b32 v251, v251, v250
v_lshlrev_b32 v251, 4, v251
v_lshl_add_u32 v251, v252, 13, v251
v_subrev_u32 v210, 2048, v251
v_lshrrev_b32 v252, 5, v255
v_add_u32 v252, 6, v252
v_and_b32 v251, 3, v252
v_bfe_u32 v250, v252, 3, 1
v_lshl_or_b32 v251, v250, 2, v251
v_lshlrev_b32 v251, 1, v251
v_and_b32 v250, 31, v255
v_xor_b32 v251, v251, v250
v_lshlrev_b32 v251, 4, v251
v_lshl_add_u32 v251, v252, 13, v251
v_subrev_u32 v211, 3072, v251
v_lshrrev_b32 v252, 5, v255
v_add_u32 v252, 8, v252
v_and_b32 v251, 3, v252
v_bfe_u32 v250, v252, 3, 1
v_lshl_or_b32 v251, v250, 2, v251
v_lshlrev_b32 v251, 1, v251
v_and_b32 v250, 31, v255
v_xor_b32 v251, v251, v250
v_lshlrev_b32 v251, 4, v251
v_lshl_add_u32 v251, v252, 13, v251
v_subrev_u32 v212, 0, v251
v_lshrrev_b32 v252, 5, v255
v_add_u32 v252, 10, v252
v_and_b32 v251, 3, v252
v_bfe_u32 v250, v252, 3, 1
v_lshl_or_b32 v251, v250, 2, v251
v_lshlrev_b32 v251, 1, v251
v_and_b32 v250, 31, v255
v_xor_b32 v251, v251, v250
v_lshlrev_b32 v251, 4, v251
v_lshl_add_u32 v251, v252, 13, v251
v_subrev_u32 v213, 1024, v251
v_lshrrev_b32 v252, 5, v255
v_add_u32 v252, 12, v252
v_and_b32 v251, 3, v252
v_bfe_u32 v250, v252, 3, 1
v_lshl_or_b32 v251, v250, 2, v251
v_lshlrev_b32 v251, 1, v251
v_and_b32 v250, 31, v255
v_xor_b32 v251, v251, v250
v_lshlrev_b32 v251, 4, v251
v_lshl_add_u32 v251, v252, 13, v251
v_subrev_u32 v214, 2048, v251
v_lshrrev_b32 v252, 5, v255
v_add_u32 v252, 14, v252
v_and_b32 v251, 3, v252
v_bfe_u32 v250, v252, 3, 1
v_lshl_or_b32 v251, v250, 2, v251
v_lshlrev_b32 v251, 1, v251
v_and_b32 v250, 31, v255
v_xor_b32 v251, v251, v250
v_lshlrev_b32 v251, 4, v251
v_lshl_add_u32 v251, v252, 13, v251
v_subrev_u32 v215, 3072, v251
v_lshlrev_b32 v252, 4, v255
v_add_u32 v220, 0, v252
v_lshlrev_b32 v252, 4, v255
v_add_u32 v221, 18432, v252
v_lshrrev_b32 v252, 2, v254
v_and_b32 v251, 1, v253
v_lshl_or_b32 v251, v251, 2, v252
v_lshl_add_u32 v252, v253, 3, v252
v_lshlrev_b32 v252, 9, v252
v_and_b32 v250, 3, v254
v_lshl_add_u32 v252, v250, 3, v252
v_xor_b32 v250, 0, v251
v_lshl_add_u32 v128, v250, 5, v252
v_add_u32 v136, 0x10000, v128
v_xor_b32 v250, 1, v251
v_lshl_add_u32 v129, v250, 5, v252
v_add_u32 v137, 0x10000, v129
v_xor_b32 v250, 2, v251
v_lshl_add_u32 v130, v250, 5, v252
v_add_u32 v138, 0x10000, v130
v_xor_b32 v250, 3, v251
v_lshl_add_u32 v131, v250, 5, v252
v_add_u32 v139, 0x10000, v131
v_xor_b32 v250, 4, v251
v_lshl_add_u32 v132, v250, 5, v252
v_add_u32 v140, 0x10000, v132
v_xor_b32 v250, 5, v251
v_lshl_add_u32 v133, v250, 5, v252
v_add_u32 v141, 0x10000, v133
v_xor_b32 v250, 6, v251
v_lshl_add_u32 v134, v250, 5, v252
v_add_u32 v142, 0x10000, v134
v_xor_b32 v250, 7, v251
v_lshl_add_u32 v135, v250, 5, v252
v_add_u32 v143, 0x10000, v135
v_lshlrev_b32 v222, 3, v254
v_lshlrev_b32 v223, 4, v253
v_lshlrev_b32 v252, 4, v255
v_add_u32 v252, 0, v252
s_mov_b32 s56, 0xe38e39
v_mul_hi_u32 v251, s56, v252
v_mul_u32_u24 v250, 288, v251
v_sub_u32 v250, v252, v250
v_mul_u32_u24 v251, 9216, v251
v_add_u32 v251, v251, v250
v_subrev_u32 v230, 0, v251
v_lshlrev_b32 v252, 4, v255
v_add_u32 v252, 1024, v252
s_mov_b32 s56, 0xe38e39
v_mul_hi_u32 v251, s56, v252
v_mul_u32_u24 v250, 288, v251
v_sub_u32 v250, v252, v250
v_mul_u32_u24 v251, 9216, v251
v_add_u32 v251, v251, v250
v_subrev_u32 v231, 1024, v251
v_lshlrev_b32 v252, 4, v255
v_add_u32 v252, 2048, v252
s_mov_b32 s56, 0xe38e39
v_mul_hi_u32 v251, s56, v252
v_mul_u32_u24 v250, 288, v251
v_sub_u32 v250, v252, v250
v_mul_u32_u24 v251, 9216, v251
v_add_u32 v251, v251, v250
v_subrev_u32 v232, 2048, v251
v_lshlrev_b32 v252, 4, v255
v_add_u32 v252, 3072, v252
s_mov_b32 s56, 0xe38e39
v_mul_hi_u32 v251, s56, v252
v_mul_u32_u24 v250, 288, v251
v_sub_u32 v250, v252, v250
v_mul_u32_u24 v251, 9216, v251
v_add_u32 v251, v251, v250
v_subrev_u32 v233, 3072, v251
v_lshlrev_b32 v252, 4, v255
v_add_u32 v252, 4096, v252
s_mov_b32 s56, 0xe38e39
v_mul_hi_u32 v251, s56, v252
v_mul_u32_u24 v250, 288, v251
v_sub_u32 v250, v252, v250
v_mul_u32_u24 v251, 9216, v251
v_add_u32 v251, v251, v250
v_subrev_u32 v234, 0, v251
v_cmp_gt_u32 vcc, 32, v255
v_mov_b32 v252, 0x70000000
s_nop 0
v_cndmask_b32 v234, v252, v234
v_lshlrev_b32 v252, 4, v255
v_add_u32 v235, 0, v252
v_lshlrev_b32 v252, 4, v255
v_add_u32 v236, 18432, v252
v_lshlrev_b32 v252, 4, v255
v_add_u32 v237, 36864, v252
v_lshlrev_b32 v252, 4, v255
v_add_u32 v238, 55296, v252
v_lshrrev_b32 v252, 2, v254
v_lshl_add_u32 v252, v253, 2, v252
v_mul_u32_u24 v252, 288, v252
v_and_b32 v251, 3, v254
v_lshl_add_u32 v239, v251, 3, v252
v_add_u32 v240, 0x10000, v239
v_lshrrev_b32 v252, 4, v255
v_and_b32 v251, 15, v255
v_add_u32 v250, 0, v252
v_xor_b32 v250, v250, v251
v_lshlrev_b32 v250, 4, v250
v_lshl_add_u32 v224, v252, 8, v250
v_add_u32 v250, 4, v252
v_xor_b32 v250, v250, v251
v_lshlrev_b32 v250, 4, v250
v_lshl_add_u32 v225, v252, 8, v250
v_add_u32 v250, 8, v252
v_xor_b32 v250, v250, v251
v_lshlrev_b32 v250, 4, v250
v_lshl_add_u32 v226, v252, 8, v250
v_add_u32 v250, 12, v252
v_xor_b32 v250, v250, v251
v_lshlrev_b32 v250, 4, v250
v_lshl_add_u32 v227, v252, 8, v250
v_add_u32 v250, 0, v252
v_lshlrev_b32 v250, 1, v250
v_xor_b32 v250, v250, v251
v_lshlrev_b32 v250, 4, v250
v_lshl_add_u32 v228, v252, 8, v250
v_add_u32 v250, 4, v252
v_lshlrev_b32 v250, 1, v250
v_xor_b32 v250, v250, v251
v_lshlrev_b32 v250, 4, v250
v_lshl_add_u32 v229, v252, 8, v250
v_mov_b32 v246, 0
v_mov_b32 v248, 1
buffer_load_dword v247, v246, s[76:79], 0 offen sc1
s_waitcnt vmcnt(0)
s_cmp_lg_u32 s40, 0
s_cbranch_scc1 L_lk_i0
s_mov_b32 s58, 0
L_lc_i0:
v_and_b32 v252, 0xffff, v247
v_cmp_ge_u32 vcc, v252, v248
s_nop 3
s_cmp_eq_u64 vcc, -1
s_cbranch_scc1 L_lk_i0
s_add_u32 s58, s58, 1
s_cmp_ge_u32 s58, 65536
s_cbranch_scc1 L_lk_i0
s_sleep 8
buffer_load_dword v247, v246, s[76:79], 0 offen sc1
s_waitcnt vmcnt(0)
s_branch L_lc_i0
L_lk_i0:
s_barrier
s_sub_u32 s20, s2, 192
s_cmp_ge_u32 s20, 32
s_cbranch_scc1 K1_cs3
s_mov_b32 s4, s62
s_mov_b32 s5, s63
s_mov_b32 s6, 0x480000
s_mov_b32 s7, 0x20000
s_mov_b32 s21, 8192
s_lshl_b32 s22, s20, 8
s_lshl_b32 s23, s20, 9
s_add_u32 s23, s23, 0x8000
s_mov_b32 s25, 16
s_lshr_b32 s28, s20, 1
s_add_u32 s28, s28, 32
s_branch K1_csgo
K1_cs3:
s_mov_b32 s4, s64
s_mov_b32 s5, s65
s_mov_b32 s6, 0x510000
s_mov_b32 s7, 0x20000
s_sub_u32 s20, s20, 32
s_mov_b32 s21, 9216
s_mul_i32 s22, s20, 288
s_mul_i32 s23, s20, 576
s_add_u32 s23, s23, 0xc000
s_mov_b32 s25, 18
s_add_u32 s28, s20, 48
K1_csgo:
s_cmp_eq_u32 s25, 16
s_cselect_b32 s26, 16, 14
s_mov_b32 s27, 0xe38e38f
s_cselect_b32 s27, 0x10000000, s27
v_mul_hi_u32 v2, s27, v0
v_mul_lo_u32 v1, s25, v2
v_sub_u32 v1, v0, v1
v_mul_lo_u32 v3, s21, v2
v_lshl_add_u32 v3, v1, 4, v3
s_mul_i32 s24, s21, s26
v_mov_b32 v4, 0x70000000
v_cmp_gt_u32 vcc, s26, v2
s_nop 1
v_cndmask_b32 v3, v4, v3
v_mov_b32 v8, 0
v_mov_b32 v9, 0
v_mov_b32 v10, 0
v_mov_b32 v11, 0
v_mov_b32 v12, 0
v_mov_b32 v13, 0
v_mov_b32 v14, 0
v_mov_b32 v15, 0
buffer_load_dwordx4 a[0:3], v3, s[4:7], s22 offen
s_add_u32 s22, s22, s24
buffer_load_dwordx4 a[4:7], v3, s[4:7], s22 offen
s_add_u32 s22, s22, s24
buffer_load_dwordx4 a[8:11], v3, s[4:7], s22 offen
s_add_u32 s22, s22, s24
buffer_load_dwordx4 a[12:15], v3, s[4:7], s22 offen
s_add_u32 s22, s22, s24
buffer_load_dwordx4 a[16:19], v3, s[4:7], s22 offen
s_add_u32 s22, s22, s24
buffer_load_dwordx4 a[20:23], v3, s[4:7], s22 offen
s_add_u32 s22, s22, s24
buffer_load_dwordx4 a[24:27], v3, s[4:7], s22 offen
s_add_u32 s22, s22, s24
buffer_load_dwordx4 a[28:31], v3, s[4:7], s22 offen
s_add_u32 s22, s22, s24
buffer_load_dwordx4 a[32:35], v3, s[4:7], s22 offen
s_add_u32 s22, s22, s24
buffer_load_dwordx4 a[36:39], v3, s[4:7], s22 offen
s_add_u32 s22, s22, s24
v_mov_b32 v246, 0
buffer_load_dword v247, v246, s[76:79], 0 offen sc1
s_waitcnt vmcnt(10)
buffer_load_dwordx4 a[40:43], v3, s[4:7], s22 offen
s_add_u32 s22, s22, s24
v_accvgpr_read_b32 v4, a0
v_lshlrev_b32 v6, 16, v4
v_and_b32 v7, 0xffff0000, v4
v_pk_add_f32 v[8:9], v[8:9], v[6:7]
v_accvgpr_read_b32 v4, a1
v_lshlrev_b32 v6, 16, v4
v_and_b32 v7, 0xffff0000, v4
v_pk_add_f32 v[10:11], v[10:11], v[6:7]
v_accvgpr_read_b32 v4, a2
v_lshlrev_b32 v6, 16, v4
v_and_b32 v7, 0xffff0000, v4
v_pk_add_f32 v[12:13], v[12:13], v[6:7]
v_accvgpr_read_b32 v4, a3
v_lshlrev_b32 v6, 16, v4
v_and_b32 v7, 0xffff0000, v4
v_pk_add_f32 v[14:15], v[14:15], v[6:7]
s_waitcnt vmcnt(10)
buffer_load_dwordx4 a[44:47], v3, s[4:7], s22 offen
s_add_u32 s22, s22, s24
v_accvgpr_read_b32 v4, a4
v_lshlrev_b32 v6, 16, v4
v_and_b32 v7, 0xffff0000, v4
v_pk_add_f32 v[8:9], v[8:9], v[6:7]
v_accvgpr_read_b32 v4, a5
v_lshlrev_b32 v6, 16, v4
v_and_b32 v7, 0xffff0000, v4
v_pk_add_f32 v[10:11], v[10:11], v[6:7]
v_accvgpr_read_b32 v4, a6
v_lshlrev_b32 v6, 16, v4
v_and_b32 v7, 0xffff0000, v4
v_pk_add_f32 v[12:13], v[12:13], v[6:7]
v_accvgpr_read_b32 v4, a7
v_lshlrev_b32 v6, 16, v4
v_and_b32 v7, 0xffff0000, v4
v_pk_add_f32 v[14:15], v[14:15], v[6:7]
s_waitcnt vmcnt(10)
buffer_load_dwordx4 a[48:51], v3, s[4:7], s22 offen
s_add_u32 s22, s22, s24
v_accvgpr_read_b32 v4, a8
v_lshlrev_b32 v6, 16, v4
v_and_b32 v7, 0xffff0000, v4
v_pk_add_f32 v[8:9], v[8:9], v[6:7]
v_accvgpr_read_b32 v4, a9
v_lshlrev_b32 v6, 16, v4
v_and_b32 v7, 0xffff0000, v4
v_pk_add_f32 v[10:11], v[10:11], v[6:7]
v_accvgpr_read_b32 v4, a10
v_lshlrev_b32 v6, 16, v4
v_and_b32 v7, 0xffff0000, v4
v_pk_add_f32 v[12:13], v[12:13], v[6:7]
v_accvgpr_read_b32 v4, a11
v_lshlrev_b32 v6, 16, v4
v_and_b32 v7, 0xffff0000, v4
v_pk_add_f32 v[14:15], v[14:15], v[6:7]
s_waitcnt vmcnt(10)
buffer_load_dwordx4 a[52:55], v3, s[4:7], s22 offen
s_add_u32 s22, s22, s24
v_accvgpr_read_b32 v4, a12
v_lshlrev_b32 v6, 16, v4
v_and_b32 v7, 0xffff0000, v4
v_pk_add_f32 v[8:9], v[8:9], v[6:7]
v_accvgpr_read_b32 v4, a13
v_lshlrev_b32 v6, 16, v4
v_and_b32 v7, 0xffff0000, v4
v_pk_add_f32 v[10:11], v[10:11], v[6:7]
v_accvgpr_read_b32 v4, a14
v_lshlrev_b32 v6, 16, v4
v_and_b32 v7, 0xffff0000, v4
v_pk_add_f32 v[12:13], v[12:13], v[6:7]
v_accvgpr_read_b32 v4, a15
v_lshlrev_b32 v6, 16, v4
v_and_b32 v7, 0xffff0000, v4
v_pk_add_f32 v[14:15], v[14:15], v[6:7]
s_waitcnt vmcnt(10)
buffer_load_dwordx4 a[56:59], v3, s[4:7], s22 offen
s_add_u32 s22, s22, s24
v_accvgpr_read_b32 v4, a16
v_lshlrev_b32 v6, 16, v4
v_and_b32 v7, 0xffff0000, v4
v_pk_add_f32 v[8:9], v[8:9], v[6:7]
v_accvgpr_read_b32 v4, a17
v_lshlrev_b32 v6, 16, v4
v_and_b32 v7, 0xffff0000, v4
v_pk_add_f32 v[10:11], v[10:11], v[6:7]
v_accvgpr_read_b32 v4, a18
v_lshlrev_b32 v6, 16, v4
v_and_b32 v7, 0xffff0000, v4
v_pk_add_f32 v[12:13], v[12:13], v[6:7]
v_accvgpr_read_b32 v4, a19
v_lshlrev_b32 v6, 16, v4
v_and_b32 v7, 0xffff0000, v4
v_pk_add_f32 v[14:15], v[14:15], v[6:7]
s_waitcnt vmcnt(10)
buffer_load_dwordx4 a[60:63], v3, s[4:7], s22 offen
s_add_u32 s22, s22, s24
v_accvgpr_read_b32 v4, a20
v_lshlrev_b32 v6, 16, v4
v_and_b32 v7, 0xffff0000, v4
v_pk_add_f32 v[8:9], v[8:9], v[6:7]
v_accvgpr_read_b32 v4, a21
v_lshlrev_b32 v6, 16, v4
v_and_b32 v7, 0xffff0000, v4
v_pk_add_f32 v[10:11], v[10:11], v[6:7]
v_accvgpr_read_b32 v4, a22
v_lshlrev_b32 v6, 16, v4
v_and_b32 v7, 0xffff0000, v4
v_pk_add_f32 v[12:13], v[12:13], v[6:7]
v_accvgpr_read_b32 v4, a23
v_lshlrev_b32 v6, 16, v4
v_and_b32 v7, 0xffff0000, v4
v_pk_add_f32 v[14:15], v[14:15], v[6:7]
s_waitcnt vmcnt(10)
buffer_load_dwordx4 a[64:67], v3, s[4:7], s22 offen
s_add_u32 s22, s22, s24
v_accvgpr_read_b32 v4, a24
v_lshlrev_b32 v6, 16, v4
v_and_b32 v7, 0xffff0000, v4
v_pk_add_f32 v[8:9], v[8:9], v[6:7]
v_accvgpr_read_b32 v4, a25
v_lshlrev_b32 v6, 16, v4
v_and_b32 v7, 0xffff0000, v4
v_pk_add_f32 v[10:11], v[10:11], v[6:7]
v_accvgpr_read_b32 v4, a26
v_lshlrev_b32 v6, 16, v4
v_and_b32 v7, 0xffff0000, v4
v_pk_add_f32 v[12:13], v[12:13], v[6:7]
v_accvgpr_read_b32 v4, a27
v_lshlrev_b32 v6, 16, v4
v_and_b32 v7, 0xffff0000, v4
v_pk_add_f32 v[14:15], v[14:15], v[6:7]
s_waitcnt vmcnt(10)
buffer_load_dwordx4 a[68:71], v3, s[4:7], s22 offen
s_add_u32 s22, s22, s24
v_accvgpr_read_b32 v4, a28
v_lshlrev_b32 v6, 16, v4
v_and_b32 v7, 0xffff0000, v4
v_pk_add_f32 v[8:9], v[8:9], v[6:7]
v_accvgpr_read_b32 v4, a29
v_lshlrev_b32 v6, 16, v4
v_and_b32 v7, 0xffff0000, v4
v_pk_add_f32 v[10:11], v[10:11], v[6:7]
v_accvgpr_read_b32 v4, a30
v_lshlrev_b32 v6, 16, v4
v_and_b32 v7, 0xffff0000, v4
v_pk_add_f32 v[12:13], v[12:13], v[6:7]
v_accvgpr_read_b32 v4, a31
v_lshlrev_b32 v6, 16, v4
v_and_b32 v7, 0xffff0000, v4
v_pk_add_f32 v[14:15], v[14:15], v[6:7]
s_waitcnt vmcnt(10)
buffer_load_dwordx4 a[72:75], v3, s[4:7], s22 offen
s_add_u32 s22, s22, s24
v_accvgpr_read_b32 v4, a32
v_lshlrev_b32 v6, 16, v4
v_and_b32 v7, 0xffff0000, v4
v_pk_add_f32 v[8:9], v[8:9], v[6:7]
v_accvgpr_read_b32 v4, a33
v_lshlrev_b32 v6, 16, v4
v_and_b32 v7, 0xffff0000, v4
v_pk_add_f32 v[10:11], v[10:11], v[6:7]
v_accvgpr_read_b32 v4, a34
v_lshlrev_b32 v6, 16, v4
v_and_b32 v7, 0xffff0000, v4
v_pk_add_f32 v[12:13], v[12:13], v[6:7]
v_accvgpr_read_b32 v4, a35
v_lshlrev_b32 v6, 16, v4
v_and_b32 v7, 0xffff0000, v4
v_pk_add_f32 v[14:15], v[14:15], v[6:7]
s_waitcnt vmcnt(10)
buffer_load_dwordx4 a[76:79], v3, s[4:7], s22 offen
s_add_u32 s22, s22, s24
v_accvgpr_read_b32 v4, a36
v_lshlrev_b32 v6, 16, v4
v_and_b32 v7, 0xffff0000, v4
v_pk_add_f32 v[8:9], v[8:9], v[6:7]
v_accvgpr_read_b32 v4, a37
v_lshlrev_b32 v6, 16, v4
v_and_b32 v7, 0xffff0000, v4
v_pk_add_f32 v[10:11], v[10:11], v[6:7]
v_accvgpr_read_b32 v4, a38
v_lshlrev_b32 v6, 16, v4
v_and_b32 v7, 0xffff0000, v4
v_pk_add_f32 v[12:13], v[12:13], v[6:7]
v_accvgpr_read_b32 v4, a39
v_lshlrev_b32 v6, 16, v4
v_and_b32 v7, 0xffff0000, v4
v_pk_add_f32 v[14:15], v[14:15], v[6:7]
s_waitcnt vmcnt(9)
buffer_load_dwordx4 a[80:83], v3, s[4:7], s22 offen
s_add_u32 s22, s22, s24
v_accvgpr_read_b32 v4, a40
v_lshlrev_b32 v6, 16, v4
v_and_b32 v7, 0xffff0000, v4
v_pk_add_f32 v[8:9], v[8:9], v[6:7]
v_accvgpr_read_b32 v4, a41
v_lshlrev_b32 v6, 16, v4
v_and_b32 v7, 0xffff0000, v4
v_pk_add_f32 v[10:11], v[10:11], v[6:7]
v_accvgpr_read_b32 v4, a42
v_lshlrev_b32 v6, 16, v4
v_and_b32 v7, 0xffff0000, v4
v_pk_add_f32 v[12:13], v[12:13], v[6:7]
v_accvgpr_read_b32 v4, a43
v_lshlrev_b32 v6, 16, v4
v_and_b32 v7, 0xffff0000, v4
v_pk_add_f32 v[14:15], v[14:15], v[6:7]
s_waitcnt vmcnt(9)
buffer_load_dwordx4 a[84:87], v3, s[4:7], s22 offen
s_add_u32 s22, s22, s24
v_accvgpr_read_b32 v4, a44
v_lshlrev_b32 v6, 16, v4
v_and_b32 v7, 0xffff0000, v4
v_pk_add_f32 v[8:9], v[8:9], v[6:7]
v_accvgpr_read_b32 v4, a45
v_lshlrev_b32 v6, 16, v4
v_and_b32 v7, 0xffff0000, v4
v_pk_add_f32 v[10:11], v[10:11], v[6:7]
v_accvgpr_read_b32 v4, a46
v_lshlrev_b32 v6, 16, v4
v_and_b32 v7, 0xffff0000, v4
v_pk_add_f32 v[12:13], v[12:13], v[6:7]
v_accvgpr_read_b32 v4, a47
v_lshlrev_b32 v6, 16, v4
v_and_b32 v7, 0xffff0000, v4
v_pk_add_f32 v[14:15], v[14:15], v[6:7]
s_waitcnt vmcnt(9)
buffer_load_dwordx4 a[88:91], v3, s[4:7], s22 offen
s_add_u32 s22, s22, s24
v_accvgpr_read_b32 v4, a48
v_lshlrev_b32 v6, 16, v4
v_and_b32 v7, 0xffff0000, v4
v_pk_add_f32 v[8:9], v[8:9], v[6:7]
v_accvgpr_read_b32 v4, a49
v_lshlrev_b32 v6, 16, v4
v_and_b32 v7, 0xffff0000, v4
v_pk_add_f32 v[10:11], v[10:11], v[6:7]
v_accvgpr_read_b32 v4, a50
v_lshlrev_b32 v6, 16, v4
v_and_b32 v7, 0xffff0000, v4
v_pk_add_f32 v[12:13], v[12:13], v[6:7]
v_accvgpr_read_b32 v4, a51
v_lshlrev_b32 v6, 16, v4
v_and_b32 v7, 0xffff0000, v4
v_pk_add_f32 v[14:15], v[14:15], v[6:7]
s_waitcnt vmcnt(9)
buffer_load_dwordx4 a[92:95], v3, s[4:7], s22 offen
s_add_u32 s22, s22, s24
v_accvgpr_read_b32 v4, a52
v_lshlrev_b32 v6, 16, v4
v_and_b32 v7, 0xffff0000, v4
v_pk_add_f32 v[8:9], v[8:9], v[6:7]
v_accvgpr_read_b32 v4, a53
v_lshlrev_b32 v6, 16, v4
v_and_b32 v7, 0xffff0000, v4
v_pk_add_f32 v[10:11], v[10:11], v[6:7]
v_accvgpr_read_b32 v4, a54
v_lshlrev_b32 v6, 16, v4
v_and_b32 v7, 0xffff0000, v4
v_pk_add_f32 v[12:13], v[12:13], v[6:7]
v_accvgpr_read_b32 v4, a55
v_lshlrev_b32 v6, 16, v4
v_and_b32 v7, 0xffff0000, v4
v_pk_add_f32 v[14:15], v[14:15], v[6:7]
s_waitcnt vmcnt(9)
buffer_load_dwordx4 a[96:99], v3, s[4:7], s22 offen
s_add_u32 s22, s22, s24
v_accvgpr_read_b32 v4, a56
v_lshlrev_b32 v6, 16, v4
v_and_b32 v7, 0xffff0000, v4
v_pk_add_f32 v[8:9], v[8:9], v[6:7]
v_accvgpr_read_b32 v4, a57
v_lshlrev_b32 v6, 16, v4
v_and_b32 v7, 0xffff0000, v4
v_pk_add_f32 v[10:11], v[10:11], v[6:7]
v_accvgpr_read_b32 v4, a58
v_lshlrev_b32 v6, 16, v4
v_and_b32 v7, 0xffff0000, v4
v_pk_add_f32 v[12:13], v[12:13], v[6:7]
v_accvgpr_read_b32 v4, a59
v_lshlrev_b32 v6, 16, v4
v_and_b32 v7, 0xffff0000, v4
v_pk_add_f32 v[14:15], v[14:15], v[6:7]
s_waitcnt vmcnt(9)
buffer_load_dwordx4 a[100:103], v3, s[4:7], s22 offen
s_add_u32 s22, s22, s24
v_accvgpr_read_b32 v4, a60
v_lshlrev_b32 v6, 16, v4
v_and_b32 v7, 0xffff0000, v4
v_pk_add_f32 v[8:9], v[8:9], v[6:7]
v_accvgpr_read_b32 v4, a61
v_lshlrev_b32 v6, 16, v4
v_and_b32 v7, 0xffff0000, v4
v_pk_add_f32 v[10:11], v[10:11], v[6:7]
v_accvgpr_read_b32 v4, a62
v_lshlrev_b32 v6, 16, v4
v_and_b32 v7, 0xffff0000, v4
v_pk_add_f32 v[12:13], v[12:13], v[6:7]
v_accvgpr_read_b32 v4, a63
v_lshlrev_b32 v6, 16, v4
v_and_b32 v7, 0xffff0000, v4
v_pk_add_f32 v[14:15], v[14:15], v[6:7]
s_waitcnt vmcnt(9)
buffer_load_dwordx4 a[104:107], v3, s[4:7], s22 offen
s_add_u32 s22, s22, s24
v_accvgpr_read_b32 v4, a64
v_lshlrev_b32 v6, 16, v4
v_and_b32 v7, 0xffff0000, v4
v_pk_add_f32 v[8:9], v[8:9], v[6:7]
v_accvgpr_read_b32 v4, a65
v_lshlrev_b32 v6, 16, v4
v_and_b32 v7, 0xffff0000, v4
v_pk_add_f32 v[10:11], v[10:11], v[6:7]
v_accvgpr_read_b32 v4, a66
v_lshlrev_b32 v6, 16, v4
v_and_b32 v7, 0xffff0000, v4
v_pk_add_f32 v[12:13], v[12:13], v[6:7]
v_accvgpr_read_b32 v4, a67
v_lshlrev_b32 v6, 16, v4
v_and_b32 v7, 0xffff0000, v4
v_pk_add_f32 v[14:15], v[14:15], v[6:7]
s_waitcnt vmcnt(9)
buffer_load_dwordx4 a[108:111], v3, s[4:7], s22 offen
s_add_u32 s22, s22, s24
v_accvgpr_read_b32 v4, a68
v_lshlrev_b32 v6, 16, v4
v_and_b32 v7, 0xffff0000, v4
v_pk_add_f32 v[8:9], v[8:9], v[6:7]
v_accvgpr_read_b32 v4, a69
v_lshlrev_b32 v6, 16, v4
v_and_b32 v7, 0xffff0000, v4
v_pk_add_f32 v[10:11], v[10:11], v[6:7]
v_accvgpr_read_b32 v4, a70
v_lshlrev_b32 v6, 16, v4
v_and_b32 v7, 0xffff0000, v4
v_pk_add_f32 v[12:13], v[12:13], v[6:7]
v_accvgpr_read_b32 v4, a71
v_lshlrev_b32 v6, 16, v4
v_and_b32 v7, 0xffff0000, v4
v_pk_add_f32 v[14:15], v[14:15], v[6:7]
s_waitcnt vmcnt(9)
buffer_load_dwordx4 a[112:115], v3, s[4:7], s22 offen
s_add_u32 s22, s22, s24
v_accvgpr_read_b32 v4, a72
v_lshlrev_b32 v6, 16, v4
v_and_b32 v7, 0xffff0000, v4
v_pk_add_f32 v[8:9], v[8:9], v[6:7]
v_accvgpr_read_b32 v4, a73
v_lshlrev_b32 v6, 16, v4
v_and_b32 v7, 0xffff0000, v4
v_pk_add_f32 v[10:11], v[10:11], v[6:7]
v_accvgpr_read_b32 v4, a74
v_lshlrev_b32 v6, 16, v4
v_and_b32 v7, 0xffff0000, v4
v_pk_add_f32 v[12:13], v[12:13], v[6:7]
v_accvgpr_read_b32 v4, a75
v_lshlrev_b32 v6, 16, v4
v_and_b32 v7, 0xffff0000, v4
v_pk_add_f32 v[14:15], v[14:15], v[6:7]
s_waitcnt vmcnt(9)
buffer_load_dwordx4 a[116:119], v3, s[4:7], s22 offen
s_add_u32 s22, s22, s24
v_accvgpr_read_b32 v4, a76
v_lshlrev_b32 v6, 16, v4
v_and_b32 v7, 0xffff0000, v4
v_pk_add_f32 v[8:9], v[8:9], v[6:7]
v_accvgpr_read_b32 v4, a77
v_lshlrev_b32 v6, 16, v4
v_and_b32 v7, 0xffff0000, v4
v_pk_add_f32 v[10:11], v[10:11], v[6:7]
v_accvgpr_read_b32 v4, a78
v_lshlrev_b32 v6, 16, v4
v_and_b32 v7, 0xffff0000, v4
v_pk_add_f32 v[12:13], v[12:13], v[6:7]
v_accvgpr_read_b32 v4, a79
v_lshlrev_b32 v6, 16, v4
v_and_b32 v7, 0xffff0000, v4
v_pk_add_f32 v[14:15], v[14:15], v[6:7]
s_waitcnt vmcnt(9)
buffer_load_dwordx4 a[120:123], v3, s[4:7], s22 offen
s_add_u32 s22, s22, s24
v_accvgpr_read_b32 v4, a80
v_lshlrev_b32 v6, 16, v4
v_and_b32 v7, 0xffff0000, v4
v_pk_add_f32 v[8:9], v[8:9], v[6:7]
v_accvgpr_read_b32 v4, a81
v_lshlrev_b32 v6, 16, v4
v_and_b32 v7, 0xffff0000, v4
v_pk_add_f32 v[10:11], v[10:11], v[6:7]
v_accvgpr_read_b32 v4, a82
v_lshlrev_b32 v6, 16, v4
v_and_b32 v7, 0xffff0000, v4
v_pk_add_f32 v[12:13], v[12:13], v[6:7]
v_accvgpr_read_b32 v4, a83
v_lshlrev_b32 v6, 16, v4
v_and_b32 v7, 0xffff0000, v4
v_pk_add_f32 v[14:15], v[14:15], v[6:7]
s_waitcnt vmcnt(9)
buffer_load_dwordx4 a[124:127], v3, s[4:7], s22 offen
s_add_u32 s22, s22, s24
v_accvgpr_read_b32 v4, a84
v_lshlrev_b32 v6, 16, v4
v_and_b32 v7, 0xffff0000, v4
v_pk_add_f32 v[8:9], v[8:9], v[6:7]
v_accvgpr_read_b32 v4, a85
v_lshlrev_b32 v6, 16, v4
v_and_b32 v7, 0xffff0000, v4
v_pk_add_f32 v[10:11], v[10:11], v[6:7]
v_accvgpr_read_b32 v4, a86
v_lshlrev_b32 v6, 16, v4
v_and_b32 v7, 0xffff0000, v4
v_pk_add_f32 v[12:13], v[12:13], v[6:7]
v_accvgpr_read_b32 v4, a87
v_lshlrev_b32 v6, 16, v4
v_and_b32 v7, 0xffff0000, v4
v_pk_add_f32 v[14:15], v[14:15], v[6:7]
s_waitcnt vmcnt(9)
buffer_load_dwordx4 a[128:131], v3, s[4:7], s22 offen
s_add_u32 s22, s22, s24
v_accvgpr_read_b32 v4, a88
v_lshlrev_b32 v6, 16, v4
v_and_b32 v7, 0xffff0000, v4
v_pk_add_f32 v[8:9], v[8:9], v[6:7]
v_accvgpr_read_b32 v4, a89
v_lshlrev_b32 v6, 16, v4
v_and_b32 v7, 0xffff0000, v4
v_pk_add_f32 v[10:11], v[10:11], v[6:7]
v_accvgpr_read_b32 v4, a90
v_lshlrev_b32 v6, 16, v4
v_and_b32 v7, 0xffff0000, v4
v_pk_add_f32 v[12:13], v[12:13], v[6:7]
v_accvgpr_read_b32 v4, a91
v_lshlrev_b32 v6, 16, v4
v_and_b32 v7, 0xffff0000, v4
v_pk_add_f32 v[14:15], v[14:15], v[6:7]
s_waitcnt vmcnt(9)
buffer_load_dwordx4 a[132:135], v3, s[4:7], s22 offen
s_add_u32 s22, s22, s24
v_accvgpr_read_b32 v4, a92
v_lshlrev_b32 v6, 16, v4
v_and_b32 v7, 0xffff0000, v4
v_pk_add_f32 v[8:9], v[8:9], v[6:7]
v_accvgpr_read_b32 v4, a93
v_lshlrev_b32 v6, 16, v4
v_and_b32 v7, 0xffff0000, v4
v_pk_add_f32 v[10:11], v[10:11], v[6:7]
v_accvgpr_read_b32 v4, a94
v_lshlrev_b32 v6, 16, v4
v_and_b32 v7, 0xffff0000, v4
v_pk_add_f32 v[12:13], v[12:13], v[6:7]
v_accvgpr_read_b32 v4, a95
v_lshlrev_b32 v6, 16, v4
v_and_b32 v7, 0xffff0000, v4
v_pk_add_f32 v[14:15], v[14:15], v[6:7]
s_waitcnt vmcnt(9)
buffer_load_dwordx4 a[136:139], v3, s[4:7], s22 offen
s_add_u32 s22, s22, s24
v_accvgpr_read_b32 v4, a96
v_lshlrev_b32 v6, 16, v4
v_and_b32 v7, 0xffff0000, v4
v_pk_add_f32 v[8:9], v[8:9], v[6:7]
v_accvgpr_read_b32 v4, a97
v_lshlrev_b32 v6, 16, v4
v_and_b32 v7, 0xffff0000, v4
v_pk_add_f32 v[10:11], v[10:11], v[6:7]
v_accvgpr_read_b32 v4, a98
v_lshlrev_b32 v6, 16, v4
v_and_b32 v7, 0xffff0000, v4
v_pk_add_f32 v[12:13], v[12:13], v[6:7]
v_accvgpr_read_b32 v4, a99
v_lshlrev_b32 v6, 16, v4
v_and_b32 v7, 0xffff0000, v4
v_pk_add_f32 v[14:15], v[14:15], v[6:7]
s_waitcnt vmcnt(9)
buffer_load_dwordx4 a[140:143], v3, s[4:7], s22 offen
s_add_u32 s22, s22, s24
v_accvgpr_read_b32 v4, a100
v_lshlrev_b32 v6, 16, v4
v_and_b32 v7, 0xffff0000, v4
v_pk_add_f32 v[8:9], v[8:9], v[6:7]
v_accvgpr_read_b32 v4, a101
v_lshlrev_b32 v6, 16, v4
v_and_b32 v7, 0xffff0000, v4
v_pk_add_f32 v[10:11], v[10:11], v[6:7]
v_accvgpr_read_b32 v4, a102
v_lshlrev_b32 v6, 16, v4
v_and_b32 v7, 0xffff0000, v4
v_pk_add_f32 v[12:13], v[12:13], v[6:7]
v_accvgpr_read_b32 v4, a103
v_lshlrev_b32 v6, 16, v4
v_and_b32 v7, 0xffff0000, v4
v_pk_add_f32 v[14:15], v[14:15], v[6:7]
s_waitcnt vmcnt(9)
buffer_load_dwordx4 v[60:63], v3, s[4:7], s22 offen
s_add_u32 s22, s22, s24
v_accvgpr_read_b32 v4, a104
v_lshlrev_b32 v6, 16, v4
v_and_b32 v7, 0xffff0000, v4
v_pk_add_f32 v[8:9], v[8:9], v[6:7]
v_accvgpr_read_b32 v4, a105
v_lshlrev_b32 v6, 16, v4
v_and_b32 v7, 0xffff0000, v4
v_pk_add_f32 v[10:11], v[10:11], v[6:7]
v_accvgpr_read_b32 v4, a106
v_lshlrev_b32 v6, 16, v4
v_and_b32 v7, 0xffff0000, v4
v_pk_add_f32 v[12:13], v[12:13], v[6:7]
v_accvgpr_read_b32 v4, a107
v_lshlrev_b32 v6, 16, v4
v_and_b32 v7, 0xffff0000, v4
v_pk_add_f32 v[14:15], v[14:15], v[6:7]
s_waitcnt vmcnt(9)
buffer_load_dwordx4 v[64:67], v3, s[4:7], s22 offen
s_add_u32 s22, s22, s24
v_accvgpr_read_b32 v4, a108
v_lshlrev_b32 v6, 16, v4
v_and_b32 v7, 0xffff0000, v4
v_pk_add_f32 v[8:9], v[8:9], v[6:7]
v_accvgpr_read_b32 v4, a109
v_lshlrev_b32 v6, 16, v4
v_and_b32 v7, 0xffff0000, v4
v_pk_add_f32 v[10:11], v[10:11], v[6:7]
v_accvgpr_read_b32 v4, a110
v_lshlrev_b32 v6, 16, v4
v_and_b32 v7, 0xffff0000, v4
v_pk_add_f32 v[12:13], v[12:13], v[6:7]
v_accvgpr_read_b32 v4, a111
v_lshlrev_b32 v6, 16, v4
v_and_b32 v7, 0xffff0000, v4
v_pk_add_f32 v[14:15], v[14:15], v[6:7]
s_waitcnt vmcnt(9)
buffer_load_dwordx4 v[68:71], v3, s[4:7], s22 offen
s_add_u32 s22, s22, s24
v_accvgpr_read_b32 v4, a112
v_lshlrev_b32 v6, 16, v4
v_and_b32 v7, 0xffff0000, v4
v_pk_add_f32 v[8:9], v[8:9], v[6:7]
v_accvgpr_read_b32 v4, a113
v_lshlrev_b32 v6, 16, v4
v_and_b32 v7, 0xffff0000, v4
v_pk_add_f32 v[10:11], v[10:11], v[6:7]
v_accvgpr_read_b32 v4, a114
v_lshlrev_b32 v6, 16, v4
v_and_b32 v7, 0xffff0000, v4
v_pk_add_f32 v[12:13], v[12:13], v[6:7]
v_accvgpr_read_b32 v4, a115
v_lshlrev_b32 v6, 16, v4
v_and_b32 v7, 0xffff0000, v4
v_pk_add_f32 v[14:15], v[14:15], v[6:7]
s_waitcnt vmcnt(9)
buffer_load_dwordx4 v[72:75], v3, s[4:7], s22 offen
s_add_u32 s22, s22, s24
v_accvgpr_read_b32 v4, a116
v_lshlrev_b32 v6, 16, v4
v_and_b32 v7, 0xffff0000, v4
v_pk_add_f32 v[8:9], v[8:9], v[6:7]
v_accvgpr_read_b32 v4, a117
v_lshlrev_b32 v6, 16, v4
v_and_b32 v7, 0xffff0000, v4
v_pk_add_f32 v[10:11], v[10:11], v[6:7]
v_accvgpr_read_b32 v4, a118
v_lshlrev_b32 v6, 16, v4
v_and_b32 v7, 0xffff0000, v4
v_pk_add_f32 v[12:13], v[12:13], v[6:7]
v_accvgpr_read_b32 v4, a119
v_lshlrev_b32 v6, 16, v4
v_and_b32 v7, 0xffff0000, v4
v_pk_add_f32 v[14:15], v[14:15], v[6:7]
s_waitcnt vmcnt(9)
buffer_load_dwordx4 v[76:79], v3, s[4:7], s22 offen
s_add_u32 s22, s22, s24
v_accvgpr_read_b32 v4, a120
v_lshlrev_b32 v6, 16, v4
v_and_b32 v7, 0xffff0000, v4
v_pk_add_f32 v[8:9], v[8:9], v[6:7]
v_accvgpr_read_b32 v4, a121
v_lshlrev_b32 v6, 16, v4
v_and_b32 v7, 0xffff0000, v4
v_pk_add_f32 v[10:11], v[10:11], v[6:7]
v_accvgpr_read_b32 v4, a122
v_lshlrev_b32 v6, 16, v4
v_and_b32 v7, 0xffff0000, v4
v_pk_add_f32 v[12:13], v[12:13], v[6:7]
v_accvgpr_read_b32 v4, a123
v_lshlrev_b32 v6, 16, v4
v_and_b32 v7, 0xffff0000, v4
v_pk_add_f32 v[14:15], v[14:15], v[6:7]
s_waitcnt vmcnt(9)
buffer_load_dwordx4 v[80:83], v3, s[4:7], s22 offen
s_add_u32 s22, s22, s24
v_accvgpr_read_b32 v4, a124
v_lshlrev_b32 v6, 16, v4
v_and_b32 v7, 0xffff0000, v4
v_pk_add_f32 v[8:9], v[8:9], v[6:7]
v_accvgpr_read_b32 v4, a125
v_lshlrev_b32 v6, 16, v4
v_and_b32 v7, 0xffff0000, v4
v_pk_add_f32 v[10:11], v[10:11], v[6:7]
v_accvgpr_read_b32 v4, a126
v_lshlrev_b32 v6, 16, v4
v_and_b32 v7, 0xffff0000, v4
v_pk_add_f32 v[12:13], v[12:13], v[6:7]
v_accvgpr_read_b32 v4, a127
v_lshlrev_b32 v6, 16, v4
v_and_b32 v7, 0xffff0000, v4
v_pk_add_f32 v[14:15], v[14:15], v[6:7]
s_waitcnt vmcnt(9)
v_accvgpr_read_b32 v4, a128
v_lshlrev_b32 v6, 16, v4
v_and_b32 v7, 0xffff0000, v4
v_pk_add_f32 v[8:9], v[8:9], v[6:7]
v_accvgpr_read_b32 v4, a129
v_lshlrev_b32 v6, 16, v4
v_and_b32 v7, 0xffff0000, v4
v_pk_add_f32 v[10:11], v[10:11], v[6:7]
v_accvgpr_read_b32 v4, a130
v_lshlrev_b32 v6, 16, v4
v_and_b32 v7, 0xffff0000, v4
v_pk_add_f32 v[12:13], v[12:13], v[6:7]
v_accvgpr_read_b32 v4, a131
v_lshlrev_b32 v6, 16, v4
v_and_b32 v7, 0xffff0000, v4
v_pk_add_f32 v[14:15], v[14:15], v[6:7]
s_waitcnt vmcnt(8)
v_accvgpr_read_b32 v4, a132
v_lshlrev_b32 v6, 16, v4
v_and_b32 v7, 0xffff0000, v4
v_pk_add_f32 v[8:9], v[8:9], v[6:7]
v_accvgpr_read_b32 v4, a133
v_lshlrev_b32 v6, 16, v4
v_and_b32 v7, 0xffff0000, v4
v_pk_add_f32 v[10:11], v[10:11], v[6:7]
v_accvgpr_read_b32 v4, a134
v_lshlrev_b32 v6, 16, v4
v_and_b32 v7, 0xffff0000, v4
v_pk_add_f32 v[12:13], v[12:13], v[6:7]
v_accvgpr_read_b32 v4, a135
v_lshlrev_b32 v6, 16, v4
v_and_b32 v7, 0xffff0000, v4
v_pk_add_f32 v[14:15], v[14:15], v[6:7]
s_waitcnt vmcnt(7)
v_accvgpr_read_b32 v4, a136
v_lshlrev_b32 v6, 16, v4
v_and_b32 v7, 0xffff0000, v4
v_pk_add_f32 v[8:9], v[8:9], v[6:7]
v_accvgpr_read_b32 v4, a137
v_lshlrev_b32 v6, 16, v4
v_and_b32 v7, 0xffff0000, v4
v_pk_add_f32 v[10:11], v[10:11], v[6:7]
v_accvgpr_read_b32 v4, a138
v_lshlrev_b32 v6, 16, v4
v_and_b32 v7, 0xffff0000, v4
v_pk_add_f32 v[12:13], v[12:13], v[6:7]
v_accvgpr_read_b32 v4, a139
v_lshlrev_b32 v6, 16, v4
v_and_b32 v7, 0xffff0000, v4
v_pk_add_f32 v[14:15], v[14:15], v[6:7]
s_waitcnt vmcnt(6)
v_accvgpr_read_b32 v4, a140
v_lshlrev_b32 v6, 16, v4
v_and_b32 v7, 0xffff0000, v4
v_pk_add_f32 v[8:9], v[8:9], v[6:7]
v_accvgpr_read_b32 v4, a141
v_lshlrev_b32 v6, 16, v4
v_and_b32 v7, 0xffff0000, v4
v_pk_add_f32 v[10:11], v[10:11], v[6:7]
v_accvgpr_read_b32 v4, a142
v_lshlrev_b32 v6, 16, v4
v_and_b32 v7, 0xffff0000, v4
v_pk_add_f32 v[12:13], v[12:13], v[6:7]
v_accvgpr_read_b32 v4, a143
v_lshlrev_b32 v6, 16, v4
v_and_b32 v7, 0xffff0000, v4
v_pk_add_f32 v[14:15], v[14:15], v[6:7]
s_waitcnt vmcnt(5)
v_mov_b32 v4, v60
v_lshlrev_b32 v6, 16, v4
v_and_b32 v7, 0xffff0000, v4
v_pk_add_f32 v[8:9], v[8:9], v[6:7]
v_mov_b32 v4, v61
v_lshlrev_b32 v6, 16, v4
v_and_b32 v7, 0xffff0000, v4
v_pk_add_f32 v[10:11], v[10:11], v[6:7]
v_mov_b32 v4, v62
v_lshlrev_b32 v6, 16, v4
v_and_b32 v7, 0xffff0000, v4
v_pk_add_f32 v[12:13], v[12:13], v[6:7]
v_mov_b32 v4, v63
v_lshlrev_b32 v6, 16, v4
v_and_b32 v7, 0xffff0000, v4
v_pk_add_f32 v[14:15], v[14:15], v[6:7]
s_waitcnt vmcnt(4)
v_mov_b32 v4, v64
v_lshlrev_b32 v6, 16, v4
v_and_b32 v7, 0xffff0000, v4
v_pk_add_f32 v[8:9], v[8:9], v[6:7]
v_mov_b32 v4, v65
v_lshlrev_b32 v6, 16, v4
v_and_b32 v7, 0xffff0000, v4
v_pk_add_f32 v[10:11], v[10:11], v[6:7]
v_mov_b32 v4, v66
v_lshlrev_b32 v6, 16, v4
v_and_b32 v7, 0xffff0000, v4
v_pk_add_f32 v[12:13], v[12:13], v[6:7]
v_mov_b32 v4, v67
v_lshlrev_b32 v6, 16, v4
v_and_b32 v7, 0xffff0000, v4
v_pk_add_f32 v[14:15], v[14:15], v[6:7]
s_waitcnt vmcnt(3)
v_mov_b32 v4, v68
v_lshlrev_b32 v6, 16, v4
v_and_b32 v7, 0xffff0000, v4
v_pk_add_f32 v[8:9], v[8:9], v[6:7]
v_mov_b32 v4, v69
v_lshlrev_b32 v6, 16, v4
v_and_b32 v7, 0xffff0000, v4
v_pk_add_f32 v[10:11], v[10:11], v[6:7]
v_mov_b32 v4, v70
v_lshlrev_b32 v6, 16, v4
v_and_b32 v7, 0xffff0000, v4
v_pk_add_f32 v[12:13], v[12:13], v[6:7]
v_mov_b32 v4, v71
v_lshlrev_b32 v6, 16, v4
v_and_b32 v7, 0xffff0000, v4
v_pk_add_f32 v[14:15], v[14:15], v[6:7]
s_waitcnt vmcnt(2)
v_mov_b32 v4, v72
v_lshlrev_b32 v6, 16, v4
v_and_b32 v7, 0xffff0000, v4
v_pk_add_f32 v[8:9], v[8:9], v[6:7]
v_mov_b32 v4, v73
v_lshlrev_b32 v6, 16, v4
v_and_b32 v7, 0xffff0000, v4
v_pk_add_f32 v[10:11], v[10:11], v[6:7]
v_mov_b32 v4, v74
v_lshlrev_b32 v6, 16, v4
v_and_b32 v7, 0xffff0000, v4
v_pk_add_f32 v[12:13], v[12:13], v[6:7]
v_mov_b32 v4, v75
v_lshlrev_b32 v6, 16, v4
v_and_b32 v7, 0xffff0000, v4
v_pk_add_f32 v[14:15], v[14:15], v[6:7]
s_waitcnt vmcnt(1)
v_mov_b32 v4, v76
v_lshlrev_b32 v6, 16, v4
v_and_b32 v7, 0xffff0000, v4
v_pk_add_f32 v[8:9], v[8:9], v[6:7]
v_mov_b32 v4, v77
v_lshlrev_b32 v6, 16, v4
v_and_b32 v7, 0xffff0000, v4
v_pk_add_f32 v[10:11], v[10:11], v[6:7]
v_mov_b32 v4, v78
v_lshlrev_b32 v6, 16, v4
v_and_b32 v7, 0xffff0000, v4
v_pk_add_f32 v[12:13], v[12:13], v[6:7]
v_mov_b32 v4, v79
v_lshlrev_b32 v6, 16, v4
v_and_b32 v7, 0xffff0000, v4
v_pk_add_f32 v[14:15], v[14:15], v[6:7]
s_waitcnt vmcnt(0)
v_mov_b32 v4, v80
v_lshlrev_b32 v6, 16, v4
v_and_b32 v7, 0xffff0000, v4
v_pk_add_f32 v[8:9], v[8:9], v[6:7]
v_mov_b32 v4, v81
v_lshlrev_b32 v6, 16, v4
v_and_b32 v7, 0xffff0000, v4
v_pk_add_f32 v[10:11], v[10:11], v[6:7]
v_mov_b32 v4, v82
v_lshlrev_b32 v6, 16, v4
v_and_b32 v7, 0xffff0000, v4
v_pk_add_f32 v[12:13], v[12:13], v[6:7]
v_mov_b32 v4, v83
v_lshlrev_b32 v6, 16, v4
v_and_b32 v7, 0xffff0000, v4
v_pk_add_f32 v[14:15], v[14:15], v[6:7]
v_mul_u32_u24 v4, 576, v2
v_lshl_add_u32 v4, v1, 5, v4
ds_write_b128 v4, v[8:11]
ds_write_b128 v4, v[12:15] offset:16
s_waitcnt lgkmcnt(0)
s_barrier
s_lshl_b32 s25, s25, 3
v_cmp_gt_u32 vcc, s25, v0
s_nop 3
s_and_saveexec_b64 s[56:57], vcc
s_cbranch_execz K1_csd
v_lshlrev_b32 v4, 2, v0
ds_read_b32 v8, v4
ds_read_b32 v9, v4 offset:576
ds_read_b32 v10, v4 offset:1152
ds_read_b32 v11, v4 offset:1728
ds_read_b32 v12, v4 offset:2304
ds_read_b32 v13, v4 offset:2880
ds_read_b32 v14, v4 offset:3456
ds_read_b32 v15, v4 offset:4032
s_waitcnt lgkmcnt(0)
ds_read_b32 v16, v4 offset:4608
ds_read_b32 v17, v4 offset:5184
ds_read_b32 v18, v4 offset:5760
ds_read_b32 v19, v4 offset:6336
ds_read_b32 v20, v4 offset:6912
ds_read_b32 v21, v4 offset:7488
ds_read_b32 v22, v4 offset:8064
ds_read_b32 v23, v4 offset:8640
s_waitcnt lgkmcnt(0)
v_add_f32 v8, v8, v9
v_add_f32 v8, v8, v10
v_add_f32 v8, v8, v11
v_add_f32 v8, v8, v12
v_add_f32 v8, v8, v13
v_add_f32 v8, v8, v14
v_add_f32 v8, v8, v15
v_add_f32 v8, v8, v16
v_add_f32 v8, v8, v17
v_add_f32 v8, v8, v18
v_add_f32 v8, v8, v19
v_add_f32 v8, v8, v20
v_add_f32 v8, v8, v21
s_cmp_eq_u32 s26, 16
s_cbranch_scc0 K1_cs14
v_add_f32 v8, v8, v22
v_add_f32 v8, v8, v23
K1_cs14:
buffer_store_dword v8, v4, s[36:39], s23 offen sc1
K1_csd:
s_mov_b64 exec, s[56:57]
s_waitcnt vmcnt(0)
s_barrier
v_mov_b32 v246, 0
v_mov_b32 v248, 1
s_cmp_lg_u32 s40, 0
s_cbranch_scc1 L_lk_i2
s_mov_b32 s58, 0
L_lc_i2:
v_and_b32 v252, 0xffff, v247
v_cmp_ge_u32 vcc, v252, v248
s_nop 3
s_cmp_eq_u64 vcc, -1
s_cbranch_scc1 L_lk_i2
s_add_u32 s58, s58, 1
s_cmp_ge_u32 s58, 65536
s_cbranch_scc1 L_lk_i2
s_sleep 2
buffer_load_dword v247, v246, s[76:79], 0 offen sc1
s_waitcnt vmcnt(0)
s_branch L_lc_i2
L_lk_i2:
s_lshl_b32 s28, s28, 7
s_cmp_lg_u32 s40, 0
s_cbranch_scc1 L_nosig_cs
s_mov_b64 exec, 1
v_mov_b32 v252, 1
v_mov_b32 v251, 0
s_nop 0
buffer_atomic_add v252, v251, s[72:75], s28 offen
s_mov_b64 exec, -1
L_nosig_cs:
s_load_dwordx2 s[64:65], s[0:1], 64
s_load_dwordx2 s[66:67], s[0:1], 24
s_load_dwordx2 s[68:69], s[0:1], 8
s_load_dwordx2 s[62:63], s[0:1], 16
s_and_b32 s56, s2, 7
s_lshl_b32 s41, s56, 1
s_bfe_u32 s57, s2, 0x10003
s_add_u32 s41, s41, s57
s_lshr_b32 s42, s2, 4
s_lshl_b32 s43, s56, 2
s_bfe_u32 s57, s2, 0x20003
s_add_u32 s43, s43, s57
s_lshr_b32 s44, s2, 5
s_mul_i32 s53, s40, 5120
s_lshl_b32 s54, s40, 13
s_lshl_b32 s55, s40, 12
s_mul_i32 s49, s40, 131072
s_lshl_b32 s56, s41, 9
s_add_u32 s49, s49, s56
s_lshl_b32 s56, s42, 3
s_lshl_b32 s57, s40, 1
s_add_u32 s56, s56, s57
s_mul_i32 s50, s56, 18432
s_mul_i32 s47, s40, 147456
s_mul_i32 s56, s43, 288
s_add_u32 s47, s47, s56
s_lshl_b32 s56, s44, 4
s_lshl_b32 s57, s40, 2
s_add_u32 s56, s56, s57
s_mul_i32 s48, s56, 18432
s_lshl_b32 s51, s41, 19
s_add_u32 s51, s51, s55
s_mov_b32 s52, s51
s_waitcnt lgkmcnt(0)
s_mov_b32 s4, s64
s_mov_b32 s5, s65
s_mov_b32 s6, 0x510000
s_mov_b32 s7, 0x20000
s_mov_b32 s20, s68
s_mov_b32 s21, s69
s_mov_b32 s22, 0x800000
s_mov_b32 s23, 0x20000
s_mov_b32 s24, s62
s_mov_b32 s25, s63
s_mov_b32 s26, 0x800000
s_mov_b32 s27, 0x20000
s_add_u32 s28, s70, 0x600000
s_addc_u32 s29, s71, 0
s_mov_b32 s30, 0x1200000
s_mov_b32 s31, 0x20000
s_add_u32 s16, s70, 0x300000
s_addc_u32 s17, s71, 0
s_mov_b32 s18, 0x240000
s_mov_b32 s19, 0x20000
s_lshl_b32 s56, s42, 1
v_min_u32 v252, 1, v255
v_add_u32 v252, s56, v252
s_add_u32 s57, s41, 32
v_mov_b32 v251, s57
v_cmp_gt_u32 vcc, 2, v255
s_nop 1
v_cndmask_b32 v252, v251, v252
v_lshlrev_b32 v246, 7, v252
v_mov_b32 v252, 6
v_mov_b32 v251, 2
v_cndmask_b32 v248, v251, v252
buffer_load_dword v247, v246, s[72:75], 0 offen sc1
s_waitcnt vmcnt(0)
s_cmp_lg_u32 s40, 0
s_cbranch_scc1 L_lk_q2
s_mov_b32 s58, 0
L_lc_q2:
v_and_b32 v252, 0xffff, v247
v_cmp_ge_u32 vcc, v252, v248
s_nop 3
s_cmp_eq_u64 vcc, -1
s_cbranch_scc1 L_lk_q2
s_add_u32 s58, s58, 1
s_cmp_ge_u32 s58, 65536
s_cbranch_scc1 L_lk_q2
s_sleep 40
buffer_load_dword v247, v246, s[72:75], 0 offen sc1
s_waitcnt vmcnt(0)
s_branch L_lc_q2
L_lk_q2:
s_barrier
s_mov_b32 s8, s66
s_mov_b32 s9, s67
s_mov_b32 s10, 0x480000
s_mov_b32 s11, 0x20000
s_add_u32 s12, s70, 0x4000000
s_addc_u32 s13, s71, 0
s_mov_b32 s14, 0x240000
s_mov_b32 s15, 0x20000
s_add_u32 m0, s54, 0x0
s_nop 0
buffer_load_dwordx4 v208, s[8:11], s49 offen lds
buffer_load_dwordx4 v209, s[8:11], s49 offen offset:1024 lds
buffer_load_dwordx4 v210, s[8:11], s49 offen offset:2048 lds
buffer_load_dwordx4 v211, s[8:11], s49 offen offset:3072 lds
s_add_u32 m0, s54, 0x1000
s_nop 0
buffer_load_dwordx4 v212, s[8:11], s49 offen lds
buffer_load_dwordx4 v213, s[8:11], s49 offen offset:1024 lds
buffer_load_dwordx4 v214, s[8:11], s49 offen offset:2048 lds
buffer_load_dwordx4 v215, s[8:11], s49 offen offset:3072 lds
s_add_u32 s49, s49, 524288
buffer_load_dwordx4 a[0:3], v220, s[12:15], s50 offen sc1
buffer_load_dwordx4 a[4:7], v221, s[12:15], s50 offen sc1
buffer_load_dwordx4 a[8:11], v220, s[12:15], s50 offen offset:1024 sc1
buffer_load_dwordx4 a[12:15], v221, s[12:15], s50 offen offset:1024 sc1
buffer_load_dwordx4 a[16:19], v220, s[12:15], s50 offen offset:2048 sc1
buffer_load_dwordx4 a[20:23], v221, s[12:15], s50 offen offset:2048 sc1
buffer_load_dwordx4 a[24:27], v220, s[12:15], s50 offen offset:3072 sc1
buffer_load_dwordx4 a[28:31], v221, s[12:15], s50 offen offset:3072 sc1
s_add_u32 m0, s54, 0x8000
s_nop 0
buffer_load_dwordx4 v208, s[8:11], s49 offen lds
buffer_load_dwordx4 v209, s[8:11], s49 offen offset:1024 lds
buffer_load_dwordx4 v210, s[8:11], s49 offen offset:2048 lds
buffer_load_dwordx4 v211, s[8:11], s49 offen offset:3072 lds
s_add_u32 m0, s54, 0x9000
s_nop 0
buffer_load_dwordx4 v212, s[8:11], s49 offen lds
buffer_load_dwordx4 v213, s[8:11], s49 offen offset:1024 lds
buffer_load_dwordx4 v214, s[8:11], s49 offen offset:2048 lds
buffer_load_dwordx4 v215, s[8:11], s49 offen offset:3072 lds
s_add_u32 s49, s49, 524288
s_add_u32 s50, s50, 4096
buffer_load_dwordx4 a[32:35], v220, s[12:15], s50 offen sc1
buffer_load_dwordx4 a[36:39], v221, s[12:15], s50 offen sc1
buffer_load_dwordx4 a[40:43], v220, s[12:15], s50 offen offset:1024 sc1
buffer_load_dwordx4 a[44:47], v221, s[12:15], s50 offen offset:1024 sc1
buffer_load_dword v241, v246, s[36:39], 0 offen
buffer_load_dword v242, v246, s[36:39], 0 offen
buffer_load_dword v243, v246, s[36:39], 0 offen
buffer_load_dword v241, v246, s[36:39], 0 offen
s_mov_b32 s62, -1
M_q:
s_getpc_b64 s[32:33]
M_pc_b:
s_add_u32 s32, s32, M_g3-M_pc_b
s_addc_u32 s33, s33, 0
s_mov_b32 s34, M_last-M_g3
s_mov_b32 s35, 0x20000
s_lshr_b32 s56, s2, 3
s_lshl_b32 s56, s56, 2
s_add_u32 s56, s56, s40
v_mov_b32 v251, s56
s_mov_b32 s56, (M_last-M_g3+16383)/16384
v_mul_lo_u32 v251, s56, v251
v_add_u32 v251, v251, v255
v_lshlrev_b32 v251, 7, v251
v_cmp_gt_u32 vcc, s56, v255
v_mov_b32 v250, 0x70000000
s_nop 0
v_cndmask_b32 v244, v250, v251
s_waitcnt vmcnt(20)
s_barrier
ds_read_b64_tr_b16 a[192:193], v128
ds_read_b64_tr_b16 a[194:195], v128 offset:2048
ds_read_b64_tr_b16 a[196:197], v128 offset:16384
ds_read_b64_tr_b16 a[198:199], v128 offset:18432
ds_read_b64_tr_b16 a[200:201], v129
ds_read_b64_tr_b16 a[202:203], v129 offset:2048
ds_read_b64_tr_b16 a[204:205], v129 offset:16384
ds_read_b64_tr_b16 a[206:207], v129 offset:18432
ds_read_b64_tr_b16 a[208:209], v130
ds_read_b64_tr_b16 a[210:211], v130 offset:2048
ds_read_b64_tr_b16 a[212:213], v130 offset:16384
ds_read_b64_tr_b16 a[214:215], v130 offset:18432
s_waitcnt lgkmcnt(8)
ds_read_b64_tr_b16 a[216:217], v131
ds_read_b64_tr_b16 a[218:219], v131 offset:2048
ds_read_b64_tr_b16 a[220:221], v131 offset:16384
ds_read_b64_tr_b16 a[222:223], v131 offset:18432
v_mfma_f32_16x16x32_bf16 v[0:3], a[192:195], a[0:3], 0
s_add_u32 m0, s54, 0x10000
ds_read_b64_tr_b16 a[224:225], v132
ds_read_b64_tr_b16 a[226:227], v132 offset:2048
v_mfma_f32_16x16x32_bf16 v[0:3], a[196:199], a[8:11], v[0:3]
buffer_load_dwordx4 v208, s[8:11], s49 offen lds
v_mfma_f32_16x16x32_bf16 v[4:7], a[192:195], a[4:7], 0
ds_read_b64_tr_b16 a[228:229], v132 offset:16384
v_mfma_f32_16x16x32_bf16 v[4:7], a[196:199], a[12:15], v[4:7]
s_waitcnt lgkmcnt(11)
ds_read_b64_tr_b16 a[230:231], v132 offset:18432
v_mfma_f32_16x16x32_bf16 v[8:11], a[200:203], a[0:3], 0
ds_read_b64_tr_b16 a[192:193], v133
ds_read_b64_tr_b16 a[194:195], v133 offset:2048
v_mfma_f32_16x16x32_bf16 v[8:11], a[204:207], a[8:11], v[8:11]
buffer_load_dwordx4 v209, s[8:11], s49 offen offset:1024 lds
v_mfma_f32_16x16x32_bf16 v[12:15], a[200:203], a[4:7], 0
ds_read_b64_tr_b16 a[196:197], v133 offset:16384
v_mfma_f32_16x16x32_bf16 v[12:15], a[204:207], a[12:15], v[12:15]
s_waitcnt lgkmcnt(11)
ds_read_b64_tr_b16 a[198:199], v133 offset:18432
v_mfma_f32_16x16x32_bf16 v[16:19], a[208:211], a[0:3], 0
ds_read_b64_tr_b16 a[200:201], v134
ds_read_b64_tr_b16 a[202:203], v134 offset:2048
v_mfma_f32_16x16x32_bf16 v[16:19], a[212:215], a[8:11], v[16:19]
buffer_load_dwordx4 a[48:51], v220, s[12:15], s50 offen offset:2048 sc1
v_mfma_f32_16x16x32_bf16 v[20:23], a[208:211], a[4:7], 0
ds_read_b64_tr_b16 a[204:205], v134 offset:16384
v_mfma_f32_16x16x32_bf16 v[20:23], a[212:215], a[12:15], v[20:23]
s_waitcnt lgkmcnt(11)
ds_read_b64_tr_b16 a[206:207], v134 offset:18432
v_mfma_f32_16x16x32_bf16 v[24:27], a[216:219], a[0:3], 0
ds_read_b64_tr_b16 a[208:209], v135
ds_read_b64_tr_b16 a[210:211], v135 offset:2048
v_mfma_f32_16x16x32_bf16 v[24:27], a[220:223], a[8:11], v[24:27]
buffer_load_dwordx4 v210, s[8:11], s49 offen offset:2048 lds
v_mfma_f32_16x16x32_bf16 v[28:31], a[216:219], a[4:7], 0
ds_read_b64_tr_b16 a[212:213], v135 offset:16384
v_mfma_f32_16x16x32_bf16 v[28:31], a[220:223], a[12:15], v[28:31]
s_waitcnt lgkmcnt(11)
ds_read_b64_tr_b16 a[214:215], v135 offset:18432
v_mfma_f32_16x16x32_bf16 v[32:35], a[224:227], a[0:3], 0
ds_read_b64_tr_b16 a[216:217], v128 offset:256
ds_read_b64_tr_b16 a[218:219], v128 offset:2304
v_mfma_f32_16x16x32_bf16 v[32:35], a[228:231], a[8:11], v[32:35]
buffer_load_dwordx4 v211, s[8:11], s49 offen offset:3072 lds
v_mfma_f32_16x16x32_bf16 v[36:39], a[224:227], a[4:7], 0
ds_read_b64_tr_b16 a[220:221], v128 offset:16640
v_mfma_f32_16x16x32_bf16 v[36:39], a[228:231], a[12:15], v[36:39]
s_waitcnt lgkmcnt(11)
ds_read_b64_tr_b16 a[222:223], v128 offset:18688
v_mfma_f32_16x16x32_bf16 v[40:43], a[192:195], a[0:3], 0
ds_read_b64_tr_b16 a[224:225], v129 offset:256
ds_read_b64_tr_b16 a[226:227], v129 offset:2304
v_mfma_f32_16x16x32_bf16 v[40:43], a[196:199], a[8:11], v[40:43]
buffer_load_dwordx4 a[52:55], v221, s[12:15], s50 offen offset:2048 sc1
v_mfma_f32_16x16x32_bf16 v[44:47], a[192:195], a[4:7], 0
ds_read_b64_tr_b16 a[228:229], v129 offset:16640
v_mfma_f32_16x16x32_bf16 v[44:47], a[196:199], a[12:15], v[44:47]
s_waitcnt lgkmcnt(11)
ds_read_b64_tr_b16 a[230:231], v129 offset:18688
v_mfma_f32_16x16x32_bf16 v[48:51], a[200:203], a[0:3], 0
s_add_u32 m0, s54, 0x11000
ds_read_b64_tr_b16 a[192:193], v130 offset:256
ds_read_b64_tr_b16 a[194:195], v130 offset:2304
v_mfma_f32_16x16x32_bf16 v[48:51], a[204:207], a[8:11], v[48:51]
buffer_load_dwordx4 v212, s[8:11], s49 offen lds
v_mfma_f32_16x16x32_bf16 v[52:55], a[200:203], a[4:7], 0
ds_read_b64_tr_b16 a[196:197], v130 offset:16640
v_mfma_f32_16x16x32_bf16 v[52:55], a[204:207], a[12:15], v[52:55]
s_waitcnt lgkmcnt(11)
ds_read_b64_tr_b16 a[198:199], v130 offset:18688
v_mfma_f32_16x16x32_bf16 v[56:59], a[208:211], a[0:3], 0
ds_read_b64_tr_b16 a[200:201], v131 offset:256
ds_read_b64_tr_b16 a[202:203], v131 offset:2304
v_mfma_f32_16x16x32_bf16 v[56:59], a[212:215], a[8:11], v[56:59]
buffer_load_dwordx4 v213, s[8:11], s49 offen offset:1024 lds
v_mfma_f32_16x16x32_bf16 v[60:63], a[208:211], a[4:7], 0
ds_read_b64_tr_b16 a[204:205], v131 offset:16640
v_mfma_f32_16x16x32_bf16 v[60:63], a[212:215], a[12:15], v[60:63]
s_waitcnt lgkmcnt(11)
ds_read_b64_tr_b16 a[206:207], v131 offset:18688
v_mfma_f32_16x16x32_bf16 v[64:67], a[216:219], a[0:3], 0
ds_read_b64_tr_b16 a[208:209], v132 offset:256
ds_read_b64_tr_b16 a[210:211], v132 offset:2304
v_mfma_f32_16x16x32_bf16 v[64:67], a[220:223], a[8:11], v[64:67]
buffer_load_dwordx4 a[56:59], v220, s[12:15], s50 offen offset:3072 sc1
v_mfma_f32_16x16x32_bf16 v[68:71], a[216:219], a[4:7], 0
ds_read_b64_tr_b16 a[212:213], v132 offset:16640
v_mfma_f32_16x16x32_bf16 v[68:71], a[220:223], a[12:15], v[68:71]
s_waitcnt lgkmcnt(11)
ds_read_b64_tr_b16 a[214:215], v132 offset:18688
v_mfma_f32_16x16x32_bf16 v[72:75], a[224:227], a[0:3], 0
ds_read_b64_tr_b16 a[216:217], v133 offset:256
ds_read_b64_tr_b16 a[218:219], v133 offset:2304
v_mfma_f32_16x16x32_bf16 v[72:75], a[228:231], a[8:11], v[72:75]
buffer_load_dwordx4 v214, s[8:11], s49 offen offset:2048 lds
v_mfma_f32_16x16x32_bf16 v[76:79], a[224:227], a[4:7], 0
ds_read_b64_tr_b16 a[220:221], v133 offset:16640
v_mfma_f32_16x16x32_bf16 v[76:79], a[228:231], a[12:15], v[76:79]
s_waitcnt lgkmcnt(11)
ds_read_b64_tr_b16 a[222:223], v133 offset:18688
v_mfma_f32_16x16x32_bf16 v[80:83], a[192:195], a[0:3], 0
ds_read_b64_tr_b16 a[224:225], v134 offset:256
ds_read_b64_tr_b16 a[226:227], v134 offset:2304
v_mfma_f32_16x16x32_bf16 v[80:83], a[196:199], a[8:11], v[80:83]
buffer_load_dwordx4 v215, s[8:11], s49 offen offset:3072 lds
v_mfma_f32_16x16x32_bf16 v[84:87], a[192:195], a[4:7], 0
ds_read_b64_tr_b16 a[228:229], v134 offset:16640
v_mfma_f32_16x16x32_bf16 v[84:87], a[196:199], a[12:15], v[84:87]
s_waitcnt lgkmcnt(11)
ds_read_b64_tr_b16 a[230:231], v134 offset:18688
v_mfma_f32_16x16x32_bf16 v[88:91], a[200:203], a[0:3], 0
ds_read_b64_tr_b16 a[192:193], v135 offset:256
ds_read_b64_tr_b16 a[194:195], v135 offset:2304
v_mfma_f32_16x16x32_bf16 v[88:91], a[204:207], a[8:11], v[88:91]
buffer_load_dwordx4 a[60:63], v221, s[12:15], s50 offen offset:3072 sc1
v_mfma_f32_16x16x32_bf16 v[92:95], a[200:203], a[4:7], 0
s_waitcnt vmcnt(20)
ds_read_b64_tr_b16 a[196:197], v135 offset:16640
v_mfma_f32_16x16x32_bf16 v[92:95], a[204:207], a[12:15], v[92:95]
s_waitcnt lgkmcnt(11)
s_barrier
ds_read_b64_tr_b16 a[198:199], v135 offset:18688
v_mfma_f32_16x16x32_bf16 v[96:99], a[208:211], a[0:3], 0
s_lshl_b32 s63, s42, 7
s_lshl_b32 s57, s40, 5
s_add_u32 s63, s63, s57
s_lshl_b32 s63, s63, 3
ds_read_b64_tr_b16 a[200:201], v128 offset:32768
ds_read_b64_tr_b16 a[202:203], v128 offset:34816
v_mfma_f32_16x16x32_bf16 v[96:99], a[212:215], a[8:11], v[96:99]
buffer_load_dwordx2 v[216:217], v222, s[36:39], s63 offen sc1
v_mfma_f32_16x16x32_bf16 v[100:103], a[208:211], a[4:7], 0
ds_read_b64_tr_b16 a[204:205], v128 offset:49152
v_mfma_f32_16x16x32_bf16 v[100:103], a[212:215], a[12:15], v[100:103]
s_waitcnt lgkmcnt(11)
ds_read_b64_tr_b16 a[206:207], v128 offset:51200
v_mfma_f32_16x16x32_bf16 v[104:107], a[216:219], a[0:3], 0
ds_read_b64_tr_b16 a[208:209], v129 offset:32768
ds_read_b64_tr_b16 a[210:211], v129 offset:34816
v_mfma_f32_16x16x32_bf16 v[104:107], a[220:223], a[8:11], v[104:107]
buffer_load_dwordx2 v[218:219], v222, s[36:39], s63 offen offset:128 sc1
v_mfma_f32_16x16x32_bf16 v[108:111], a[216:219], a[4:7], 0
ds_read_b64_tr_b16 a[212:213], v129 offset:49152
v_mfma_f32_16x16x32_bf16 v[108:111], a[220:223], a[12:15], v[108:111]
s_waitcnt lgkmcnt(11)
ds_read_b64_tr_b16 a[214:215], v129 offset:51200
v_mfma_f32_16x16x32_bf16 v[112:115], a[224:227], a[0:3], 0
s_lshl_b32 s63, s41, 10
s_add_u32 s63, s63, 0x8000
ds_read_b64_tr_b16 a[216:217], v130 offset:32768
ds_read_b64_tr_b16 a[218:219], v130 offset:34816
v_mfma_f32_16x16x32_bf16 v[112:115], a[228:231], a[8:11], v[112:115]
buffer_load_dwordx4 v[144:147], v223, s[36:39], s63 offen sc1
v_mfma_f32_16x16x32_bf16 v[116:119], a[224:227], a[4:7], 0
ds_read_b64_tr_b16 a[220:221], v130 offset:49152
v_mfma_f32_16x16x32_bf16 v[116:119], a[228:231], a[12:15], v[116:119]
s_waitcnt lgkmcnt(11)
ds_read_b64_tr_b16 a[222:223], v130 offset:51200
v_mfma_f32_16x16x32_bf16 v[120:123], a[192:195], a[0:3], 0
ds_read_b64_tr_b16 a[224:225], v131 offset:32768
ds_read_b64_tr_b16 a[226:227], v131 offset:34816
v_mfma_f32_16x16x32_bf16 v[120:123], a[196:199], a[8:11], v[120:123]
buffer_load_dwordx4 v[148:151], v223, s[36:39], s63 offen offset:64 sc1
v_mfma_f32_16x16x32_bf16 v[124:127], a[192:195], a[4:7], 0
s_add_u32 s49, s49, 524288
ds_read_b64_tr_b16 a[228:229], v131 offset:49152
v_mfma_f32_16x16x32_bf16 v[124:127], a[196:199], a[12:15], v[124:127]
s_waitcnt lgkmcnt(11)
ds_read_b64_tr_b16 a[230:231], v131 offset:51200
v_mfma_f32_16x16x32_bf16 v[0:3], a[200:203], a[16:19], v[0:3]
s_add_u32 m0, s54, 0x18000
ds_read_b64_tr_b16 a[192:193], v132 offset:32768
ds_read_b64_tr_b16 a[194:195], v132 offset:34816
v_mfma_f32_16x16x32_bf16 v[0:3], a[204:207], a[24:27], v[0:3]
buffer_load_dwordx4 v208, s[8:11], s49 offen lds
v_mfma_f32_16x16x32_bf16 v[4:7], a[200:203], a[20:23], v[4:7]
ds_read_b64_tr_b16 a[196:197], v132 offset:49152
v_mfma_f32_16x16x32_bf16 v[4:7], a[204:207], a[28:31], v[4:7]
s_waitcnt lgkmcnt(11)
ds_read_b64_tr_b16 a[198:199], v132 offset:51200
v_mfma_f32_16x16x32_bf16 v[8:11], a[208:211], a[16:19], v[8:11]
ds_read_b64_tr_b16 a[200:201], v133 offset:32768
ds_read_b64_tr_b16 a[202:203], v133 offset:34816
v_mfma_f32_16x16x32_bf16 v[8:11], a[212:215], a[24:27], v[8:11]
buffer_load_dwordx4 v209, s[8:11], s49 offen offset:1024 lds
v_mfma_f32_16x16x32_bf16 v[12:15], a[208:211], a[20:23], v[12:15]
ds_read_b64_tr_b16 a[204:205], v133 offset:49152
v_mfma_f32_16x16x32_bf16 v[12:15], a[212:215], a[28:31], v[12:15]
s_waitcnt lgkmcnt(11)
ds_read_b64_tr_b16 a[206:207], v133 offset:51200
v_mfma_f32_16x16x32_bf16 v[16:19], a[216:219], a[16:19], v[16:19]
s_add_u32 s50, s50, 4096
ds_read_b64_tr_b16 a[208:209], v134 offset:32768
ds_read_b64_tr_b16 a[210:211], v134 offset:34816
v_mfma_f32_16x16x32_bf16 v[16:19], a[220:223], a[24:27], v[16:19]
buffer_load_dwordx4 a[64:67], v220, s[12:15], s50 offen sc1
v_mfma_f32_16x16x32_bf16 v[20:23], a[216:219], a[20:23], v[20:23]
ds_read_b64_tr_b16 a[212:213], v134 offset:49152
v_mfma_f32_16x16x32_bf16 v[20:23], a[220:223], a[28:31], v[20:23]
s_waitcnt lgkmcnt(11)
ds_read_b64_tr_b16 a[214:215], v134 offset:51200
v_mfma_f32_16x16x32_bf16 v[24:27], a[224:227], a[16:19], v[24:27]
ds_read_b64_tr_b16 a[216:217], v135 offset:32768
ds_read_b64_tr_b16 a[218:219], v135 offset:34816
v_mfma_f32_16x16x32_bf16 v[24:27], a[228:231], a[24:27], v[24:27]
buffer_load_dwordx4 v210, s[8:11], s49 offen offset:2048 lds
v_mfma_f32_16x16x32_bf16 v[28:31], a[224:227], a[20:23], v[28:31]
ds_read_b64_tr_b16 a[220:221], v135 offset:49152
v_mfma_f32_16x16x32_bf16 v[28:31], a[228:231], a[28:31], v[28:31]
s_waitcnt lgkmcnt(11)
ds_read_b64_tr_b16 a[222:223], v135 offset:51200
v_mfma_f32_16x16x32_bf16 v[32:35], a[192:195], a[16:19], v[32:35]
ds_read_b64_tr_b16 a[224:225], v128 offset:33024
ds_read_b64_tr_b16 a[226:227], v128 offset:35072
v_mfma_f32_16x16x32_bf16 v[32:35], a[196:199], a[24:27], v[32:35]
buffer_load_dwordx4 v211, s[8:11], s49 offen offset:3072 lds
v_mfma_f32_16x16x32_bf16 v[36:39], a[192:195], a[20:23], v[36:39]
ds_read_b64_tr_b16 a[228:229], v128 offset:49408
v_mfma_f32_16x16x32_bf16 v[36:39], a[196:199], a[28:31], v[36:39]
s_waitcnt lgkmcnt(11)
ds_read_b64_tr_b16 a[230:231], v128 offset:51456
v_mfma_f32_16x16x32_bf16 v[40:43], a[200:203], a[16:19], v[40:43]
ds_read_b64_tr_b16 a[192:193], v129 offset:33024
ds_read_b64_tr_b16 a[194:195], v129 offset:35072
v_mfma_f32_16x16x32_bf16 v[40:43], a[204:207], a[24:27], v[40:43]
buffer_load_dwordx4 a[68:71], v221, s[12:15], s50 offen sc1
v_mfma_f32_16x16x32_bf16 v[44:47], a[200:203], a[20:23], v[44:47]
ds_read_b64_tr_b16 a[196:197], v129 offset:49408
v_mfma_f32_16x16x32_bf16 v[44:47], a[204:207], a[28:31], v[44:47]
s_waitcnt lgkmcnt(11)
ds_read_b64_tr_b16 a[198:199], v129 offset:51456
v_mfma_f32_16x16x32_bf16 v[48:51], a[208:211], a[16:19], v[48:51]
s_add_u32 m0, s54, 0x19000
ds_read_b64_tr_b16 a[200:201], v130 offset:33024
ds_read_b64_tr_b16 a[202:203], v130 offset:35072
v_mfma_f32_16x16x32_bf16 v[48:51], a[212:215], a[24:27], v[48:51]
buffer_load_dwordx4 v212, s[8:11], s49 offen lds
v_mfma_f32_16x16x32_bf16 v[52:55], a[208:211], a[20:23], v[52:55]
ds_read_b64_tr_b16 a[204:205], v130 offset:49408
v_mfma_f32_16x16x32_bf16 v[52:55], a[212:215], a[28:31], v[52:55]
s_waitcnt lgkmcnt(11)
ds_read_b64_tr_b16 a[206:207], v130 offset:51456
v_mfma_f32_16x16x32_bf16 v[56:59], a[216:219], a[16:19], v[56:59]
ds_read_b64_tr_b16 a[208:209], v131 offset:33024
ds_read_b64_tr_b16 a[210:211], v131 offset:35072
v_mfma_f32_16x16x32_bf16 v[56:59], a[220:223], a[24:27], v[56:59]
buffer_load_dwordx4 v213, s[8:11], s49 offen offset:1024 lds
v_mfma_f32_16x16x32_bf16 v[60:63], a[216:219], a[20:23], v[60:63]
ds_read_b64_tr_b16 a[212:213], v131 offset:49408
v_mfma_f32_16x16x32_bf16 v[60:63], a[220:223], a[28:31], v[60:63]
s_waitcnt lgkmcnt(11)
ds_read_b64_tr_b16 a[214:215], v131 offset:51456
v_mfma_f32_16x16x32_bf16 v[64:67], a[224:227], a[16:19], v[64:67]
ds_read_b64_tr_b16 a[216:217], v132 offset:33024
ds_read_b64_tr_b16 a[218:219], v132 offset:35072
v_mfma_f32_16x16x32_bf16 v[64:67], a[228:231], a[24:27], v[64:67]
buffer_load_dwordx4 a[72:75], v220, s[12:15], s50 offen offset:1024 sc1
v_mfma_f32_16x16x32_bf16 v[68:71], a[224:227], a[20:23], v[68:71]
ds_read_b64_tr_b16 a[220:221], v132 offset:49408
v_mfma_f32_16x16x32_bf16 v[68:71], a[228:231], a[28:31], v[68:71]
s_waitcnt lgkmcnt(11)
ds_read_b64_tr_b16 a[222:223], v132 offset:51456
v_mfma_f32_16x16x32_bf16 v[72:75], a[192:195], a[16:19], v[72:75]
ds_read_b64_tr_b16 a[224:225], v133 offset:33024
ds_read_b64_tr_b16 a[226:227], v133 offset:35072
v_mfma_f32_16x16x32_bf16 v[72:75], a[196:199], a[24:27], v[72:75]
buffer_load_dwordx4 v214, s[8:11], s49 offen offset:2048 lds
v_mfma_f32_16x16x32_bf16 v[76:79], a[192:195], a[20:23], v[76:79]
ds_read_b64_tr_b16 a[228:229], v133 offset:49408
v_mfma_f32_16x16x32_bf16 v[76:79], a[196:199], a[28:31], v[76:79]
s_waitcnt lgkmcnt(11)
ds_read_b64_tr_b16 a[230:231], v133 offset:51456
v_mfma_f32_16x16x32_bf16 v[80:83], a[200:203], a[16:19], v[80:83]
ds_read_b64_tr_b16 a[192:193], v134 offset:33024
ds_read_b64_tr_b16 a[194:195], v134 offset:35072
v_mfma_f32_16x16x32_bf16 v[80:83], a[204:207], a[24:27], v[80:83]
buffer_load_dwordx4 v215, s[8:11], s49 offen offset:3072 lds
v_mfma_f32_16x16x32_bf16 v[84:87], a[200:203], a[20:23], v[84:87]
ds_read_b64_tr_b16 a[196:197], v134 offset:49408
v_mfma_f32_16x16x32_bf16 v[84:87], a[204:207], a[28:31], v[84:87]
s_waitcnt lgkmcnt(11)
ds_read_b64_tr_b16 a[198:199], v134 offset:51456
v_mfma_f32_16x16x32_bf16 v[88:91], a[208:211], a[16:19], v[88:91]
ds_read_b64_tr_b16 a[200:201], v135 offset:33024
ds_read_b64_tr_b16 a[202:203], v135 offset:35072
v_mfma_f32_16x16x32_bf16 v[88:91], a[212:215], a[24:27], v[88:91]
buffer_load_dwordx4 a[76:79], v221, s[12:15], s50 offen offset:1024 sc1
v_mfma_f32_16x16x32_bf16 v[92:95], a[208:211], a[20:23], v[92:95]
s_waitcnt vmcnt(17)
ds_read_b64_tr_b16 a[204:205], v135 offset:49408
v_mfma_f32_16x16x32_bf16 v[92:95], a[212:215], a[28:31], v[92:95]
s_waitcnt lgkmcnt(11)
s_barrier
ds_read_b64_tr_b16 a[206:207], v135 offset:51456
v_mfma_f32_16x16x32_bf16 v[96:99], a[216:219], a[16:19], v[96:99]
ds_read_b64_tr_b16 a[208:209], v136
ds_read_b64_tr_b16 a[210:211], v136 offset:2048
v_mfma_f32_16x16x32_bf16 v[96:99], a[220:223], a[24:27], v[96:99]
buffer_load_dwordx4 v[152:155], v223, s[36:39], s63 offen offset:128 sc1
v_mfma_f32_16x16x32_bf16 v[100:103], a[216:219], a[20:23], v[100:103]
ds_read_b64_tr_b16 a[212:213], v136 offset:16384
v_mfma_f32_16x16x32_bf16 v[100:103], a[220:223], a[28:31], v[100:103]
s_waitcnt lgkmcnt(11)
ds_read_b64_tr_b16 a[214:215], v136 offset:18432
v_mfma_f32_16x16x32_bf16 v[104:107], a[224:227], a[16:19], v[104:107]
ds_read_b64_tr_b16 a[216:217], v137
ds_read_b64_tr_b16 a[218:219], v137 offset:2048
v_mfma_f32_16x16x32_bf16 v[104:107], a[228:231], a[24:27], v[104:107]
buffer_load_dwordx4 v[156:159], v223, s[36:39], s63 offen offset:192 sc1
v_mfma_f32_16x16x32_bf16 v[108:111], a[224:227], a[20:23], v[108:111]
ds_read_b64_tr_b16 a[220:221], v137 offset:16384
v_mfma_f32_16x16x32_bf16 v[108:111], a[228:231], a[28:31], v[108:111]
s_waitcnt lgkmcnt(11)
ds_read_b64_tr_b16 a[222:223], v137 offset:18432
v_mfma_f32_16x16x32_bf16 v[112:115], a[192:195], a[16:19], v[112:115]
ds_read_b64_tr_b16 a[224:225], v138
ds_read_b64_tr_b16 a[226:227], v138 offset:2048
v_mfma_f32_16x16x32_bf16 v[112:115], a[196:199], a[24:27], v[112:115]
buffer_load_dwordx4 v[160:163], v223, s[36:39], s63 offen offset:256 sc1
v_mfma_f32_16x16x32_bf16 v[116:119], a[192:195], a[20:23], v[116:119]
ds_read_b64_tr_b16 a[228:229], v138 offset:16384
v_mfma_f32_16x16x32_bf16 v[116:119], a[196:199], a[28:31], v[116:119]
s_waitcnt lgkmcnt(11)
ds_read_b64_tr_b16 a[230:231], v138 offset:18432
v_mfma_f32_16x16x32_bf16 v[120:123], a[200:203], a[16:19], v[120:123]
ds_read_b64_tr_b16 a[192:193], v139
ds_read_b64_tr_b16 a[194:195], v139 offset:2048
v_mfma_f32_16x16x32_bf16 v[120:123], a[204:207], a[24:27], v[120:123]
buffer_load_dwordx4 v[164:167], v223, s[36:39], s63 offen offset:320 sc1
v_mfma_f32_16x16x32_bf16 v[124:127], a[200:203], a[20:23], v[124:127]
s_add_u32 s49, s49, 524288
ds_read_b64_tr_b16 a[196:197], v139 offset:16384
v_mfma_f32_16x16x32_bf16 v[124:127], a[204:207], a[28:31], v[124:127]
s_waitcnt lgkmcnt(11)
ds_read_b64_tr_b16 a[198:199], v139 offset:18432
s_cmp_eq_u32 s62, -1
s_cbranch_scc1 M_nox1
s_cmp_lg_u32 s40, 0
s_cbranch_scc1 L_nosig_x1
s_mov_b64 exec, 1
v_mov_b32 v252, 1
v_mov_b32 v251, 0
s_nop 0
buffer_atomic_add v252, v251, s[72:75], s62 offen
s_mov_b64 exec, -1
L_nosig_x1:
M_nox1:
s_add_u32 s56, s44, 80
s_add_u32 s57, s43, 48
v_mov_b32 v252, s56
v_mov_b32 v251, s57
v_cmp_eq_u32 vcc, 0, v255
s_nop 1
v_cndmask_b32 v252, v251, v252
v_lshlrev_b32 v246, 7, v252
v_mov_b32 v252, 24
v_mov_b32 v251, 1
v_cndmask_b32 v248, v251, v252
v_mfma_f32_16x16x32_bf16 v[0:3], a[208:211], a[32:35], v[0:3]
s_add_u32 m0, s54, 0x0
ds_read_b64_tr_b16 a[200:201], v140
ds_read_b64_tr_b16 a[202:203], v140 offset:2048
v_mfma_f32_16x16x32_bf16 v[0:3], a[212:215], a[40:43], v[0:3]
buffer_load_dwordx4 v208, s[8:11], s49 offen lds
v_mfma_f32_16x16x32_bf16 v[4:7], a[208:211], a[36:39], v[4:7]
ds_read_b64_tr_b16 a[204:205], v140 offset:16384
v_mfma_f32_16x16x32_bf16 v[4:7], a[212:215], a[44:47], v[4:7]
s_waitcnt lgkmcnt(11)
ds_read_b64_tr_b16 a[206:207], v140 offset:18432
v_mfma_f32_16x16x32_bf16 v[8:11], a[216:219], a[32:35], v[8:11]
ds_read_b64_tr_b16 a[208:209], v141
ds_read_b64_tr_b16 a[210:211], v141 offset:2048
v_mfma_f32_16x16x32_bf16 v[8:11], a[220:223], a[40:43], v[8:11]
buffer_load_dwordx4 v209, s[8:11], s49 offen offset:1024 lds
v_mfma_f32_16x16x32_bf16 v[12:15], a[216:219], a[36:39], v[12:15]
ds_read_b64_tr_b16 a[212:213], v141 offset:16384
v_mfma_f32_16x16x32_bf16 v[12:15], a[220:223], a[44:47], v[12:15]
s_waitcnt lgkmcnt(11)
ds_read_b64_tr_b16 a[214:215], v141 offset:18432
v_mfma_f32_16x16x32_bf16 v[16:19], a[224:227], a[32:35], v[16:19]
ds_read_b64_tr_b16 a[216:217], v142
ds_read_b64_tr_b16 a[218:219], v142 offset:2048
v_mfma_f32_16x16x32_bf16 v[16:19], a[228:231], a[40:43], v[16:19]
buffer_load_dwordx4 a[80:83], v220, s[12:15], s50 offen offset:2048 sc1
v_mfma_f32_16x16x32_bf16 v[20:23], a[224:227], a[36:39], v[20:23]
ds_read_b64_tr_b16 a[220:221], v142 offset:16384
v_mfma_f32_16x16x32_bf16 v[20:23], a[228:231], a[44:47], v[20:23]
s_waitcnt lgkmcnt(11)
ds_read_b64_tr_b16 a[222:223], v142 offset:18432
v_mfma_f32_16x16x32_bf16 v[24:27], a[192:195], a[32:35], v[24:27]
ds_read_b64_tr_b16 a[224:225], v143
ds_read_b64_tr_b16 a[226:227], v143 offset:2048
v_mfma_f32_16x16x32_bf16 v[24:27], a[196:199], a[40:43], v[24:27]
buffer_load_dwordx4 v210, s[8:11], s49 offen offset:2048 lds
v_mfma_f32_16x16x32_bf16 v[28:31], a[192:195], a[36:39], v[28:31]
ds_read_b64_tr_b16 a[228:229], v143 offset:16384
v_mfma_f32_16x16x32_bf16 v[28:31], a[196:199], a[44:47], v[28:31]
s_waitcnt lgkmcnt(11)
ds_read_b64_tr_b16 a[230:231], v143 offset:18432
v_mfma_f32_16x16x32_bf16 v[32:35], a[200:203], a[32:35], v[32:35]
ds_read_b64_tr_b16 a[192:193], v136 offset:256
ds_read_b64_tr_b16 a[194:195], v136 offset:2304
v_mfma_f32_16x16x32_bf16 v[32:35], a[204:207], a[40:43], v[32:35]
buffer_load_dwordx4 v211, s[8:11], s49 offen offset:3072 lds
v_mfma_f32_16x16x32_bf16 v[36:39], a[200:203], a[36:39], v[36:39]
ds_read_b64_tr_b16 a[196:197], v136 offset:16640
v_mfma_f32_16x16x32_bf16 v[36:39], a[204:207], a[44:47], v[36:39]
s_waitcnt lgkmcnt(11)
ds_read_b64_tr_b16 a[198:199], v136 offset:18688
v_mfma_f32_16x16x32_bf16 v[40:43], a[208:211], a[32:35], v[40:43]
ds_read_b64_tr_b16 a[200:201], v137 offset:256
ds_read_b64_tr_b16 a[202:203], v137 offset:2304
v_mfma_f32_16x16x32_bf16 v[40:43], a[212:215], a[40:43], v[40:43]
buffer_load_dwordx4 a[84:87], v221, s[12:15], s50 offen offset:2048 sc1
v_mfma_f32_16x16x32_bf16 v[44:47], a[208:211], a[36:39], v[44:47]
ds_read_b64_tr_b16 a[204:205], v137 offset:16640
v_mfma_f32_16x16x32_bf16 v[44:47], a[212:215], a[44:47], v[44:47]
s_waitcnt lgkmcnt(11)
ds_read_b64_tr_b16 a[206:207], v137 offset:18688
v_mfma_f32_16x16x32_bf16 v[48:51], a[216:219], a[32:35], v[48:51]
s_add_u32 m0, s54, 0x1000
ds_read_b64_tr_b16 a[208:209], v138 offset:256
ds_read_b64_tr_b16 a[210:211], v138 offset:2304
v_mfma_f32_16x16x32_bf16 v[48:51], a[220:223], a[40:43], v[48:51]
buffer_load_dwordx4 v212, s[8:11], s49 offen lds
v_mfma_f32_16x16x32_bf16 v[52:55], a[216:219], a[36:39], v[52:55]
ds_read_b64_tr_b16 a[212:213], v138 offset:16640
v_mfma_f32_16x16x32_bf16 v[52:55], a[220:223], a[44:47], v[52:55]
s_waitcnt lgkmcnt(11)
ds_read_b64_tr_b16 a[214:215], v138 offset:18688
v_mfma_f32_16x16x32_bf16 v[56:59], a[224:227], a[32:35], v[56:59]
ds_read_b64_tr_b16 a[216:217], v139 offset:256
ds_read_b64_tr_b16 a[218:219], v139 offset:2304
v_mfma_f32_16x16x32_bf16 v[56:59], a[228:231], a[40:43], v[56:59]
buffer_load_dwordx4 v213, s[8:11], s49 offen offset:1024 lds
v_mfma_f32_16x16x32_bf16 v[60:63], a[224:227], a[36:39], v[60:63]
ds_read_b64_tr_b16 a[220:221], v139 offset:16640
v_mfma_f32_16x16x32_bf16 v[60:63], a[228:231], a[44:47], v[60:63]
s_waitcnt lgkmcnt(11)
ds_read_b64_tr_b16 a[222:223], v139 offset:18688
v_mfma_f32_16x16x32_bf16 v[64:67], a[192:195], a[32:35], v[64:67]
ds_read_b64_tr_b16 a[224:225], v140 offset:256
ds_read_b64_tr_b16 a[226:227], v140 offset:2304
v_mfma_f32_16x16x32_bf16 v[64:67], a[196:199], a[40:43], v[64:67]
buffer_load_dwordx4 a[88:91], v220, s[12:15], s50 offen offset:3072 sc1
v_mfma_f32_16x16x32_bf16 v[68:71], a[192:195], a[36:39], v[68:71]
ds_read_b64_tr_b16 a[228:229], v140 offset:16640
v_mfma_f32_16x16x32_bf16 v[68:71], a[196:199], a[44:47], v[68:71]
s_waitcnt lgkmcnt(11)
ds_read_b64_tr_b16 a[230:231], v140 offset:18688
v_mfma_f32_16x16x32_bf16 v[72:75], a[200:203], a[32:35], v[72:75]
ds_read_b64_tr_b16 a[192:193], v141 offset:256
ds_read_b64_tr_b16 a[194:195], v141 offset:2304
v_mfma_f32_16x16x32_bf16 v[72:75], a[204:207], a[40:43], v[72:75]
buffer_load_dwordx4 v214, s[8:11], s49 offen offset:2048 lds
v_mfma_f32_16x16x32_bf16 v[76:79], a[200:203], a[36:39], v[76:79]
ds_read_b64_tr_b16 a[196:197], v141 offset:16640
v_mfma_f32_16x16x32_bf16 v[76:79], a[204:207], a[44:47], v[76:79]
s_waitcnt lgkmcnt(11)
ds_read_b64_tr_b16 a[198:199], v141 offset:18688
v_mfma_f32_16x16x32_bf16 v[80:83], a[208:211], a[32:35], v[80:83]
ds_read_b64_tr_b16 a[200:201], v142 offset:256
ds_read_b64_tr_b16 a[202:203], v142 offset:2304
v_mfma_f32_16x16x32_bf16 v[80:83], a[212:215], a[40:43], v[80:83]
buffer_load_dwordx4 v215, s[8:11], s49 offen offset:3072 lds
v_mfma_f32_16x16x32_bf16 v[84:87], a[208:211], a[36:39], v[84:87]
ds_read_b64_tr_b16 a[204:205], v142 offset:16640
v_mfma_f32_16x16x32_bf16 v[84:87], a[212:215], a[44:47], v[84:87]
s_waitcnt lgkmcnt(11)
ds_read_b64_tr_b16 a[206:207], v142 offset:18688
v_mfma_f32_16x16x32_bf16 v[88:91], a[216:219], a[32:35], v[88:91]
ds_read_b64_tr_b16 a[208:209], v143 offset:256
ds_read_b64_tr_b16 a[210:211], v143 offset:2304
v_mfma_f32_16x16x32_bf16 v[88:91], a[220:223], a[40:43], v[88:91]
buffer_load_dwordx4 a[92:95], v221, s[12:15], s50 offen offset:3072 sc1
v_mfma_f32_16x16x32_bf16 v[92:95], a[216:219], a[36:39], v[92:95]
s_waitcnt vmcnt(17)
ds_read_b64_tr_b16 a[212:213], v143 offset:16640
v_mfma_f32_16x16x32_bf16 v[92:95], a[220:223], a[44:47], v[92:95]
s_waitcnt lgkmcnt(11)
s_barrier
ds_read_b64_tr_b16 a[214:215], v143 offset:18688
v_mfma_f32_16x16x32_bf16 v[96:99], a[224:227], a[32:35], v[96:99]
ds_read_b64_tr_b16 a[216:217], v136 offset:32768
ds_read_b64_tr_b16 a[218:219], v136 offset:34816
v_mfma_f32_16x16x32_bf16 v[96:99], a[228:231], a[40:43], v[96:99]
buffer_load_dwordx4 v[168:171], v223, s[36:39], s63 offen offset:384 sc1
v_mfma_f32_16x16x32_bf16 v[100:103], a[224:227], a[36:39], v[100:103]
ds_read_b64_tr_b16 a[220:221], v136 offset:49152
v_mfma_f32_16x16x32_bf16 v[100:103], a[228:231], a[44:47], v[100:103]
s_waitcnt lgkmcnt(11)
ds_read_b64_tr_b16 a[222:223], v136 offset:51200
v_mfma_f32_16x16x32_bf16 v[104:107], a[192:195], a[32:35], v[104:107]
ds_read_b64_tr_b16 a[224:225], v137 offset:32768
ds_read_b64_tr_b16 a[226:227], v137 offset:34816
v_mfma_f32_16x16x32_bf16 v[104:107], a[196:199], a[40:43], v[104:107]
buffer_load_dwordx4 v[172:175], v223, s[36:39], s63 offen offset:448 sc1
v_mfma_f32_16x16x32_bf16 v[108:111], a[192:195], a[36:39], v[108:111]
ds_read_b64_tr_b16 a[228:229], v137 offset:49152
v_mfma_f32_16x16x32_bf16 v[108:111], a[196:199], a[44:47], v[108:111]
s_waitcnt lgkmcnt(11)
ds_read_b64_tr_b16 a[230:231], v137 offset:51200
v_mfma_f32_16x16x32_bf16 v[112:115], a[200:203], a[32:35], v[112:115]
ds_read_b64_tr_b16 a[192:193], v138 offset:32768
ds_read_b64_tr_b16 a[194:195], v138 offset:34816
v_mfma_f32_16x16x32_bf16 v[112:115], a[204:207], a[40:43], v[112:115]
buffer_load_dwordx4 v[176:179], v223, s[36:39], s63 offen offset:512 sc1
v_mfma_f32_16x16x32_bf16 v[116:119], a[200:203], a[36:39], v[116:119]
ds_read_b64_tr_b16 a[196:197], v138 offset:49152
v_mfma_f32_16x16x32_bf16 v[116:119], a[204:207], a[44:47], v[116:119]
s_waitcnt lgkmcnt(11)
ds_read_b64_tr_b16 a[198:199], v138 offset:51200
v_mfma_f32_16x16x32_bf16 v[120:123], a[208:211], a[32:35], v[120:123]
ds_read_b64_tr_b16 a[200:201], v139 offset:32768
ds_read_b64_tr_b16 a[202:203], v139 offset:34816
v_mfma_f32_16x16x32_bf16 v[120:123], a[212:215], a[40:43], v[120:123]
buffer_load_dwordx4 v[180:183], v223, s[36:39], s63 offen offset:576 sc1
v_mfma_f32_16x16x32_bf16 v[124:127], a[208:211], a[36:39], v[124:127]
s_add_u32 s49, s49, 524288
ds_read_b64_tr_b16 a[204:205], v139 offset:49152
v_mfma_f32_16x16x32_bf16 v[124:127], a[212:215], a[44:47], v[124:127]
s_waitcnt lgkmcnt(11)
ds_read_b64_tr_b16 a[206:207], v139 offset:51200
v_mfma_f32_16x16x32_bf16 v[0:3], a[216:219], a[48:51], v[0:3]
s_add_u32 m0, s54, 0x8000
ds_read_b64_tr_b16 a[208:209], v140 offset:32768
ds_read_b64_tr_b16 a[210:211], v140 offset:34816
v_mfma_f32_16x16x32_bf16 v[0:3], a[220:223], a[56:59], v[0:3]
buffer_load_dwordx4 v208, s[8:11], s49 offen lds
v_mfma_f32_16x16x32_bf16 v[4:7], a[216:219], a[52:55], v[4:7]
ds_read_b64_tr_b16 a[212:213], v140 offset:49152
v_mfma_f32_16x16x32_bf16 v[4:7], a[220:223], a[60:63], v[4:7]
s_waitcnt lgkmcnt(11)
ds_read_b64_tr_b16 a[214:215], v140 offset:51200
v_mfma_f32_16x16x32_bf16 v[8:11], a[224:227], a[48:51], v[8:11]
ds_read_b64_tr_b16 a[216:217], v141 offset:32768
ds_read_b64_tr_b16 a[218:219], v141 offset:34816
v_mfma_f32_16x16x32_bf16 v[8:11], a[228:231], a[56:59], v[8:11]
buffer_load_dwordx4 v209, s[8:11], s49 offen offset:1024 lds
v_mfma_f32_16x16x32_bf16 v[12:15], a[224:227], a[52:55], v[12:15]
ds_read_b64_tr_b16 a[220:221], v141 offset:49152
v_mfma_f32_16x16x32_bf16 v[12:15], a[228:231], a[60:63], v[12:15]
s_waitcnt lgkmcnt(11)
ds_read_b64_tr_b16 a[222:223], v141 offset:51200
v_mfma_f32_16x16x32_bf16 v[16:19], a[192:195], a[48:51], v[16:19]
s_add_u32 s50, s50, 4096
ds_read_b64_tr_b16 a[224:225], v142 offset:32768
ds_read_b64_tr_b16 a[226:227], v142 offset:34816
v_mfma_f32_16x16x32_bf16 v[16:19], a[196:199], a[56:59], v[16:19]
buffer_load_dwordx4 a[96:99], v220, s[12:15], s50 offen sc1
v_mfma_f32_16x16x32_bf16 v[20:23], a[192:195], a[52:55], v[20:23]
ds_read_b64_tr_b16 a[228:229], v142 offset:49152
v_mfma_f32_16x16x32_bf16 v[20:23], a[196:199], a[60:63], v[20:23]
s_waitcnt lgkmcnt(11)
ds_read_b64_tr_b16 a[230:231], v142 offset:51200
v_mfma_f32_16x16x32_bf16 v[24:27], a[200:203], a[48:51], v[24:27]
ds_read_b64_tr_b16 a[192:193], v143 offset:32768
ds_read_b64_tr_b16 a[194:195], v143 offset:34816
v_mfma_f32_16x16x32_bf16 v[24:27], a[204:207], a[56:59], v[24:27]
buffer_load_dwordx4 v210, s[8:11], s49 offen offset:2048 lds
v_mfma_f32_16x16x32_bf16 v[28:31], a[200:203], a[52:55], v[28:31]
ds_read_b64_tr_b16 a[196:197], v143 offset:49152
v_mfma_f32_16x16x32_bf16 v[28:31], a[204:207], a[60:63], v[28:31]
s_waitcnt lgkmcnt(11)
ds_read_b64_tr_b16 a[198:199], v143 offset:51200
v_mfma_f32_16x16x32_bf16 v[32:35], a[208:211], a[48:51], v[32:35]
ds_read_b64_tr_b16 a[200:201], v136 offset:33024
ds_read_b64_tr_b16 a[202:203], v136 offset:35072
v_mfma_f32_16x16x32_bf16 v[32:35], a[212:215], a[56:59], v[32:35]
buffer_load_dwordx4 v211, s[8:11], s49 offen offset:3072 lds
v_mfma_f32_16x16x32_bf16 v[36:39], a[208:211], a[52:55], v[36:39]
ds_read_b64_tr_b16 a[204:205], v136 offset:49408
v_mfma_f32_16x16x32_bf16 v[36:39], a[212:215], a[60:63], v[36:39]
s_waitcnt lgkmcnt(11)
ds_read_b64_tr_b16 a[206:207], v136 offset:51456
v_mfma_f32_16x16x32_bf16 v[40:43], a[216:219], a[48:51], v[40:43]
ds_read_b64_tr_b16 a[208:209], v137 offset:33024
ds_read_b64_tr_b16 a[210:211], v137 offset:35072
v_mfma_f32_16x16x32_bf16 v[40:43], a[220:223], a[56:59], v[40:43]
buffer_load_dwordx4 a[100:103], v221, s[12:15], s50 offen sc1
v_mfma_f32_16x16x32_bf16 v[44:47], a[216:219], a[52:55], v[44:47]
ds_read_b64_tr_b16 a[212:213], v137 offset:49408
v_mfma_f32_16x16x32_bf16 v[44:47], a[220:223], a[60:63], v[44:47]
s_waitcnt lgkmcnt(11)
ds_read_b64_tr_b16 a[214:215], v137 offset:51456
v_mfma_f32_16x16x32_bf16 v[48:51], a[224:227], a[48:51], v[48:51]
s_add_u32 m0, s54, 0x9000
ds_read_b64_tr_b16 a[216:217], v138 offset:33024
ds_read_b64_tr_b16 a[218:219], v138 offset:35072
v_mfma_f32_16x16x32_bf16 v[48:51], a[228:231], a[56:59], v[48:51]
buffer_load_dwordx4 v212, s[8:11], s49 offen lds
v_mfma_f32_16x16x32_bf16 v[52:55], a[224:227], a[52:55], v[52:55]
ds_read_b64_tr_b16 a[220:221], v138 offset:49408
v_mfma_f32_16x16x32_bf16 v[52:55], a[228:231], a[60:63], v[52:55]
s_waitcnt lgkmcnt(11)
ds_read_b64_tr_b16 a[222:223], v138 offset:51456
v_mfma_f32_16x16x32_bf16 v[56:59], a[192:195], a[48:51], v[56:59]
ds_read_b64_tr_b16 a[224:225], v139 offset:33024
ds_read_b64_tr_b16 a[226:227], v139 offset:35072
v_mfma_f32_16x16x32_bf16 v[56:59], a[196:199], a[56:59], v[56:59]
buffer_load_dwordx4 v213, s[8:11], s49 offen offset:1024 lds
v_mfma_f32_16x16x32_bf16 v[60:63], a[192:195], a[52:55], v[60:63]
ds_read_b64_tr_b16 a[228:229], v139 offset:49408
v_mfma_f32_16x16x32_bf16 v[60:63], a[196:199], a[60:63], v[60:63]
s_waitcnt lgkmcnt(11)
ds_read_b64_tr_b16 a[230:231], v139 offset:51456
v_mfma_f32_16x16x32_bf16 v[64:67], a[200:203], a[48:51], v[64:67]
ds_read_b64_tr_b16 a[192:193], v140 offset:33024
ds_read_b64_tr_b16 a[194:195], v140 offset:35072
v_mfma_f32_16x16x32_bf16 v[64:67], a[204:207], a[56:59], v[64:67]
buffer_load_dwordx4 a[104:107], v220, s[12:15], s50 offen offset:1024 sc1
v_mfma_f32_16x16x32_bf16 v[68:71], a[200:203], a[52:55], v[68:71]
ds_read_b64_tr_b16 a[196:197], v140 offset:49408
v_mfma_f32_16x16x32_bf16 v[68:71], a[204:207], a[60:63], v[68:71]
s_waitcnt lgkmcnt(11)
ds_read_b64_tr_b16 a[198:199], v140 offset:51456
v_mfma_f32_16x16x32_bf16 v[72:75], a[208:211], a[48:51], v[72:75]
ds_read_b64_tr_b16 a[200:201], v141 offset:33024
ds_read_b64_tr_b16 a[202:203], v141 offset:35072
v_mfma_f32_16x16x32_bf16 v[72:75], a[212:215], a[56:59], v[72:75]
buffer_load_dwordx4 v214, s[8:11], s49 offen offset:2048 lds
v_mfma_f32_16x16x32_bf16 v[76:79], a[208:211], a[52:55], v[76:79]
ds_read_b64_tr_b16 a[204:205], v141 offset:49408
v_mfma_f32_16x16x32_bf16 v[76:79], a[212:215], a[60:63], v[76:79]
s_waitcnt lgkmcnt(11)
ds_read_b64_tr_b16 a[206:207], v141 offset:51456
v_mfma_f32_16x16x32_bf16 v[80:83], a[216:219], a[48:51], v[80:83]
ds_read_b64_tr_b16 a[208:209], v142 offset:33024
ds_read_b64_tr_b16 a[210:211], v142 offset:35072
v_mfma_f32_16x16x32_bf16 v[80:83], a[220:223], a[56:59], v[80:83]
buffer_load_dwordx4 v215, s[8:11], s49 offen offset:3072 lds
v_mfma_f32_16x16x32_bf16 v[84:87], a[216:219], a[52:55], v[84:87]
ds_read_b64_tr_b16 a[212:213], v142 offset:49408
v_mfma_f32_16x16x32_bf16 v[84:87], a[220:223], a[60:63], v[84:87]
s_waitcnt lgkmcnt(11)
ds_read_b64_tr_b16 a[214:215], v142 offset:51456
v_mfma_f32_16x16x32_bf16 v[88:91], a[224:227], a[48:51], v[88:91]
ds_read_b64_tr_b16 a[216:217], v143 offset:33024
ds_read_b64_tr_b16 a[218:219], v143 offset:35072
v_mfma_f32_16x16x32_bf16 v[88:91], a[228:231], a[56:59], v[88:91]
buffer_load_dwordx4 a[108:111], v221, s[12:15], s50 offen offset:1024 sc1
v_mfma_f32_16x16x32_bf16 v[92:95], a[224:227], a[52:55], v[92:95]
s_waitcnt vmcnt(17)
ds_read_b64_tr_b16 a[220:221], v143 offset:49408
v_mfma_f32_16x16x32_bf16 v[92:95], a[228:231], a[60:63], v[92:95]
s_waitcnt lgkmcnt(11)
s_barrier
ds_read_b64_tr_b16 a[222:223], v143 offset:51456
v_mfma_f32_16x16x32_bf16 v[96:99], a[192:195], a[48:51], v[96:99]
ds_read_b64_tr_b16 a[224:225], v128
ds_read_b64_tr_b16 a[226:227], v128 offset:2048
v_mfma_f32_16x16x32_bf16 v[96:99], a[196:199], a[56:59], v[96:99]
buffer_load_dwordx4 v[184:187], v223, s[36:39], s63 offen offset:640 sc1
v_mfma_f32_16x16x32_bf16 v[100:103], a[192:195], a[52:55], v[100:103]
ds_read_b64_tr_b16 a[228:229], v128 offset:16384
v_mfma_f32_16x16x32_bf16 v[100:103], a[196:199], a[60:63], v[100:103]
s_waitcnt lgkmcnt(11)
ds_read_b64_tr_b16 a[230:231], v128 offset:18432
v_mfma_f32_16x16x32_bf16 v[104:107], a[200:203], a[48:51], v[104:107]
ds_read_b64_tr_b16 a[192:193], v129
ds_read_b64_tr_b16 a[194:195], v129 offset:2048
v_mfma_f32_16x16x32_bf16 v[104:107], a[204:207], a[56:59], v[104:107]
buffer_load_dwordx4 v[188:191], v223, s[36:39], s63 offen offset:704 sc1
v_mfma_f32_16x16x32_bf16 v[108:111], a[200:203], a[52:55], v[108:111]
ds_read_b64_tr_b16 a[196:197], v129 offset:16384
v_mfma_f32_16x16x32_bf16 v[108:111], a[204:207], a[60:63], v[108:111]
s_waitcnt lgkmcnt(11)
ds_read_b64_tr_b16 a[198:199], v129 offset:18432
v_mfma_f32_16x16x32_bf16 v[112:115], a[208:211], a[48:51], v[112:115]
ds_read_b64_tr_b16 a[200:201], v130
ds_read_b64_tr_b16 a[202:203], v130 offset:2048
v_mfma_f32_16x16x32_bf16 v[112:115], a[212:215], a[56:59], v[112:115]
buffer_load_dwordx4 v[192:195], v223, s[36:39], s63 offen offset:768 sc1
v_mfma_f32_16x16x32_bf16 v[116:119], a[208:211], a[52:55], v[116:119]
ds_read_b64_tr_b16 a[204:205], v130 offset:16384
v_mfma_f32_16x16x32_bf16 v[116:119], a[212:215], a[60:63], v[116:119]
s_waitcnt lgkmcnt(11)
ds_read_b64_tr_b16 a[206:207], v130 offset:18432
v_mfma_f32_16x16x32_bf16 v[120:123], a[216:219], a[48:51], v[120:123]
ds_read_b64_tr_b16 a[208:209], v131
ds_read_b64_tr_b16 a[210:211], v131 offset:2048
v_mfma_f32_16x16x32_bf16 v[120:123], a[220:223], a[56:59], v[120:123]
buffer_load_dwordx4 v[196:199], v223, s[36:39], s63 offen offset:832 sc1
v_mfma_f32_16x16x32_bf16 v[124:127], a[216:219], a[52:55], v[124:127]
s_add_u32 s49, s49, 524288
ds_read_b64_tr_b16 a[212:213], v131 offset:16384
v_mfma_f32_16x16x32_bf16 v[124:127], a[220:223], a[60:63], v[124:127]
s_waitcnt lgkmcnt(11)
ds_read_b64_tr_b16 a[214:215], v131 offset:18432
v_mfma_f32_16x16x32_bf16 v[0:3], a[224:227], a[64:67], v[0:3]
s_add_u32 m0, s54, 0x10000
ds_read_b64_tr_b16 a[216:217], v132
ds_read_b64_tr_b16 a[218:219], v132 offset:2048
v_mfma_f32_16x16x32_bf16 v[0:3], a[228:231], a[72:75], v[0:3]
buffer_load_dwordx4 v208, s[8:11], s49 offen lds
v_mfma_f32_16x16x32_bf16 v[4:7], a[224:227], a[68:71], v[4:7]
ds_read_b64_tr_b16 a[220:221], v132 offset:16384
v_mfma_f32_16x16x32_bf16 v[4:7], a[228:231], a[76:79], v[4:7]
s_waitcnt lgkmcnt(11)
ds_read_b64_tr_b16 a[222:223], v132 offset:18432
v_mfma_f32_16x16x32_bf16 v[8:11], a[192:195], a[64:67], v[8:11]
ds_read_b64_tr_b16 a[224:225], v133
ds_read_b64_tr_b16 a[226:227], v133 offset:2048
v_mfma_f32_16x16x32_bf16 v[8:11], a[196:199], a[72:75], v[8:11]
buffer_load_dwordx4 v209, s[8:11], s49 offen offset:1024 lds
v_mfma_f32_16x16x32_bf16 v[12:15], a[192:195], a[68:71], v[12:15]
ds_read_b64_tr_b16 a[228:229], v133 offset:16384
v_mfma_f32_16x16x32_bf16 v[12:15], a[196:199], a[76:79], v[12:15]
s_waitcnt lgkmcnt(11)
ds_read_b64_tr_b16 a[230:231], v133 offset:18432
v_mfma_f32_16x16x32_bf16 v[16:19], a[200:203], a[64:67], v[16:19]
ds_read_b64_tr_b16 a[192:193], v134
ds_read_b64_tr_b16 a[194:195], v134 offset:2048
v_mfma_f32_16x16x32_bf16 v[16:19], a[204:207], a[72:75], v[16:19]
buffer_load_dwordx4 a[112:115], v220, s[12:15], s50 offen offset:2048 sc1
v_mfma_f32_16x16x32_bf16 v[20:23], a[200:203], a[68:71], v[20:23]
ds_read_b64_tr_b16 a[196:197], v134 offset:16384
v_mfma_f32_16x16x32_bf16 v[20:23], a[204:207], a[76:79], v[20:23]
s_waitcnt lgkmcnt(11)
ds_read_b64_tr_b16 a[198:199], v134 offset:18432
v_mfma_f32_16x16x32_bf16 v[24:27], a[208:211], a[64:67], v[24:27]
ds_read_b64_tr_b16 a[200:201], v135
ds_read_b64_tr_b16 a[202:203], v135 offset:2048
v_mfma_f32_16x16x32_bf16 v[24:27], a[212:215], a[72:75], v[24:27]
buffer_load_dwordx4 v210, s[8:11], s49 offen offset:2048 lds
v_mfma_f32_16x16x32_bf16 v[28:31], a[208:211], a[68:71], v[28:31]
ds_read_b64_tr_b16 a[204:205], v135 offset:16384
v_mfma_f32_16x16x32_bf16 v[28:31], a[212:215], a[76:79], v[28:31]
s_waitcnt lgkmcnt(11)
ds_read_b64_tr_b16 a[206:207], v135 offset:18432
v_mfma_f32_16x16x32_bf16 v[32:35], a[216:219], a[64:67], v[32:35]
ds_read_b64_tr_b16 a[208:209], v128 offset:256
ds_read_b64_tr_b16 a[210:211], v128 offset:2304
v_mfma_f32_16x16x32_bf16 v[32:35], a[220:223], a[72:75], v[32:35]
buffer_load_dwordx4 v211, s[8:11], s49 offen offset:3072 lds
v_mfma_f32_16x16x32_bf16 v[36:39], a[216:219], a[68:71], v[36:39]
ds_read_b64_tr_b16 a[212:213], v128 offset:16640
v_mfma_f32_16x16x32_bf16 v[36:39], a[220:223], a[76:79], v[36:39]
s_waitcnt lgkmcnt(11)
ds_read_b64_tr_b16 a[214:215], v128 offset:18688
v_mfma_f32_16x16x32_bf16 v[40:43], a[224:227], a[64:67], v[40:43]
ds_read_b64_tr_b16 a[216:217], v129 offset:256
ds_read_b64_tr_b16 a[218:219], v129 offset:2304
v_mfma_f32_16x16x32_bf16 v[40:43], a[228:231], a[72:75], v[40:43]
buffer_load_dwordx4 a[116:119], v221, s[12:15], s50 offen offset:2048 sc1
v_mfma_f32_16x16x32_bf16 v[44:47], a[224:227], a[68:71], v[44:47]
ds_read_b64_tr_b16 a[220:221], v129 offset:16640
v_mfma_f32_16x16x32_bf16 v[44:47], a[228:231], a[76:79], v[44:47]
s_waitcnt lgkmcnt(11)
ds_read_b64_tr_b16 a[222:223], v129 offset:18688
v_mfma_f32_16x16x32_bf16 v[48:51], a[192:195], a[64:67], v[48:51]
s_add_u32 m0, s54, 0x11000
ds_read_b64_tr_b16 a[224:225], v130 offset:256
ds_read_b64_tr_b16 a[226:227], v130 offset:2304
v_mfma_f32_16x16x32_bf16 v[48:51], a[196:199], a[72:75], v[48:51]
buffer_load_dwordx4 v212, s[8:11], s49 offen lds
v_mfma_f32_16x16x32_bf16 v[52:55], a[192:195], a[68:71], v[52:55]
ds_read_b64_tr_b16 a[228:229], v130 offset:16640
v_mfma_f32_16x16x32_bf16 v[52:55], a[196:199], a[76:79], v[52:55]
s_waitcnt lgkmcnt(11)
ds_read_b64_tr_b16 a[230:231], v130 offset:18688
v_mfma_f32_16x16x32_bf16 v[56:59], a[200:203], a[64:67], v[56:59]
ds_read_b64_tr_b16 a[192:193], v131 offset:256
v_mfma_f32_16x16x32_bf16 v[56:59], a[204:207], a[72:75], v[56:59]
ds_read_b64_tr_b16 a[194:195], v131 offset:2304
v_mfma_f32_16x16x32_bf16 v[60:63], a[200:203], a[68:71], v[60:63]
ds_read_b64_tr_b16 a[196:197], v131 offset:16640
v_mfma_f32_16x16x32_bf16 v[60:63], a[204:207], a[76:79], v[60:63]
s_waitcnt lgkmcnt(11)
ds_read_b64_tr_b16 a[198:199], v131 offset:18688
v_mfma_f32_16x16x32_bf16 v[64:67], a[208:211], a[64:67], v[64:67]
ds_read_b64_tr_b16 a[200:201], v132 offset:256
ds_read_b64_tr_b16 a[202:203], v132 offset:2304
v_mfma_f32_16x16x32_bf16 v[64:67], a[212:215], a[72:75], v[64:67]
buffer_load_dwordx4 v213, s[8:11], s49 offen offset:1024 lds
v_mfma_f32_16x16x32_bf16 v[68:71], a[208:211], a[68:71], v[68:71]
ds_read_b64_tr_b16 a[204:205], v132 offset:16640
v_mfma_f32_16x16x32_bf16 v[68:71], a[212:215], a[76:79], v[68:71]
s_waitcnt lgkmcnt(11)
ds_read_b64_tr_b16 a[206:207], v132 offset:18688
v_mfma_f32_16x16x32_bf16 v[72:75], a[216:219], a[64:67], v[72:75]
ds_read_b64_tr_b16 a[208:209], v133 offset:256
ds_read_b64_tr_b16 a[210:211], v133 offset:2304
v_mfma_f32_16x16x32_bf16 v[72:75], a[220:223], a[72:75], v[72:75]
buffer_load_dwordx4 a[120:123], v220, s[12:15], s50 offen offset:3072 sc1
v_mfma_f32_16x16x32_bf16 v[76:79], a[216:219], a[68:71], v[76:79]
ds_read_b64_tr_b16 a[212:213], v133 offset:16640
v_mfma_f32_16x16x32_bf16 v[76:79], a[220:223], a[76:79], v[76:79]
s_waitcnt lgkmcnt(11)
ds_read_b64_tr_b16 a[214:215], v133 offset:18688
v_mfma_f32_16x16x32_bf16 v[80:83], a[224:227], a[64:67], v[80:83]
ds_read_b64_tr_b16 a[216:217], v134 offset:256
ds_read_b64_tr_b16 a[218:219], v134 offset:2304
v_mfma_f32_16x16x32_bf16 v[80:83], a[228:231], a[72:75], v[80:83]
buffer_load_dwordx4 v214, s[8:11], s49 offen offset:2048 lds
v_mfma_f32_16x16x32_bf16 v[84:87], a[224:227], a[68:71], v[84:87]
ds_read_b64_tr_b16 a[220:221], v134 offset:16640
v_mfma_f32_16x16x32_bf16 v[84:87], a[228:231], a[76:79], v[84:87]
s_waitcnt lgkmcnt(11)
ds_read_b64_tr_b16 a[222:223], v134 offset:18688
v_mfma_f32_16x16x32_bf16 v[88:91], a[192:195], a[64:67], v[88:91]
ds_read_b64_tr_b16 a[224:225], v135 offset:256
ds_read_b64_tr_b16 a[226:227], v135 offset:2304
v_mfma_f32_16x16x32_bf16 v[88:91], a[196:199], a[72:75], v[88:91]
buffer_load_dwordx4 v215, s[8:11], s49 offen offset:3072 lds
v_mfma_f32_16x16x32_bf16 v[92:95], a[192:195], a[68:71], v[92:95]
s_waitcnt vmcnt(16)
ds_read_b64_tr_b16 a[228:229], v135 offset:16640
v_mfma_f32_16x16x32_bf16 v[92:95], a[196:199], a[76:79], v[92:95]
s_waitcnt lgkmcnt(11)
s_barrier
ds_read_b64_tr_b16 a[230:231], v135 offset:18688
v_mfma_f32_16x16x32_bf16 v[96:99], a[200:203], a[64:67], v[96:99]
ds_read_b64_tr_b16 a[192:193], v128 offset:32768
ds_read_b64_tr_b16 a[194:195], v128 offset:34816
v_mfma_f32_16x16x32_bf16 v[96:99], a[204:207], a[72:75], v[96:99]
buffer_load_dwordx4 a[124:127], v221, s[12:15], s50 offen offset:3072 sc1
v_mfma_f32_16x16x32_bf16 v[100:103], a[200:203], a[68:71], v[100:103]
ds_read_b64_tr_b16 a[196:197], v128 offset:49152
v_mfma_f32_16x16x32_bf16 v[100:103], a[204:207], a[76:79], v[100:103]
s_waitcnt lgkmcnt(11)
ds_read_b64_tr_b16 a[198:199], v128 offset:51200
v_mfma_f32_16x16x32_bf16 v[104:107], a[208:211], a[64:67], v[104:107]
ds_read_b64_tr_b16 a[200:201], v129 offset:32768
ds_read_b64_tr_b16 a[202:203], v129 offset:34816
v_mfma_f32_16x16x32_bf16 v[104:107], a[212:215], a[72:75], v[104:107]
buffer_load_dwordx4 v[200:203], v223, s[36:39], s63 offen offset:896 sc1
v_mfma_f32_16x16x32_bf16 v[108:111], a[208:211], a[68:71], v[108:111]
ds_read_b64_tr_b16 a[204:205], v129 offset:49152
v_mfma_f32_16x16x32_bf16 v[108:111], a[212:215], a[76:79], v[108:111]
s_waitcnt lgkmcnt(11)
ds_read_b64_tr_b16 a[206:207], v129 offset:51200
v_mfma_f32_16x16x32_bf16 v[112:115], a[216:219], a[64:67], v[112:115]
ds_read_b64_tr_b16 a[208:209], v130 offset:32768
ds_read_b64_tr_b16 a[210:211], v130 offset:34816
v_mfma_f32_16x16x32_bf16 v[112:115], a[220:223], a[72:75], v[112:115]
buffer_load_dwordx4 v[204:207], v223, s[36:39], s63 offen offset:960 sc1
v_mfma_f32_16x16x32_bf16 v[116:119], a[216:219], a[68:71], v[116:119]
s_add_u32 s49, s49, 524288
ds_read_b64_tr_b16 a[212:213], v130 offset:49152
v_mfma_f32_16x16x32_bf16 v[116:119], a[220:223], a[76:79], v[116:119]
s_waitcnt lgkmcnt(11)
ds_read_b64_tr_b16 a[214:215], v130 offset:51200
v_mfma_f32_16x16x32_bf16 v[120:123], a[224:227], a[64:67], v[120:123]
ds_read_b64_tr_b16 a[216:217], v131 offset:32768
v_mfma_f32_16x16x32_bf16 v[120:123], a[228:231], a[72:75], v[120:123]
ds_read_b64_tr_b16 a[218:219], v131 offset:34816
v_mfma_f32_16x16x32_bf16 v[124:127], a[224:227], a[68:71], v[124:127]
ds_read_b64_tr_b16 a[220:221], v131 offset:49152
v_mfma_f32_16x16x32_bf16 v[124:127], a[228:231], a[76:79], v[124:127]
s_waitcnt lgkmcnt(11)
ds_read_b64_tr_b16 a[222:223], v131 offset:51200
v_mfma_f32_16x16x32_bf16 v[0:3], a[192:195], a[80:83], v[0:3]
ds_read_b64_tr_b16 a[224:225], v132 offset:32768
ds_read_b64_tr_b16 a[226:227], v132 offset:34816
v_mfma_f32_16x16x32_bf16 v[0:3], a[196:199], a[88:91], v[0:3]
buffer_load_dword v247, v246, s[72:75], 0 offen sc1
v_mfma_f32_16x16x32_bf16 v[4:7], a[192:195], a[84:87], v[4:7]
ds_read_b64_tr_b16 a[228:229], v132 offset:49152
v_mfma_f32_16x16x32_bf16 v[4:7], a[196:199], a[92:95], v[4:7]
s_waitcnt lgkmcnt(11)
ds_read_b64_tr_b16 a[230:231], v132 offset:51200
v_mfma_f32_16x16x32_bf16 v[8:11], a[200:203], a[80:83], v[8:11]
s_add_u32 m0, s54, 0x18000
ds_read_b64_tr_b16 a[192:193], v133 offset:32768
ds_read_b64_tr_b16 a[194:195], v133 offset:34816
v_mfma_f32_16x16x32_bf16 v[8:11], a[204:207], a[88:91], v[8:11]
buffer_load_dwordx4 v208, s[8:11], s49 offen lds
v_mfma_f32_16x16x32_bf16 v[12:15], a[200:203], a[84:87], v[12:15]
ds_read_b64_tr_b16 a[196:197], v133 offset:49152
v_mfma_f32_16x16x32_bf16 v[12:15], a[204:207], a[92:95], v[12:15]
s_waitcnt lgkmcnt(11)
ds_read_b64_tr_b16 a[198:199], v133 offset:51200
v_mfma_f32_16x16x32_bf16 v[16:19], a[208:211], a[80:83], v[16:19]
s_add_u32 s50, s50, 4096
ds_read_b64_tr_b16 a[200:201], v134 offset:32768
ds_read_b64_tr_b16 a[202:203], v134 offset:34816
v_mfma_f32_16x16x32_bf16 v[16:19], a[212:215], a[88:91], v[16:19]
buffer_load_dwordx4 a[128:131], v220, s[12:15], s50 offen sc1
v_mfma_f32_16x16x32_bf16 v[20:23], a[208:211], a[84:87], v[20:23]
ds_read_b64_tr_b16 a[204:205], v134 offset:49152
v_mfma_f32_16x16x32_bf16 v[20:23], a[212:215], a[92:95], v[20:23]
s_waitcnt lgkmcnt(11)
ds_read_b64_tr_b16 a[206:207], v134 offset:51200
v_mfma_f32_16x16x32_bf16 v[24:27], a[216:219], a[80:83], v[24:27]
ds_read_b64_tr_b16 a[208:209], v135 offset:32768
ds_read_b64_tr_b16 a[210:211], v135 offset:34816
v_mfma_f32_16x16x32_bf16 v[24:27], a[220:223], a[88:91], v[24:27]
buffer_load_dwordx4 v209, s[8:11], s49 offen offset:1024 lds
v_mfma_f32_16x16x32_bf16 v[28:31], a[216:219], a[84:87], v[28:31]
ds_read_b64_tr_b16 a[212:213], v135 offset:49152
v_mfma_f32_16x16x32_bf16 v[28:31], a[220:223], a[92:95], v[28:31]
s_waitcnt lgkmcnt(11)
ds_read_b64_tr_b16 a[214:215], v135 offset:51200
v_mfma_f32_16x16x32_bf16 v[32:35], a[224:227], a[80:83], v[32:35]
ds_read_b64_tr_b16 a[216:217], v128 offset:33024
ds_read_b64_tr_b16 a[218:219], v128 offset:35072
v_mfma_f32_16x16x32_bf16 v[32:35], a[228:231], a[88:91], v[32:35]
buffer_load_dwordx4 v210, s[8:11], s49 offen offset:2048 lds
v_mfma_f32_16x16x32_bf16 v[36:39], a[224:227], a[84:87], v[36:39]
ds_read_b64_tr_b16 a[220:221], v128 offset:49408
v_mfma_f32_16x16x32_bf16 v[36:39], a[228:231], a[92:95], v[36:39]
s_waitcnt lgkmcnt(11)
ds_read_b64_tr_b16 a[222:223], v128 offset:51456
v_mfma_f32_16x16x32_bf16 v[40:43], a[192:195], a[80:83], v[40:43]
ds_read_b64_tr_b16 a[224:225], v129 offset:33024
v_mfma_f32_16x16x32_bf16 v[40:43], a[196:199], a[88:91], v[40:43]
ds_read_b64_tr_b16 a[226:227], v129 offset:35072
v_mfma_f32_16x16x32_bf16 v[44:47], a[192:195], a[84:87], v[44:47]
ds_read_b64_tr_b16 a[228:229], v129 offset:49408
v_mfma_f32_16x16x32_bf16 v[44:47], a[196:199], a[92:95], v[44:47]
s_waitcnt lgkmcnt(11)
ds_read_b64_tr_b16 a[230:231], v129 offset:51456
v_mfma_f32_16x16x32_bf16 v[48:51], a[200:203], a[80:83], v[48:51]
ds_read_b64_tr_b16 a[192:193], v130 offset:33024
ds_read_b64_tr_b16 a[194:195], v130 offset:35072
v_mfma_f32_16x16x32_bf16 v[48:51], a[204:207], a[88:91], v[48:51]
buffer_load_dwordx4 a[132:135], v221, s[12:15], s50 offen sc1
v_mfma_f32_16x16x32_bf16 v[52:55], a[200:203], a[84:87], v[52:55]
ds_read_b64_tr_b16 a[196:197], v130 offset:49408
v_mfma_f32_16x16x32_bf16 v[52:55], a[204:207], a[92:95], v[52:55]
s_waitcnt lgkmcnt(11)
ds_read_b64_tr_b16 a[198:199], v130 offset:51456
v_mfma_f32_16x16x32_bf16 v[56:59], a[208:211], a[80:83], v[56:59]
ds_read_b64_tr_b16 a[200:201], v131 offset:33024
ds_read_b64_tr_b16 a[202:203], v131 offset:35072
v_mfma_f32_16x16x32_bf16 v[56:59], a[212:215], a[88:91], v[56:59]
buffer_load_dwordx4 v211, s[8:11], s49 offen offset:3072 lds
v_mfma_f32_16x16x32_bf16 v[60:63], a[208:211], a[84:87], v[60:63]
ds_read_b64_tr_b16 a[204:205], v131 offset:49408
v_mfma_f32_16x16x32_bf16 v[60:63], a[212:215], a[92:95], v[60:63]
s_waitcnt lgkmcnt(11)
ds_read_b64_tr_b16 a[206:207], v131 offset:51456
v_mfma_f32_16x16x32_bf16 v[64:67], a[216:219], a[80:83], v[64:67]
s_add_u32 m0, s54, 0x19000
ds_read_b64_tr_b16 a[208:209], v132 offset:33024
ds_read_b64_tr_b16 a[210:211], v132 offset:35072
v_mfma_f32_16x16x32_bf16 v[64:67], a[220:223], a[88:91], v[64:67]
buffer_load_dwordx4 v212, s[8:11], s49 offen lds
v_mfma_f32_16x16x32_bf16 v[68:71], a[216:219], a[84:87], v[68:71]
ds_read_b64_tr_b16 a[212:213], v132 offset:49408
v_mfma_f32_16x16x32_bf16 v[68:71], a[220:223], a[92:95], v[68:71]
s_waitcnt lgkmcnt(11)
ds_read_b64_tr_b16 a[214:215], v132 offset:51456
v_mfma_f32_16x16x32_bf16 v[72:75], a[224:227], a[80:83], v[72:75]
ds_read_b64_tr_b16 a[216:217], v133 offset:33024
ds_read_b64_tr_b16 a[218:219], v133 offset:35072
v_mfma_f32_16x16x32_bf16 v[72:75], a[228:231], a[88:91], v[72:75]
buffer_load_dwordx4 a[136:139], v220, s[12:15], s50 offen offset:1024 sc1
v_mfma_f32_16x16x32_bf16 v[76:79], a[224:227], a[84:87], v[76:79]
ds_read_b64_tr_b16 a[220:221], v133 offset:49408
v_mfma_f32_16x16x32_bf16 v[76:79], a[228:231], a[92:95], v[76:79]
s_waitcnt lgkmcnt(11)
ds_read_b64_tr_b16 a[222:223], v133 offset:51456
v_mfma_f32_16x16x32_bf16 v[80:83], a[192:195], a[80:83], v[80:83]
ds_read_b64_tr_b16 a[224:225], v134 offset:33024
v_mfma_f32_16x16x32_bf16 v[80:83], a[196:199], a[88:91], v[80:83]
ds_read_b64_tr_b16 a[226:227], v134 offset:35072
v_mfma_f32_16x16x32_bf16 v[84:87], a[192:195], a[84:87], v[84:87]
ds_read_b64_tr_b16 a[228:229], v134 offset:49408
v_mfma_f32_16x16x32_bf16 v[84:87], a[196:199], a[92:95], v[84:87]
s_waitcnt lgkmcnt(11)
ds_read_b64_tr_b16 a[230:231], v134 offset:51456
v_mfma_f32_16x16x32_bf16 v[88:91], a[200:203], a[80:83], v[88:91]
ds_read_b64_tr_b16 a[192:193], v135 offset:33024
ds_read_b64_tr_b16 a[194:195], v135 offset:35072
v_mfma_f32_16x16x32_bf16 v[88:91], a[204:207], a[88:91], v[88:91]
buffer_load_dwordx4 v213, s[8:11], s49 offen offset:1024 lds
v_mfma_f32_16x16x32_bf16 v[92:95], a[200:203], a[84:87], v[92:95]
s_waitcnt vmcnt(13)
ds_read_b64_tr_b16 a[196:197], v135 offset:49408
v_mfma_f32_16x16x32_bf16 v[92:95], a[204:207], a[92:95], v[92:95]
s_waitcnt lgkmcnt(11)
s_barrier
ds_read_b64_tr_b16 a[198:199], v135 offset:51456
v_mfma_f32_16x16x32_bf16 v[96:99], a[208:211], a[80:83], v[96:99]
ds_read_b64_tr_b16 a[200:201], v136
ds_read_b64_tr_b16 a[202:203], v136 offset:2048
v_mfma_f32_16x16x32_bf16 v[96:99], a[212:215], a[88:91], v[96:99]
buffer_load_dwordx4 v214, s[8:11], s49 offen offset:2048 lds
v_mfma_f32_16x16x32_bf16 v[100:103], a[208:211], a[84:87], v[100:103]
ds_read_b64_tr_b16 a[204:205], v136 offset:16384
v_mfma_f32_16x16x32_bf16 v[100:103], a[212:215], a[92:95], v[100:103]
s_waitcnt lgkmcnt(11)
ds_read_b64_tr_b16 a[206:207], v136 offset:18432
v_mfma_f32_16x16x32_bf16 v[104:107], a[216:219], a[80:83], v[104:107]
ds_read_b64_tr_b16 a[208:209], v137
ds_read_b64_tr_b16 a[210:211], v137 offset:2048
v_mfma_f32_16x16x32_bf16 v[104:107], a[220:223], a[88:91], v[104:107]
buffer_load_dwordx4 a[140:143], v221, s[12:15], s50 offen offset:1024 sc1
v_mfma_f32_16x16x32_bf16 v[108:111], a[216:219], a[84:87], v[108:111]
ds_read_b64_tr_b16 a[212:213], v137 offset:16384
v_mfma_f32_16x16x32_bf16 v[108:111], a[220:223], a[92:95], v[108:111]
s_waitcnt lgkmcnt(11)
ds_read_b64_tr_b16 a[214:215], v137 offset:18432
v_mfma_f32_16x16x32_bf16 v[112:115], a[224:227], a[80:83], v[112:115]
ds_read_b64_tr_b16 a[216:217], v138
ds_read_b64_tr_b16 a[218:219], v138 offset:2048
v_mfma_f32_16x16x32_bf16 v[112:115], a[228:231], a[88:91], v[112:115]
buffer_load_dwordx4 v215, s[8:11], s49 offen offset:3072 lds
v_mfma_f32_16x16x32_bf16 v[116:119], a[224:227], a[84:87], v[116:119]
s_add_u32 s49, s49, 524288
ds_read_b64_tr_b16 a[220:221], v138 offset:16384
v_mfma_f32_16x16x32_bf16 v[116:119], a[228:231], a[92:95], v[116:119]
s_waitcnt lgkmcnt(11)
ds_read_b64_tr_b16 a[222:223], v138 offset:18432
v_mfma_f32_16x16x32_bf16 v[120:123], a[192:195], a[80:83], v[120:123]
ds_read_b64_tr_b16 a[224:225], v139
v_mfma_f32_16x16x32_bf16 v[120:123], a[196:199], a[88:91], v[120:123]
ds_read_b64_tr_b16 a[226:227], v139 offset:2048
v_mfma_f32_16x16x32_bf16 v[124:127], a[192:195], a[84:87], v[124:127]
ds_read_b64_tr_b16 a[228:229], v139 offset:16384
v_mfma_f32_16x16x32_bf16 v[124:127], a[196:199], a[92:95], v[124:127]
s_waitcnt lgkmcnt(11)
ds_read_b64_tr_b16 a[230:231], v139 offset:18432
v_mfma_f32_16x16x32_bf16 v[0:3], a[200:203], a[96:99], v[0:3]
ds_read_b64_tr_b16 a[192:193], v140
ds_read_b64_tr_b16 a[194:195], v140 offset:2048
v_mfma_f32_16x16x32_bf16 v[0:3], a[204:207], a[104:107], v[0:3]
buffer_load_dword v245, v244, s[32:35], 0 offen
v_mfma_f32_16x16x32_bf16 v[4:7], a[200:203], a[100:103], v[4:7]
ds_read_b64_tr_b16 a[196:197], v140 offset:16384
v_mfma_f32_16x16x32_bf16 v[4:7], a[204:207], a[108:111], v[4:7]
s_waitcnt lgkmcnt(11)
ds_read_b64_tr_b16 a[198:199], v140 offset:18432
v_mfma_f32_16x16x32_bf16 v[8:11], a[208:211], a[96:99], v[8:11]
s_add_u32 m0, s54, 0x0
ds_read_b64_tr_b16 a[200:201], v141
ds_read_b64_tr_b16 a[202:203], v141 offset:2048
v_mfma_f32_16x16x32_bf16 v[8:11], a[212:215], a[104:107], v[8:11]
buffer_load_dwordx4 v208, s[8:11], s49 offen lds
v_mfma_f32_16x16x32_bf16 v[12:15], a[208:211], a[100:103], v[12:15]
ds_read_b64_tr_b16 a[204:205], v141 offset:16384
v_mfma_f32_16x16x32_bf16 v[12:15], a[212:215], a[108:111], v[12:15]
s_waitcnt lgkmcnt(11)
ds_read_b64_tr_b16 a[206:207], v141 offset:18432
v_mfma_f32_16x16x32_bf16 v[16:19], a[216:219], a[96:99], v[16:19]
ds_read_b64_tr_b16 a[208:209], v142
v_mfma_f32_16x16x32_bf16 v[16:19], a[220:223], a[104:107], v[16:19]
ds_read_b64_tr_b16 a[210:211], v142 offset:2048
v_mfma_f32_16x16x32_bf16 v[20:23], a[216:219], a[100:103], v[20:23]
ds_read_b64_tr_b16 a[212:213], v142 offset:16384
v_mfma_f32_16x16x32_bf16 v[20:23], a[220:223], a[108:111], v[20:23]
s_waitcnt lgkmcnt(11)
ds_read_b64_tr_b16 a[214:215], v142 offset:18432
v_mfma_f32_16x16x32_bf16 v[24:27], a[224:227], a[96:99], v[24:27]
ds_read_b64_tr_b16 a[216:217], v143
ds_read_b64_tr_b16 a[218:219], v143 offset:2048
v_mfma_f32_16x16x32_bf16 v[24:27], a[228:231], a[104:107], v[24:27]
buffer_load_dwordx4 v209, s[8:11], s49 offen offset:1024 lds
v_mfma_f32_16x16x32_bf16 v[28:31], a[224:227], a[100:103], v[28:31]
ds_read_b64_tr_b16 a[220:221], v143 offset:16384
v_mfma_f32_16x16x32_bf16 v[28:31], a[228:231], a[108:111], v[28:31]
s_waitcnt lgkmcnt(11)
ds_read_b64_tr_b16 a[222:223], v143 offset:18432
v_mfma_f32_16x16x32_bf16 v[32:35], a[192:195], a[96:99], v[32:35]
ds_read_b64_tr_b16 a[224:225], v136 offset:256
v_mfma_f32_16x16x32_bf16 v[32:35], a[196:199], a[104:107], v[32:35]
ds_read_b64_tr_b16 a[226:227], v136 offset:2304
v_mfma_f32_16x16x32_bf16 v[36:39], a[192:195], a[100:103], v[36:39]
ds_read_b64_tr_b16 a[228:229], v136 offset:16640
v_mfma_f32_16x16x32_bf16 v[36:39], a[196:199], a[108:111], v[36:39]
s_waitcnt lgkmcnt(11)
ds_read_b64_tr_b16 a[230:231], v136 offset:18688
v_mfma_f32_16x16x32_bf16 v[40:43], a[200:203], a[96:99], v[40:43]
ds_read_b64_tr_b16 a[192:193], v137 offset:256
ds_read_b64_tr_b16 a[194:195], v137 offset:2304
v_mfma_f32_16x16x32_bf16 v[40:43], a[204:207], a[104:107], v[40:43]
buffer_load_dwordx4 v210, s[8:11], s49 offen offset:2048 lds
v_mfma_f32_16x16x32_bf16 v[44:47], a[200:203], a[100:103], v[44:47]
ds_read_b64_tr_b16 a[196:197], v137 offset:16640
v_mfma_f32_16x16x32_bf16 v[44:47], a[204:207], a[108:111], v[44:47]
s_waitcnt lgkmcnt(11)
ds_read_b64_tr_b16 a[198:199], v137 offset:18688
v_mfma_f32_16x16x32_bf16 v[48:51], a[208:211], a[96:99], v[48:51]
ds_read_b64_tr_b16 a[200:201], v138 offset:256
v_mfma_f32_16x16x32_bf16 v[48:51], a[212:215], a[104:107], v[48:51]
ds_read_b64_tr_b16 a[202:203], v138 offset:2304
v_mfma_f32_16x16x32_bf16 v[52:55], a[208:211], a[100:103], v[52:55]
ds_read_b64_tr_b16 a[204:205], v138 offset:16640
v_mfma_f32_16x16x32_bf16 v[52:55], a[212:215], a[108:111], v[52:55]
s_waitcnt lgkmcnt(11)
ds_read_b64_tr_b16 a[206:207], v138 offset:18688
v_mfma_f32_16x16x32_bf16 v[56:59], a[216:219], a[96:99], v[56:59]
ds_read_b64_tr_b16 a[208:209], v139 offset:256
ds_read_b64_tr_b16 a[210:211], v139 offset:2304
v_mfma_f32_16x16x32_bf16 v[56:59], a[220:223], a[104:107], v[56:59]
buffer_load_dwordx4 v211, s[8:11], s49 offen offset:3072 lds
v_mfma_f32_16x16x32_bf16 v[60:63], a[216:219], a[100:103], v[60:63]
ds_read_b64_tr_b16 a[212:213], v139 offset:16640
v_mfma_f32_16x16x32_bf16 v[60:63], a[220:223], a[108:111], v[60:63]
s_waitcnt lgkmcnt(11)
ds_read_b64_tr_b16 a[214:215], v139 offset:18688
v_mfma_f32_16x16x32_bf16 v[64:67], a[224:227], a[96:99], v[64:67]
s_add_u32 m0, s54, 0x1000
ds_read_b64_tr_b16 a[216:217], v140 offset:256
ds_read_b64_tr_b16 a[218:219], v140 offset:2304
v_mfma_f32_16x16x32_bf16 v[64:67], a[228:231], a[104:107], v[64:67]
buffer_load_dwordx4 v212, s[8:11], s49 offen lds
v_mfma_f32_16x16x32_bf16 v[68:71], a[224:227], a[100:103], v[68:71]
ds_read_b64_tr_b16 a[220:221], v140 offset:16640
v_mfma_f32_16x16x32_bf16 v[68:71], a[228:231], a[108:111], v[68:71]
s_waitcnt lgkmcnt(11)
ds_read_b64_tr_b16 a[222:223], v140 offset:18688
v_mfma_f32_16x16x32_bf16 v[72:75], a[192:195], a[96:99], v[72:75]
ds_read_b64_tr_b16 a[224:225], v141 offset:256
v_mfma_f32_16x16x32_bf16 v[72:75], a[196:199], a[104:107], v[72:75]
ds_read_b64_tr_b16 a[226:227], v141 offset:2304
v_mfma_f32_16x16x32_bf16 v[76:79], a[192:195], a[100:103], v[76:79]
ds_read_b64_tr_b16 a[228:229], v141 offset:16640
v_mfma_f32_16x16x32_bf16 v[76:79], a[196:199], a[108:111], v[76:79]
s_waitcnt lgkmcnt(11)
ds_read_b64_tr_b16 a[230:231], v141 offset:18688
v_mfma_f32_16x16x32_bf16 v[80:83], a[200:203], a[96:99], v[80:83]
ds_read_b64_tr_b16 a[192:193], v142 offset:256
ds_read_b64_tr_b16 a[194:195], v142 offset:2304
v_mfma_f32_16x16x32_bf16 v[80:83], a[204:207], a[104:107], v[80:83]
buffer_load_dwordx4 v213, s[8:11], s49 offen offset:1024 lds
v_mfma_f32_16x16x32_bf16 v[84:87], a[200:203], a[100:103], v[84:87]
ds_read_b64_tr_b16 a[196:197], v142 offset:16640
v_mfma_f32_16x16x32_bf16 v[84:87], a[204:207], a[108:111], v[84:87]
s_waitcnt lgkmcnt(11)
ds_read_b64_tr_b16 a[198:199], v142 offset:18688
v_mfma_f32_16x16x32_bf16 v[88:91], a[208:211], a[96:99], v[88:91]
ds_read_b64_tr_b16 a[200:201], v143 offset:256
v_mfma_f32_16x16x32_bf16 v[88:91], a[212:215], a[104:107], v[88:91]
ds_read_b64_tr_b16 a[202:203], v143 offset:2304
v_mfma_f32_16x16x32_bf16 v[92:95], a[208:211], a[100:103], v[92:95]
s_waitcnt vmcnt(7)
ds_read_b64_tr_b16 a[204:205], v143 offset:16640
v_mfma_f32_16x16x32_bf16 v[92:95], a[212:215], a[108:111], v[92:95]
s_waitcnt lgkmcnt(11)
s_barrier
ds_read_b64_tr_b16 a[206:207], v143 offset:18688
v_mfma_f32_16x16x32_bf16 v[96:99], a[216:219], a[96:99], v[96:99]
ds_read_b64_tr_b16 a[208:209], v136 offset:32768
ds_read_b64_tr_b16 a[210:211], v136 offset:34816
v_mfma_f32_16x16x32_bf16 v[96:99], a[220:223], a[104:107], v[96:99]
buffer_load_dwordx4 v214, s[8:11], s49 offen offset:2048 lds
v_mfma_f32_16x16x32_bf16 v[100:103], a[216:219], a[100:103], v[100:103]
ds_read_b64_tr_b16 a[212:213], v136 offset:49152
v_mfma_f32_16x16x32_bf16 v[100:103], a[220:223], a[108:111], v[100:103]
s_waitcnt lgkmcnt(11)
ds_read_b64_tr_b16 a[214:215], v136 offset:51200
v_mfma_f32_16x16x32_bf16 v[104:107], a[224:227], a[96:99], v[104:107]
ds_read_b64_tr_b16 a[216:217], v137 offset:32768
v_mfma_f32_16x16x32_bf16 v[104:107], a[228:231], a[104:107], v[104:107]
ds_read_b64_tr_b16 a[218:219], v137 offset:34816
v_mfma_f32_16x16x32_bf16 v[108:111], a[224:227], a[100:103], v[108:111]
ds_read_b64_tr_b16 a[220:221], v137 offset:49152
v_mfma_f32_16x16x32_bf16 v[108:111], a[228:231], a[108:111], v[108:111]
s_waitcnt lgkmcnt(11)
ds_read_b64_tr_b16 a[222:223], v137 offset:51200
v_mfma_f32_16x16x32_bf16 v[112:115], a[192:195], a[96:99], v[112:115]
ds_read_b64_tr_b16 a[224:225], v138 offset:32768
ds_read_b64_tr_b16 a[226:227], v138 offset:34816
v_mfma_f32_16x16x32_bf16 v[112:115], a[196:199], a[104:107], v[112:115]
buffer_load_dwordx4 v215, s[8:11], s49 offen offset:3072 lds
v_mfma_f32_16x16x32_bf16 v[116:119], a[192:195], a[100:103], v[116:119]
s_add_u32 s49, s49, 524288
ds_read_b64_tr_b16 a[228:229], v138 offset:49152
v_mfma_f32_16x16x32_bf16 v[116:119], a[196:199], a[108:111], v[116:119]
s_waitcnt lgkmcnt(11)
ds_read_b64_tr_b16 a[230:231], v138 offset:51200
v_mfma_f32_16x16x32_bf16 v[120:123], a[200:203], a[96:99], v[120:123]
ds_read_b64_tr_b16 a[192:193], v139 offset:32768
v_mfma_f32_16x16x32_bf16 v[120:123], a[204:207], a[104:107], v[120:123]
ds_read_b64_tr_b16 a[194:195], v139 offset:34816
v_mfma_f32_16x16x32_bf16 v[124:127], a[200:203], a[100:103], v[124:127]
ds_read_b64_tr_b16 a[196:197], v139 offset:49152
v_mfma_f32_16x16x32_bf16 v[124:127], a[204:207], a[108:111], v[124:127]
s_waitcnt lgkmcnt(11)
ds_read_b64_tr_b16 a[198:199], v139 offset:51200
s_cmp_lg_u32 s40, 0
s_cbranch_scc1 L_lk_x1
s_mov_b32 s58, 0
L_lc_x1:
v_and_b32 v252, 0xffff, v247
v_cmp_ge_u32 vcc, v252, v248
s_nop 3
s_cmp_eq_u64 vcc, -1
s_cbranch_scc1 L_lk_x1
s_add_u32 s58, s58, 1
s_cmp_ge_u32 s58, 65536
s_cbranch_scc1 L_lk_x1
s_sleep 24
buffer_load_dword v247, v246, s[72:75], 0 offen sc1
s_waitcnt vmcnt(0)
s_branch L_lc_x1
L_lk_x1:
s_barrier
v_mfma_f32_16x16x32_bf16 v[0:3], a[208:211], a[112:115], v[0:3]
s_add_u32 m0, s53, 0x8000
ds_read_b64_tr_b16 a[200:201], v140 offset:32768
ds_read_b64_tr_b16 a[202:203], v140 offset:34816
v_mfma_f32_16x16x32_bf16 v[0:3], a[212:215], a[120:123], v[0:3]
buffer_load_dwordx4 v230, s[4:7], s47 offen lds
v_mfma_f32_16x16x32_bf16 v[4:7], a[208:211], a[116:119], v[4:7]
ds_read_b64_tr_b16 a[204:205], v140 offset:49152
v_mfma_f32_16x16x32_bf16 v[4:7], a[212:215], a[124:127], v[4:7]
s_waitcnt lgkmcnt(11)
ds_read_b64_tr_b16 a[206:207], v140 offset:51200
v_mfma_f32_16x16x32_bf16 v[8:11], a[216:219], a[112:115], v[8:11]
ds_read_b64_tr_b16 a[208:209], v141 offset:32768
ds_read_b64_tr_b16 a[210:211], v141 offset:34816
v_mfma_f32_16x16x32_bf16 v[8:11], a[220:223], a[120:123], v[8:11]
buffer_load_dwordx4 v231, s[4:7], s47 offen offset:1024 lds
v_mfma_f32_16x16x32_bf16 v[12:15], a[216:219], a[116:119], v[12:15]
ds_read_b64_tr_b16 a[212:213], v141 offset:49152
v_mfma_f32_16x16x32_bf16 v[12:15], a[220:223], a[124:127], v[12:15]
s_waitcnt lgkmcnt(11)
ds_read_b64_tr_b16 a[214:215], v141 offset:51200
v_mfma_f32_16x16x32_bf16 v[16:19], a[224:227], a[112:115], v[16:19]
ds_read_b64_tr_b16 a[216:217], v142 offset:32768
ds_read_b64_tr_b16 a[218:219], v142 offset:34816
v_mfma_f32_16x16x32_bf16 v[16:19], a[228:231], a[120:123], v[16:19]
buffer_load_dwordx4 v232, s[4:7], s47 offen offset:2048 lds
v_mfma_f32_16x16x32_bf16 v[20:23], a[224:227], a[116:119], v[20:23]
ds_read_b64_tr_b16 a[220:221], v142 offset:49152
v_mfma_f32_16x16x32_bf16 v[20:23], a[228:231], a[124:127], v[20:23]
s_waitcnt lgkmcnt(11)
ds_read_b64_tr_b16 a[222:223], v142 offset:51200
v_mfma_f32_16x16x32_bf16 v[24:27], a[192:195], a[112:115], v[24:27]
ds_read_b64_tr_b16 a[224:225], v143 offset:32768
ds_read_b64_tr_b16 a[226:227], v143 offset:34816
v_mfma_f32_16x16x32_bf16 v[24:27], a[196:199], a[120:123], v[24:27]
buffer_load_dwordx4 v233, s[4:7], s47 offen offset:3072 lds
v_mfma_f32_16x16x32_bf16 v[28:31], a[192:195], a[116:119], v[28:31]
ds_read_b64_tr_b16 a[228:229], v143 offset:49152
v_mfma_f32_16x16x32_bf16 v[28:31], a[196:199], a[124:127], v[28:31]
s_waitcnt lgkmcnt(11)
ds_read_b64_tr_b16 a[230:231], v143 offset:51200
v_mfma_f32_16x16x32_bf16 v[32:35], a[200:203], a[112:115], v[32:35]
s_add_u32 m0, s53, 0x9000
ds_read_b64_tr_b16 a[192:193], v136 offset:33024
ds_read_b64_tr_b16 a[194:195], v136 offset:35072
v_mfma_f32_16x16x32_bf16 v[32:35], a[204:207], a[120:123], v[32:35]
buffer_load_dwordx4 v234, s[4:7], s47 offen lds
v_mfma_f32_16x16x32_bf16 v[36:39], a[200:203], a[116:119], v[36:39]
ds_read_b64_tr_b16 a[196:197], v136 offset:49408
v_mfma_f32_16x16x32_bf16 v[36:39], a[204:207], a[124:127], v[36:39]
s_waitcnt lgkmcnt(11)
ds_read_b64_tr_b16 a[198:199], v136 offset:51456
v_mfma_f32_16x16x32_bf16 v[40:43], a[208:211], a[112:115], v[40:43]
ds_read_b64_tr_b16 a[200:201], v137 offset:33024
v_mfma_f32_16x16x32_bf16 v[40:43], a[212:215], a[120:123], v[40:43]
ds_read_b64_tr_b16 a[202:203], v137 offset:35072
v_mfma_f32_16x16x32_bf16 v[44:47], a[208:211], a[116:119], v[44:47]
ds_read_b64_tr_b16 a[204:205], v137 offset:49408
v_mfma_f32_16x16x32_bf16 v[44:47], a[212:215], a[124:127], v[44:47]
s_waitcnt lgkmcnt(11)
ds_read_b64_tr_b16 a[206:207], v137 offset:51456
v_mfma_f32_16x16x32_bf16 v[48:51], a[216:219], a[112:115], v[48:51]
ds_read_b64_tr_b16 a[208:209], v138 offset:33024
ds_read_b64_tr_b16 a[210:211], v138 offset:35072
v_mfma_f32_16x16x32_bf16 v[48:51], a[220:223], a[120:123], v[48:51]
buffer_load_dwordx4 a[0:3], v235, s[16:19], s48 offen sc1
v_mfma_f32_16x16x32_bf16 v[52:55], a[216:219], a[116:119], v[52:55]
ds_read_b64_tr_b16 a[212:213], v138 offset:49408
v_mfma_f32_16x16x32_bf16 v[52:55], a[220:223], a[124:127], v[52:55]
s_waitcnt lgkmcnt(11)
ds_read_b64_tr_b16 a[214:215], v138 offset:51456
v_mfma_f32_16x16x32_bf16 v[56:59], a[224:227], a[112:115], v[56:59]
ds_read_b64_tr_b16 a[216:217], v139 offset:33024
ds_read_b64_tr_b16 a[218:219], v139 offset:35072
v_mfma_f32_16x16x32_bf16 v[56:59], a[228:231], a[120:123], v[56:59]
buffer_load_dwordx4 a[4:7], v235, s[16:19], s48 offen offset:1024 sc1
v_mfma_f32_16x16x32_bf16 v[60:63], a[224:227], a[116:119], v[60:63]
ds_read_b64_tr_b16 a[220:221], v139 offset:49408
v_mfma_f32_16x16x32_bf16 v[60:63], a[228:231], a[124:127], v[60:63]
s_waitcnt lgkmcnt(11)
ds_read_b64_tr_b16 a[222:223], v139 offset:51456
v_mfma_f32_16x16x32_bf16 v[64:67], a[192:195], a[112:115], v[64:67]
ds_read_b64_tr_b16 a[224:225], v140 offset:33024
ds_read_b64_tr_b16 a[226:227], v140 offset:35072
v_mfma_f32_16x16x32_bf16 v[64:67], a[196:199], a[120:123], v[64:67]
buffer_load_dwordx4 a[8:11], v236, s[16:19], s48 offen sc1
v_mfma_f32_16x16x32_bf16 v[68:71], a[192:195], a[116:119], v[68:71]
ds_read_b64_tr_b16 a[228:229], v140 offset:49408
v_mfma_f32_16x16x32_bf16 v[68:71], a[196:199], a[124:127], v[68:71]
s_waitcnt lgkmcnt(11)
ds_read_b64_tr_b16 a[230:231], v140 offset:51456
v_mfma_f32_16x16x32_bf16 v[72:75], a[200:203], a[112:115], v[72:75]
ds_read_b64_tr_b16 a[192:193], v141 offset:33024
ds_read_b64_tr_b16 a[194:195], v141 offset:35072
v_mfma_f32_16x16x32_bf16 v[72:75], a[204:207], a[120:123], v[72:75]
buffer_load_dwordx4 a[12:15], v236, s[16:19], s48 offen offset:1024 sc1
v_mfma_f32_16x16x32_bf16 v[76:79], a[200:203], a[116:119], v[76:79]
ds_read_b64_tr_b16 a[196:197], v141 offset:49408
v_mfma_f32_16x16x32_bf16 v[76:79], a[204:207], a[124:127], v[76:79]
s_waitcnt lgkmcnt(11)
ds_read_b64_tr_b16 a[198:199], v141 offset:51456
v_mfma_f32_16x16x32_bf16 v[80:83], a[208:211], a[112:115], v[80:83]
ds_read_b64_tr_b16 a[200:201], v142 offset:33024
v_mfma_f32_16x16x32_bf16 v[80:83], a[212:215], a[120:123], v[80:83]
ds_read_b64_tr_b16 a[202:203], v142 offset:35072
v_mfma_f32_16x16x32_bf16 v[84:87], a[208:211], a[116:119], v[84:87]
ds_read_b64_tr_b16 a[204:205], v142 offset:49408
v_mfma_f32_16x16x32_bf16 v[84:87], a[212:215], a[124:127], v[84:87]
s_waitcnt lgkmcnt(11)
ds_read_b64_tr_b16 a[206:207], v142 offset:51456
v_mfma_f32_16x16x32_bf16 v[88:91], a[216:219], a[112:115], v[88:91]
ds_read_b64_tr_b16 a[208:209], v143 offset:33024
ds_read_b64_tr_b16 a[210:211], v143 offset:35072
v_mfma_f32_16x16x32_bf16 v[88:91], a[220:223], a[120:123], v[88:91]
buffer_load_dwordx4 a[16:19], v237, s[16:19], s48 offen sc1
v_mfma_f32_16x16x32_bf16 v[92:95], a[216:219], a[116:119], v[92:95]
s_waitcnt vmcnt(10)
ds_read_b64_tr_b16 a[212:213], v143 offset:49408
v_mfma_f32_16x16x32_bf16 v[92:95], a[220:223], a[124:127], v[92:95]
s_waitcnt lgkmcnt(11)
s_barrier
ds_read_b64_tr_b16 a[214:215], v143 offset:51456
v_mfma_f32_16x16x32_bf16 v[96:99], a[224:227], a[112:115], v[96:99]
ds_read_b64_tr_b16 a[216:217], v128
ds_read_b64_tr_b16 a[218:219], v128 offset:2048
v_mfma_f32_16x16x32_bf16 v[96:99], a[228:231], a[120:123], v[96:99]
buffer_load_dwordx4 a[20:23], v237, s[16:19], s48 offen offset:1024 sc1
v_mfma_f32_16x16x32_bf16 v[100:103], a[224:227], a[116:119], v[100:103]
ds_read_b64_tr_b16 a[220:221], v128 offset:16384
v_mfma_f32_16x16x32_bf16 v[100:103], a[228:231], a[124:127], v[100:103]
s_waitcnt lgkmcnt(11)
ds_read_b64_tr_b16 a[222:223], v128 offset:18432
v_mfma_f32_16x16x32_bf16 v[104:107], a[192:195], a[112:115], v[104:107]
ds_read_b64_tr_b16 a[224:225], v129
ds_read_b64_tr_b16 a[226:227], v129 offset:2048
v_mfma_f32_16x16x32_bf16 v[104:107], a[196:199], a[120:123], v[104:107]
buffer_load_dwordx4 a[24:27], v238, s[16:19], s48 offen sc1
v_mfma_f32_16x16x32_bf16 v[108:111], a[192:195], a[116:119], v[108:111]
ds_read_b64_tr_b16 a[228:229], v129 offset:16384
v_mfma_f32_16x16x32_bf16 v[108:111], a[196:199], a[124:127], v[108:111]
s_waitcnt lgkmcnt(11)
ds_read_b64_tr_b16 a[230:231], v129 offset:18432
v_mfma_f32_16x16x32_bf16 v[112:115], a[200:203], a[112:115], v[112:115]
ds_read_b64_tr_b16 a[192:193], v130
ds_read_b64_tr_b16 a[194:195], v130 offset:2048
v_mfma_f32_16x16x32_bf16 v[112:115], a[204:207], a[120:123], v[112:115]
buffer_load_dwordx4 a[28:31], v238, s[16:19], s48 offen offset:1024 sc1
v_mfma_f32_16x16x32_bf16 v[116:119], a[200:203], a[116:119], v[116:119]
s_add_u32 s47, s47, 589824
s_add_u32 s48, s48, 2048
ds_read_b64_tr_b16 a[196:197], v130 offset:16384
v_mfma_f32_16x16x32_bf16 v[116:119], a[204:207], a[124:127], v[116:119]
s_waitcnt lgkmcnt(11)
ds_read_b64_tr_b16 a[198:199], v130 offset:18432
v_mfma_f32_16x16x32_bf16 v[120:123], a[208:211], a[112:115], v[120:123]
ds_read_b64_tr_b16 a[200:201], v131
v_mfma_f32_16x16x32_bf16 v[120:123], a[212:215], a[120:123], v[120:123]
ds_read_b64_tr_b16 a[202:203], v131 offset:2048
v_mfma_f32_16x16x32_bf16 v[124:127], a[208:211], a[116:119], v[124:127]
ds_read_b64_tr_b16 a[204:205], v131 offset:16384
v_mfma_f32_16x16x32_bf16 v[124:127], a[212:215], a[124:127], v[124:127]
s_waitcnt lgkmcnt(11)
ds_read_b64_tr_b16 a[206:207], v131 offset:18432
v_mfma_f32_16x16x32_bf16 v[0:3], a[216:219], a[128:131], v[0:3]
s_add_u32 m0, s53, 0x10000
ds_read_b64_tr_b16 a[208:209], v132
ds_read_b64_tr_b16 a[210:211], v132 offset:2048
v_mfma_f32_16x16x32_bf16 v[0:3], a[220:223], a[136:139], v[0:3]
buffer_load_dwordx4 v230, s[4:7], s47 offen lds
v_mfma_f32_16x16x32_bf16 v[4:7], a[216:219], a[132:135], v[4:7]
ds_read_b64_tr_b16 a[212:213], v132 offset:16384
v_mfma_f32_16x16x32_bf16 v[4:7], a[220:223], a[140:143], v[4:7]
s_waitcnt lgkmcnt(11)
ds_read_b64_tr_b16 a[214:215], v132 offset:18432
v_mfma_f32_16x16x32_bf16 v[8:11], a[224:227], a[128:131], v[8:11]
ds_read_b64_tr_b16 a[216:217], v133
ds_read_b64_tr_b16 a[218:219], v133 offset:2048
v_mfma_f32_16x16x32_bf16 v[8:11], a[228:231], a[136:139], v[8:11]
buffer_load_dwordx4 v231, s[4:7], s47 offen offset:1024 lds
v_mfma_f32_16x16x32_bf16 v[12:15], a[224:227], a[132:135], v[12:15]
ds_read_b64_tr_b16 a[220:221], v133 offset:16384
v_mfma_f32_16x16x32_bf16 v[12:15], a[228:231], a[140:143], v[12:15]
s_waitcnt lgkmcnt(11)
ds_read_b64_tr_b16 a[222:223], v133 offset:18432
v_mfma_f32_16x16x32_bf16 v[16:19], a[192:195], a[128:131], v[16:19]
ds_read_b64_tr_b16 a[224:225], v134
ds_read_b64_tr_b16 a[226:227], v134 offset:2048
v_mfma_f32_16x16x32_bf16 v[16:19], a[196:199], a[136:139], v[16:19]
buffer_load_dwordx4 v232, s[4:7], s47 offen offset:2048 lds
v_mfma_f32_16x16x32_bf16 v[20:23], a[192:195], a[132:135], v[20:23]
ds_read_b64_tr_b16 a[228:229], v134 offset:16384
v_mfma_f32_16x16x32_bf16 v[20:23], a[196:199], a[140:143], v[20:23]
s_waitcnt lgkmcnt(11)
ds_read_b64_tr_b16 a[230:231], v134 offset:18432
v_mfma_f32_16x16x32_bf16 v[24:27], a[200:203], a[128:131], v[24:27]
ds_read_b64_tr_b16 a[192:193], v135
ds_read_b64_tr_b16 a[194:195], v135 offset:2048
v_mfma_f32_16x16x32_bf16 v[24:27], a[204:207], a[136:139], v[24:27]
buffer_load_dwordx4 v233, s[4:7], s47 offen offset:3072 lds
v_mfma_f32_16x16x32_bf16 v[28:31], a[200:203], a[132:135], v[28:31]
ds_read_b64_tr_b16 a[196:197], v135 offset:16384
v_mfma_f32_16x16x32_bf16 v[28:31], a[204:207], a[140:143], v[28:31]
s_waitcnt lgkmcnt(11)
ds_read_b64_tr_b16 a[198:199], v135 offset:18432
v_mfma_f32_16x16x32_bf16 v[32:35], a[208:211], a[128:131], v[32:35]
s_add_u32 m0, s53, 0x11000
ds_read_b64_tr_b16 a[200:201], v128 offset:256
ds_read_b64_tr_b16 a[202:203], v128 offset:2304
v_mfma_f32_16x16x32_bf16 v[32:35], a[212:215], a[136:139], v[32:35]
buffer_load_dwordx4 v234, s[4:7], s47 offen lds
v_mfma_f32_16x16x32_bf16 v[36:39], a[208:211], a[132:135], v[36:39]
ds_read_b64_tr_b16 a[204:205], v128 offset:16640
v_mfma_f32_16x16x32_bf16 v[36:39], a[212:215], a[140:143], v[36:39]
s_waitcnt lgkmcnt(11)
ds_read_b64_tr_b16 a[206:207], v128 offset:18688
v_mfma_f32_16x16x32_bf16 v[40:43], a[216:219], a[128:131], v[40:43]
ds_read_b64_tr_b16 a[208:209], v129 offset:256
v_mfma_f32_16x16x32_bf16 v[40:43], a[220:223], a[136:139], v[40:43]
ds_read_b64_tr_b16 a[210:211], v129 offset:2304
v_mfma_f32_16x16x32_bf16 v[44:47], a[216:219], a[132:135], v[44:47]
ds_read_b64_tr_b16 a[212:213], v129 offset:16640
v_mfma_f32_16x16x32_bf16 v[44:47], a[220:223], a[140:143], v[44:47]
s_waitcnt lgkmcnt(11)
ds_read_b64_tr_b16 a[214:215], v129 offset:18688
v_mfma_f32_16x16x32_bf16 v[48:51], a[224:227], a[128:131], v[48:51]
ds_read_b64_tr_b16 a[216:217], v130 offset:256
ds_read_b64_tr_b16 a[218:219], v130 offset:2304
v_mfma_f32_16x16x32_bf16 v[48:51], a[228:231], a[136:139], v[48:51]
buffer_load_dwordx4 a[32:35], v235, s[16:19], s48 offen sc1
v_mfma_f32_16x16x32_bf16 v[52:55], a[224:227], a[132:135], v[52:55]
ds_read_b64_tr_b16 a[220:221], v130 offset:16640
v_mfma_f32_16x16x32_bf16 v[52:55], a[228:231], a[140:143], v[52:55]
s_waitcnt lgkmcnt(11)
ds_read_b64_tr_b16 a[222:223], v130 offset:18688
v_mfma_f32_16x16x32_bf16 v[56:59], a[192:195], a[128:131], v[56:59]
ds_read_b64_tr_b16 a[224:225], v131 offset:256
ds_read_b64_tr_b16 a[226:227], v131 offset:2304
v_mfma_f32_16x16x32_bf16 v[56:59], a[196:199], a[136:139], v[56:59]
buffer_load_dwordx4 a[36:39], v235, s[16:19], s48 offen offset:1024 sc1
v_mfma_f32_16x16x32_bf16 v[60:63], a[192:195], a[132:135], v[60:63]
ds_read_b64_tr_b16 a[228:229], v131 offset:16640
v_mfma_f32_16x16x32_bf16 v[60:63], a[196:199], a[140:143], v[60:63]
s_waitcnt lgkmcnt(11)
ds_read_b64_tr_b16 a[230:231], v131 offset:18688
v_mfma_f32_16x16x32_bf16 v[64:67], a[200:203], a[128:131], v[64:67]
ds_read_b64_tr_b16 a[192:193], v132 offset:256
ds_read_b64_tr_b16 a[194:195], v132 offset:2304
v_mfma_f32_16x16x32_bf16 v[64:67], a[204:207], a[136:139], v[64:67]
buffer_load_dwordx4 a[40:43], v236, s[16:19], s48 offen sc1
v_mfma_f32_16x16x32_bf16 v[68:71], a[200:203], a[132:135], v[68:71]
ds_read_b64_tr_b16 a[196:197], v132 offset:16640
v_mfma_f32_16x16x32_bf16 v[68:71], a[204:207], a[140:143], v[68:71]
s_waitcnt lgkmcnt(11)
ds_read_b64_tr_b16 a[198:199], v132 offset:18688
v_mfma_f32_16x16x32_bf16 v[72:75], a[208:211], a[128:131], v[72:75]
ds_read_b64_tr_b16 a[200:201], v133 offset:256
ds_read_b64_tr_b16 a[202:203], v133 offset:2304
v_mfma_f32_16x16x32_bf16 v[72:75], a[212:215], a[136:139], v[72:75]
buffer_load_dwordx4 a[44:47], v236, s[16:19], s48 offen offset:1024 sc1
v_mfma_f32_16x16x32_bf16 v[76:79], a[208:211], a[132:135], v[76:79]
ds_read_b64_tr_b16 a[204:205], v133 offset:16640
v_mfma_f32_16x16x32_bf16 v[76:79], a[212:215], a[140:143], v[76:79]
s_waitcnt lgkmcnt(11)
ds_read_b64_tr_b16 a[206:207], v133 offset:18688
v_mfma_f32_16x16x32_bf16 v[80:83], a[216:219], a[128:131], v[80:83]
ds_read_b64_tr_b16 a[208:209], v134 offset:256
v_mfma_f32_16x16x32_bf16 v[80:83], a[220:223], a[136:139], v[80:83]
ds_read_b64_tr_b16 a[210:211], v134 offset:2304
v_mfma_f32_16x16x32_bf16 v[84:87], a[216:219], a[132:135], v[84:87]
ds_read_b64_tr_b16 a[212:213], v134 offset:16640
v_mfma_f32_16x16x32_bf16 v[84:87], a[220:223], a[140:143], v[84:87]
s_waitcnt lgkmcnt(11)
ds_read_b64_tr_b16 a[214:215], v134 offset:18688
v_mfma_f32_16x16x32_bf16 v[88:91], a[224:227], a[128:131], v[88:91]
ds_read_b64_tr_b16 a[216:217], v135 offset:256
ds_read_b64_tr_b16 a[218:219], v135 offset:2304
v_mfma_f32_16x16x32_bf16 v[88:91], a[228:231], a[136:139], v[88:91]
buffer_load_dwordx4 a[48:51], v237, s[16:19], s48 offen sc1
v_mfma_f32_16x16x32_bf16 v[92:95], a[224:227], a[132:135], v[92:95]
ds_read_b64_tr_b16 a[220:221], v135 offset:16640
v_mfma_f32_16x16x32_bf16 v[92:95], a[228:231], a[140:143], v[92:95]
s_waitcnt lgkmcnt(11)
ds_read_b64_tr_b16 a[222:223], v135 offset:18688
v_mfma_f32_16x16x32_bf16 v[96:99], a[192:195], a[128:131], v[96:99]
v_mfma_f32_16x16x32_bf16 v[96:99], a[196:199], a[136:139], v[96:99]
buffer_load_dwordx4 a[52:55], v237, s[16:19], s48 offen offset:1024 sc1
v_mfma_f32_16x16x32_bf16 v[100:103], a[192:195], a[132:135], v[100:103]
v_mfma_f32_16x16x32_bf16 v[100:103], a[196:199], a[140:143], v[100:103]
s_waitcnt lgkmcnt(8)
v_mfma_f32_16x16x32_bf16 v[104:107], a[200:203], a[128:131], v[104:107]
v_mfma_f32_16x16x32_bf16 v[104:107], a[204:207], a[136:139], v[104:107]
buffer_load_dwordx4 a[56:59], v238, s[16:19], s48 offen sc1
v_mfma_f32_16x16x32_bf16 v[108:111], a[200:203], a[132:135], v[108:111]
v_mfma_f32_16x16x32_bf16 v[108:111], a[204:207], a[140:143], v[108:111]
s_waitcnt lgkmcnt(4)
v_mfma_f32_16x16x32_bf16 v[112:115], a[208:211], a[128:131], v[112:115]
v_mfma_f32_16x16x32_bf16 v[112:115], a[212:215], a[136:139], v[112:115]
buffer_load_dwordx4 a[60:63], v238, s[16:19], s48 offen offset:1024 sc1
v_mfma_f32_16x16x32_bf16 v[116:119], a[208:211], a[132:135], v[116:119]
s_add_u32 s47, s47, 589824
s_add_u32 s48, s48, 2048
v_mfma_f32_16x16x32_bf16 v[116:119], a[212:215], a[140:143], v[116:119]
s_waitcnt lgkmcnt(0)
v_mfma_f32_16x16x32_bf16 v[120:123], a[216:219], a[128:131], v[120:123]
v_mfma_f32_16x16x32_bf16 v[120:123], a[220:223], a[136:139], v[120:123]
v_mfma_f32_16x16x32_bf16 v[124:127], a[216:219], a[132:135], v[124:127]
v_mfma_f32_16x16x32_bf16 v[124:127], a[220:223], a[140:143], v[124:127]
s_waitcnt vmcnt(48)
s_nop 7
v_mul_f32 v217, 0x3e0293ee, v217
v_pk_fma_f32 v[0:1], v[216:217], v[144:145], v[0:1] op_sel_hi:[0,1,1] neg_lo:[1,0,0] neg_hi:[1,0,0]
v_pk_fma_f32 v[2:3], v[216:217], v[146:147], v[2:3] op_sel_hi:[0,1,1] neg_lo:[1,0,0] neg_hi:[1,0,0]
v_pk_fma_f32 v[8:9], v[216:217], v[148:149], v[8:9] op_sel_hi:[0,1,1] neg_lo:[1,0,0] neg_hi:[1,0,0]
v_pk_fma_f32 v[10:11], v[216:217], v[150:151], v[10:11] op_sel_hi:[0,1,1] neg_lo:[1,0,0] neg_hi:[1,0,0]
v_pk_mul_f32 v[0:1], v[0:1], v[216:217] op_sel:[0,1]
v_pk_mul_f32 v[2:3], v[2:3], v[216:217] op_sel:[0,1]
v_pk_mul_f32 v[8:9], v[8:9], v[216:217] op_sel:[0,1]
v_pk_mul_f32 v[10:11], v[10:11], v[216:217] op_sel:[0,1]
v_cvt_pk_bf16_f32 v0, v0, v1
v_cvt_pk_bf16_f32 v1, v2, v3
v_cvt_pk_bf16_f32 v8, v8, v9
v_cvt_pk_bf16_f32 v9, v10, v11
s_nop 0
v_permlane16_swap_b32 v0, v8
v_permlane16_swap_b32 v1, v9
s_nop 0
v_accvgpr_write_b32 a128, v0
v_accvgpr_write_b32 a129, v1
v_accvgpr_write_b32 a130, v8
v_accvgpr_write_b32 a131, v9
v_pk_fma_f32 v[16:17], v[216:217], v[152:153], v[16:17] op_sel_hi:[0,1,1] neg_lo:[1,0,0] neg_hi:[1,0,0]
v_pk_fma_f32 v[18:19], v[216:217], v[154:155], v[18:19] op_sel_hi:[0,1,1] neg_lo:[1,0,0] neg_hi:[1,0,0]
v_pk_fma_f32 v[24:25], v[216:217], v[156:157], v[24:25] op_sel_hi:[0,1,1] neg_lo:[1,0,0] neg_hi:[1,0,0]
v_pk_fma_f32 v[26:27], v[216:217], v[158:159], v[26:27] op_sel_hi:[0,1,1] neg_lo:[1,0,0] neg_hi:[1,0,0]
v_pk_mul_f32 v[16:17], v[16:17], v[216:217] op_sel:[0,1]
v_pk_mul_f32 v[18:19], v[18:19], v[216:217] op_sel:[0,1]
v_pk_mul_f32 v[24:25], v[24:25], v[216:217] op_sel:[0,1]
v_pk_mul_f32 v[26:27], v[26:27], v[216:217] op_sel:[0,1]
v_cvt_pk_bf16_f32 v16, v16, v17
v_cvt_pk_bf16_f32 v17, v18, v19
v_cvt_pk_bf16_f32 v24, v24, v25
v_cvt_pk_bf16_f32 v25, v26, v27
s_nop 0
v_permlane16_swap_b32 v16, v24
v_permlane16_swap_b32 v17, v25
s_nop 0
v_accvgpr_write_b32 a132, v16
v_accvgpr_write_b32 a133, v17
v_accvgpr_write_b32 a134, v24
v_accvgpr_write_b32 a135, v25
v_pk_fma_f32 v[32:33], v[216:217], v[160:161], v[32:33] op_sel_hi:[0,1,1] neg_lo:[1,0,0] neg_hi:[1,0,0]
v_pk_fma_f32 v[34:35], v[216:217], v[162:163], v[34:35] op_sel_hi:[0,1,1] neg_lo:[1,0,0] neg_hi:[1,0,0]
v_pk_fma_f32 v[40:41], v[216:217], v[164:165], v[40:41] op_sel_hi:[0,1,1] neg_lo:[1,0,0] neg_hi:[1,0,0]
v_pk_fma_f32 v[42:43], v[216:217], v[166:167], v[42:43] op_sel_hi:[0,1,1] neg_lo:[1,0,0] neg_hi:[1,0,0]
v_pk_mul_f32 v[32:33], v[32:33], v[216:217] op_sel:[0,1]
v_pk_mul_f32 v[34:35], v[34:35], v[216:217] op_sel:[0,1]
v_pk_mul_f32 v[40:41], v[40:41], v[216:217] op_sel:[0,1]
v_pk_mul_f32 v[42:43], v[42:43], v[216:217] op_sel:[0,1]
v_cvt_pk_bf16_f32 v32, v32, v33
v_cvt_pk_bf16_f32 v33, v34, v35
v_cvt_pk_bf16_f32 v40, v40, v41
v_cvt_pk_bf16_f32 v41, v42, v43
s_nop 0
v_permlane16_swap_b32 v32, v40
v_permlane16_swap_b32 v33, v41
s_nop 0
v_accvgpr_write_b32 a136, v32
v_accvgpr_write_b32 a137, v33
v_accvgpr_write_b32 a138, v40
v_accvgpr_write_b32 a139, v41
v_pk_fma_f32 v[48:49], v[216:217], v[168:169], v[48:49] op_sel_hi:[0,1,1] neg_lo:[1,0,0] neg_hi:[1,0,0]
v_pk_fma_f32 v[50:51], v[216:217], v[170:171], v[50:51] op_sel_hi:[0,1,1] neg_lo:[1,0,0] neg_hi:[1,0,0]
v_pk_fma_f32 v[56:57], v[216:217], v[172:173], v[56:57] op_sel_hi:[0,1,1] neg_lo:[1,0,0] neg_hi:[1,0,0]
v_pk_fma_f32 v[58:59], v[216:217], v[174:175], v[58:59] op_sel_hi:[0,1,1] neg_lo:[1,0,0] neg_hi:[1,0,0]
v_pk_mul_f32 v[48:49], v[48:49], v[216:217] op_sel:[0,1]
v_pk_mul_f32 v[50:51], v[50:51], v[216:217] op_sel:[0,1]
v_pk_mul_f32 v[56:57], v[56:57], v[216:217] op_sel:[0,1]
v_pk_mul_f32 v[58:59], v[58:59], v[216:217] op_sel:[0,1]
v_cvt_pk_bf16_f32 v48, v48, v49
v_cvt_pk_bf16_f32 v49, v50, v51
v_cvt_pk_bf16_f32 v56, v56, v57
v_cvt_pk_bf16_f32 v57, v58, v59
s_nop 0
v_permlane16_swap_b32 v48, v56
v_permlane16_swap_b32 v49, v57
s_nop 0
v_accvgpr_write_b32 a140, v48
v_accvgpr_write_b32 a141, v49
v_accvgpr_write_b32 a142, v56
v_accvgpr_write_b32 a143, v57
v_pk_fma_f32 v[64:65], v[216:217], v[176:177], v[64:65] op_sel_hi:[0,1,1] neg_lo:[1,0,0] neg_hi:[1,0,0]
v_pk_fma_f32 v[66:67], v[216:217], v[178:179], v[66:67] op_sel_hi:[0,1,1] neg_lo:[1,0,0] neg_hi:[1,0,0]
v_pk_fma_f32 v[72:73], v[216:217], v[180:181], v[72:73] op_sel_hi:[0,1,1] neg_lo:[1,0,0] neg_hi:[1,0,0]
v_pk_fma_f32 v[74:75], v[216:217], v[182:183], v[74:75] op_sel_hi:[0,1,1] neg_lo:[1,0,0] neg_hi:[1,0,0]
v_pk_mul_f32 v[64:65], v[64:65], v[216:217] op_sel:[0,1]
v_pk_mul_f32 v[66:67], v[66:67], v[216:217] op_sel:[0,1]
v_pk_mul_f32 v[72:73], v[72:73], v[216:217] op_sel:[0,1]
v_pk_mul_f32 v[74:75], v[74:75], v[216:217] op_sel:[0,1]
v_cvt_pk_bf16_f32 v64, v64, v65
v_cvt_pk_bf16_f32 v65, v66, v67
v_cvt_pk_bf16_f32 v72, v72, v73
v_cvt_pk_bf16_f32 v73, v74, v75
s_nop 0
v_permlane16_swap_b32 v64, v72
v_permlane16_swap_b32 v65, v73
s_nop 0
v_accvgpr_write_b32 a160, v64
v_accvgpr_write_b32 a161, v65
v_accvgpr_write_b32 a162, v72
v_accvgpr_write_b32 a163, v73
v_pk_fma_f32 v[80:81], v[216:217], v[184:185], v[80:81] op_sel_hi:[0,1,1] neg_lo:[1,0,0] neg_hi:[1,0,0]
v_pk_fma_f32 v[82:83], v[216:217], v[186:187], v[82:83] op_sel_hi:[0,1,1] neg_lo:[1,0,0] neg_hi:[1,0,0]
v_pk_fma_f32 v[88:89], v[216:217], v[188:189], v[88:89] op_sel_hi:[0,1,1] neg_lo:[1,0,0] neg_hi:[1,0,0]
v_pk_fma_f32 v[90:91], v[216:217], v[190:191], v[90:91] op_sel_hi:[0,1,1] neg_lo:[1,0,0] neg_hi:[1,0,0]
v_pk_mul_f32 v[80:81], v[80:81], v[216:217] op_sel:[0,1]
v_pk_mul_f32 v[82:83], v[82:83], v[216:217] op_sel:[0,1]
v_pk_mul_f32 v[88:89], v[88:89], v[216:217] op_sel:[0,1]
v_pk_mul_f32 v[90:91], v[90:91], v[216:217] op_sel:[0,1]
v_cvt_pk_bf16_f32 v80, v80, v81
v_cvt_pk_bf16_f32 v81, v82, v83
v_cvt_pk_bf16_f32 v88, v88, v89
v_cvt_pk_bf16_f32 v89, v90, v91
s_nop 0
v_permlane16_swap_b32 v80, v88
v_permlane16_swap_b32 v81, v89
s_nop 0
v_accvgpr_write_b32 a164, v80
v_accvgpr_write_b32 a165, v81
v_accvgpr_write_b32 a166, v88
v_accvgpr_write_b32 a167, v89
v_pk_fma_f32 v[96:97], v[216:217], v[192:193], v[96:97] op_sel_hi:[0,1,1] neg_lo:[1,0,0] neg_hi:[1,0,0]
v_pk_fma_f32 v[98:99], v[216:217], v[194:195], v[98:99] op_sel_hi:[0,1,1] neg_lo:[1,0,0] neg_hi:[1,0,0]
v_pk_fma_f32 v[104:105], v[216:217], v[196:197], v[104:105] op_sel_hi:[0,1,1] neg_lo:[1,0,0] neg_hi:[1,0,0]
v_pk_fma_f32 v[106:107], v[216:217], v[198:199], v[106:107] op_sel_hi:[0,1,1] neg_lo:[1,0,0] neg_hi:[1,0,0]
v_pk_mul_f32 v[96:97], v[96:97], v[216:217] op_sel:[0,1]
v_pk_mul_f32 v[98:99], v[98:99], v[216:217] op_sel:[0,1]
v_pk_mul_f32 v[104:105], v[104:105], v[216:217] op_sel:[0,1]
v_pk_mul_f32 v[106:107], v[106:107], v[216:217] op_sel:[0,1]
v_cvt_pk_bf16_f32 v96, v96, v97
v_cvt_pk_bf16_f32 v97, v98, v99
v_cvt_pk_bf16_f32 v104, v104, v105
v_cvt_pk_bf16_f32 v105, v106, v107
s_nop 0
v_permlane16_swap_b32 v96, v104
v_permlane16_swap_b32 v97, v105
s_nop 0
v_accvgpr_write_b32 a168, v96
v_accvgpr_write_b32 a169, v97
v_accvgpr_write_b32 a170, v104
v_accvgpr_write_b32 a171, v105
v_pk_fma_f32 v[112:113], v[216:217], v[200:201], v[112:113] op_sel_hi:[0,1,1] neg_lo:[1,0,0] neg_hi:[1,0,0]
v_pk_fma_f32 v[114:115], v[216:217], v[202:203], v[114:115] op_sel_hi:[0,1,1] neg_lo:[1,0,0] neg_hi:[1,0,0]
v_pk_fma_f32 v[120:121], v[216:217], v[204:205], v[120:121] op_sel_hi:[0,1,1] neg_lo:[1,0,0] neg_hi:[1,0,0]
v_pk_fma_f32 v[122:123], v[216:217], v[206:207], v[122:123] op_sel_hi:[0,1,1] neg_lo:[1,0,0] neg_hi:[1,0,0]
v_pk_mul_f32 v[112:113], v[112:113], v[216:217] op_sel:[0,1]
v_pk_mul_f32 v[114:115], v[114:115], v[216:217] op_sel:[0,1]
v_pk_mul_f32 v[120:121], v[120:121], v[216:217] op_sel:[0,1]
v_pk_mul_f32 v[122:123], v[122:123], v[216:217] op_sel:[0,1]
v_cvt_pk_bf16_f32 v112, v112, v113
v_cvt_pk_bf16_f32 v113, v114, v115
v_cvt_pk_bf16_f32 v120, v120, v121
v_cvt_pk_bf16_f32 v121, v122, v123
s_nop 0
v_permlane16_swap_b32 v112, v120
v_permlane16_swap_b32 v113, v121
s_nop 0
v_accvgpr_write_b32 a172, v112
v_accvgpr_write_b32 a173, v113
v_accvgpr_write_b32 a174, v120
v_accvgpr_write_b32 a175, v121
v_mul_f32 v219, 0x3e0293ee, v219
v_pk_fma_f32 v[4:5], v[218:219], v[144:145], v[4:5] op_sel_hi:[0,1,1] neg_lo:[1,0,0] neg_hi:[1,0,0]
v_pk_fma_f32 v[6:7], v[218:219], v[146:147], v[6:7] op_sel_hi:[0,1,1] neg_lo:[1,0,0] neg_hi:[1,0,0]
v_pk_fma_f32 v[12:13], v[218:219], v[148:149], v[12:13] op_sel_hi:[0,1,1] neg_lo:[1,0,0] neg_hi:[1,0,0]
v_pk_fma_f32 v[14:15], v[218:219], v[150:151], v[14:15] op_sel_hi:[0,1,1] neg_lo:[1,0,0] neg_hi:[1,0,0]
v_pk_mul_f32 v[4:5], v[4:5], v[218:219] op_sel:[0,1]
v_pk_mul_f32 v[6:7], v[6:7], v[218:219] op_sel:[0,1]
v_pk_mul_f32 v[12:13], v[12:13], v[218:219] op_sel:[0,1]
v_pk_mul_f32 v[14:15], v[14:15], v[218:219] op_sel:[0,1]
v_cvt_pk_bf16_f32 v4, v4, v5
v_cvt_pk_bf16_f32 v5, v6, v7
v_cvt_pk_bf16_f32 v12, v12, v13
v_cvt_pk_bf16_f32 v13, v14, v15
s_nop 0
v_permlane16_swap_b32 v4, v12
v_permlane16_swap_b32 v5, v13
s_nop 0
v_accvgpr_write_b32 a144, v4
v_accvgpr_write_b32 a145, v5
v_accvgpr_write_b32 a146, v12
v_accvgpr_write_b32 a147, v13
v_pk_fma_f32 v[20:21], v[218:219], v[152:153], v[20:21] op_sel_hi:[0,1,1] neg_lo:[1,0,0] neg_hi:[1,0,0]
v_pk_fma_f32 v[22:23], v[218:219], v[154:155], v[22:23] op_sel_hi:[0,1,1] neg_lo:[1,0,0] neg_hi:[1,0,0]
v_pk_fma_f32 v[28:29], v[218:219], v[156:157], v[28:29] op_sel_hi:[0,1,1] neg_lo:[1,0,0] neg_hi:[1,0,0]
v_pk_fma_f32 v[30:31], v[218:219], v[158:159], v[30:31] op_sel_hi:[0,1,1] neg_lo:[1,0,0] neg_hi:[1,0,0]
v_pk_mul_f32 v[20:21], v[20:21], v[218:219] op_sel:[0,1]
v_pk_mul_f32 v[22:23], v[22:23], v[218:219] op_sel:[0,1]
v_pk_mul_f32 v[28:29], v[28:29], v[218:219] op_sel:[0,1]
v_pk_mul_f32 v[30:31], v[30:31], v[218:219] op_sel:[0,1]
v_cvt_pk_bf16_f32 v20, v20, v21
v_cvt_pk_bf16_f32 v21, v22, v23
v_cvt_pk_bf16_f32 v28, v28, v29
v_cvt_pk_bf16_f32 v29, v30, v31
s_nop 0
v_permlane16_swap_b32 v20, v28
v_permlane16_swap_b32 v21, v29
s_nop 0
v_accvgpr_write_b32 a148, v20
v_accvgpr_write_b32 a149, v21
v_accvgpr_write_b32 a150, v28
v_accvgpr_write_b32 a151, v29
v_pk_fma_f32 v[36:37], v[218:219], v[160:161], v[36:37] op_sel_hi:[0,1,1] neg_lo:[1,0,0] neg_hi:[1,0,0]
v_pk_fma_f32 v[38:39], v[218:219], v[162:163], v[38:39] op_sel_hi:[0,1,1] neg_lo:[1,0,0] neg_hi:[1,0,0]
v_pk_fma_f32 v[44:45], v[218:219], v[164:165], v[44:45] op_sel_hi:[0,1,1] neg_lo:[1,0,0] neg_hi:[1,0,0]
v_pk_fma_f32 v[46:47], v[218:219], v[166:167], v[46:47] op_sel_hi:[0,1,1] neg_lo:[1,0,0] neg_hi:[1,0,0]
v_pk_mul_f32 v[36:37], v[36:37], v[218:219] op_sel:[0,1]
v_pk_mul_f32 v[38:39], v[38:39], v[218:219] op_sel:[0,1]
v_pk_mul_f32 v[44:45], v[44:45], v[218:219] op_sel:[0,1]
v_pk_mul_f32 v[46:47], v[46:47], v[218:219] op_sel:[0,1]
v_cvt_pk_bf16_f32 v36, v36, v37
v_cvt_pk_bf16_f32 v37, v38, v39
v_cvt_pk_bf16_f32 v44, v44, v45
v_cvt_pk_bf16_f32 v45, v46, v47
s_nop 0
v_permlane16_swap_b32 v36, v44
v_permlane16_swap_b32 v37, v45
s_nop 0
v_accvgpr_write_b32 a152, v36
v_accvgpr_write_b32 a153, v37
v_accvgpr_write_b32 a154, v44
v_accvgpr_write_b32 a155, v45
v_pk_fma_f32 v[52:53], v[218:219], v[168:169], v[52:53] op_sel_hi:[0,1,1] neg_lo:[1,0,0] neg_hi:[1,0,0]
v_pk_fma_f32 v[54:55], v[218:219], v[170:171], v[54:55] op_sel_hi:[0,1,1] neg_lo:[1,0,0] neg_hi:[1,0,0]
v_pk_fma_f32 v[60:61], v[218:219], v[172:173], v[60:61] op_sel_hi:[0,1,1] neg_lo:[1,0,0] neg_hi:[1,0,0]
v_pk_fma_f32 v[62:63], v[218:219], v[174:175], v[62:63] op_sel_hi:[0,1,1] neg_lo:[1,0,0] neg_hi:[1,0,0]
v_pk_mul_f32 v[52:53], v[52:53], v[218:219] op_sel:[0,1]
v_pk_mul_f32 v[54:55], v[54:55], v[218:219] op_sel:[0,1]
v_pk_mul_f32 v[60:61], v[60:61], v[218:219] op_sel:[0,1]
v_pk_mul_f32 v[62:63], v[62:63], v[218:219] op_sel:[0,1]
v_cvt_pk_bf16_f32 v52, v52, v53
v_cvt_pk_bf16_f32 v53, v54, v55
v_cvt_pk_bf16_f32 v60, v60, v61
v_cvt_pk_bf16_f32 v61, v62, v63
s_nop 0
v_permlane16_swap_b32 v52, v60
v_permlane16_swap_b32 v53, v61
s_nop 0
v_accvgpr_write_b32 a156, v52
v_accvgpr_write_b32 a157, v53
v_accvgpr_write_b32 a158, v60
v_accvgpr_write_b32 a159, v61
v_pk_fma_f32 v[68:69], v[218:219], v[176:177], v[68:69] op_sel_hi:[0,1,1] neg_lo:[1,0,0] neg_hi:[1,0,0]
v_pk_fma_f32 v[70:71], v[218:219], v[178:179], v[70:71] op_sel_hi:[0,1,1] neg_lo:[1,0,0] neg_hi:[1,0,0]
v_pk_fma_f32 v[76:77], v[218:219], v[180:181], v[76:77] op_sel_hi:[0,1,1] neg_lo:[1,0,0] neg_hi:[1,0,0]
v_pk_fma_f32 v[78:79], v[218:219], v[182:183], v[78:79] op_sel_hi:[0,1,1] neg_lo:[1,0,0] neg_hi:[1,0,0]
v_pk_mul_f32 v[68:69], v[68:69], v[218:219] op_sel:[0,1]
v_pk_mul_f32 v[70:71], v[70:71], v[218:219] op_sel:[0,1]
v_pk_mul_f32 v[76:77], v[76:77], v[218:219] op_sel:[0,1]
v_pk_mul_f32 v[78:79], v[78:79], v[218:219] op_sel:[0,1]
v_cvt_pk_bf16_f32 v68, v68, v69
v_cvt_pk_bf16_f32 v69, v70, v71
v_cvt_pk_bf16_f32 v76, v76, v77
v_cvt_pk_bf16_f32 v77, v78, v79
s_nop 0
v_permlane16_swap_b32 v68, v76
v_permlane16_swap_b32 v69, v77
s_nop 0
v_accvgpr_write_b32 a176, v68
v_accvgpr_write_b32 a177, v69
v_accvgpr_write_b32 a178, v76
v_accvgpr_write_b32 a179, v77
v_pk_fma_f32 v[84:85], v[218:219], v[184:185], v[84:85] op_sel_hi:[0,1,1] neg_lo:[1,0,0] neg_hi:[1,0,0]
v_pk_fma_f32 v[86:87], v[218:219], v[186:187], v[86:87] op_sel_hi:[0,1,1] neg_lo:[1,0,0] neg_hi:[1,0,0]
v_pk_fma_f32 v[92:93], v[218:219], v[188:189], v[92:93] op_sel_hi:[0,1,1] neg_lo:[1,0,0] neg_hi:[1,0,0]
v_pk_fma_f32 v[94:95], v[218:219], v[190:191], v[94:95] op_sel_hi:[0,1,1] neg_lo:[1,0,0] neg_hi:[1,0,0]
v_pk_mul_f32 v[84:85], v[84:85], v[218:219] op_sel:[0,1]
v_pk_mul_f32 v[86:87], v[86:87], v[218:219] op_sel:[0,1]
v_pk_mul_f32 v[92:93], v[92:93], v[218:219] op_sel:[0,1]
v_pk_mul_f32 v[94:95], v[94:95], v[218:219] op_sel:[0,1]
v_cvt_pk_bf16_f32 v84, v84, v85
v_cvt_pk_bf16_f32 v85, v86, v87
v_cvt_pk_bf16_f32 v92, v92, v93
v_cvt_pk_bf16_f32 v93, v94, v95
s_nop 0
v_permlane16_swap_b32 v84, v92
v_permlane16_swap_b32 v85, v93
s_nop 0
v_accvgpr_write_b32 a180, v84
v_accvgpr_write_b32 a181, v85
v_accvgpr_write_b32 a182, v92
v_accvgpr_write_b32 a183, v93
v_pk_fma_f32 v[100:101], v[218:219], v[192:193], v[100:101] op_sel_hi:[0,1,1] neg_lo:[1,0,0] neg_hi:[1,0,0]
v_pk_fma_f32 v[102:103], v[218:219], v[194:195], v[102:103] op_sel_hi:[0,1,1] neg_lo:[1,0,0] neg_hi:[1,0,0]
v_pk_fma_f32 v[108:109], v[218:219], v[196:197], v[108:109] op_sel_hi:[0,1,1] neg_lo:[1,0,0] neg_hi:[1,0,0]
v_pk_fma_f32 v[110:111], v[218:219], v[198:199], v[110:111] op_sel_hi:[0,1,1] neg_lo:[1,0,0] neg_hi:[1,0,0]
v_pk_mul_f32 v[100:101], v[100:101], v[218:219] op_sel:[0,1]
v_pk_mul_f32 v[102:103], v[102:103], v[218:219] op_sel:[0,1]
v_pk_mul_f32 v[108:109], v[108:109], v[218:219] op_sel:[0,1]
v_pk_mul_f32 v[110:111], v[110:111], v[218:219] op_sel:[0,1]
v_cvt_pk_bf16_f32 v100, v100, v101
v_cvt_pk_bf16_f32 v101, v102, v103
v_cvt_pk_bf16_f32 v108, v108, v109
v_cvt_pk_bf16_f32 v109, v110, v111
s_nop 0
v_permlane16_swap_b32 v100, v108
v_permlane16_swap_b32 v101, v109
s_nop 0
v_accvgpr_write_b32 a184, v100
v_accvgpr_write_b32 a185, v101
v_accvgpr_write_b32 a186, v108
v_accvgpr_write_b32 a187, v109
v_pk_fma_f32 v[116:117], v[218:219], v[200:201], v[116:117] op_sel_hi:[0,1,1] neg_lo:[1,0,0] neg_hi:[1,0,0]
v_pk_fma_f32 v[118:119], v[218:219], v[202:203], v[118:119] op_sel_hi:[0,1,1] neg_lo:[1,0,0] neg_hi:[1,0,0]
v_pk_fma_f32 v[124:125], v[218:219], v[204:205], v[124:125] op_sel_hi:[0,1,1] neg_lo:[1,0,0] neg_hi:[1,0,0]
v_pk_fma_f32 v[126:127], v[218:219], v[206:207], v[126:127] op_sel_hi:[0,1,1] neg_lo:[1,0,0] neg_hi:[1,0,0]
v_pk_mul_f32 v[116:117], v[116:117], v[218:219] op_sel:[0,1]
v_pk_mul_f32 v[118:119], v[118:119], v[218:219] op_sel:[0,1]
v_pk_mul_f32 v[124:125], v[124:125], v[218:219] op_sel:[0,1]
v_pk_mul_f32 v[126:127], v[126:127], v[218:219] op_sel:[0,1]
v_cvt_pk_bf16_f32 v116, v116, v117
v_cvt_pk_bf16_f32 v117, v118, v119
v_cvt_pk_bf16_f32 v124, v124, v125
v_cvt_pk_bf16_f32 v125, v126, v127
s_nop 0
v_permlane16_swap_b32 v116, v124
v_permlane16_swap_b32 v117, v125
s_nop 0
v_accvgpr_write_b32 a188, v116
v_accvgpr_write_b32 a189, v117
v_accvgpr_write_b32 a190, v124
v_accvgpr_write_b32 a191, v125
M_g3:
s_lshl_b32 s56, s44, 8
s_lshl_b32 s57, s40, 6
s_add_u32 s56, s56, s57
s_lshl_b32 s56, s56, 3
s_add_u32 s56, s56, 0x20000
v_lshlrev_b32 v252, 3, v255
buffer_load_dwordx2 v[196:197], v252, s[36:39], s56 offen sc1
s_add_u32 s56, s56, 16384
buffer_load_dwordx2 v[198:199], v252, s[36:39], s56 offen sc1
s_add_u32 s56, s56, 16384
buffer_load_dwordx2 v[200:201], v252, s[36:39], s56 offen sc1
s_add_u32 s56, s56, 16384
buffer_load_dwordx2 v[202:203], v252, s[36:39], s56 offen sc1
s_add_u32 s56, s56, 16384
buffer_load_dwordx2 v[204:205], v252, s[36:39], s56 offen sc1
s_add_u32 s56, s56, 16384
buffer_load_dwordx2 v[206:207], v252, s[36:39], s56 offen sc1
s_add_u32 s56, s56, 16384
s_mul_i32 s56, s43, 576
s_add_u32 s56, s56, 0xc000
v_lshlrev_b32 v252, 4, v253
buffer_load_dwordx4 v[160:163], v252, s[36:39], s56 offen sc1
buffer_load_dwordx4 v[164:167], v252, s[36:39], s56 offen offset:64 sc1
buffer_load_dwordx4 v[168:171], v252, s[36:39], s56 offen offset:128 sc1
buffer_load_dwordx4 v[172:175], v252, s[36:39], s56 offen offset:192 sc1
buffer_load_dwordx4 v[176:179], v252, s[36:39], s56 offen offset:256 sc1
buffer_load_dwordx4 v[180:183], v252, s[36:39], s56 offen offset:320 sc1
buffer_load_dwordx4 v[184:187], v252, s[36:39], s56 offen offset:384 sc1
buffer_load_dwordx4 v[188:191], v252, s[36:39], s56 offen offset:448 sc1
buffer_load_dwordx4 v[192:195], v252, s[36:39], s56 offen offset:512 sc1
s_waitcnt vmcnt(28)
s_barrier
ds_read_b64_tr_b16 a[96:97], v239 offset:32768
ds_read_b64_tr_b16 a[98:99], v239 offset:37888
ds_read_b64_tr_b16 a[100:101], v239 offset:43008
ds_read_b64_tr_b16 a[102:103], v239 offset:48128
ds_read_b64_tr_b16 a[104:105], v239 offset:32800
ds_read_b64_tr_b16 a[106:107], v239 offset:37920
ds_read_b64_tr_b16 a[108:109], v239 offset:43040
ds_read_b64_tr_b16 a[110:111], v239 offset:48160
s_waitcnt lgkmcnt(4)
v_mfma_f32_16x16x32_bf16 v[0:3], a[96:99], a[0:3], 0
ds_read_b64_tr_b16 a[112:113], v239 offset:32832
v_mfma_f32_16x16x32_bf16 v[0:3], a[100:103], a[4:7], v[0:3]
ds_read_b64_tr_b16 a[114:115], v239 offset:37952
v_mfma_f32_16x16x32_bf16 v[4:7], a[96:99], a[8:11], 0
ds_read_b64_tr_b16 a[116:117], v239 offset:43072
v_mfma_f32_16x16x32_bf16 v[4:7], a[100:103], a[12:15], v[4:7]
s_add_u32 m0, s53, 0x18000
ds_read_b64_tr_b16 a[118:119], v239 offset:48192
v_mfma_f32_16x16x32_bf16 v[8:11], a[96:99], a[16:19], 0
buffer_load_dwordx4 v230, s[4:7], s47 offen lds
v_mfma_f32_16x16x32_bf16 v[8:11], a[100:103], a[20:23], v[8:11]
v_mfma_f32_16x16x32_bf16 v[12:15], a[96:99], a[24:27], 0
buffer_load_dwordx4 v231, s[4:7], s47 offen offset:1024 lds
v_mfma_f32_16x16x32_bf16 v[12:15], a[100:103], a[28:31], v[12:15]
s_waitcnt lgkmcnt(4)
v_mfma_f32_16x16x32_bf16 v[16:19], a[104:107], a[0:3], 0
ds_read_b64_tr_b16 a[96:97], v239 offset:32864
v_mfma_f32_16x16x32_bf16 v[16:19], a[108:111], a[4:7], v[16:19]
ds_read_b64_tr_b16 a[98:99], v239 offset:37984
v_mfma_f32_16x16x32_bf16 v[20:23], a[104:107], a[8:11], 0
ds_read_b64_tr_b16 a[100:101], v239 offset:43104
v_mfma_f32_16x16x32_bf16 v[20:23], a[108:111], a[12:15], v[20:23]
ds_read_b64_tr_b16 a[102:103], v239 offset:48224
v_mfma_f32_16x16x32_bf16 v[24:27], a[104:107], a[16:19], 0
buffer_load_dwordx4 v232, s[4:7], s47 offen offset:2048 lds
v_mfma_f32_16x16x32_bf16 v[24:27], a[108:111], a[20:23], v[24:27]
v_mfma_f32_16x16x32_bf16 v[28:31], a[104:107], a[24:27], 0
buffer_load_dwordx4 v233, s[4:7], s47 offen offset:3072 lds
v_mfma_f32_16x16x32_bf16 v[28:31], a[108:111], a[28:31], v[28:31]
s_waitcnt lgkmcnt(4)
v_mfma_f32_16x16x32_bf16 v[32:35], a[112:115], a[0:3], 0
ds_read_b64_tr_b16 a[104:105], v239 offset:32896
v_mfma_f32_16x16x32_bf16 v[32:35], a[116:119], a[4:7], v[32:35]
ds_read_b64_tr_b16 a[106:107], v239 offset:38016
v_mfma_f32_16x16x32_bf16 v[36:39], a[112:115], a[8:11], 0
ds_read_b64_tr_b16 a[108:109], v239 offset:43136
v_mfma_f32_16x16x32_bf16 v[36:39], a[116:119], a[12:15], v[36:39]
ds_read_b64_tr_b16 a[110:111], v239 offset:48256
v_mfma_f32_16x16x32_bf16 v[40:43], a[112:115], a[16:19], 0
v_mfma_f32_16x16x32_bf16 v[40:43], a[116:119], a[20:23], v[40:43]
s_add_u32 m0, s53, 0x19000
v_mfma_f32_16x16x32_bf16 v[44:47], a[112:115], a[24:27], 0
buffer_load_dwordx4 v234, s[4:7], s47 offen lds
v_mfma_f32_16x16x32_bf16 v[44:47], a[116:119], a[28:31], v[44:47]
s_waitcnt lgkmcnt(4)
v_mfma_f32_16x16x32_bf16 v[48:51], a[96:99], a[0:3], 0
ds_read_b64_tr_b16 a[112:113], v239 offset:32928
v_mfma_f32_16x16x32_bf16 v[48:51], a[100:103], a[4:7], v[48:51]
ds_read_b64_tr_b16 a[114:115], v239 offset:38048
v_mfma_f32_16x16x32_bf16 v[52:55], a[96:99], a[8:11], 0
ds_read_b64_tr_b16 a[116:117], v239 offset:43168
v_mfma_f32_16x16x32_bf16 v[52:55], a[100:103], a[12:15], v[52:55]
ds_read_b64_tr_b16 a[118:119], v239 offset:48288
v_mfma_f32_16x16x32_bf16 v[56:59], a[96:99], a[16:19], 0
buffer_load_dwordx4 a[64:67], v235, s[16:19], s48 offen sc1
v_mfma_f32_16x16x32_bf16 v[56:59], a[100:103], a[20:23], v[56:59]
v_mfma_f32_16x16x32_bf16 v[60:63], a[96:99], a[24:27], 0
buffer_load_dwordx4 a[68:71], v235, s[16:19], s48 offen offset:1024 sc1
v_mfma_f32_16x16x32_bf16 v[60:63], a[100:103], a[28:31], v[60:63]
s_waitcnt lgkmcnt(4)
v_mfma_f32_16x16x32_bf16 v[64:67], a[104:107], a[0:3], 0
ds_read_b64_tr_b16 a[96:97], v239 offset:32960
v_mfma_f32_16x16x32_bf16 v[64:67], a[108:111], a[4:7], v[64:67]
ds_read_b64_tr_b16 a[98:99], v239 offset:38080
v_mfma_f32_16x16x32_bf16 v[68:71], a[104:107], a[8:11], 0
ds_read_b64_tr_b16 a[100:101], v239 offset:43200
v_mfma_f32_16x16x32_bf16 v[68:71], a[108:111], a[12:15], v[68:71]
ds_read_b64_tr_b16 a[102:103], v239 offset:48320
v_mfma_f32_16x16x32_bf16 v[72:75], a[104:107], a[16:19], 0
v_mfma_f32_16x16x32_bf16 v[72:75], a[108:111], a[20:23], v[72:75]
v_mfma_f32_16x16x32_bf16 v[76:79], a[104:107], a[24:27], 0
buffer_load_dwordx4 a[72:75], v236, s[16:19], s48 offen sc1
v_mfma_f32_16x16x32_bf16 v[76:79], a[108:111], a[28:31], v[76:79]
s_waitcnt lgkmcnt(4)
v_mfma_f32_16x16x32_bf16 v[80:83], a[112:115], a[0:3], 0
ds_read_b64_tr_b16 a[104:105], v239 offset:32992
v_mfma_f32_16x16x32_bf16 v[80:83], a[116:119], a[4:7], v[80:83]
ds_read_b64_tr_b16 a[106:107], v239 offset:38112
v_mfma_f32_16x16x32_bf16 v[84:87], a[112:115], a[8:11], 0
ds_read_b64_tr_b16 a[108:109], v239 offset:43232
v_mfma_f32_16x16x32_bf16 v[84:87], a[116:119], a[12:15], v[84:87]
ds_read_b64_tr_b16 a[110:111], v239 offset:48352
v_mfma_f32_16x16x32_bf16 v[88:91], a[112:115], a[16:19], 0
buffer_load_dwordx4 a[76:79], v236, s[16:19], s48 offen offset:1024 sc1
v_mfma_f32_16x16x32_bf16 v[88:91], a[116:119], a[20:23], v[88:91]
v_mfma_f32_16x16x32_bf16 v[92:95], a[112:115], a[24:27], 0
buffer_load_dwordx4 a[80:83], v237, s[16:19], s48 offen sc1
v_mfma_f32_16x16x32_bf16 v[92:95], a[116:119], a[28:31], v[92:95]
s_waitcnt lgkmcnt(4)
v_mfma_f32_16x16x32_bf16 v[96:99], a[96:99], a[0:3], 0
ds_read_b64_tr_b16 a[112:113], v239 offset:33024
v_mfma_f32_16x16x32_bf16 v[96:99], a[100:103], a[4:7], v[96:99]
ds_read_b64_tr_b16 a[114:115], v239 offset:38144
v_mfma_f32_16x16x32_bf16 v[100:103], a[96:99], a[8:11], 0
ds_read_b64_tr_b16 a[116:117], v239 offset:43264
v_mfma_f32_16x16x32_bf16 v[100:103], a[100:103], a[12:15], v[100:103]
ds_read_b64_tr_b16 a[118:119], v239 offset:48384
v_mfma_f32_16x16x32_bf16 v[104:107], a[96:99], a[16:19], 0
v_mfma_f32_16x16x32_bf16 v[104:107], a[100:103], a[20:23], v[104:107]
v_mfma_f32_16x16x32_bf16 v[108:111], a[96:99], a[24:27], 0
s_waitcnt vmcnt(25)
v_mfma_f32_16x16x32_bf16 v[108:111], a[100:103], a[28:31], v[108:111]
s_waitcnt lgkmcnt(4)
s_barrier
v_mfma_f32_16x16x32_bf16 v[112:115], a[104:107], a[0:3], 0
ds_read_b64_tr_b16 a[96:97], v240
v_mfma_f32_16x16x32_bf16 v[112:115], a[108:111], a[4:7], v[112:115]
ds_read_b64_tr_b16 a[98:99], v240 offset:5120
v_mfma_f32_16x16x32_bf16 v[116:119], a[104:107], a[8:11], 0
ds_read_b64_tr_b16 a[100:101], v240 offset:10240
v_mfma_f32_16x16x32_bf16 v[116:119], a[108:111], a[12:15], v[116:119]
ds_read_b64_tr_b16 a[102:103], v240 offset:15360
v_mfma_f32_16x16x32_bf16 v[120:123], a[104:107], a[16:19], 0
buffer_load_dwordx4 a[84:87], v237, s[16:19], s48 offen offset:1024 sc1
v_mfma_f32_16x16x32_bf16 v[120:123], a[108:111], a[20:23], v[120:123]
v_mfma_f32_16x16x32_bf16 v[124:127], a[104:107], a[24:27], 0
buffer_load_dwordx4 a[88:91], v238, s[16:19], s48 offen sc1
v_mfma_f32_16x16x32_bf16 v[124:127], a[108:111], a[28:31], v[124:127]
s_waitcnt lgkmcnt(4)
v_mfma_f32_16x16x32_bf16 v[128:131], a[112:115], a[0:3], 0
ds_read_b64_tr_b16 a[104:105], v240 offset:32
v_mfma_f32_16x16x32_bf16 v[128:131], a[116:119], a[4:7], v[128:131]
ds_read_b64_tr_b16 a[106:107], v240 offset:5152
v_mfma_f32_16x16x32_bf16 v[132:135], a[112:115], a[8:11], 0
ds_read_b64_tr_b16 a[108:109], v240 offset:10272
v_mfma_f32_16x16x32_bf16 v[132:135], a[116:119], a[12:15], v[132:135]
ds_read_b64_tr_b16 a[110:111], v240 offset:15392
v_mfma_f32_16x16x32_bf16 v[136:139], a[112:115], a[16:19], 0
buffer_load_dwordx4 a[92:95], v238, s[16:19], s48 offen offset:1024 sc1
v_mfma_f32_16x16x32_bf16 v[136:139], a[116:119], a[20:23], v[136:139]
s_add_u32 s47, s47, 589824
s_add_u32 s48, s48, 2048
v_mfma_f32_16x16x32_bf16 v[140:143], a[112:115], a[24:27], 0
v_mfma_f32_16x16x32_bf16 v[140:143], a[116:119], a[28:31], v[140:143]
s_waitcnt lgkmcnt(4)
v_mfma_f32_16x16x32_bf16 v[0:3], a[96:99], a[32:35], v[0:3]
ds_read_b64_tr_b16 a[112:113], v240 offset:64
v_mfma_f32_16x16x32_bf16 v[0:3], a[100:103], a[36:39], v[0:3]
ds_read_b64_tr_b16 a[114:115], v240 offset:5184
v_mfma_f32_16x16x32_bf16 v[4:7], a[96:99], a[40:43], v[4:7]
ds_read_b64_tr_b16 a[116:117], v240 offset:10304
v_mfma_f32_16x16x32_bf16 v[4:7], a[100:103], a[44:47], v[4:7]
s_add_u32 m0, s53, 0x0
ds_read_b64_tr_b16 a[118:119], v240 offset:15424
v_mfma_f32_16x16x32_bf16 v[8:11], a[96:99], a[48:51], v[8:11]
buffer_load_dwordx4 v230, s[4:7], s47 offen lds
v_mfma_f32_16x16x32_bf16 v[8:11], a[100:103], a[52:55], v[8:11]
v_mfma_f32_16x16x32_bf16 v[12:15], a[96:99], a[56:59], v[12:15]
buffer_load_dwordx4 v231, s[4:7], s47 offen offset:1024 lds
v_mfma_f32_16x16x32_bf16 v[12:15], a[100:103], a[60:63], v[12:15]
s_waitcnt lgkmcnt(4)
v_mfma_f32_16x16x32_bf16 v[16:19], a[104:107], a[32:35], v[16:19]
ds_read_b64_tr_b16 a[96:97], v240 offset:96
v_mfma_f32_16x16x32_bf16 v[16:19], a[108:111], a[36:39], v[16:19]
ds_read_b64_tr_b16 a[98:99], v240 offset:5216
v_mfma_f32_16x16x32_bf16 v[20:23], a[104:107], a[40:43], v[20:23]
ds_read_b64_tr_b16 a[100:101], v240 offset:10336
v_mfma_f32_16x16x32_bf16 v[20:23], a[108:111], a[44:47], v[20:23]
ds_read_b64_tr_b16 a[102:103], v240 offset:15456
v_mfma_f32_16x16x32_bf16 v[24:27], a[104:107], a[48:51], v[24:27]
buffer_load_dwordx4 v232, s[4:7], s47 offen offset:2048 lds
v_mfma_f32_16x16x32_bf16 v[24:27], a[108:111], a[52:55], v[24:27]
v_mfma_f32_16x16x32_bf16 v[28:31], a[104:107], a[56:59], v[28:31]
buffer_load_dwordx4 v233, s[4:7], s47 offen offset:3072 lds
v_mfma_f32_16x16x32_bf16 v[28:31], a[108:111], a[60:63], v[28:31]
s_waitcnt lgkmcnt(4)
v_mfma_f32_16x16x32_bf16 v[32:35], a[112:115], a[32:35], v[32:35]
ds_read_b64_tr_b16 a[104:105], v240 offset:128
v_mfma_f32_16x16x32_bf16 v[32:35], a[116:119], a[36:39], v[32:35]
ds_read_b64_tr_b16 a[106:107], v240 offset:5248
v_mfma_f32_16x16x32_bf16 v[36:39], a[112:115], a[40:43], v[36:39]
ds_read_b64_tr_b16 a[108:109], v240 offset:10368
v_mfma_f32_16x16x32_bf16 v[36:39], a[116:119], a[44:47], v[36:39]
ds_read_b64_tr_b16 a[110:111], v240 offset:15488
v_mfma_f32_16x16x32_bf16 v[40:43], a[112:115], a[48:51], v[40:43]
v_mfma_f32_16x16x32_bf16 v[40:43], a[116:119], a[52:55], v[40:43]
s_add_u32 m0, s53, 0x1000
v_mfma_f32_16x16x32_bf16 v[44:47], a[112:115], a[56:59], v[44:47]
buffer_load_dwordx4 v234, s[4:7], s47 offen lds
v_mfma_f32_16x16x32_bf16 v[44:47], a[116:119], a[60:63], v[44:47]
s_waitcnt lgkmcnt(4)
v_mfma_f32_16x16x32_bf16 v[48:51], a[96:99], a[32:35], v[48:51]
ds_read_b64_tr_b16 a[112:113], v240 offset:160
v_mfma_f32_16x16x32_bf16 v[48:51], a[100:103], a[36:39], v[48:51]
ds_read_b64_tr_b16 a[114:115], v240 offset:5280
v_mfma_f32_16x16x32_bf16 v[52:55], a[96:99], a[40:43], v[52:55]
ds_read_b64_tr_b16 a[116:117], v240 offset:10400
v_mfma_f32_16x16x32_bf16 v[52:55], a[100:103], a[44:47], v[52:55]
ds_read_b64_tr_b16 a[118:119], v240 offset:15520
v_mfma_f32_16x16x32_bf16 v[56:59], a[96:99], a[48:51], v[56:59]
buffer_load_dwordx4 a[0:3], v235, s[16:19], s48 offen sc1
v_mfma_f32_16x16x32_bf16 v[56:59], a[100:103], a[52:55], v[56:59]
v_mfma_f32_16x16x32_bf16 v[60:63], a[96:99], a[56:59], v[60:63]
buffer_load_dwordx4 a[4:7], v235, s[16:19], s48 offen offset:1024 sc1
v_mfma_f32_16x16x32_bf16 v[60:63], a[100:103], a[60:63], v[60:63]
s_waitcnt lgkmcnt(4)
v_mfma_f32_16x16x32_bf16 v[64:67], a[104:107], a[32:35], v[64:67]
ds_read_b64_tr_b16 a[96:97], v240 offset:192
v_mfma_f32_16x16x32_bf16 v[64:67], a[108:111], a[36:39], v[64:67]
ds_read_b64_tr_b16 a[98:99], v240 offset:5312
v_mfma_f32_16x16x32_bf16 v[68:71], a[104:107], a[40:43], v[68:71]
ds_read_b64_tr_b16 a[100:101], v240 offset:10432
v_mfma_f32_16x16x32_bf16 v[68:71], a[108:111], a[44:47], v[68:71]
ds_read_b64_tr_b16 a[102:103], v240 offset:15552
v_mfma_f32_16x16x32_bf16 v[72:75], a[104:107], a[48:51], v[72:75]
v_mfma_f32_16x16x32_bf16 v[72:75], a[108:111], a[52:55], v[72:75]
v_mfma_f32_16x16x32_bf16 v[76:79], a[104:107], a[56:59], v[76:79]
buffer_load_dwordx4 a[8:11], v236, s[16:19], s48 offen sc1
v_mfma_f32_16x16x32_bf16 v[76:79], a[108:111], a[60:63], v[76:79]
s_waitcnt lgkmcnt(4)
v_mfma_f32_16x16x32_bf16 v[80:83], a[112:115], a[32:35], v[80:83]
ds_read_b64_tr_b16 a[104:105], v240 offset:224
v_mfma_f32_16x16x32_bf16 v[80:83], a[116:119], a[36:39], v[80:83]
ds_read_b64_tr_b16 a[106:107], v240 offset:5344
v_mfma_f32_16x16x32_bf16 v[84:87], a[112:115], a[40:43], v[84:87]
ds_read_b64_tr_b16 a[108:109], v240 offset:10464
v_mfma_f32_16x16x32_bf16 v[84:87], a[116:119], a[44:47], v[84:87]
ds_read_b64_tr_b16 a[110:111], v240 offset:15584
v_mfma_f32_16x16x32_bf16 v[88:91], a[112:115], a[48:51], v[88:91]
buffer_load_dwordx4 a[12:15], v236, s[16:19], s48 offen offset:1024 sc1
v_mfma_f32_16x16x32_bf16 v[88:91], a[116:119], a[52:55], v[88:91]
v_mfma_f32_16x16x32_bf16 v[92:95], a[112:115], a[56:59], v[92:95]
buffer_load_dwordx4 a[16:19], v237, s[16:19], s48 offen sc1
v_mfma_f32_16x16x32_bf16 v[92:95], a[116:119], a[60:63], v[92:95]
s_waitcnt lgkmcnt(4)
v_mfma_f32_16x16x32_bf16 v[96:99], a[96:99], a[32:35], v[96:99]
ds_read_b64_tr_b16 a[112:113], v240 offset:256
v_mfma_f32_16x16x32_bf16 v[96:99], a[100:103], a[36:39], v[96:99]
ds_read_b64_tr_b16 a[114:115], v240 offset:5376
v_mfma_f32_16x16x32_bf16 v[100:103], a[96:99], a[40:43], v[100:103]
ds_read_b64_tr_b16 a[116:117], v240 offset:10496
v_mfma_f32_16x16x32_bf16 v[100:103], a[100:103], a[44:47], v[100:103]
ds_read_b64_tr_b16 a[118:119], v240 offset:15616
v_mfma_f32_16x16x32_bf16 v[104:107], a[96:99], a[48:51], v[104:107]
v_mfma_f32_16x16x32_bf16 v[104:107], a[100:103], a[52:55], v[104:107]
v_mfma_f32_16x16x32_bf16 v[108:111], a[96:99], a[56:59], v[108:111]
s_waitcnt vmcnt(10)
v_mfma_f32_16x16x32_bf16 v[108:111], a[100:103], a[60:63], v[108:111]
s_waitcnt lgkmcnt(4)
s_barrier
v_mfma_f32_16x16x32_bf16 v[112:115], a[104:107], a[32:35], v[112:115]
ds_read_b64_tr_b16 a[96:97], v240 offset:32768
v_mfma_f32_16x16x32_bf16 v[112:115], a[108:111], a[36:39], v[112:115]
ds_read_b64_tr_b16 a[98:99], v240 offset:37888
v_mfma_f32_16x16x32_bf16 v[116:119], a[104:107], a[40:43], v[116:119]
ds_read_b64_tr_b16 a[100:101], v240 offset:43008
v_mfma_f32_16x16x32_bf16 v[116:119], a[108:111], a[44:47], v[116:119]
ds_read_b64_tr_b16 a[102:103], v240 offset:48128
v_mfma_f32_16x16x32_bf16 v[120:123], a[104:107], a[48:51], v[120:123]
buffer_load_dwordx4 a[20:23], v237, s[16:19], s48 offen offset:1024 sc1
v_mfma_f32_16x16x32_bf16 v[120:123], a[108:111], a[52:55], v[120:123]
v_mfma_f32_16x16x32_bf16 v[124:127], a[104:107], a[56:59], v[124:127]
buffer_load_dwordx4 a[24:27], v238, s[16:19], s48 offen sc1
v_mfma_f32_16x16x32_bf16 v[124:127], a[108:111], a[60:63], v[124:127]
s_waitcnt lgkmcnt(4)
v_mfma_f32_16x16x32_bf16 v[128:131], a[112:115], a[32:35], v[128:131]
ds_read_b64_tr_b16 a[104:105], v240 offset:32800
v_mfma_f32_16x16x32_bf16 v[128:131], a[116:119], a[36:39], v[128:131]
ds_read_b64_tr_b16 a[106:107], v240 offset:37920
v_mfma_f32_16x16x32_bf16 v[132:135], a[112:115], a[40:43], v[132:135]
ds_read_b64_tr_b16 a[108:109], v240 offset:43040
v_mfma_f32_16x16x32_bf16 v[132:135], a[116:119], a[44:47], v[132:135]
ds_read_b64_tr_b16 a[110:111], v240 offset:48160
v_mfma_f32_16x16x32_bf16 v[136:139], a[112:115], a[48:51], v[136:139]
buffer_load_dwordx4 a[28:31], v238, s[16:19], s48 offen offset:1024 sc1
v_mfma_f32_16x16x32_bf16 v[136:139], a[116:119], a[52:55], v[136:139]
s_add_u32 s47, s47, 589824
s_add_u32 s48, s48, 2048
v_mfma_f32_16x16x32_bf16 v[140:143], a[112:115], a[56:59], v[140:143]
v_mfma_f32_16x16x32_bf16 v[140:143], a[116:119], a[60:63], v[140:143]
s_waitcnt lgkmcnt(4)
v_mfma_f32_16x16x32_bf16 v[0:3], a[96:99], a[64:67], v[0:3]
ds_read_b64_tr_b16 a[112:113], v240 offset:32832
v_mfma_f32_16x16x32_bf16 v[0:3], a[100:103], a[68:71], v[0:3]
ds_read_b64_tr_b16 a[114:115], v240 offset:37952
v_mfma_f32_16x16x32_bf16 v[4:7], a[96:99], a[72:75], v[4:7]
ds_read_b64_tr_b16 a[116:117], v240 offset:43072
v_mfma_f32_16x16x32_bf16 v[4:7], a[100:103], a[76:79], v[4:7]
s_add_u32 m0, s53, 0x8000
ds_read_b64_tr_b16 a[118:119], v240 offset:48192
v_mfma_f32_16x16x32_bf16 v[8:11], a[96:99], a[80:83], v[8:11]
buffer_load_dwordx4 v230, s[4:7], s47 offen lds
v_mfma_f32_16x16x32_bf16 v[8:11], a[100:103], a[84:87], v[8:11]
v_mfma_f32_16x16x32_bf16 v[12:15], a[96:99], a[88:91], v[12:15]
buffer_load_dwordx4 v231, s[4:7], s47 offen offset:1024 lds
v_mfma_f32_16x16x32_bf16 v[12:15], a[100:103], a[92:95], v[12:15]
s_waitcnt lgkmcnt(4)
v_mfma_f32_16x16x32_bf16 v[16:19], a[104:107], a[64:67], v[16:19]
ds_read_b64_tr_b16 a[96:97], v240 offset:32864
v_mfma_f32_16x16x32_bf16 v[16:19], a[108:111], a[68:71], v[16:19]
ds_read_b64_tr_b16 a[98:99], v240 offset:37984
v_mfma_f32_16x16x32_bf16 v[20:23], a[104:107], a[72:75], v[20:23]
ds_read_b64_tr_b16 a[100:101], v240 offset:43104
v_mfma_f32_16x16x32_bf16 v[20:23], a[108:111], a[76:79], v[20:23]
ds_read_b64_tr_b16 a[102:103], v240 offset:48224
v_mfma_f32_16x16x32_bf16 v[24:27], a[104:107], a[80:83], v[24:27]
buffer_load_dwordx4 v232, s[4:7], s47 offen offset:2048 lds
v_mfma_f32_16x16x32_bf16 v[24:27], a[108:111], a[84:87], v[24:27]
v_mfma_f32_16x16x32_bf16 v[28:31], a[104:107], a[88:91], v[28:31]
buffer_load_dwordx4 v233, s[4:7], s47 offen offset:3072 lds
v_mfma_f32_16x16x32_bf16 v[28:31], a[108:111], a[92:95], v[28:31]
s_waitcnt lgkmcnt(4)
v_mfma_f32_16x16x32_bf16 v[32:35], a[112:115], a[64:67], v[32:35]
ds_read_b64_tr_b16 a[104:105], v240 offset:32896
v_mfma_f32_16x16x32_bf16 v[32:35], a[116:119], a[68:71], v[32:35]
ds_read_b64_tr_b16 a[106:107], v240 offset:38016
v_mfma_f32_16x16x32_bf16 v[36:39], a[112:115], a[72:75], v[36:39]
ds_read_b64_tr_b16 a[108:109], v240 offset:43136
v_mfma_f32_16x16x32_bf16 v[36:39], a[116:119], a[76:79], v[36:39]
ds_read_b64_tr_b16 a[110:111], v240 offset:48256
v_mfma_f32_16x16x32_bf16 v[40:43], a[112:115], a[80:83], v[40:43]
v_mfma_f32_16x16x32_bf16 v[40:43], a[116:119], a[84:87], v[40:43]
s_add_u32 m0, s53, 0x9000
v_mfma_f32_16x16x32_bf16 v[44:47], a[112:115], a[88:91], v[44:47]
buffer_load_dwordx4 v234, s[4:7], s47 offen lds
v_mfma_f32_16x16x32_bf16 v[44:47], a[116:119], a[92:95], v[44:47]
s_waitcnt lgkmcnt(4)
v_mfma_f32_16x16x32_bf16 v[48:51], a[96:99], a[64:67], v[48:51]
ds_read_b64_tr_b16 a[112:113], v240 offset:32928
v_mfma_f32_16x16x32_bf16 v[48:51], a[100:103], a[68:71], v[48:51]
ds_read_b64_tr_b16 a[114:115], v240 offset:38048
v_mfma_f32_16x16x32_bf16 v[52:55], a[96:99], a[72:75], v[52:55]
ds_read_b64_tr_b16 a[116:117], v240 offset:43168
v_mfma_f32_16x16x32_bf16 v[52:55], a[100:103], a[76:79], v[52:55]
ds_read_b64_tr_b16 a[118:119], v240 offset:48288
v_mfma_f32_16x16x32_bf16 v[56:59], a[96:99], a[80:83], v[56:59]
buffer_load_dwordx4 a[32:35], v235, s[16:19], s48 offen sc1
v_mfma_f32_16x16x32_bf16 v[56:59], a[100:103], a[84:87], v[56:59]
v_mfma_f32_16x16x32_bf16 v[60:63], a[96:99], a[88:91], v[60:63]
buffer_load_dwordx4 a[36:39], v235, s[16:19], s48 offen offset:1024 sc1
v_mfma_f32_16x16x32_bf16 v[60:63], a[100:103], a[92:95], v[60:63]
s_waitcnt lgkmcnt(4)
v_mfma_f32_16x16x32_bf16 v[64:67], a[104:107], a[64:67], v[64:67]
ds_read_b64_tr_b16 a[96:97], v240 offset:32960
v_mfma_f32_16x16x32_bf16 v[64:67], a[108:111], a[68:71], v[64:67]
ds_read_b64_tr_b16 a[98:99], v240 offset:38080
v_mfma_f32_16x16x32_bf16 v[68:71], a[104:107], a[72:75], v[68:71]
ds_read_b64_tr_b16 a[100:101], v240 offset:43200
v_mfma_f32_16x16x32_bf16 v[68:71], a[108:111], a[76:79], v[68:71]
ds_read_b64_tr_b16 a[102:103], v240 offset:48320
v_mfma_f32_16x16x32_bf16 v[72:75], a[104:107], a[80:83], v[72:75]
v_mfma_f32_16x16x32_bf16 v[72:75], a[108:111], a[84:87], v[72:75]
v_mfma_f32_16x16x32_bf16 v[76:79], a[104:107], a[88:91], v[76:79]
buffer_load_dwordx4 a[40:43], v236, s[16:19], s48 offen sc1
v_mfma_f32_16x16x32_bf16 v[76:79], a[108:111], a[92:95], v[76:79]
s_waitcnt lgkmcnt(4)
v_mfma_f32_16x16x32_bf16 v[80:83], a[112:115], a[64:67], v[80:83]
ds_read_b64_tr_b16 a[104:105], v240 offset:32992
v_mfma_f32_16x16x32_bf16 v[80:83], a[116:119], a[68:71], v[80:83]
ds_read_b64_tr_b16 a[106:107], v240 offset:38112
v_mfma_f32_16x16x32_bf16 v[84:87], a[112:115], a[72:75], v[84:87]
ds_read_b64_tr_b16 a[108:109], v240 offset:43232
v_mfma_f32_16x16x32_bf16 v[84:87], a[116:119], a[76:79], v[84:87]
ds_read_b64_tr_b16 a[110:111], v240 offset:48352
v_mfma_f32_16x16x32_bf16 v[88:91], a[112:115], a[80:83], v[88:91]
buffer_load_dwordx4 a[44:47], v236, s[16:19], s48 offen offset:1024 sc1
v_mfma_f32_16x16x32_bf16 v[88:91], a[116:119], a[84:87], v[88:91]
v_mfma_f32_16x16x32_bf16 v[92:95], a[112:115], a[88:91], v[92:95]
buffer_load_dwordx4 a[48:51], v237, s[16:19], s48 offen sc1
v_mfma_f32_16x16x32_bf16 v[92:95], a[116:119], a[92:95], v[92:95]
s_waitcnt lgkmcnt(4)
v_mfma_f32_16x16x32_bf16 v[96:99], a[96:99], a[64:67], v[96:99]
ds_read_b64_tr_b16 a[112:113], v240 offset:33024
v_mfma_f32_16x16x32_bf16 v[96:99], a[100:103], a[68:71], v[96:99]
ds_read_b64_tr_b16 a[114:115], v240 offset:38144
v_mfma_f32_16x16x32_bf16 v[100:103], a[96:99], a[72:75], v[100:103]
ds_read_b64_tr_b16 a[116:117], v240 offset:43264
v_mfma_f32_16x16x32_bf16 v[100:103], a[100:103], a[76:79], v[100:103]
ds_read_b64_tr_b16 a[118:119], v240 offset:48384
v_mfma_f32_16x16x32_bf16 v[104:107], a[96:99], a[80:83], v[104:107]
v_mfma_f32_16x16x32_bf16 v[104:107], a[100:103], a[84:87], v[104:107]
v_mfma_f32_16x16x32_bf16 v[108:111], a[96:99], a[88:91], v[108:111]
s_waitcnt vmcnt(10)
v_mfma_f32_16x16x32_bf16 v[108:111], a[100:103], a[92:95], v[108:111]
s_waitcnt lgkmcnt(4)
s_barrier
v_mfma_f32_16x16x32_bf16 v[112:115], a[104:107], a[64:67], v[112:115]
ds_read_b64_tr_b16 a[96:97], v239
v_mfma_f32_16x16x32_bf16 v[112:115], a[108:111], a[68:71], v[112:115]
ds_read_b64_tr_b16 a[98:99], v239 offset:5120
v_mfma_f32_16x16x32_bf16 v[116:119], a[104:107], a[72:75], v[116:119]
ds_read_b64_tr_b16 a[100:101], v239 offset:10240
v_mfma_f32_16x16x32_bf16 v[116:119], a[108:111], a[76:79], v[116:119]
ds_read_b64_tr_b16 a[102:103], v239 offset:15360
v_mfma_f32_16x16x32_bf16 v[120:123], a[104:107], a[80:83], v[120:123]
buffer_load_dwordx4 a[52:55], v237, s[16:19], s48 offen offset:1024 sc1
v_mfma_f32_16x16x32_bf16 v[120:123], a[108:111], a[84:87], v[120:123]
v_mfma_f32_16x16x32_bf16 v[124:127], a[104:107], a[88:91], v[124:127]
buffer_load_dwordx4 a[56:59], v238, s[16:19], s48 offen sc1
v_mfma_f32_16x16x32_bf16 v[124:127], a[108:111], a[92:95], v[124:127]
s_waitcnt lgkmcnt(4)
v_mfma_f32_16x16x32_bf16 v[128:131], a[112:115], a[64:67], v[128:131]
ds_read_b64_tr_b16 a[104:105], v239 offset:32
v_mfma_f32_16x16x32_bf16 v[128:131], a[116:119], a[68:71], v[128:131]
ds_read_b64_tr_b16 a[106:107], v239 offset:5152
v_mfma_f32_16x16x32_bf16 v[132:135], a[112:115], a[72:75], v[132:135]
ds_read_b64_tr_b16 a[108:109], v239 offset:10272
v_mfma_f32_16x16x32_bf16 v[132:135], a[116:119], a[76:79], v[132:135]
ds_read_b64_tr_b16 a[110:111], v239 offset:15392
v_mfma_f32_16x16x32_bf16 v[136:139], a[112:115], a[80:83], v[136:139]
buffer_load_dwordx4 a[60:63], v238, s[16:19], s48 offen offset:1024 sc1
v_mfma_f32_16x16x32_bf16 v[136:139], a[116:119], a[84:87], v[136:139]
s_add_u32 s47, s47, 589824
s_add_u32 s48, s48, 2048
v_mfma_f32_16x16x32_bf16 v[140:143], a[112:115], a[88:91], v[140:143]
v_mfma_f32_16x16x32_bf16 v[140:143], a[116:119], a[92:95], v[140:143]
s_waitcnt lgkmcnt(4)
v_mfma_f32_16x16x32_bf16 v[0:3], a[96:99], a[0:3], v[0:3]
ds_read_b64_tr_b16 a[112:113], v239 offset:64
v_add_f32 v196, v196, v198
v_mfma_f32_16x16x32_bf16 v[0:3], a[100:103], a[4:7], v[0:3]
ds_read_b64_tr_b16 a[114:115], v239 offset:5184
v_add_f32 v197, v197, v199
v_mfma_f32_16x16x32_bf16 v[4:7], a[96:99], a[8:11], v[4:7]
ds_read_b64_tr_b16 a[116:117], v239 offset:10304
v_add_f32 v196, v196, v200
v_mfma_f32_16x16x32_bf16 v[4:7], a[100:103], a[12:15], v[4:7]
s_add_u32 m0, s53, 0x10000
ds_read_b64_tr_b16 a[118:119], v239 offset:15424
v_add_f32 v197, v197, v201
v_mfma_f32_16x16x32_bf16 v[8:11], a[96:99], a[16:19], v[8:11]
buffer_load_dwordx4 v230, s[4:7], s47 offen lds
v_mfma_f32_16x16x32_bf16 v[8:11], a[100:103], a[20:23], v[8:11]
v_add_f32 v196, v196, v202
v_add_f32 v197, v197, v203
v_mfma_f32_16x16x32_bf16 v[12:15], a[96:99], a[24:27], v[12:15]
buffer_load_dwordx4 v231, s[4:7], s47 offen offset:1024 lds
v_mfma_f32_16x16x32_bf16 v[12:15], a[100:103], a[28:31], v[12:15]
s_waitcnt lgkmcnt(4)
v_add_f32 v196, v196, v204
v_add_f32 v197, v197, v205
v_mfma_f32_16x16x32_bf16 v[16:19], a[104:107], a[0:3], v[16:19]
ds_read_b64_tr_b16 a[96:97], v239 offset:96
v_add_f32 v196, v196, v206
v_mfma_f32_16x16x32_bf16 v[16:19], a[108:111], a[4:7], v[16:19]
ds_read_b64_tr_b16 a[98:99], v239 offset:5216
v_add_f32 v197, v197, v207
v_mfma_f32_16x16x32_bf16 v[20:23], a[104:107], a[8:11], v[20:23]
ds_read_b64_tr_b16 a[100:101], v239 offset:10336
v_mul_f32 v196, 0x3ae38e39, v196
v_mfma_f32_16x16x32_bf16 v[20:23], a[108:111], a[12:15], v[20:23]
ds_read_b64_tr_b16 a[102:103], v239 offset:15456
v_mul_f32 v197, 0x3ae38e39, v197
v_mfma_f32_16x16x32_bf16 v[24:27], a[104:107], a[16:19], v[24:27]
buffer_load_dwordx4 v232, s[4:7], s47 offen offset:2048 lds
v_mfma_f32_16x16x32_bf16 v[24:27], a[108:111], a[20:23], v[24:27]
v_fma_f32 v197, -v196, v196, v197
v_max_f32 v197, 0, v197
v_mfma_f32_16x16x32_bf16 v[28:31], a[104:107], a[24:27], v[28:31]
buffer_load_dwordx4 v233, s[4:7], s47 offen offset:3072 lds
v_mfma_f32_16x16x32_bf16 v[28:31], a[108:111], a[28:31], v[28:31]
s_waitcnt lgkmcnt(4)
v_add_f32 v197, 0x3727c5ac, v197
v_mfma_f32_16x16x32_bf16 v[32:35], a[112:115], a[0:3], v[32:35]
ds_read_b64_tr_b16 a[104:105], v239 offset:128
v_mfma_f32_16x16x32_bf16 v[32:35], a[116:119], a[4:7], v[32:35]
ds_read_b64_tr_b16 a[106:107], v239 offset:5248
v_mfma_f32_16x16x32_bf16 v[36:39], a[112:115], a[8:11], v[36:39]
ds_read_b64_tr_b16 a[108:109], v239 offset:10368
v_mfma_f32_16x16x32_bf16 v[36:39], a[116:119], a[12:15], v[36:39]
ds_read_b64_tr_b16 a[110:111], v239 offset:15488
v_mfma_f32_16x16x32_bf16 v[40:43], a[112:115], a[16:19], v[40:43]
v_rsq_f32 v198, v197
v_mfma_f32_16x16x32_bf16 v[40:43], a[116:119], a[20:23], v[40:43]
s_add_u32 m0, s53, 0x11000
v_lshlrev_b32 v208, 2, v254
v_mul_f32 v199, v197, v198
v_mfma_f32_16x16x32_bf16 v[44:47], a[112:115], a[24:27], v[44:47]
buffer_load_dwordx4 v234, s[4:7], s47 offen lds
v_mfma_f32_16x16x32_bf16 v[44:47], a[116:119], a[28:31], v[44:47]
s_waitcnt lgkmcnt(4)
v_mul_f32 v200, v198, v198
v_mul_f32 v200, v200, v198
v_mfma_f32_16x16x32_bf16 v[48:51], a[96:99], a[0:3], v[48:51]
ds_read_b64_tr_b16 a[112:113], v239 offset:160
v_mul_f32 v200, 0xbdd2d3e8, v200
v_mfma_f32_16x16x32_bf16 v[48:51], a[100:103], a[4:7], v[48:51]
ds_read_b64_tr_b16 a[114:115], v239 offset:5280
v_mul_f32 v201, 0xc0135761, v198
v_mfma_f32_16x16x32_bf16 v[52:55], a[96:99], a[8:11], v[52:55]
ds_read_b64_tr_b16 a[116:117], v239 offset:10400
v_add_u32 v209, 64, v208
v_mfma_f32_16x16x32_bf16 v[52:55], a[100:103], a[12:15], v[52:55]
ds_read_b64_tr_b16 a[118:119], v239 offset:15520
v_add_u32 v210, 128, v208
v_mfma_f32_16x16x32_bf16 v[56:59], a[96:99], a[16:19], v[56:59]
buffer_load_dwordx4 a[64:67], v235, s[16:19], s48 offen sc1
v_mfma_f32_16x16x32_bf16 v[56:59], a[100:103], a[20:23], v[56:59]
v_add_u32 v211, 192, v208
v_mfma_f32_16x16x32_bf16 v[60:63], a[96:99], a[24:27], v[60:63]
buffer_load_dwordx4 a[68:71], v235, s[16:19], s48 offen offset:1024 sc1
v_mfma_f32_16x16x32_bf16 v[60:63], a[100:103], a[28:31], v[60:63]
s_waitcnt lgkmcnt(4)
v_mfma_f32_16x16x32_bf16 v[64:67], a[104:107], a[0:3], v[64:67]
ds_read_b64_tr_b16 a[96:97], v239 offset:192
v_mfma_f32_16x16x32_bf16 v[64:67], a[108:111], a[4:7], v[64:67]
ds_read_b64_tr_b16 a[98:99], v239 offset:5312
v_mfma_f32_16x16x32_bf16 v[68:71], a[104:107], a[8:11], v[68:71]
ds_read_b64_tr_b16 a[100:101], v239 offset:10432
v_mfma_f32_16x16x32_bf16 v[68:71], a[108:111], a[12:15], v[68:71]
ds_read_b64_tr_b16 a[102:103], v239 offset:15552
v_mfma_f32_16x16x32_bf16 v[72:75], a[104:107], a[16:19], v[72:75]
v_mfma_f32_16x16x32_bf16 v[72:75], a[108:111], a[20:23], v[72:75]
v_mfma_f32_16x16x32_bf16 v[76:79], a[104:107], a[24:27], v[76:79]
buffer_load_dwordx4 a[72:75], v236, s[16:19], s48 offen sc1
v_mfma_f32_16x16x32_bf16 v[76:79], a[108:111], a[28:31], v[76:79]
s_waitcnt lgkmcnt(4)
v_mfma_f32_16x16x32_bf16 v[80:83], a[112:115], a[0:3], v[80:83]
ds_read_b64_tr_b16 a[104:105], v239 offset:224
v_mfma_f32_16x16x32_bf16 v[80:83], a[116:119], a[4:7], v[80:83]
ds_read_b64_tr_b16 a[106:107], v239 offset:5344
v_mfma_f32_16x16x32_bf16 v[84:87], a[112:115], a[8:11], v[84:87]
ds_read_b64_tr_b16 a[108:109], v239 offset:10464
v_mfma_f32_16x16x32_bf16 v[84:87], a[116:119], a[12:15], v[84:87]
ds_read_b64_tr_b16 a[110:111], v239 offset:15584
v_mfma_f32_16x16x32_bf16 v[88:91], a[112:115], a[16:19], v[88:91]
buffer_load_dwordx4 a[76:79], v236, s[16:19], s48 offen offset:1024 sc1
v_mfma_f32_16x16x32_bf16 v[88:91], a[116:119], a[20:23], v[88:91]
v_mfma_f32_16x16x32_bf16 v[92:95], a[112:115], a[24:27], v[92:95]
buffer_load_dwordx4 a[80:83], v237, s[16:19], s48 offen sc1
v_mfma_f32_16x16x32_bf16 v[92:95], a[116:119], a[28:31], v[92:95]
s_waitcnt lgkmcnt(4)
v_mfma_f32_16x16x32_bf16 v[96:99], a[96:99], a[0:3], v[96:99]
ds_read_b64_tr_b16 a[112:113], v239 offset:256
v_mfma_f32_16x16x32_bf16 v[96:99], a[100:103], a[4:7], v[96:99]
ds_read_b64_tr_b16 a[114:115], v239 offset:5376
v_mfma_f32_16x16x32_bf16 v[100:103], a[96:99], a[8:11], v[100:103]
ds_read_b64_tr_b16 a[116:117], v239 offset:10496
v_mfma_f32_16x16x32_bf16 v[100:103], a[100:103], a[12:15], v[100:103]
ds_read_b64_tr_b16 a[118:119], v239 offset:15616
v_mfma_f32_16x16x32_bf16 v[104:107], a[96:99], a[16:19], v[104:107]
v_mfma_f32_16x16x32_bf16 v[104:107], a[100:103], a[20:23], v[104:107]
v_mfma_f32_16x16x32_bf16 v[108:111], a[96:99], a[24:27], v[108:111]
s_waitcnt vmcnt(10)
v_mfma_f32_16x16x32_bf16 v[108:111], a[100:103], a[28:31], v[108:111]
s_waitcnt lgkmcnt(4)
s_barrier
v_mfma_f32_16x16x32_bf16 v[112:115], a[104:107], a[0:3], v[112:115]
ds_read_b64_tr_b16 a[96:97], v239 offset:32768
v_mfma_f32_16x16x32_bf16 v[112:115], a[108:111], a[4:7], v[112:115]
ds_read_b64_tr_b16 a[98:99], v239 offset:37888
v_mfma_f32_16x16x32_bf16 v[116:119], a[104:107], a[8:11], v[116:119]
ds_read_b64_tr_b16 a[100:101], v239 offset:43008
v_mfma_f32_16x16x32_bf16 v[116:119], a[108:111], a[12:15], v[116:119]
ds_read_b64_tr_b16 a[102:103], v239 offset:48128
v_mfma_f32_16x16x32_bf16 v[120:123], a[104:107], a[16:19], v[120:123]
buffer_load_dwordx4 a[84:87], v237, s[16:19], s48 offen offset:1024 sc1
v_mfma_f32_16x16x32_bf16 v[120:123], a[108:111], a[20:23], v[120:123]
v_mfma_f32_16x16x32_bf16 v[124:127], a[104:107], a[24:27], v[124:127]
buffer_load_dwordx4 a[88:91], v238, s[16:19], s48 offen sc1
v_mfma_f32_16x16x32_bf16 v[124:127], a[108:111], a[28:31], v[124:127]
s_waitcnt lgkmcnt(4)
v_mfma_f32_16x16x32_bf16 v[128:131], a[112:115], a[0:3], v[128:131]
ds_read_b64_tr_b16 a[104:105], v239 offset:32800
v_mfma_f32_16x16x32_bf16 v[128:131], a[116:119], a[4:7], v[128:131]
ds_read_b64_tr_b16 a[106:107], v239 offset:37920
v_mfma_f32_16x16x32_bf16 v[132:135], a[112:115], a[8:11], v[132:135]
ds_read_b64_tr_b16 a[108:109], v239 offset:43040
v_mfma_f32_16x16x32_bf16 v[132:135], a[116:119], a[12:15], v[132:135]
ds_read_b64_tr_b16 a[110:111], v239 offset:48160
v_mfma_f32_16x16x32_bf16 v[136:139], a[112:115], a[16:19], v[136:139]
buffer_load_dwordx4 a[92:95], v238, s[16:19], s48 offen offset:1024 sc1
v_mfma_f32_16x16x32_bf16 v[136:139], a[116:119], a[20:23], v[136:139]
s_add_u32 s47, s47, 589824
s_add_u32 s48, s48, 2048
v_mfma_f32_16x16x32_bf16 v[140:143], a[112:115], a[24:27], v[140:143]
v_mfma_f32_16x16x32_bf16 v[140:143], a[116:119], a[28:31], v[140:143]
s_waitcnt lgkmcnt(4)
v_mfma_f32_16x16x32_bf16 v[0:3], a[96:99], a[32:35], v[0:3]
ds_read_b64_tr_b16 a[112:113], v239 offset:32832
v_mfma_f32_16x16x32_bf16 v[0:3], a[100:103], a[36:39], v[0:3]
ds_read_b64_tr_b16 a[114:115], v239 offset:37952
v_mfma_f32_16x16x32_bf16 v[4:7], a[96:99], a[40:43], v[4:7]
ds_read_b64_tr_b16 a[116:117], v239 offset:43072
v_mfma_f32_16x16x32_bf16 v[4:7], a[100:103], a[44:47], v[4:7]
s_add_u32 m0, s53, 0x18000
ds_read_b64_tr_b16 a[118:119], v239 offset:48192
v_mfma_f32_16x16x32_bf16 v[8:11], a[96:99], a[48:51], v[8:11]
buffer_load_dwordx4 v230, s[4:7], s47 offen lds
v_mfma_f32_16x16x32_bf16 v[8:11], a[100:103], a[52:55], v[8:11]
ds_bpermute_b32 v144, v208, v196
v_mfma_f32_16x16x32_bf16 v[12:15], a[96:99], a[56:59], v[12:15]
buffer_load_dwordx4 v231, s[4:7], s47 offen offset:1024 lds
v_mfma_f32_16x16x32_bf16 v[12:15], a[100:103], a[60:63], v[12:15]
s_waitcnt lgkmcnt(5)
ds_bpermute_b32 v145, v208, v201
v_mfma_f32_16x16x32_bf16 v[16:19], a[104:107], a[32:35], v[16:19]
ds_read_b64_tr_b16 a[96:97], v239 offset:32864
v_mfma_f32_16x16x32_bf16 v[16:19], a[108:111], a[36:39], v[16:19]
ds_read_b64_tr_b16 a[98:99], v239 offset:37984
v_mfma_f32_16x16x32_bf16 v[20:23], a[104:107], a[40:43], v[20:23]
ds_read_b64_tr_b16 a[100:101], v239 offset:43104
v_mfma_f32_16x16x32_bf16 v[20:23], a[108:111], a[44:47], v[20:23]
ds_read_b64_tr_b16 a[102:103], v239 offset:48224
v_mfma_f32_16x16x32_bf16 v[24:27], a[104:107], a[48:51], v[24:27]
buffer_load_dwordx4 v232, s[4:7], s47 offen offset:2048 lds
v_mfma_f32_16x16x32_bf16 v[24:27], a[108:111], a[52:55], v[24:27]
ds_bpermute_b32 v146, v208, v200
v_mfma_f32_16x16x32_bf16 v[28:31], a[104:107], a[56:59], v[28:31]
buffer_load_dwordx4 v233, s[4:7], s47 offen offset:3072 lds
v_mfma_f32_16x16x32_bf16 v[28:31], a[108:111], a[60:63], v[28:31]
s_waitcnt lgkmcnt(7)
ds_bpermute_b32 v147, v208, v199
v_mfma_f32_16x16x32_bf16 v[32:35], a[112:115], a[32:35], v[32:35]
ds_read_b64_tr_b16 a[104:105], v239 offset:32896
v_mfma_f32_16x16x32_bf16 v[32:35], a[116:119], a[36:39], v[32:35]
ds_read_b64_tr_b16 a[106:107], v239 offset:38016
v_mfma_f32_16x16x32_bf16 v[36:39], a[112:115], a[40:43], v[36:39]
ds_read_b64_tr_b16 a[108:109], v239 offset:43136
v_mfma_f32_16x16x32_bf16 v[36:39], a[116:119], a[44:47], v[36:39]
ds_read_b64_tr_b16 a[110:111], v239 offset:48256
v_mfma_f32_16x16x32_bf16 v[40:43], a[112:115], a[48:51], v[40:43]
v_mfma_f32_16x16x32_bf16 v[40:43], a[116:119], a[52:55], v[40:43]
s_add_u32 m0, s53, 0x19000
ds_bpermute_b32 v148, v209, v196
v_mfma_f32_16x16x32_bf16 v[44:47], a[112:115], a[56:59], v[44:47]
buffer_load_dwordx4 v234, s[4:7], s47 offen lds
v_mfma_f32_16x16x32_bf16 v[44:47], a[116:119], a[60:63], v[44:47]
s_waitcnt lgkmcnt(7)
ds_bpermute_b32 v149, v209, v201
v_mfma_f32_16x16x32_bf16 v[48:51], a[96:99], a[32:35], v[48:51]
ds_read_b64_tr_b16 a[112:113], v239 offset:32928
v_mfma_f32_16x16x32_bf16 v[48:51], a[100:103], a[36:39], v[48:51]
ds_read_b64_tr_b16 a[114:115], v239 offset:38048
v_mfma_f32_16x16x32_bf16 v[52:55], a[96:99], a[40:43], v[52:55]
ds_read_b64_tr_b16 a[116:117], v239 offset:43168
v_mfma_f32_16x16x32_bf16 v[52:55], a[100:103], a[44:47], v[52:55]
ds_read_b64_tr_b16 a[118:119], v239 offset:48288
v_mfma_f32_16x16x32_bf16 v[56:59], a[96:99], a[48:51], v[56:59]
buffer_load_dwordx4 a[0:3], v235, s[16:19], s48 offen sc1
v_mfma_f32_16x16x32_bf16 v[56:59], a[100:103], a[52:55], v[56:59]
ds_bpermute_b32 v150, v209, v200
v_mfma_f32_16x16x32_bf16 v[60:63], a[96:99], a[56:59], v[60:63]
buffer_load_dwordx4 a[4:7], v235, s[16:19], s48 offen offset:1024 sc1
v_mfma_f32_16x16x32_bf16 v[60:63], a[100:103], a[60:63], v[60:63]
s_waitcnt lgkmcnt(7)
ds_bpermute_b32 v151, v209, v199
v_mfma_f32_16x16x32_bf16 v[64:67], a[104:107], a[32:35], v[64:67]
ds_read_b64_tr_b16 a[96:97], v239 offset:32960
v_mfma_f32_16x16x32_bf16 v[64:67], a[108:111], a[36:39], v[64:67]
ds_read_b64_tr_b16 a[98:99], v239 offset:38080
v_mfma_f32_16x16x32_bf16 v[68:71], a[104:107], a[40:43], v[68:71]
ds_read_b64_tr_b16 a[100:101], v239 offset:43200
v_mfma_f32_16x16x32_bf16 v[68:71], a[108:111], a[44:47], v[68:71]
ds_read_b64_tr_b16 a[102:103], v239 offset:48320
v_mfma_f32_16x16x32_bf16 v[72:75], a[104:107], a[48:51], v[72:75]
v_mfma_f32_16x16x32_bf16 v[72:75], a[108:111], a[52:55], v[72:75]
ds_bpermute_b32 v152, v210, v196
v_mfma_f32_16x16x32_bf16 v[76:79], a[104:107], a[56:59], v[76:79]
buffer_load_dwordx4 a[8:11], v236, s[16:19], s48 offen sc1
v_mfma_f32_16x16x32_bf16 v[76:79], a[108:111], a[60:63], v[76:79]
s_waitcnt lgkmcnt(7)
ds_bpermute_b32 v153, v210, v201
v_mfma_f32_16x16x32_bf16 v[80:83], a[112:115], a[32:35], v[80:83]
ds_read_b64_tr_b16 a[104:105], v239 offset:32992
v_mfma_f32_16x16x32_bf16 v[80:83], a[116:119], a[36:39], v[80:83]
ds_read_b64_tr_b16 a[106:107], v239 offset:38112
v_mfma_f32_16x16x32_bf16 v[84:87], a[112:115], a[40:43], v[84:87]
ds_read_b64_tr_b16 a[108:109], v239 offset:43232
v_mfma_f32_16x16x32_bf16 v[84:87], a[116:119], a[44:47], v[84:87]
ds_read_b64_tr_b16 a[110:111], v239 offset:48352
v_mfma_f32_16x16x32_bf16 v[88:91], a[112:115], a[48:51], v[88:91]
buffer_load_dwordx4 a[12:15], v236, s[16:19], s48 offen offset:1024 sc1
v_mfma_f32_16x16x32_bf16 v[88:91], a[116:119], a[52:55], v[88:91]
ds_bpermute_b32 v154, v210, v200
v_mfma_f32_16x16x32_bf16 v[92:95], a[112:115], a[56:59], v[92:95]
buffer_load_dwordx4 a[16:19], v237, s[16:19], s48 offen sc1
v_mfma_f32_16x16x32_bf16 v[92:95], a[116:119], a[60:63], v[92:95]
s_waitcnt lgkmcnt(7)
ds_bpermute_b32 v155, v210, v199
v_mfma_f32_16x16x32_bf16 v[96:99], a[96:99], a[32:35], v[96:99]
ds_read_b64_tr_b16 a[112:113], v239 offset:33024
v_mfma_f32_16x16x32_bf16 v[96:99], a[100:103], a[36:39], v[96:99]
ds_read_b64_tr_b16 a[114:115], v239 offset:38144
v_mfma_f32_16x16x32_bf16 v[100:103], a[96:99], a[40:43], v[100:103]
ds_read_b64_tr_b16 a[116:117], v239 offset:43264
v_mfma_f32_16x16x32_bf16 v[100:103], a[100:103], a[44:47], v[100:103]
ds_read_b64_tr_b16 a[118:119], v239 offset:48384
v_mfma_f32_16x16x32_bf16 v[104:107], a[96:99], a[48:51], v[104:107]
v_mfma_f32_16x16x32_bf16 v[104:107], a[100:103], a[52:55], v[104:107]
ds_bpermute_b32 v156, v211, v196
v_mfma_f32_16x16x32_bf16 v[108:111], a[96:99], a[56:59], v[108:111]
s_waitcnt vmcnt(10)
v_mfma_f32_16x16x32_bf16 v[108:111], a[100:103], a[60:63], v[108:111]
s_waitcnt lgkmcnt(7)
s_barrier
ds_bpermute_b32 v157, v211, v201
v_mfma_f32_16x16x32_bf16 v[112:115], a[104:107], a[32:35], v[112:115]
ds_read_b64_tr_b16 a[96:97], v240
v_mfma_f32_16x16x32_bf16 v[112:115], a[108:111], a[36:39], v[112:115]
ds_read_b64_tr_b16 a[98:99], v240 offset:5120
v_mfma_f32_16x16x32_bf16 v[116:119], a[104:107], a[40:43], v[116:119]
ds_read_b64_tr_b16 a[100:101], v240 offset:10240
v_mfma_f32_16x16x32_bf16 v[116:119], a[108:111], a[44:47], v[116:119]
ds_read_b64_tr_b16 a[102:103], v240 offset:15360
v_mfma_f32_16x16x32_bf16 v[120:123], a[104:107], a[48:51], v[120:123]
buffer_load_dwordx4 a[20:23], v237, s[16:19], s48 offen offset:1024 sc1
v_mfma_f32_16x16x32_bf16 v[120:123], a[108:111], a[52:55], v[120:123]
ds_bpermute_b32 v158, v211, v200
v_mfma_f32_16x16x32_bf16 v[124:127], a[104:107], a[56:59], v[124:127]
buffer_load_dwordx4 a[24:27], v238, s[16:19], s48 offen sc1
v_mfma_f32_16x16x32_bf16 v[124:127], a[108:111], a[60:63], v[124:127]
s_waitcnt lgkmcnt(7)
ds_bpermute_b32 v159, v211, v199
v_mfma_f32_16x16x32_bf16 v[128:131], a[112:115], a[32:35], v[128:131]
ds_read_b64_tr_b16 a[104:105], v240 offset:32
v_mfma_f32_16x16x32_bf16 v[128:131], a[116:119], a[36:39], v[128:131]
ds_read_b64_tr_b16 a[106:107], v240 offset:5152
v_mfma_f32_16x16x32_bf16 v[132:135], a[112:115], a[40:43], v[132:135]
ds_read_b64_tr_b16 a[108:109], v240 offset:10272
v_mfma_f32_16x16x32_bf16 v[132:135], a[116:119], a[44:47], v[132:135]
ds_read_b64_tr_b16 a[110:111], v240 offset:15392
v_mfma_f32_16x16x32_bf16 v[136:139], a[112:115], a[48:51], v[136:139]
buffer_load_dwordx4 a[28:31], v238, s[16:19], s48 offen offset:1024 sc1
v_mfma_f32_16x16x32_bf16 v[136:139], a[116:119], a[52:55], v[136:139]
s_add_u32 s47, s47, 589824
s_add_u32 s48, s48, 2048
v_mfma_f32_16x16x32_bf16 v[140:143], a[112:115], a[56:59], v[140:143]
v_mfma_f32_16x16x32_bf16 v[140:143], a[116:119], a[60:63], v[140:143]
s_waitcnt lgkmcnt(6)
v_mfma_f32_16x16x32_bf16 v[0:3], a[96:99], a[64:67], v[0:3]
ds_read_b64_tr_b16 a[112:113], v240 offset:64
v_mfma_f32_16x16x32_bf16 v[0:3], a[100:103], a[68:71], v[0:3]
ds_read_b64_tr_b16 a[114:115], v240 offset:5184
v_mfma_f32_16x16x32_bf16 v[4:7], a[96:99], a[72:75], v[4:7]
ds_read_b64_tr_b16 a[116:117], v240 offset:10304
v_mfma_f32_16x16x32_bf16 v[4:7], a[100:103], a[76:79], v[4:7]
s_add_u32 m0, s53, 0x0
ds_read_b64_tr_b16 a[118:119], v240 offset:15424
v_mfma_f32_16x16x32_bf16 v[8:11], a[96:99], a[80:83], v[8:11]
buffer_load_dwordx4 v230, s[4:7], s47 offen lds
v_mfma_f32_16x16x32_bf16 v[8:11], a[100:103], a[84:87], v[8:11]
v_mfma_f32_16x16x32_bf16 v[12:15], a[96:99], a[88:91], v[12:15]
buffer_load_dwordx4 v231, s[4:7], s47 offen offset:1024 lds
v_mfma_f32_16x16x32_bf16 v[12:15], a[100:103], a[92:95], v[12:15]
s_waitcnt lgkmcnt(4)
v_mfma_f32_16x16x32_bf16 v[16:19], a[104:107], a[64:67], v[16:19]
ds_read_b64_tr_b16 a[96:97], v240 offset:96
v_mfma_f32_16x16x32_bf16 v[16:19], a[108:111], a[68:71], v[16:19]
ds_read_b64_tr_b16 a[98:99], v240 offset:5216
v_mfma_f32_16x16x32_bf16 v[20:23], a[104:107], a[72:75], v[20:23]
ds_read_b64_tr_b16 a[100:101], v240 offset:10336
v_mfma_f32_16x16x32_bf16 v[20:23], a[108:111], a[76:79], v[20:23]
ds_read_b64_tr_b16 a[102:103], v240 offset:15456
v_mfma_f32_16x16x32_bf16 v[24:27], a[104:107], a[80:83], v[24:27]
buffer_load_dwordx4 v232, s[4:7], s47 offen offset:2048 lds
v_mfma_f32_16x16x32_bf16 v[24:27], a[108:111], a[84:87], v[24:27]
v_mfma_f32_16x16x32_bf16 v[28:31], a[104:107], a[88:91], v[28:31]
buffer_load_dwordx4 v233, s[4:7], s47 offen offset:3072 lds
v_mfma_f32_16x16x32_bf16 v[28:31], a[108:111], a[92:95], v[28:31]
s_waitcnt lgkmcnt(4)
v_mfma_f32_16x16x32_bf16 v[32:35], a[112:115], a[64:67], v[32:35]
ds_read_b64_tr_b16 a[104:105], v240 offset:128
v_mfma_f32_16x16x32_bf16 v[32:35], a[116:119], a[68:71], v[32:35]
ds_read_b64_tr_b16 a[106:107], v240 offset:5248
v_mfma_f32_16x16x32_bf16 v[36:39], a[112:115], a[72:75], v[36:39]
ds_read_b64_tr_b16 a[108:109], v240 offset:10368
v_mfma_f32_16x16x32_bf16 v[36:39], a[116:119], a[76:79], v[36:39]
ds_read_b64_tr_b16 a[110:111], v240 offset:15488
v_mfma_f32_16x16x32_bf16 v[40:43], a[112:115], a[80:83], v[40:43]
v_mfma_f32_16x16x32_bf16 v[40:43], a[116:119], a[84:87], v[40:43]
s_add_u32 m0, s53, 0x1000
v_mfma_f32_16x16x32_bf16 v[44:47], a[112:115], a[88:91], v[44:47]
buffer_load_dwordx4 v234, s[4:7], s47 offen lds
v_mfma_f32_16x16x32_bf16 v[44:47], a[116:119], a[92:95], v[44:47]
s_waitcnt lgkmcnt(4)
v_mfma_f32_16x16x32_bf16 v[48:51], a[96:99], a[64:67], v[48:51]
ds_read_b64_tr_b16 a[112:113], v240 offset:160
v_mfma_f32_16x16x32_bf16 v[48:51], a[100:103], a[68:71], v[48:51]
ds_read_b64_tr_b16 a[114:115], v240 offset:5280
v_mfma_f32_16x16x32_bf16 v[52:55], a[96:99], a[72:75], v[52:55]
ds_read_b64_tr_b16 a[116:117], v240 offset:10400
v_mfma_f32_16x16x32_bf16 v[52:55], a[100:103], a[76:79], v[52:55]
ds_read_b64_tr_b16 a[118:119], v240 offset:15520
v_mfma_f32_16x16x32_bf16 v[56:59], a[96:99], a[80:83], v[56:59]
buffer_load_dwordx4 a[32:35], v235, s[16:19], s48 offen sc1
v_mfma_f32_16x16x32_bf16 v[56:59], a[100:103], a[84:87], v[56:59]
v_mfma_f32_16x16x32_bf16 v[60:63], a[96:99], a[88:91], v[60:63]
buffer_load_dwordx4 a[36:39], v235, s[16:19], s48 offen offset:1024 sc1
v_mfma_f32_16x16x32_bf16 v[60:63], a[100:103], a[92:95], v[60:63]
s_waitcnt lgkmcnt(4)
v_mfma_f32_16x16x32_bf16 v[64:67], a[104:107], a[64:67], v[64:67]
ds_read_b64_tr_b16 a[96:97], v240 offset:192
v_mfma_f32_16x16x32_bf16 v[64:67], a[108:111], a[68:71], v[64:67]
ds_read_b64_tr_b16 a[98:99], v240 offset:5312
v_mfma_f32_16x16x32_bf16 v[68:71], a[104:107], a[72:75], v[68:71]
ds_read_b64_tr_b16 a[100:101], v240 offset:10432
v_mfma_f32_16x16x32_bf16 v[68:71], a[108:111], a[76:79], v[68:71]
ds_read_b64_tr_b16 a[102:103], v240 offset:15552
v_mfma_f32_16x16x32_bf16 v[72:75], a[104:107], a[80:83], v[72:75]
v_mfma_f32_16x16x32_bf16 v[72:75], a[108:111], a[84:87], v[72:75]
v_mfma_f32_16x16x32_bf16 v[76:79], a[104:107], a[88:91], v[76:79]
buffer_load_dwordx4 a[40:43], v236, s[16:19], s48 offen sc1
v_mfma_f32_16x16x32_bf16 v[76:79], a[108:111], a[92:95], v[76:79]
s_waitcnt lgkmcnt(4)
v_mfma_f32_16x16x32_bf16 v[80:83], a[112:115], a[64:67], v[80:83]
ds_read_b64_tr_b16 a[104:105], v240 offset:224
v_mfma_f32_16x16x32_bf16 v[80:83], a[116:119], a[68:71], v[80:83]
ds_read_b64_tr_b16 a[106:107], v240 offset:5344
v_mfma_f32_16x16x32_bf16 v[84:87], a[112:115], a[72:75], v[84:87]
ds_read_b64_tr_b16 a[108:109], v240 offset:10464
v_mfma_f32_16x16x32_bf16 v[84:87], a[116:119], a[76:79], v[84:87]
ds_read_b64_tr_b16 a[110:111], v240 offset:15584
v_mfma_f32_16x16x32_bf16 v[88:91], a[112:115], a[80:83], v[88:91]
buffer_load_dwordx4 a[44:47], v236, s[16:19], s48 offen offset:1024 sc1
v_mfma_f32_16x16x32_bf16 v[88:91], a[116:119], a[84:87], v[88:91]
v_mfma_f32_16x16x32_bf16 v[92:95], a[112:115], a[88:91], v[92:95]
buffer_load_dwordx4 a[48:51], v237, s[16:19], s48 offen sc1
v_mfma_f32_16x16x32_bf16 v[92:95], a[116:119], a[92:95], v[92:95]
s_waitcnt lgkmcnt(4)
v_mfma_f32_16x16x32_bf16 v[96:99], a[96:99], a[64:67], v[96:99]
ds_read_b64_tr_b16 a[112:113], v240 offset:256
v_mfma_f32_16x16x32_bf16 v[96:99], a[100:103], a[68:71], v[96:99]
ds_read_b64_tr_b16 a[114:115], v240 offset:5376
v_mfma_f32_16x16x32_bf16 v[100:103], a[96:99], a[72:75], v[100:103]
ds_read_b64_tr_b16 a[116:117], v240 offset:10496
v_mfma_f32_16x16x32_bf16 v[100:103], a[100:103], a[76:79], v[100:103]
ds_read_b64_tr_b16 a[118:119], v240 offset:15616
v_mfma_f32_16x16x32_bf16 v[104:107], a[96:99], a[80:83], v[104:107]
v_mfma_f32_16x16x32_bf16 v[104:107], a[100:103], a[84:87], v[104:107]
v_mfma_f32_16x16x32_bf16 v[108:111], a[96:99], a[88:91], v[108:111]
s_waitcnt vmcnt(10)
v_mfma_f32_16x16x32_bf16 v[108:111], a[100:103], a[92:95], v[108:111]
s_waitcnt lgkmcnt(4)
s_barrier
v_mfma_f32_16x16x32_bf16 v[112:115], a[104:107], a[64:67], v[112:115]
ds_read_b64_tr_b16 a[96:97], v240 offset:32768
v_mfma_f32_16x16x32_bf16 v[112:115], a[108:111], a[68:71], v[112:115]
ds_read_b64_tr_b16 a[98:99], v240 offset:37888
v_mfma_f32_16x16x32_bf16 v[116:119], a[104:107], a[72:75], v[116:119]
ds_read_b64_tr_b16 a[100:101], v240 offset:43008
v_mfma_f32_16x16x32_bf16 v[116:119], a[108:111], a[76:79], v[116:119]
ds_read_b64_tr_b16 a[102:103], v240 offset:48128
v_mfma_f32_16x16x32_bf16 v[120:123], a[104:107], a[80:83], v[120:123]
buffer_load_dwordx4 a[52:55], v237, s[16:19], s48 offen offset:1024 sc1
v_mfma_f32_16x16x32_bf16 v[120:123], a[108:111], a[84:87], v[120:123]
v_mfma_f32_16x16x32_bf16 v[124:127], a[104:107], a[88:91], v[124:127]
buffer_load_dwordx4 a[56:59], v238, s[16:19], s48 offen sc1
v_mfma_f32_16x16x32_bf16 v[124:127], a[108:111], a[92:95], v[124:127]
s_waitcnt lgkmcnt(4)
v_mfma_f32_16x16x32_bf16 v[128:131], a[112:115], a[64:67], v[128:131]
ds_read_b64_tr_b16 a[104:105], v240 offset:32800
v_mfma_f32_16x16x32_bf16 v[128:131], a[116:119], a[68:71], v[128:131]
ds_read_b64_tr_b16 a[106:107], v240 offset:37920
v_mfma_f32_16x16x32_bf16 v[132:135], a[112:115], a[72:75], v[132:135]
ds_read_b64_tr_b16 a[108:109], v240 offset:43040
v_mfma_f32_16x16x32_bf16 v[132:135], a[116:119], a[76:79], v[132:135]
ds_read_b64_tr_b16 a[110:111], v240 offset:48160
v_mfma_f32_16x16x32_bf16 v[136:139], a[112:115], a[80:83], v[136:139]
buffer_load_dwordx4 a[60:63], v238, s[16:19], s48 offen offset:1024 sc1
v_mfma_f32_16x16x32_bf16 v[136:139], a[116:119], a[84:87], v[136:139]
s_add_u32 s47, s47, 589824
s_add_u32 s48, s48, 2048
v_mfma_f32_16x16x32_bf16 v[140:143], a[112:115], a[88:91], v[140:143]
v_mfma_f32_16x16x32_bf16 v[140:143], a[116:119], a[92:95], v[140:143]
s_waitcnt lgkmcnt(4)
v_mfma_f32_16x16x32_bf16 v[0:3], a[96:99], a[0:3], v[0:3]
ds_read_b64_tr_b16 a[112:113], v240 offset:32832
v_mfma_f32_16x16x32_bf16 v[0:3], a[100:103], a[4:7], v[0:3]
ds_read_b64_tr_b16 a[114:115], v240 offset:37952
v_mfma_f32_16x16x32_bf16 v[4:7], a[96:99], a[8:11], v[4:7]
ds_read_b64_tr_b16 a[116:117], v240 offset:43072
v_mfma_f32_16x16x32_bf16 v[4:7], a[100:103], a[12:15], v[4:7]
s_add_u32 m0, s53, 0x8000
ds_read_b64_tr_b16 a[118:119], v240 offset:48192
v_mfma_f32_16x16x32_bf16 v[8:11], a[96:99], a[16:19], v[8:11]
buffer_load_dwordx4 v230, s[4:7], s47 offen lds
v_mfma_f32_16x16x32_bf16 v[8:11], a[100:103], a[20:23], v[8:11]
v_mfma_f32_16x16x32_bf16 v[12:15], a[96:99], a[24:27], v[12:15]
buffer_load_dwordx4 v231, s[4:7], s47 offen offset:1024 lds
v_mfma_f32_16x16x32_bf16 v[12:15], a[100:103], a[28:31], v[12:15]
s_waitcnt lgkmcnt(4)
v_mfma_f32_16x16x32_bf16 v[16:19], a[104:107], a[0:3], v[16:19]
ds_read_b64_tr_b16 a[96:97], v240 offset:32864
v_mfma_f32_16x16x32_bf16 v[16:19], a[108:111], a[4:7], v[16:19]
ds_read_b64_tr_b16 a[98:99], v240 offset:37984
v_mfma_f32_16x16x32_bf16 v[20:23], a[104:107], a[8:11], v[20:23]
ds_read_b64_tr_b16 a[100:101], v240 offset:43104
v_mfma_f32_16x16x32_bf16 v[20:23], a[108:111], a[12:15], v[20:23]
ds_read_b64_tr_b16 a[102:103], v240 offset:48224
v_mfma_f32_16x16x32_bf16 v[24:27], a[104:107], a[16:19], v[24:27]
buffer_load_dwordx4 v232, s[4:7], s47 offen offset:2048 lds
v_mfma_f32_16x16x32_bf16 v[24:27], a[108:111], a[20:23], v[24:27]
v_mfma_f32_16x16x32_bf16 v[28:31], a[104:107], a[24:27], v[28:31]
buffer_load_dwordx4 v233, s[4:7], s47 offen offset:3072 lds
v_mfma_f32_16x16x32_bf16 v[28:31], a[108:111], a[28:31], v[28:31]
s_waitcnt lgkmcnt(4)
v_mfma_f32_16x16x32_bf16 v[32:35], a[112:115], a[0:3], v[32:35]
ds_read_b64_tr_b16 a[104:105], v240 offset:32896
v_mfma_f32_16x16x32_bf16 v[32:35], a[116:119], a[4:7], v[32:35]
ds_read_b64_tr_b16 a[106:107], v240 offset:38016
v_mfma_f32_16x16x32_bf16 v[36:39], a[112:115], a[8:11], v[36:39]
ds_read_b64_tr_b16 a[108:109], v240 offset:43136
v_mfma_f32_16x16x32_bf16 v[36:39], a[116:119], a[12:15], v[36:39]
ds_read_b64_tr_b16 a[110:111], v240 offset:48256
v_mfma_f32_16x16x32_bf16 v[40:43], a[112:115], a[16:19], v[40:43]
v_mfma_f32_16x16x32_bf16 v[40:43], a[116:119], a[20:23], v[40:43]
s_add_u32 m0, s53, 0x9000
v_mfma_f32_16x16x32_bf16 v[44:47], a[112:115], a[24:27], v[44:47]
buffer_load_dwordx4 v234, s[4:7], s47 offen lds
v_mfma_f32_16x16x32_bf16 v[44:47], a[116:119], a[28:31], v[44:47]
s_waitcnt lgkmcnt(4)
v_mfma_f32_16x16x32_bf16 v[48:51], a[96:99], a[0:3], v[48:51]
ds_read_b64_tr_b16 a[112:113], v240 offset:32928
v_mfma_f32_16x16x32_bf16 v[48:51], a[100:103], a[4:7], v[48:51]
ds_read_b64_tr_b16 a[114:115], v240 offset:38048
v_mfma_f32_16x16x32_bf16 v[52:55], a[96:99], a[8:11], v[52:55]
ds_read_b64_tr_b16 a[116:117], v240 offset:43168
v_mfma_f32_16x16x32_bf16 v[52:55], a[100:103], a[12:15], v[52:55]
ds_read_b64_tr_b16 a[118:119], v240 offset:48288
v_mfma_f32_16x16x32_bf16 v[56:59], a[96:99], a[16:19], v[56:59]
buffer_load_dwordx4 a[64:67], v235, s[16:19], s48 offen sc1
v_mfma_f32_16x16x32_bf16 v[56:59], a[100:103], a[20:23], v[56:59]
v_mfma_f32_16x16x32_bf16 v[60:63], a[96:99], a[24:27], v[60:63]
buffer_load_dwordx4 a[68:71], v235, s[16:19], s48 offen offset:1024 sc1
v_mfma_f32_16x16x32_bf16 v[60:63], a[100:103], a[28:31], v[60:63]
s_waitcnt lgkmcnt(4)
v_mfma_f32_16x16x32_bf16 v[64:67], a[104:107], a[0:3], v[64:67]
ds_read_b64_tr_b16 a[96:97], v240 offset:32960
v_mfma_f32_16x16x32_bf16 v[64:67], a[108:111], a[4:7], v[64:67]
ds_read_b64_tr_b16 a[98:99], v240 offset:38080
v_mfma_f32_16x16x32_bf16 v[68:71], a[104:107], a[8:11], v[68:71]
ds_read_b64_tr_b16 a[100:101], v240 offset:43200
v_mfma_f32_16x16x32_bf16 v[68:71], a[108:111], a[12:15], v[68:71]
ds_read_b64_tr_b16 a[102:103], v240 offset:48320
v_mfma_f32_16x16x32_bf16 v[72:75], a[104:107], a[16:19], v[72:75]
v_mfma_f32_16x16x32_bf16 v[72:75], a[108:111], a[20:23], v[72:75]
v_mfma_f32_16x16x32_bf16 v[76:79], a[104:107], a[24:27], v[76:79]
buffer_load_dwordx4 a[72:75], v236, s[16:19], s48 offen sc1
v_mfma_f32_16x16x32_bf16 v[76:79], a[108:111], a[28:31], v[76:79]
s_waitcnt lgkmcnt(4)
v_mfma_f32_16x16x32_bf16 v[80:83], a[112:115], a[0:3], v[80:83]
ds_read_b64_tr_b16 a[104:105], v240 offset:32992
v_mfma_f32_16x16x32_bf16 v[80:83], a[116:119], a[4:7], v[80:83]
ds_read_b64_tr_b16 a[106:107], v240 offset:38112
v_mfma_f32_16x16x32_bf16 v[84:87], a[112:115], a[8:11], v[84:87]
ds_read_b64_tr_b16 a[108:109], v240 offset:43232
v_mfma_f32_16x16x32_bf16 v[84:87], a[116:119], a[12:15], v[84:87]
ds_read_b64_tr_b16 a[110:111], v240 offset:48352
v_mfma_f32_16x16x32_bf16 v[88:91], a[112:115], a[16:19], v[88:91]
buffer_load_dwordx4 a[76:79], v236, s[16:19], s48 offen offset:1024 sc1
v_mfma_f32_16x16x32_bf16 v[88:91], a[116:119], a[20:23], v[88:91]
v_mfma_f32_16x16x32_bf16 v[92:95], a[112:115], a[24:27], v[92:95]
buffer_load_dwordx4 a[80:83], v237, s[16:19], s48 offen sc1
v_mfma_f32_16x16x32_bf16 v[92:95], a[116:119], a[28:31], v[92:95]
s_waitcnt lgkmcnt(4)
v_mfma_f32_16x16x32_bf16 v[96:99], a[96:99], a[0:3], v[96:99]
ds_read_b64_tr_b16 a[112:113], v240 offset:33024
v_mfma_f32_16x16x32_bf16 v[96:99], a[100:103], a[4:7], v[96:99]
ds_read_b64_tr_b16 a[114:115], v240 offset:38144
v_mfma_f32_16x16x32_bf16 v[100:103], a[96:99], a[8:11], v[100:103]
ds_read_b64_tr_b16 a[116:117], v240 offset:43264
v_mfma_f32_16x16x32_bf16 v[100:103], a[100:103], a[12:15], v[100:103]
ds_read_b64_tr_b16 a[118:119], v240 offset:48384
v_mfma_f32_16x16x32_bf16 v[104:107], a[96:99], a[16:19], v[104:107]
v_mfma_f32_16x16x32_bf16 v[104:107], a[100:103], a[20:23], v[104:107]
v_mfma_f32_16x16x32_bf16 v[108:111], a[96:99], a[24:27], v[108:111]
s_waitcnt vmcnt(10)
v_mfma_f32_16x16x32_bf16 v[108:111], a[100:103], a[28:31], v[108:111]
s_waitcnt lgkmcnt(4)
s_barrier
v_mfma_f32_16x16x32_bf16 v[112:115], a[104:107], a[0:3], v[112:115]
ds_read_b64_tr_b16 a[96:97], v239
v_mfma_f32_16x16x32_bf16 v[112:115], a[108:111], a[4:7], v[112:115]
ds_read_b64_tr_b16 a[98:99], v239 offset:5120
v_mfma_f32_16x16x32_bf16 v[116:119], a[104:107], a[8:11], v[116:119]
ds_read_b64_tr_b16 a[100:101], v239 offset:10240
v_mfma_f32_16x16x32_bf16 v[116:119], a[108:111], a[12:15], v[116:119]
ds_read_b64_tr_b16 a[102:103], v239 offset:15360
v_mfma_f32_16x16x32_bf16 v[120:123], a[104:107], a[16:19], v[120:123]
buffer_load_dwordx4 a[84:87], v237, s[16:19], s48 offen offset:1024 sc1
v_mfma_f32_16x16x32_bf16 v[120:123], a[108:111], a[20:23], v[120:123]
v_mfma_f32_16x16x32_bf16 v[124:127], a[104:107], a[24:27], v[124:127]
buffer_load_dwordx4 a[88:91], v238, s[16:19], s48 offen sc1
v_mfma_f32_16x16x32_bf16 v[124:127], a[108:111], a[28:31], v[124:127]
s_waitcnt lgkmcnt(4)
v_mfma_f32_16x16x32_bf16 v[128:131], a[112:115], a[0:3], v[128:131]
ds_read_b64_tr_b16 a[104:105], v239 offset:32
v_mfma_f32_16x16x32_bf16 v[128:131], a[116:119], a[4:7], v[128:131]
ds_read_b64_tr_b16 a[106:107], v239 offset:5152
v_mfma_f32_16x16x32_bf16 v[132:135], a[112:115], a[8:11], v[132:135]
ds_read_b64_tr_b16 a[108:109], v239 offset:10272
v_mfma_f32_16x16x32_bf16 v[132:135], a[116:119], a[12:15], v[132:135]
ds_read_b64_tr_b16 a[110:111], v239 offset:15392
v_mfma_f32_16x16x32_bf16 v[136:139], a[112:115], a[16:19], v[136:139]
buffer_load_dwordx4 a[92:95], v238, s[16:19], s48 offen offset:1024 sc1
v_mfma_f32_16x16x32_bf16 v[136:139], a[116:119], a[20:23], v[136:139]
s_add_u32 s47, s47, 589824
s_add_u32 s48, s48, 2048
v_mfma_f32_16x16x32_bf16 v[140:143], a[112:115], a[24:27], v[140:143]
v_mfma_f32_16x16x32_bf16 v[140:143], a[116:119], a[28:31], v[140:143]
s_waitcnt lgkmcnt(4)
v_mfma_f32_16x16x32_bf16 v[0:3], a[96:99], a[32:35], v[0:3]
ds_read_b64_tr_b16 a[112:113], v239 offset:64
v_mfma_f32_16x16x32_bf16 v[0:3], a[100:103], a[36:39], v[0:3]
ds_read_b64_tr_b16 a[114:115], v239 offset:5184
v_mfma_f32_16x16x32_bf16 v[4:7], a[96:99], a[40:43], v[4:7]
ds_read_b64_tr_b16 a[116:117], v239 offset:10304
v_mfma_f32_16x16x32_bf16 v[4:7], a[100:103], a[44:47], v[4:7]
s_add_u32 m0, s55, 0x10000
ds_read_b64_tr_b16 a[118:119], v239 offset:15424
v_mfma_f32_16x16x32_bf16 v[8:11], a[96:99], a[48:51], v[8:11]
buffer_load_dwordx4 v224, s[20:23], s51 offen lds
v_mfma_f32_16x16x32_bf16 v[8:11], a[100:103], a[52:55], v[8:11]
v_mfma_f32_16x16x32_bf16 v[12:15], a[96:99], a[56:59], v[12:15]
v_mfma_f32_16x16x32_bf16 v[12:15], a[100:103], a[60:63], v[12:15]
s_waitcnt lgkmcnt(4)
v_mfma_f32_16x16x32_bf16 v[16:19], a[104:107], a[32:35], v[16:19]
ds_read_b64_tr_b16 a[96:97], v239 offset:96
v_mfma_f32_16x16x32_bf16 v[16:19], a[108:111], a[36:39], v[16:19]
ds_read_b64_tr_b16 a[98:99], v239 offset:5216
v_mfma_f32_16x16x32_bf16 v[20:23], a[104:107], a[40:43], v[20:23]
ds_read_b64_tr_b16 a[100:101], v239 offset:10336
v_mfma_f32_16x16x32_bf16 v[20:23], a[108:111], a[44:47], v[20:23]
ds_read_b64_tr_b16 a[102:103], v239 offset:15456
v_mfma_f32_16x16x32_bf16 v[24:27], a[104:107], a[48:51], v[24:27]
buffer_load_dwordx4 v225, s[20:23], s51 offen offset:1024 lds
v_mfma_f32_16x16x32_bf16 v[24:27], a[108:111], a[52:55], v[24:27]
v_mfma_f32_16x16x32_bf16 v[28:31], a[104:107], a[56:59], v[28:31]
v_mfma_f32_16x16x32_bf16 v[28:31], a[108:111], a[60:63], v[28:31]
s_waitcnt lgkmcnt(4)
v_mfma_f32_16x16x32_bf16 v[32:35], a[112:115], a[32:35], v[32:35]
ds_read_b64_tr_b16 a[104:105], v239 offset:128
v_mfma_f32_16x16x32_bf16 v[32:35], a[116:119], a[36:39], v[32:35]
ds_read_b64_tr_b16 a[106:107], v239 offset:5248
v_mfma_f32_16x16x32_bf16 v[36:39], a[112:115], a[40:43], v[36:39]
ds_read_b64_tr_b16 a[108:109], v239 offset:10368
v_mfma_f32_16x16x32_bf16 v[36:39], a[116:119], a[44:47], v[36:39]
ds_read_b64_tr_b16 a[110:111], v239 offset:15488
v_mfma_f32_16x16x32_bf16 v[40:43], a[112:115], a[48:51], v[40:43]
buffer_load_dwordx4 v226, s[20:23], s51 offen offset:2048 lds
v_mfma_f32_16x16x32_bf16 v[40:43], a[116:119], a[52:55], v[40:43]
v_mfma_f32_16x16x32_bf16 v[44:47], a[112:115], a[56:59], v[44:47]
v_mfma_f32_16x16x32_bf16 v[44:47], a[116:119], a[60:63], v[44:47]
s_waitcnt lgkmcnt(4)
v_mfma_f32_16x16x32_bf16 v[48:51], a[96:99], a[32:35], v[48:51]
ds_read_b64_tr_b16 a[112:113], v239 offset:160
v_mfma_f32_16x16x32_bf16 v[48:51], a[100:103], a[36:39], v[48:51]
ds_read_b64_tr_b16 a[114:115], v239 offset:5280
v_mfma_f32_16x16x32_bf16 v[52:55], a[96:99], a[40:43], v[52:55]
ds_read_b64_tr_b16 a[116:117], v239 offset:10400
v_mfma_f32_16x16x32_bf16 v[52:55], a[100:103], a[44:47], v[52:55]
ds_read_b64_tr_b16 a[118:119], v239 offset:15520
v_mfma_f32_16x16x32_bf16 v[56:59], a[96:99], a[48:51], v[56:59]
buffer_load_dwordx4 v227, s[20:23], s51 offen offset:3072 lds
v_mfma_f32_16x16x32_bf16 v[56:59], a[100:103], a[52:55], v[56:59]
v_mfma_f32_16x16x32_bf16 v[60:63], a[96:99], a[56:59], v[60:63]
v_mfma_f32_16x16x32_bf16 v[60:63], a[100:103], a[60:63], v[60:63]
s_waitcnt lgkmcnt(4)
v_mfma_f32_16x16x32_bf16 v[64:67], a[104:107], a[32:35], v[64:67]
ds_read_b64_tr_b16 a[96:97], v239 offset:192
v_mfma_f32_16x16x32_bf16 v[64:67], a[108:111], a[36:39], v[64:67]
ds_read_b64_tr_b16 a[98:99], v239 offset:5312
v_mfma_f32_16x16x32_bf16 v[68:71], a[104:107], a[40:43], v[68:71]
ds_read_b64_tr_b16 a[100:101], v239 offset:10432
v_mfma_f32_16x16x32_bf16 v[68:71], a[108:111], a[44:47], v[68:71]
s_add_u32 m0, s55, 0x14000
ds_read_b64_tr_b16 a[102:103], v239 offset:15552
v_mfma_f32_16x16x32_bf16 v[72:75], a[104:107], a[48:51], v[72:75]
buffer_load_dwordx4 v228, s[24:27], s52 offen lds
v_mfma_f32_16x16x32_bf16 v[72:75], a[108:111], a[52:55], v[72:75]
v_mfma_f32_16x16x32_bf16 v[76:79], a[104:107], a[56:59], v[76:79]
v_mfma_f32_16x16x32_bf16 v[76:79], a[108:111], a[60:63], v[76:79]
s_waitcnt lgkmcnt(4)
v_mfma_f32_16x16x32_bf16 v[80:83], a[112:115], a[32:35], v[80:83]
ds_read_b64_tr_b16 a[104:105], v239 offset:224
v_mfma_f32_16x16x32_bf16 v[80:83], a[116:119], a[36:39], v[80:83]
ds_read_b64_tr_b16 a[106:107], v239 offset:5344
v_mfma_f32_16x16x32_bf16 v[84:87], a[112:115], a[40:43], v[84:87]
ds_read_b64_tr_b16 a[108:109], v239 offset:10464
v_mfma_f32_16x16x32_bf16 v[84:87], a[116:119], a[44:47], v[84:87]
ds_read_b64_tr_b16 a[110:111], v239 offset:15584
v_mfma_f32_16x16x32_bf16 v[88:91], a[112:115], a[48:51], v[88:91]
buffer_load_dwordx4 v229, s[24:27], s52 offen offset:1024 lds
v_mfma_f32_16x16x32_bf16 v[88:91], a[116:119], a[52:55], v[88:91]
v_mfma_f32_16x16x32_bf16 v[92:95], a[112:115], a[56:59], v[92:95]
v_mfma_f32_16x16x32_bf16 v[92:95], a[116:119], a[60:63], v[92:95]
s_waitcnt lgkmcnt(4)
v_mfma_f32_16x16x32_bf16 v[96:99], a[96:99], a[32:35], v[96:99]
ds_read_b64_tr_b16 a[112:113], v239 offset:256
v_mfma_f32_16x16x32_bf16 v[96:99], a[100:103], a[36:39], v[96:99]
ds_read_b64_tr_b16 a[114:115], v239 offset:5376
v_mfma_f32_16x16x32_bf16 v[100:103], a[96:99], a[40:43], v[100:103]
ds_read_b64_tr_b16 a[116:117], v239 offset:10496
v_mfma_f32_16x16x32_bf16 v[100:103], a[100:103], a[44:47], v[100:103]
ds_read_b64_tr_b16 a[118:119], v239 offset:15616
v_mfma_f32_16x16x32_bf16 v[104:107], a[96:99], a[48:51], v[104:107]
buffer_load_dwordx4 v228, s[24:27], s52 offen offset:2048 lds
v_mfma_f32_16x16x32_bf16 v[104:107], a[100:103], a[52:55], v[104:107]
v_mfma_f32_16x16x32_bf16 v[108:111], a[96:99], a[56:59], v[108:111]
s_waitcnt vmcnt(7)
v_mfma_f32_16x16x32_bf16 v[108:111], a[100:103], a[60:63], v[108:111]
s_waitcnt lgkmcnt(4)
s_barrier
v_mfma_f32_16x16x32_bf16 v[112:115], a[104:107], a[32:35], v[112:115]
ds_read_b64_tr_b16 a[96:97], v239 offset:32768
v_mfma_f32_16x16x32_bf16 v[112:115], a[108:111], a[36:39], v[112:115]
ds_read_b64_tr_b16 a[98:99], v239 offset:37888
v_mfma_f32_16x16x32_bf16 v[116:119], a[104:107], a[40:43], v[116:119]
ds_read_b64_tr_b16 a[100:101], v239 offset:43008
v_mfma_f32_16x16x32_bf16 v[116:119], a[108:111], a[44:47], v[116:119]
ds_read_b64_tr_b16 a[102:103], v239 offset:48128
v_mfma_f32_16x16x32_bf16 v[120:123], a[104:107], a[48:51], v[120:123]
v_mfma_f32_16x16x32_bf16 v[120:123], a[108:111], a[52:55], v[120:123]
v_mfma_f32_16x16x32_bf16 v[124:127], a[104:107], a[56:59], v[124:127]
buffer_load_dwordx4 v229, s[24:27], s52 offen offset:3072 lds
v_mfma_f32_16x16x32_bf16 v[124:127], a[108:111], a[60:63], v[124:127]
s_waitcnt lgkmcnt(4)
s_add_u32 s51, s51, 16384
s_add_u32 s52, s52, 16384
v_mfma_f32_16x16x32_bf16 v[128:131], a[112:115], a[32:35], v[128:131]
ds_read_b64_tr_b16 a[104:105], v239 offset:32800
v_mfma_f32_16x16x32_bf16 v[128:131], a[116:119], a[36:39], v[128:131]
ds_read_b64_tr_b16 a[106:107], v239 offset:37920
v_mfma_f32_16x16x32_bf16 v[132:135], a[112:115], a[40:43], v[132:135]
ds_read_b64_tr_b16 a[108:109], v239 offset:43040
v_mfma_f32_16x16x32_bf16 v[132:135], a[116:119], a[44:47], v[132:135]
ds_read_b64_tr_b16 a[110:111], v239 offset:48160
v_mfma_f32_16x16x32_bf16 v[136:139], a[112:115], a[48:51], v[136:139]
v_mfma_f32_16x16x32_bf16 v[136:139], a[116:119], a[52:55], v[136:139]
v_mfma_f32_16x16x32_bf16 v[140:143], a[112:115], a[56:59], v[140:143]
v_mfma_f32_16x16x32_bf16 v[140:143], a[116:119], a[60:63], v[140:143]
s_waitcnt lgkmcnt(4)
v_mfma_f32_16x16x32_bf16 v[0:3], a[96:99], a[64:67], v[0:3]
ds_read_b64_tr_b16 a[112:113], v239 offset:32832
v_mfma_f32_16x16x32_bf16 v[0:3], a[100:103], a[68:71], v[0:3]
ds_read_b64_tr_b16 a[114:115], v239 offset:37952
v_mfma_f32_16x16x32_bf16 v[4:7], a[96:99], a[72:75], v[4:7]
ds_read_b64_tr_b16 a[116:117], v239 offset:43072
v_mfma_f32_16x16x32_bf16 v[4:7], a[100:103], a[76:79], v[4:7]
s_add_u32 m0, s55, 0x18000
ds_read_b64_tr_b16 a[118:119], v239 offset:48192
v_mfma_f32_16x16x32_bf16 v[8:11], a[96:99], a[80:83], v[8:11]
buffer_load_dwordx4 v224, s[20:23], s51 offen lds
v_mfma_f32_16x16x32_bf16 v[8:11], a[100:103], a[84:87], v[8:11]
v_mfma_f32_16x16x32_bf16 v[12:15], a[96:99], a[88:91], v[12:15]
v_mfma_f32_16x16x32_bf16 v[12:15], a[100:103], a[92:95], v[12:15]
s_waitcnt lgkmcnt(4)
v_mfma_f32_16x16x32_bf16 v[16:19], a[104:107], a[64:67], v[16:19]
ds_read_b64_tr_b16 a[96:97], v239 offset:32864
v_mfma_f32_16x16x32_bf16 v[16:19], a[108:111], a[68:71], v[16:19]
ds_read_b64_tr_b16 a[98:99], v239 offset:37984
v_mfma_f32_16x16x32_bf16 v[20:23], a[104:107], a[72:75], v[20:23]
ds_read_b64_tr_b16 a[100:101], v239 offset:43104
v_mfma_f32_16x16x32_bf16 v[20:23], a[108:111], a[76:79], v[20:23]
ds_read_b64_tr_b16 a[102:103], v239 offset:48224
v_mfma_f32_16x16x32_bf16 v[24:27], a[104:107], a[80:83], v[24:27]
buffer_load_dwordx4 v225, s[20:23], s51 offen offset:1024 lds
v_mfma_f32_16x16x32_bf16 v[24:27], a[108:111], a[84:87], v[24:27]
v_mfma_f32_16x16x32_bf16 v[28:31], a[104:107], a[88:91], v[28:31]
v_mfma_f32_16x16x32_bf16 v[28:31], a[108:111], a[92:95], v[28:31]
s_waitcnt lgkmcnt(4)
v_mfma_f32_16x16x32_bf16 v[32:35], a[112:115], a[64:67], v[32:35]
ds_read_b64_tr_b16 a[104:105], v239 offset:32896
v_mfma_f32_16x16x32_bf16 v[32:35], a[116:119], a[68:71], v[32:35]
ds_read_b64_tr_b16 a[106:107], v239 offset:38016
v_mfma_f32_16x16x32_bf16 v[36:39], a[112:115], a[72:75], v[36:39]
ds_read_b64_tr_b16 a[108:109], v239 offset:43136
v_mfma_f32_16x16x32_bf16 v[36:39], a[116:119], a[76:79], v[36:39]
ds_read_b64_tr_b16 a[110:111], v239 offset:48256
v_mfma_f32_16x16x32_bf16 v[40:43], a[112:115], a[80:83], v[40:43]
buffer_load_dwordx4 v226, s[20:23], s51 offen offset:2048 lds
v_mfma_f32_16x16x32_bf16 v[40:43], a[116:119], a[84:87], v[40:43]
v_mfma_f32_16x16x32_bf16 v[44:47], a[112:115], a[88:91], v[44:47]
v_mfma_f32_16x16x32_bf16 v[44:47], a[116:119], a[92:95], v[44:47]
s_waitcnt lgkmcnt(4)
v_mfma_f32_16x16x32_bf16 v[48:51], a[96:99], a[64:67], v[48:51]
ds_read_b64_tr_b16 a[112:113], v239 offset:32928
v_mfma_f32_16x16x32_bf16 v[48:51], a[100:103], a[68:71], v[48:51]
ds_read_b64_tr_b16 a[114:115], v239 offset:38048
v_mfma_f32_16x16x32_bf16 v[52:55], a[96:99], a[72:75], v[52:55]
ds_read_b64_tr_b16 a[116:117], v239 offset:43168
v_mfma_f32_16x16x32_bf16 v[52:55], a[100:103], a[76:79], v[52:55]
ds_read_b64_tr_b16 a[118:119], v239 offset:48288
v_mfma_f32_16x16x32_bf16 v[56:59], a[96:99], a[80:83], v[56:59]
buffer_load_dwordx4 v227, s[20:23], s51 offen offset:3072 lds
v_mfma_f32_16x16x32_bf16 v[56:59], a[100:103], a[84:87], v[56:59]
v_mfma_f32_16x16x32_bf16 v[60:63], a[96:99], a[88:91], v[60:63]
v_mfma_f32_16x16x32_bf16 v[60:63], a[100:103], a[92:95], v[60:63]
s_waitcnt lgkmcnt(4)
v_mfma_f32_16x16x32_bf16 v[64:67], a[104:107], a[64:67], v[64:67]
ds_read_b64_tr_b16 a[96:97], v239 offset:32960
v_mfma_f32_16x16x32_bf16 v[64:67], a[108:111], a[68:71], v[64:67]
ds_read_b64_tr_b16 a[98:99], v239 offset:38080
v_mfma_f32_16x16x32_bf16 v[68:71], a[104:107], a[72:75], v[68:71]
ds_read_b64_tr_b16 a[100:101], v239 offset:43200
v_mfma_f32_16x16x32_bf16 v[68:71], a[108:111], a[76:79], v[68:71]
s_add_u32 m0, s55, 0x1c000
ds_read_b64_tr_b16 a[102:103], v239 offset:48320
v_mfma_f32_16x16x32_bf16 v[72:75], a[104:107], a[80:83], v[72:75]
buffer_load_dwordx4 v228, s[24:27], s52 offen lds
v_mfma_f32_16x16x32_bf16 v[72:75], a[108:111], a[84:87], v[72:75]
v_mfma_f32_16x16x32_bf16 v[76:79], a[104:107], a[88:91], v[76:79]
v_mfma_f32_16x16x32_bf16 v[76:79], a[108:111], a[92:95], v[76:79]
s_waitcnt lgkmcnt(4)
v_mfma_f32_16x16x32_bf16 v[80:83], a[112:115], a[64:67], v[80:83]
ds_read_b64_tr_b16 a[104:105], v239 offset:32992
v_mfma_f32_16x16x32_bf16 v[80:83], a[116:119], a[68:71], v[80:83]
ds_read_b64_tr_b16 a[106:107], v239 offset:38112
v_mfma_f32_16x16x32_bf16 v[84:87], a[112:115], a[72:75], v[84:87]
ds_read_b64_tr_b16 a[108:109], v239 offset:43232
v_mfma_f32_16x16x32_bf16 v[84:87], a[116:119], a[76:79], v[84:87]
ds_read_b64_tr_b16 a[110:111], v239 offset:48352
v_mfma_f32_16x16x32_bf16 v[88:91], a[112:115], a[80:83], v[88:91]
buffer_load_dwordx4 v229, s[24:27], s52 offen offset:1024 lds
v_mfma_f32_16x16x32_bf16 v[88:91], a[116:119], a[84:87], v[88:91]
v_mfma_f32_16x16x32_bf16 v[92:95], a[112:115], a[88:91], v[92:95]
v_mfma_f32_16x16x32_bf16 v[92:95], a[116:119], a[92:95], v[92:95]
s_waitcnt lgkmcnt(4)
v_mfma_f32_16x16x32_bf16 v[96:99], a[96:99], a[64:67], v[96:99]
ds_read_b64_tr_b16 a[112:113], v239 offset:33024
v_mfma_f32_16x16x32_bf16 v[96:99], a[100:103], a[68:71], v[96:99]
ds_read_b64_tr_b16 a[114:115], v239 offset:38144
v_mfma_f32_16x16x32_bf16 v[100:103], a[96:99], a[72:75], v[100:103]
ds_read_b64_tr_b16 a[116:117], v239 offset:43264
v_mfma_f32_16x16x32_bf16 v[100:103], a[100:103], a[76:79], v[100:103]
ds_read_b64_tr_b16 a[118:119], v239 offset:48384
v_mfma_f32_16x16x32_bf16 v[104:107], a[96:99], a[80:83], v[104:107]
buffer_load_dwordx4 v228, s[24:27], s52 offen offset:2048 lds
v_mfma_f32_16x16x32_bf16 v[104:107], a[100:103], a[84:87], v[104:107]
v_mfma_f32_16x16x32_bf16 v[108:111], a[96:99], a[88:91], v[108:111]
v_mfma_f32_16x16x32_bf16 v[108:111], a[100:103], a[92:95], v[108:111]
s_waitcnt lgkmcnt(4)
v_mfma_f32_16x16x32_bf16 v[112:115], a[104:107], a[64:67], v[112:115]
v_mfma_f32_16x16x32_bf16 v[112:115], a[108:111], a[68:71], v[112:115]
v_mfma_f32_16x16x32_bf16 v[116:119], a[104:107], a[72:75], v[116:119]
v_mfma_f32_16x16x32_bf16 v[116:119], a[108:111], a[76:79], v[116:119]
v_mfma_f32_16x16x32_bf16 v[120:123], a[104:107], a[80:83], v[120:123]
v_mfma_f32_16x16x32_bf16 v[120:123], a[108:111], a[84:87], v[120:123]
v_mfma_f32_16x16x32_bf16 v[124:127], a[104:107], a[88:91], v[124:127]
buffer_load_dwordx4 v229, s[24:27], s52 offen offset:3072 lds
v_mfma_f32_16x16x32_bf16 v[124:127], a[108:111], a[92:95], v[124:127]
s_waitcnt lgkmcnt(0)
s_add_u32 s51, s51, 16384
s_add_u32 s52, s52, 16384
v_mfma_f32_16x16x32_bf16 v[128:131], a[112:115], a[64:67], v[128:131]
v_mfma_f32_16x16x32_bf16 v[128:131], a[116:119], a[68:71], v[128:131]
v_mfma_f32_16x16x32_bf16 v[132:135], a[112:115], a[72:75], v[132:135]
v_mfma_f32_16x16x32_bf16 v[132:135], a[116:119], a[76:79], v[132:135]
v_mfma_f32_16x16x32_bf16 v[136:139], a[112:115], a[80:83], v[136:139]
v_mfma_f32_16x16x32_bf16 v[136:139], a[116:119], a[84:87], v[136:139]
v_mfma_f32_16x16x32_bf16 v[140:143], a[112:115], a[88:91], v[140:143]
v_mfma_f32_16x16x32_bf16 v[140:143], a[116:119], a[92:95], v[140:143]
s_load_dwordx2 s[62:63], s[0:1], 32
s_load_dwordx2 s[100:101], s[0:1], 72
s_waitcnt vmcnt(63)
s_nop 3
v_pk_fma_f32 v[0:1], v[144:145], v[160:161], v[0:1] op_sel_hi:[0,1,1] neg_lo:[1,0,0] neg_hi:[1,0,0]
v_pk_fma_f32 v[2:3], v[144:145], v[162:163], v[2:3] op_sel_hi:[0,1,1] neg_lo:[1,0,0] neg_hi:[1,0,0]
v_pk_fma_f32 v[16:17], v[144:145], v[164:165], v[16:17] op_sel_hi:[0,1,1] neg_lo:[1,0,0] neg_hi:[1,0,0]
v_pk_fma_f32 v[18:19], v[144:145], v[166:167], v[18:19] op_sel_hi:[0,1,1] neg_lo:[1,0,0] neg_hi:[1,0,0]
v_pk_fma_f32 v[32:33], v[144:145], v[168:169], v[32:33] op_sel_hi:[0,1,1] neg_lo:[1,0,0] neg_hi:[1,0,0]
v_pk_fma_f32 v[34:35], v[144:145], v[170:171], v[34:35] op_sel_hi:[0,1,1] neg_lo:[1,0,0] neg_hi:[1,0,0]
v_pk_mul_f32 v[230:231], v[0:1], v[0:1]
v_pk_mul_f32 v[232:233], v[2:3], v[2:3]
v_pk_mul_f32 v[234:235], v[16:17], v[16:17]
v_pk_mul_f32 v[236:237], v[18:19], v[18:19]
v_pk_mul_f32 v[238:239], v[32:33], v[32:33]
v_pk_mul_f32 v[240:241], v[34:35], v[34:35]
v_pk_fma_f32 v[230:231], v[230:231], v[146:147], v[144:145] op_sel:[0,0,1] op_sel_hi:[1,0,1]
v_pk_fma_f32 v[232:233], v[232:233], v[146:147], v[144:145] op_sel:[0,0,1] op_sel_hi:[1,0,1]
v_pk_fma_f32 v[234:235], v[234:235], v[146:147], v[144:145] op_sel:[0,0,1] op_sel_hi:[1,0,1]
v_pk_fma_f32 v[236:237], v[236:237], v[146:147], v[144:145] op_sel:[0,0,1] op_sel_hi:[1,0,1]
v_pk_fma_f32 v[238:239], v[238:239], v[146:147], v[144:145] op_sel:[0,0,1] op_sel_hi:[1,0,1]
v_pk_fma_f32 v[240:241], v[240:241], v[146:147], v[144:145] op_sel:[0,0,1] op_sel_hi:[1,0,1]
v_pk_mul_f32 v[230:231], v[0:1], v[230:231]
v_pk_mul_f32 v[232:233], v[2:3], v[232:233]
v_pk_mul_f32 v[234:235], v[16:17], v[234:235]
v_pk_mul_f32 v[236:237], v[18:19], v[236:237]
v_pk_mul_f32 v[238:239], v[32:33], v[238:239]
v_pk_mul_f32 v[240:241], v[34:35], v[240:241]
v_exp_f32 v230, v230
v_exp_f32 v231, v231
v_exp_f32 v232, v232
v_exp_f32 v233, v233
v_exp_f32 v234, v234
v_exp_f32 v235, v235
v_exp_f32 v236, v236
v_exp_f32 v237, v237
v_exp_f32 v238, v238
v_exp_f32 v239, v239
v_exp_f32 v240, v240
v_exp_f32 v241, v241
v_pk_fma_f32 v[230:231], v[230:231], v[146:147], v[146:147] op_sel:[0,1,1]
v_pk_fma_f32 v[232:233], v[232:233], v[146:147], v[146:147] op_sel:[0,1,1]
v_pk_fma_f32 v[234:235], v[234:235], v[146:147], v[146:147] op_sel:[0,1,1]
v_pk_fma_f32 v[236:237], v[236:237], v[146:147], v[146:147] op_sel:[0,1,1]
v_pk_fma_f32 v[238:239], v[238:239], v[146:147], v[146:147] op_sel:[0,1,1]
v_pk_fma_f32 v[240:241], v[240:241], v[146:147], v[146:147] op_sel:[0,1,1]
v_rcp_f32 v230, v230
v_rcp_f32 v231, v231
v_rcp_f32 v232, v232
v_rcp_f32 v233, v233
v_rcp_f32 v234, v234
v_rcp_f32 v235, v235
v_rcp_f32 v236, v236
v_rcp_f32 v237, v237
v_rcp_f32 v238, v238
v_rcp_f32 v239, v239
v_rcp_f32 v240, v240
v_rcp_f32 v241, v241
v_pk_mul_f32 v[0:1], v[0:1], v[230:231]
v_pk_mul_f32 v[2:3], v[2:3], v[232:233]
v_pk_mul_f32 v[16:17], v[16:17], v[234:235]
v_pk_mul_f32 v[18:19], v[18:19], v[236:237]
v_pk_mul_f32 v[32:33], v[32:33], v[238:239]
v_pk_mul_f32 v[34:35], v[34:35], v[240:241]
v_pk_fma_f32 v[48:49], v[144:145], v[172:173], v[48:49] op_sel_hi:[0,1,1] neg_lo:[1,0,0] neg_hi:[1,0,0]
v_pk_fma_f32 v[50:51], v[144:145], v[174:175], v[50:51] op_sel_hi:[0,1,1] neg_lo:[1,0,0] neg_hi:[1,0,0]
v_pk_fma_f32 v[64:65], v[144:145], v[176:177], v[64:65] op_sel_hi:[0,1,1] neg_lo:[1,0,0] neg_hi:[1,0,0]
v_pk_fma_f32 v[66:67], v[144:145], v[178:179], v[66:67] op_sel_hi:[0,1,1] neg_lo:[1,0,0] neg_hi:[1,0,0]
v_pk_fma_f32 v[80:81], v[144:145], v[180:181], v[80:81] op_sel_hi:[0,1,1] neg_lo:[1,0,0] neg_hi:[1,0,0]
v_pk_fma_f32 v[82:83], v[144:145], v[182:183], v[82:83] op_sel_hi:[0,1,1] neg_lo:[1,0,0] neg_hi:[1,0,0]
v_pk_mul_f32 v[230:231], v[48:49], v[48:49]
v_pk_mul_f32 v[232:233], v[50:51], v[50:51]
v_pk_mul_f32 v[234:235], v[64:65], v[64:65]
v_pk_mul_f32 v[236:237], v[66:67], v[66:67]
v_pk_mul_f32 v[238:239], v[80:81], v[80:81]
v_pk_mul_f32 v[240:241], v[82:83], v[82:83]
v_pk_fma_f32 v[230:231], v[230:231], v[146:147], v[144:145] op_sel:[0,0,1] op_sel_hi:[1,0,1]
v_pk_fma_f32 v[232:233], v[232:233], v[146:147], v[144:145] op_sel:[0,0,1] op_sel_hi:[1,0,1]
v_pk_fma_f32 v[234:235], v[234:235], v[146:147], v[144:145] op_sel:[0,0,1] op_sel_hi:[1,0,1]
v_pk_fma_f32 v[236:237], v[236:237], v[146:147], v[144:145] op_sel:[0,0,1] op_sel_hi:[1,0,1]
v_pk_fma_f32 v[238:239], v[238:239], v[146:147], v[144:145] op_sel:[0,0,1] op_sel_hi:[1,0,1]
v_pk_fma_f32 v[240:241], v[240:241], v[146:147], v[144:145] op_sel:[0,0,1] op_sel_hi:[1,0,1]
v_pk_mul_f32 v[230:231], v[48:49], v[230:231]
v_pk_mul_f32 v[232:233], v[50:51], v[232:233]
v_pk_mul_f32 v[234:235], v[64:65], v[234:235]
v_pk_mul_f32 v[236:237], v[66:67], v[236:237]
v_pk_mul_f32 v[238:239], v[80:81], v[238:239]
v_pk_mul_f32 v[240:241], v[82:83], v[240:241]
v_exp_f32 v230, v230
v_exp_f32 v231, v231
v_exp_f32 v232, v232
v_exp_f32 v233, v233
v_exp_f32 v234, v234
v_exp_f32 v235, v235
v_exp_f32 v236, v236
v_exp_f32 v237, v237
v_exp_f32 v238, v238
v_exp_f32 v239, v239
v_exp_f32 v240, v240
v_exp_f32 v241, v241
v_pk_fma_f32 v[230:231], v[230:231], v[146:147], v[146:147] op_sel:[0,1,1]
v_pk_fma_f32 v[232:233], v[232:233], v[146:147], v[146:147] op_sel:[0,1,1]
v_pk_fma_f32 v[234:235], v[234:235], v[146:147], v[146:147] op_sel:[0,1,1]
v_pk_fma_f32 v[236:237], v[236:237], v[146:147], v[146:147] op_sel:[0,1,1]
v_pk_fma_f32 v[238:239], v[238:239], v[146:147], v[146:147] op_sel:[0,1,1]
v_pk_fma_f32 v[240:241], v[240:241], v[146:147], v[146:147] op_sel:[0,1,1]
v_rcp_f32 v230, v230
v_rcp_f32 v231, v231
v_rcp_f32 v232, v232
v_rcp_f32 v233, v233
v_rcp_f32 v234, v234
v_rcp_f32 v235, v235
v_rcp_f32 v236, v236
v_rcp_f32 v237, v237
v_rcp_f32 v238, v238
v_rcp_f32 v239, v239
v_rcp_f32 v240, v240
v_rcp_f32 v241, v241
v_pk_mul_f32 v[48:49], v[48:49], v[230:231]
v_pk_mul_f32 v[50:51], v[50:51], v[232:233]
v_pk_mul_f32 v[64:65], v[64:65], v[234:235]
v_pk_mul_f32 v[66:67], v[66:67], v[236:237]
v_pk_mul_f32 v[80:81], v[80:81], v[238:239]
v_pk_mul_f32 v[82:83], v[82:83], v[240:241]
v_pk_fma_f32 v[96:97], v[144:145], v[184:185], v[96:97] op_sel_hi:[0,1,1] neg_lo:[1,0,0] neg_hi:[1,0,0]
v_pk_fma_f32 v[98:99], v[144:145], v[186:187], v[98:99] op_sel_hi:[0,1,1] neg_lo:[1,0,0] neg_hi:[1,0,0]
v_pk_fma_f32 v[112:113], v[144:145], v[188:189], v[112:113] op_sel_hi:[0,1,1] neg_lo:[1,0,0] neg_hi:[1,0,0]
v_pk_fma_f32 v[114:115], v[144:145], v[190:191], v[114:115] op_sel_hi:[0,1,1] neg_lo:[1,0,0] neg_hi:[1,0,0]
v_pk_fma_f32 v[128:129], v[144:145], v[192:193], v[128:129] op_sel_hi:[0,1,1] neg_lo:[1,0,0] neg_hi:[1,0,0]
v_pk_fma_f32 v[130:131], v[144:145], v[194:195], v[130:131] op_sel_hi:[0,1,1] neg_lo:[1,0,0] neg_hi:[1,0,0]
v_pk_mul_f32 v[230:231], v[96:97], v[96:97]
v_pk_mul_f32 v[232:233], v[98:99], v[98:99]
v_pk_mul_f32 v[234:235], v[112:113], v[112:113]
v_pk_mul_f32 v[236:237], v[114:115], v[114:115]
v_pk_mul_f32 v[238:239], v[128:129], v[128:129]
v_pk_mul_f32 v[240:241], v[130:131], v[130:131]
v_pk_fma_f32 v[230:231], v[230:231], v[146:147], v[144:145] op_sel:[0,0,1] op_sel_hi:[1,0,1]
v_pk_fma_f32 v[232:233], v[232:233], v[146:147], v[144:145] op_sel:[0,0,1] op_sel_hi:[1,0,1]
v_pk_fma_f32 v[234:235], v[234:235], v[146:147], v[144:145] op_sel:[0,0,1] op_sel_hi:[1,0,1]
v_pk_fma_f32 v[236:237], v[236:237], v[146:147], v[144:145] op_sel:[0,0,1] op_sel_hi:[1,0,1]
v_pk_fma_f32 v[238:239], v[238:239], v[146:147], v[144:145] op_sel:[0,0,1] op_sel_hi:[1,0,1]
v_pk_fma_f32 v[240:241], v[240:241], v[146:147], v[144:145] op_sel:[0,0,1] op_sel_hi:[1,0,1]
v_pk_mul_f32 v[230:231], v[96:97], v[230:231]
v_pk_mul_f32 v[232:233], v[98:99], v[232:233]
v_pk_mul_f32 v[234:235], v[112:113], v[234:235]
v_pk_mul_f32 v[236:237], v[114:115], v[236:237]
v_pk_mul_f32 v[238:239], v[128:129], v[238:239]
v_pk_mul_f32 v[240:241], v[130:131], v[240:241]
v_exp_f32 v230, v230
v_exp_f32 v231, v231
v_exp_f32 v232, v232
v_exp_f32 v233, v233
v_exp_f32 v234, v234
v_exp_f32 v235, v235
v_exp_f32 v236, v236
v_exp_f32 v237, v237
v_exp_f32 v238, v238
v_exp_f32 v239, v239
v_exp_f32 v240, v240
v_exp_f32 v241, v241
v_pk_fma_f32 v[230:231], v[230:231], v[146:147], v[146:147] op_sel:[0,1,1]
v_pk_fma_f32 v[232:233], v[232:233], v[146:147], v[146:147] op_sel:[0,1,1]
v_pk_fma_f32 v[234:235], v[234:235], v[146:147], v[146:147] op_sel:[0,1,1]
v_pk_fma_f32 v[236:237], v[236:237], v[146:147], v[146:147] op_sel:[0,1,1]
v_pk_fma_f32 v[238:239], v[238:239], v[146:147], v[146:147] op_sel:[0,1,1]
v_pk_fma_f32 v[240:241], v[240:241], v[146:147], v[146:147] op_sel:[0,1,1]
v_rcp_f32 v230, v230
v_rcp_f32 v231, v231
v_rcp_f32 v232, v232
v_rcp_f32 v233, v233
v_rcp_f32 v234, v234
v_rcp_f32 v235, v235
v_rcp_f32 v236, v236
v_rcp_f32 v237, v237
v_rcp_f32 v238, v238
v_rcp_f32 v239, v239
v_rcp_f32 v240, v240
v_rcp_f32 v241, v241
v_pk_mul_f32 v[96:97], v[96:97], v[230:231]
v_pk_mul_f32 v[98:99], v[98:99], v[232:233]
v_pk_mul_f32 v[112:113], v[112:113], v[234:235]
v_pk_mul_f32 v[114:115], v[114:115], v[236:237]
v_pk_mul_f32 v[128:129], v[128:129], v[238:239]
v_pk_mul_f32 v[130:131], v[130:131], v[240:241]
v_pk_fma_f32 v[4:5], v[148:149], v[160:161], v[4:5] op_sel_hi:[0,1,1] neg_lo:[1,0,0] neg_hi:[1,0,0]
v_pk_fma_f32 v[6:7], v[148:149], v[162:163], v[6:7] op_sel_hi:[0,1,1] neg_lo:[1,0,0] neg_hi:[1,0,0]
v_pk_fma_f32 v[20:21], v[148:149], v[164:165], v[20:21] op_sel_hi:[0,1,1] neg_lo:[1,0,0] neg_hi:[1,0,0]
v_pk_fma_f32 v[22:23], v[148:149], v[166:167], v[22:23] op_sel_hi:[0,1,1] neg_lo:[1,0,0] neg_hi:[1,0,0]
v_pk_fma_f32 v[36:37], v[148:149], v[168:169], v[36:37] op_sel_hi:[0,1,1] neg_lo:[1,0,0] neg_hi:[1,0,0]
v_pk_fma_f32 v[38:39], v[148:149], v[170:171], v[38:39] op_sel_hi:[0,1,1] neg_lo:[1,0,0] neg_hi:[1,0,0]
v_pk_mul_f32 v[230:231], v[4:5], v[4:5]
v_pk_mul_f32 v[232:233], v[6:7], v[6:7]
v_pk_mul_f32 v[234:235], v[20:21], v[20:21]
v_pk_mul_f32 v[236:237], v[22:23], v[22:23]
v_pk_mul_f32 v[238:239], v[36:37], v[36:37]
v_pk_mul_f32 v[240:241], v[38:39], v[38:39]
v_pk_fma_f32 v[230:231], v[230:231], v[150:151], v[148:149] op_sel:[0,0,1] op_sel_hi:[1,0,1]
v_pk_fma_f32 v[232:233], v[232:233], v[150:151], v[148:149] op_sel:[0,0,1] op_sel_hi:[1,0,1]
v_pk_fma_f32 v[234:235], v[234:235], v[150:151], v[148:149] op_sel:[0,0,1] op_sel_hi:[1,0,1]
v_pk_fma_f32 v[236:237], v[236:237], v[150:151], v[148:149] op_sel:[0,0,1] op_sel_hi:[1,0,1]
v_pk_fma_f32 v[238:239], v[238:239], v[150:151], v[148:149] op_sel:[0,0,1] op_sel_hi:[1,0,1]
v_pk_fma_f32 v[240:241], v[240:241], v[150:151], v[148:149] op_sel:[0,0,1] op_sel_hi:[1,0,1]
v_pk_mul_f32 v[230:231], v[4:5], v[230:231]
v_pk_mul_f32 v[232:233], v[6:7], v[232:233]
v_pk_mul_f32 v[234:235], v[20:21], v[234:235]
v_pk_mul_f32 v[236:237], v[22:23], v[236:237]
v_pk_mul_f32 v[238:239], v[36:37], v[238:239]
v_pk_mul_f32 v[240:241], v[38:39], v[240:241]
v_exp_f32 v230, v230
v_exp_f32 v231, v231
v_exp_f32 v232, v232
v_exp_f32 v233, v233
v_exp_f32 v234, v234
v_exp_f32 v235, v235
v_exp_f32 v236, v236
v_exp_f32 v237, v237
v_exp_f32 v238, v238
v_exp_f32 v239, v239
v_exp_f32 v240, v240
v_exp_f32 v241, v241
v_pk_fma_f32 v[230:231], v[230:231], v[150:151], v[150:151] op_sel:[0,1,1]
v_pk_fma_f32 v[232:233], v[232:233], v[150:151], v[150:151] op_sel:[0,1,1]
v_pk_fma_f32 v[234:235], v[234:235], v[150:151], v[150:151] op_sel:[0,1,1]
v_pk_fma_f32 v[236:237], v[236:237], v[150:151], v[150:151] op_sel:[0,1,1]
v_pk_fma_f32 v[238:239], v[238:239], v[150:151], v[150:151] op_sel:[0,1,1]
v_pk_fma_f32 v[240:241], v[240:241], v[150:151], v[150:151] op_sel:[0,1,1]
v_rcp_f32 v230, v230
v_rcp_f32 v231, v231
v_rcp_f32 v232, v232
v_rcp_f32 v233, v233
v_rcp_f32 v234, v234
v_rcp_f32 v235, v235
v_rcp_f32 v236, v236
v_rcp_f32 v237, v237
v_rcp_f32 v238, v238
v_rcp_f32 v239, v239
v_rcp_f32 v240, v240
v_rcp_f32 v241, v241
v_pk_mul_f32 v[4:5], v[4:5], v[230:231]
v_pk_mul_f32 v[6:7], v[6:7], v[232:233]
v_pk_mul_f32 v[20:21], v[20:21], v[234:235]
v_pk_mul_f32 v[22:23], v[22:23], v[236:237]
v_pk_mul_f32 v[36:37], v[36:37], v[238:239]
v_pk_mul_f32 v[38:39], v[38:39], v[240:241]
v_pk_fma_f32 v[52:53], v[148:149], v[172:173], v[52:53] op_sel_hi:[0,1,1] neg_lo:[1,0,0] neg_hi:[1,0,0]
v_pk_fma_f32 v[54:55], v[148:149], v[174:175], v[54:55] op_sel_hi:[0,1,1] neg_lo:[1,0,0] neg_hi:[1,0,0]
v_pk_fma_f32 v[68:69], v[148:149], v[176:177], v[68:69] op_sel_hi:[0,1,1] neg_lo:[1,0,0] neg_hi:[1,0,0]
v_pk_fma_f32 v[70:71], v[148:149], v[178:179], v[70:71] op_sel_hi:[0,1,1] neg_lo:[1,0,0] neg_hi:[1,0,0]
v_pk_fma_f32 v[84:85], v[148:149], v[180:181], v[84:85] op_sel_hi:[0,1,1] neg_lo:[1,0,0] neg_hi:[1,0,0]
v_pk_fma_f32 v[86:87], v[148:149], v[182:183], v[86:87] op_sel_hi:[0,1,1] neg_lo:[1,0,0] neg_hi:[1,0,0]
v_pk_mul_f32 v[230:231], v[52:53], v[52:53]
v_pk_mul_f32 v[232:233], v[54:55], v[54:55]
v_pk_mul_f32 v[234:235], v[68:69], v[68:69]
v_pk_mul_f32 v[236:237], v[70:71], v[70:71]
v_pk_mul_f32 v[238:239], v[84:85], v[84:85]
v_pk_mul_f32 v[240:241], v[86:87], v[86:87]
v_pk_fma_f32 v[230:231], v[230:231], v[150:151], v[148:149] op_sel:[0,0,1] op_sel_hi:[1,0,1]
v_pk_fma_f32 v[232:233], v[232:233], v[150:151], v[148:149] op_sel:[0,0,1] op_sel_hi:[1,0,1]
v_pk_fma_f32 v[234:235], v[234:235], v[150:151], v[148:149] op_sel:[0,0,1] op_sel_hi:[1,0,1]
v_pk_fma_f32 v[236:237], v[236:237], v[150:151], v[148:149] op_sel:[0,0,1] op_sel_hi:[1,0,1]
v_pk_fma_f32 v[238:239], v[238:239], v[150:151], v[148:149] op_sel:[0,0,1] op_sel_hi:[1,0,1]
v_pk_fma_f32 v[240:241], v[240:241], v[150:151], v[148:149] op_sel:[0,0,1] op_sel_hi:[1,0,1]
v_pk_mul_f32 v[230:231], v[52:53], v[230:231]
v_pk_mul_f32 v[232:233], v[54:55], v[232:233]
v_pk_mul_f32 v[234:235], v[68:69], v[234:235]
v_pk_mul_f32 v[236:237], v[70:71], v[236:237]
v_pk_mul_f32 v[238:239], v[84:85], v[238:239]
v_pk_mul_f32 v[240:241], v[86:87], v[240:241]
v_exp_f32 v230, v230
v_exp_f32 v231, v231
v_exp_f32 v232, v232
v_exp_f32 v233, v233
v_exp_f32 v234, v234
v_exp_f32 v235, v235
v_exp_f32 v236, v236
v_exp_f32 v237, v237
v_exp_f32 v238, v238
v_exp_f32 v239, v239
v_exp_f32 v240, v240
v_exp_f32 v241, v241
v_pk_fma_f32 v[230:231], v[230:231], v[150:151], v[150:151] op_sel:[0,1,1]
v_pk_fma_f32 v[232:233], v[232:233], v[150:151], v[150:151] op_sel:[0,1,1]
v_pk_fma_f32 v[234:235], v[234:235], v[150:151], v[150:151] op_sel:[0,1,1]
v_pk_fma_f32 v[236:237], v[236:237], v[150:151], v[150:151] op_sel:[0,1,1]
v_pk_fma_f32 v[238:239], v[238:239], v[150:151], v[150:151] op_sel:[0,1,1]
v_pk_fma_f32 v[240:241], v[240:241], v[150:151], v[150:151] op_sel:[0,1,1]
v_rcp_f32 v230, v230
v_rcp_f32 v231, v231
v_rcp_f32 v232, v232
v_rcp_f32 v233, v233
v_rcp_f32 v234, v234
v_rcp_f32 v235, v235
v_rcp_f32 v236, v236
v_rcp_f32 v237, v237
v_rcp_f32 v238, v238
v_rcp_f32 v239, v239
v_rcp_f32 v240, v240
v_rcp_f32 v241, v241
v_pk_mul_f32 v[52:53], v[52:53], v[230:231]
v_pk_mul_f32 v[54:55], v[54:55], v[232:233]
v_pk_mul_f32 v[68:69], v[68:69], v[234:235]
v_pk_mul_f32 v[70:71], v[70:71], v[236:237]
v_pk_mul_f32 v[84:85], v[84:85], v[238:239]
v_pk_mul_f32 v[86:87], v[86:87], v[240:241]
v_pk_fma_f32 v[100:101], v[148:149], v[184:185], v[100:101] op_sel_hi:[0,1,1] neg_lo:[1,0,0] neg_hi:[1,0,0]
v_pk_fma_f32 v[102:103], v[148:149], v[186:187], v[102:103] op_sel_hi:[0,1,1] neg_lo:[1,0,0] neg_hi:[1,0,0]
v_pk_fma_f32 v[116:117], v[148:149], v[188:189], v[116:117] op_sel_hi:[0,1,1] neg_lo:[1,0,0] neg_hi:[1,0,0]
v_pk_fma_f32 v[118:119], v[148:149], v[190:191], v[118:119] op_sel_hi:[0,1,1] neg_lo:[1,0,0] neg_hi:[1,0,0]
v_pk_fma_f32 v[132:133], v[148:149], v[192:193], v[132:133] op_sel_hi:[0,1,1] neg_lo:[1,0,0] neg_hi:[1,0,0]
v_pk_fma_f32 v[134:135], v[148:149], v[194:195], v[134:135] op_sel_hi:[0,1,1] neg_lo:[1,0,0] neg_hi:[1,0,0]
v_pk_mul_f32 v[230:231], v[100:101], v[100:101]
v_pk_mul_f32 v[232:233], v[102:103], v[102:103]
v_pk_mul_f32 v[234:235], v[116:117], v[116:117]
v_pk_mul_f32 v[236:237], v[118:119], v[118:119]
v_pk_mul_f32 v[238:239], v[132:133], v[132:133]
v_pk_mul_f32 v[240:241], v[134:135], v[134:135]
v_pk_fma_f32 v[230:231], v[230:231], v[150:151], v[148:149] op_sel:[0,0,1] op_sel_hi:[1,0,1]
v_pk_fma_f32 v[232:233], v[232:233], v[150:151], v[148:149] op_sel:[0,0,1] op_sel_hi:[1,0,1]
v_pk_fma_f32 v[234:235], v[234:235], v[150:151], v[148:149] op_sel:[0,0,1] op_sel_hi:[1,0,1]
v_pk_fma_f32 v[236:237], v[236:237], v[150:151], v[148:149] op_sel:[0,0,1] op_sel_hi:[1,0,1]
v_pk_fma_f32 v[238:239], v[238:239], v[150:151], v[148:149] op_sel:[0,0,1] op_sel_hi:[1,0,1]
v_pk_fma_f32 v[240:241], v[240:241], v[150:151], v[148:149] op_sel:[0,0,1] op_sel_hi:[1,0,1]
v_pk_mul_f32 v[230:231], v[100:101], v[230:231]
v_pk_mul_f32 v[232:233], v[102:103], v[232:233]
v_pk_mul_f32 v[234:235], v[116:117], v[234:235]
v_pk_mul_f32 v[236:237], v[118:119], v[236:237]
v_pk_mul_f32 v[238:239], v[132:133], v[238:239]
v_pk_mul_f32 v[240:241], v[134:135], v[240:241]
v_exp_f32 v230, v230
v_exp_f32 v231, v231
v_exp_f32 v232, v232
v_exp_f32 v233, v233
v_exp_f32 v234, v234
v_exp_f32 v235, v235
v_exp_f32 v236, v236
v_exp_f32 v237, v237
v_exp_f32 v238, v238
v_exp_f32 v239, v239
v_exp_f32 v240, v240
v_exp_f32 v241, v241
v_pk_fma_f32 v[230:231], v[230:231], v[150:151], v[150:151] op_sel:[0,1,1]
v_pk_fma_f32 v[232:233], v[232:233], v[150:151], v[150:151] op_sel:[0,1,1]
v_pk_fma_f32 v[234:235], v[234:235], v[150:151], v[150:151] op_sel:[0,1,1]
v_pk_fma_f32 v[236:237], v[236:237], v[150:151], v[150:151] op_sel:[0,1,1]
v_pk_fma_f32 v[238:239], v[238:239], v[150:151], v[150:151] op_sel:[0,1,1]
v_pk_fma_f32 v[240:241], v[240:241], v[150:151], v[150:151] op_sel:[0,1,1]
v_rcp_f32 v230, v230
v_rcp_f32 v231, v231
v_rcp_f32 v232, v232
v_rcp_f32 v233, v233
v_rcp_f32 v234, v234
v_rcp_f32 v235, v235
v_rcp_f32 v236, v236
v_rcp_f32 v237, v237
v_rcp_f32 v238, v238
v_rcp_f32 v239, v239
v_rcp_f32 v240, v240
v_rcp_f32 v241, v241
v_pk_mul_f32 v[100:101], v[100:101], v[230:231]
v_pk_mul_f32 v[102:103], v[102:103], v[232:233]
v_pk_mul_f32 v[116:117], v[116:117], v[234:235]
v_pk_mul_f32 v[118:119], v[118:119], v[236:237]
v_pk_mul_f32 v[132:133], v[132:133], v[238:239]
v_pk_mul_f32 v[134:135], v[134:135], v[240:241]
v_pk_fma_f32 v[8:9], v[152:153], v[160:161], v[8:9] op_sel_hi:[0,1,1] neg_lo:[1,0,0] neg_hi:[1,0,0]
v_pk_fma_f32 v[10:11], v[152:153], v[162:163], v[10:11] op_sel_hi:[0,1,1] neg_lo:[1,0,0] neg_hi:[1,0,0]
v_pk_fma_f32 v[24:25], v[152:153], v[164:165], v[24:25] op_sel_hi:[0,1,1] neg_lo:[1,0,0] neg_hi:[1,0,0]
v_pk_fma_f32 v[26:27], v[152:153], v[166:167], v[26:27] op_sel_hi:[0,1,1] neg_lo:[1,0,0] neg_hi:[1,0,0]
v_pk_fma_f32 v[40:41], v[152:153], v[168:169], v[40:41] op_sel_hi:[0,1,1] neg_lo:[1,0,0] neg_hi:[1,0,0]
v_pk_fma_f32 v[42:43], v[152:153], v[170:171], v[42:43] op_sel_hi:[0,1,1] neg_lo:[1,0,0] neg_hi:[1,0,0]
v_pk_mul_f32 v[230:231], v[8:9], v[8:9]
v_pk_mul_f32 v[232:233], v[10:11], v[10:11]
v_pk_mul_f32 v[234:235], v[24:25], v[24:25]
v_pk_mul_f32 v[236:237], v[26:27], v[26:27]
v_pk_mul_f32 v[238:239], v[40:41], v[40:41]
v_pk_mul_f32 v[240:241], v[42:43], v[42:43]
v_pk_fma_f32 v[230:231], v[230:231], v[154:155], v[152:153] op_sel:[0,0,1] op_sel_hi:[1,0,1]
v_pk_fma_f32 v[232:233], v[232:233], v[154:155], v[152:153] op_sel:[0,0,1] op_sel_hi:[1,0,1]
v_pk_fma_f32 v[234:235], v[234:235], v[154:155], v[152:153] op_sel:[0,0,1] op_sel_hi:[1,0,1]
v_pk_fma_f32 v[236:237], v[236:237], v[154:155], v[152:153] op_sel:[0,0,1] op_sel_hi:[1,0,1]
v_pk_fma_f32 v[238:239], v[238:239], v[154:155], v[152:153] op_sel:[0,0,1] op_sel_hi:[1,0,1]
v_pk_fma_f32 v[240:241], v[240:241], v[154:155], v[152:153] op_sel:[0,0,1] op_sel_hi:[1,0,1]
v_pk_mul_f32 v[230:231], v[8:9], v[230:231]
v_pk_mul_f32 v[232:233], v[10:11], v[232:233]
v_pk_mul_f32 v[234:235], v[24:25], v[234:235]
v_pk_mul_f32 v[236:237], v[26:27], v[236:237]
v_pk_mul_f32 v[238:239], v[40:41], v[238:239]
v_pk_mul_f32 v[240:241], v[42:43], v[240:241]
v_exp_f32 v230, v230
v_exp_f32 v231, v231
v_exp_f32 v232, v232
v_exp_f32 v233, v233
v_exp_f32 v234, v234
v_exp_f32 v235, v235
v_exp_f32 v236, v236
v_exp_f32 v237, v237
v_exp_f32 v238, v238
v_exp_f32 v239, v239
v_exp_f32 v240, v240
v_exp_f32 v241, v241
v_pk_fma_f32 v[230:231], v[230:231], v[154:155], v[154:155] op_sel:[0,1,1]
v_pk_fma_f32 v[232:233], v[232:233], v[154:155], v[154:155] op_sel:[0,1,1]
v_pk_fma_f32 v[234:235], v[234:235], v[154:155], v[154:155] op_sel:[0,1,1]
v_pk_fma_f32 v[236:237], v[236:237], v[154:155], v[154:155] op_sel:[0,1,1]
v_pk_fma_f32 v[238:239], v[238:239], v[154:155], v[154:155] op_sel:[0,1,1]
v_pk_fma_f32 v[240:241], v[240:241], v[154:155], v[154:155] op_sel:[0,1,1]
v_rcp_f32 v230, v230
v_rcp_f32 v231, v231
v_rcp_f32 v232, v232
v_rcp_f32 v233, v233
v_rcp_f32 v234, v234
v_rcp_f32 v235, v235
v_rcp_f32 v236, v236
v_rcp_f32 v237, v237
v_rcp_f32 v238, v238
v_rcp_f32 v239, v239
v_rcp_f32 v240, v240
v_rcp_f32 v241, v241
v_pk_mul_f32 v[8:9], v[8:9], v[230:231]
v_pk_mul_f32 v[10:11], v[10:11], v[232:233]
v_pk_mul_f32 v[24:25], v[24:25], v[234:235]
v_pk_mul_f32 v[26:27], v[26:27], v[236:237]
v_pk_mul_f32 v[40:41], v[40:41], v[238:239]
v_pk_mul_f32 v[42:43], v[42:43], v[240:241]
v_pk_fma_f32 v[56:57], v[152:153], v[172:173], v[56:57] op_sel_hi:[0,1,1] neg_lo:[1,0,0] neg_hi:[1,0,0]
v_pk_fma_f32 v[58:59], v[152:153], v[174:175], v[58:59] op_sel_hi:[0,1,1] neg_lo:[1,0,0] neg_hi:[1,0,0]
v_pk_fma_f32 v[72:73], v[152:153], v[176:177], v[72:73] op_sel_hi:[0,1,1] neg_lo:[1,0,0] neg_hi:[1,0,0]
v_pk_fma_f32 v[74:75], v[152:153], v[178:179], v[74:75] op_sel_hi:[0,1,1] neg_lo:[1,0,0] neg_hi:[1,0,0]
v_pk_fma_f32 v[88:89], v[152:153], v[180:181], v[88:89] op_sel_hi:[0,1,1] neg_lo:[1,0,0] neg_hi:[1,0,0]
v_pk_fma_f32 v[90:91], v[152:153], v[182:183], v[90:91] op_sel_hi:[0,1,1] neg_lo:[1,0,0] neg_hi:[1,0,0]
v_pk_mul_f32 v[230:231], v[56:57], v[56:57]
v_pk_mul_f32 v[232:233], v[58:59], v[58:59]
v_pk_mul_f32 v[234:235], v[72:73], v[72:73]
v_pk_mul_f32 v[236:237], v[74:75], v[74:75]
v_pk_mul_f32 v[238:239], v[88:89], v[88:89]
v_pk_mul_f32 v[240:241], v[90:91], v[90:91]
v_pk_fma_f32 v[230:231], v[230:231], v[154:155], v[152:153] op_sel:[0,0,1] op_sel_hi:[1,0,1]
v_pk_fma_f32 v[232:233], v[232:233], v[154:155], v[152:153] op_sel:[0,0,1] op_sel_hi:[1,0,1]
v_pk_fma_f32 v[234:235], v[234:235], v[154:155], v[152:153] op_sel:[0,0,1] op_sel_hi:[1,0,1]
v_pk_fma_f32 v[236:237], v[236:237], v[154:155], v[152:153] op_sel:[0,0,1] op_sel_hi:[1,0,1]
v_pk_fma_f32 v[238:239], v[238:239], v[154:155], v[152:153] op_sel:[0,0,1] op_sel_hi:[1,0,1]
v_pk_fma_f32 v[240:241], v[240:241], v[154:155], v[152:153] op_sel:[0,0,1] op_sel_hi:[1,0,1]
v_pk_mul_f32 v[230:231], v[56:57], v[230:231]
v_pk_mul_f32 v[232:233], v[58:59], v[232:233]
v_pk_mul_f32 v[234:235], v[72:73], v[234:235]
v_pk_mul_f32 v[236:237], v[74:75], v[236:237]
v_pk_mul_f32 v[238:239], v[88:89], v[238:239]
v_pk_mul_f32 v[240:241], v[90:91], v[240:241]
v_exp_f32 v230, v230
v_exp_f32 v231, v231
v_exp_f32 v232, v232
v_exp_f32 v233, v233
v_exp_f32 v234, v234
v_exp_f32 v235, v235
v_exp_f32 v236, v236
v_exp_f32 v237, v237
v_exp_f32 v238, v238
v_exp_f32 v239, v239
v_exp_f32 v240, v240
v_exp_f32 v241, v241
v_pk_fma_f32 v[230:231], v[230:231], v[154:155], v[154:155] op_sel:[0,1,1]
v_pk_fma_f32 v[232:233], v[232:233], v[154:155], v[154:155] op_sel:[0,1,1]
v_pk_fma_f32 v[234:235], v[234:235], v[154:155], v[154:155] op_sel:[0,1,1]
v_pk_fma_f32 v[236:237], v[236:237], v[154:155], v[154:155] op_sel:[0,1,1]
v_pk_fma_f32 v[238:239], v[238:239], v[154:155], v[154:155] op_sel:[0,1,1]
v_pk_fma_f32 v[240:241], v[240:241], v[154:155], v[154:155] op_sel:[0,1,1]
v_rcp_f32 v230, v230
v_rcp_f32 v231, v231
v_rcp_f32 v232, v232
v_rcp_f32 v233, v233
v_rcp_f32 v234, v234
v_rcp_f32 v235, v235
v_rcp_f32 v236, v236
v_rcp_f32 v237, v237
v_rcp_f32 v238, v238
v_rcp_f32 v239, v239
v_rcp_f32 v240, v240
v_rcp_f32 v241, v241
v_pk_mul_f32 v[56:57], v[56:57], v[230:231]
v_pk_mul_f32 v[58:59], v[58:59], v[232:233]
v_pk_mul_f32 v[72:73], v[72:73], v[234:235]
v_pk_mul_f32 v[74:75], v[74:75], v[236:237]
v_pk_mul_f32 v[88:89], v[88:89], v[238:239]
v_pk_mul_f32 v[90:91], v[90:91], v[240:241]
v_pk_fma_f32 v[104:105], v[152:153], v[184:185], v[104:105] op_sel_hi:[0,1,1] neg_lo:[1,0,0] neg_hi:[1,0,0]
v_pk_fma_f32 v[106:107], v[152:153], v[186:187], v[106:107] op_sel_hi:[0,1,1] neg_lo:[1,0,0] neg_hi:[1,0,0]
v_pk_fma_f32 v[120:121], v[152:153], v[188:189], v[120:121] op_sel_hi:[0,1,1] neg_lo:[1,0,0] neg_hi:[1,0,0]
v_pk_fma_f32 v[122:123], v[152:153], v[190:191], v[122:123] op_sel_hi:[0,1,1] neg_lo:[1,0,0] neg_hi:[1,0,0]
v_pk_fma_f32 v[136:137], v[152:153], v[192:193], v[136:137] op_sel_hi:[0,1,1] neg_lo:[1,0,0] neg_hi:[1,0,0]
v_pk_fma_f32 v[138:139], v[152:153], v[194:195], v[138:139] op_sel_hi:[0,1,1] neg_lo:[1,0,0] neg_hi:[1,0,0]
v_pk_mul_f32 v[230:231], v[104:105], v[104:105]
v_pk_mul_f32 v[232:233], v[106:107], v[106:107]
v_pk_mul_f32 v[234:235], v[120:121], v[120:121]
v_pk_mul_f32 v[236:237], v[122:123], v[122:123]
v_pk_mul_f32 v[238:239], v[136:137], v[136:137]
v_pk_mul_f32 v[240:241], v[138:139], v[138:139]
v_pk_fma_f32 v[230:231], v[230:231], v[154:155], v[152:153] op_sel:[0,0,1] op_sel_hi:[1,0,1]
v_pk_fma_f32 v[232:233], v[232:233], v[154:155], v[152:153] op_sel:[0,0,1] op_sel_hi:[1,0,1]
v_pk_fma_f32 v[234:235], v[234:235], v[154:155], v[152:153] op_sel:[0,0,1] op_sel_hi:[1,0,1]
v_pk_fma_f32 v[236:237], v[236:237], v[154:155], v[152:153] op_sel:[0,0,1] op_sel_hi:[1,0,1]
v_pk_fma_f32 v[238:239], v[238:239], v[154:155], v[152:153] op_sel:[0,0,1] op_sel_hi:[1,0,1]
v_pk_fma_f32 v[240:241], v[240:241], v[154:155], v[152:153] op_sel:[0,0,1] op_sel_hi:[1,0,1]
v_pk_mul_f32 v[230:231], v[104:105], v[230:231]
v_pk_mul_f32 v[232:233], v[106:107], v[232:233]
v_pk_mul_f32 v[234:235], v[120:121], v[234:235]
v_pk_mul_f32 v[236:237], v[122:123], v[236:237]
v_pk_mul_f32 v[238:239], v[136:137], v[238:239]
v_pk_mul_f32 v[240:241], v[138:139], v[240:241]
v_exp_f32 v230, v230
v_exp_f32 v231, v231
v_exp_f32 v232, v232
v_exp_f32 v233, v233
v_exp_f32 v234, v234
v_exp_f32 v235, v235
v_exp_f32 v236, v236
v_exp_f32 v237, v237
v_exp_f32 v238, v238
v_exp_f32 v239, v239
v_exp_f32 v240, v240
v_exp_f32 v241, v241
v_pk_fma_f32 v[230:231], v[230:231], v[154:155], v[154:155] op_sel:[0,1,1]
v_pk_fma_f32 v[232:233], v[232:233], v[154:155], v[154:155] op_sel:[0,1,1]
v_pk_fma_f32 v[234:235], v[234:235], v[154:155], v[154:155] op_sel:[0,1,1]
v_pk_fma_f32 v[236:237], v[236:237], v[154:155], v[154:155] op_sel:[0,1,1]
v_pk_fma_f32 v[238:239], v[238:239], v[154:155], v[154:155] op_sel:[0,1,1]
v_pk_fma_f32 v[240:241], v[240:241], v[154:155], v[154:155] op_sel:[0,1,1]
v_rcp_f32 v230, v230
v_rcp_f32 v231, v231
v_rcp_f32 v232, v232
v_rcp_f32 v233, v233
v_rcp_f32 v234, v234
v_rcp_f32 v235, v235
v_rcp_f32 v236, v236
v_rcp_f32 v237, v237
v_rcp_f32 v238, v238
v_rcp_f32 v239, v239
v_rcp_f32 v240, v240
v_rcp_f32 v241, v241
v_pk_mul_f32 v[104:105], v[104:105], v[230:231]
v_pk_mul_f32 v[106:107], v[106:107], v[232:233]
v_pk_mul_f32 v[120:121], v[120:121], v[234:235]
v_pk_mul_f32 v[122:123], v[122:123], v[236:237]
v_pk_mul_f32 v[136:137], v[136:137], v[238:239]
v_pk_mul_f32 v[138:139], v[138:139], v[240:241]
v_pk_fma_f32 v[12:13], v[156:157], v[160:161], v[12:13] op_sel_hi:[0,1,1] neg_lo:[1,0,0] neg_hi:[1,0,0]
v_pk_fma_f32 v[14:15], v[156:157], v[162:163], v[14:15] op_sel_hi:[0,1,1] neg_lo:[1,0,0] neg_hi:[1,0,0]
v_pk_fma_f32 v[28:29], v[156:157], v[164:165], v[28:29] op_sel_hi:[0,1,1] neg_lo:[1,0,0] neg_hi:[1,0,0]
v_pk_fma_f32 v[30:31], v[156:157], v[166:167], v[30:31] op_sel_hi:[0,1,1] neg_lo:[1,0,0] neg_hi:[1,0,0]
v_pk_fma_f32 v[44:45], v[156:157], v[168:169], v[44:45] op_sel_hi:[0,1,1] neg_lo:[1,0,0] neg_hi:[1,0,0]
v_pk_fma_f32 v[46:47], v[156:157], v[170:171], v[46:47] op_sel_hi:[0,1,1] neg_lo:[1,0,0] neg_hi:[1,0,0]
v_pk_mul_f32 v[230:231], v[12:13], v[12:13]
v_pk_mul_f32 v[232:233], v[14:15], v[14:15]
v_pk_mul_f32 v[234:235], v[28:29], v[28:29]
v_pk_mul_f32 v[236:237], v[30:31], v[30:31]
v_pk_mul_f32 v[238:239], v[44:45], v[44:45]
v_pk_mul_f32 v[240:241], v[46:47], v[46:47]
v_pk_fma_f32 v[230:231], v[230:231], v[158:159], v[156:157] op_sel:[0,0,1] op_sel_hi:[1,0,1]
v_pk_fma_f32 v[232:233], v[232:233], v[158:159], v[156:157] op_sel:[0,0,1] op_sel_hi:[1,0,1]
v_pk_fma_f32 v[234:235], v[234:235], v[158:159], v[156:157] op_sel:[0,0,1] op_sel_hi:[1,0,1]
v_pk_fma_f32 v[236:237], v[236:237], v[158:159], v[156:157] op_sel:[0,0,1] op_sel_hi:[1,0,1]
v_pk_fma_f32 v[238:239], v[238:239], v[158:159], v[156:157] op_sel:[0,0,1] op_sel_hi:[1,0,1]
v_pk_fma_f32 v[240:241], v[240:241], v[158:159], v[156:157] op_sel:[0,0,1] op_sel_hi:[1,0,1]
v_pk_mul_f32 v[230:231], v[12:13], v[230:231]
v_pk_mul_f32 v[232:233], v[14:15], v[232:233]
v_pk_mul_f32 v[234:235], v[28:29], v[234:235]
v_pk_mul_f32 v[236:237], v[30:31], v[236:237]
v_pk_mul_f32 v[238:239], v[44:45], v[238:239]
v_pk_mul_f32 v[240:241], v[46:47], v[240:241]
v_exp_f32 v230, v230
v_exp_f32 v231, v231
v_exp_f32 v232, v232
v_exp_f32 v233, v233
v_exp_f32 v234, v234
v_exp_f32 v235, v235
v_exp_f32 v236, v236
v_exp_f32 v237, v237
v_exp_f32 v238, v238
v_exp_f32 v239, v239
v_exp_f32 v240, v240
v_exp_f32 v241, v241
v_pk_fma_f32 v[230:231], v[230:231], v[158:159], v[158:159] op_sel:[0,1,1]
v_pk_fma_f32 v[232:233], v[232:233], v[158:159], v[158:159] op_sel:[0,1,1]
v_pk_fma_f32 v[234:235], v[234:235], v[158:159], v[158:159] op_sel:[0,1,1]
v_pk_fma_f32 v[236:237], v[236:237], v[158:159], v[158:159] op_sel:[0,1,1]
v_pk_fma_f32 v[238:239], v[238:239], v[158:159], v[158:159] op_sel:[0,1,1]
v_pk_fma_f32 v[240:241], v[240:241], v[158:159], v[158:159] op_sel:[0,1,1]
v_rcp_f32 v230, v230
v_rcp_f32 v231, v231
v_rcp_f32 v232, v232
v_rcp_f32 v233, v233
v_rcp_f32 v234, v234
v_rcp_f32 v235, v235
v_rcp_f32 v236, v236
v_rcp_f32 v237, v237
v_rcp_f32 v238, v238
v_rcp_f32 v239, v239
v_rcp_f32 v240, v240
v_rcp_f32 v241, v241
v_pk_mul_f32 v[12:13], v[12:13], v[230:231]
v_pk_mul_f32 v[14:15], v[14:15], v[232:233]
v_pk_mul_f32 v[28:29], v[28:29], v[234:235]
v_pk_mul_f32 v[30:31], v[30:31], v[236:237]
v_pk_mul_f32 v[44:45], v[44:45], v[238:239]
v_pk_mul_f32 v[46:47], v[46:47], v[240:241]
v_pk_fma_f32 v[60:61], v[156:157], v[172:173], v[60:61] op_sel_hi:[0,1,1] neg_lo:[1,0,0] neg_hi:[1,0,0]
v_pk_fma_f32 v[62:63], v[156:157], v[174:175], v[62:63] op_sel_hi:[0,1,1] neg_lo:[1,0,0] neg_hi:[1,0,0]
v_pk_fma_f32 v[76:77], v[156:157], v[176:177], v[76:77] op_sel_hi:[0,1,1] neg_lo:[1,0,0] neg_hi:[1,0,0]
v_pk_fma_f32 v[78:79], v[156:157], v[178:179], v[78:79] op_sel_hi:[0,1,1] neg_lo:[1,0,0] neg_hi:[1,0,0]
v_pk_fma_f32 v[92:93], v[156:157], v[180:181], v[92:93] op_sel_hi:[0,1,1] neg_lo:[1,0,0] neg_hi:[1,0,0]
v_pk_fma_f32 v[94:95], v[156:157], v[182:183], v[94:95] op_sel_hi:[0,1,1] neg_lo:[1,0,0] neg_hi:[1,0,0]
v_pk_mul_f32 v[230:231], v[60:61], v[60:61]
v_pk_mul_f32 v[232:233], v[62:63], v[62:63]
v_pk_mul_f32 v[234:235], v[76:77], v[76:77]
v_pk_mul_f32 v[236:237], v[78:79], v[78:79]
v_pk_mul_f32 v[238:239], v[92:93], v[92:93]
v_pk_mul_f32 v[240:241], v[94:95], v[94:95]
v_pk_fma_f32 v[230:231], v[230:231], v[158:159], v[156:157] op_sel:[0,0,1] op_sel_hi:[1,0,1]
v_pk_fma_f32 v[232:233], v[232:233], v[158:159], v[156:157] op_sel:[0,0,1] op_sel_hi:[1,0,1]
v_pk_fma_f32 v[234:235], v[234:235], v[158:159], v[156:157] op_sel:[0,0,1] op_sel_hi:[1,0,1]
v_pk_fma_f32 v[236:237], v[236:237], v[158:159], v[156:157] op_sel:[0,0,1] op_sel_hi:[1,0,1]
v_pk_fma_f32 v[238:239], v[238:239], v[158:159], v[156:157] op_sel:[0,0,1] op_sel_hi:[1,0,1]
v_pk_fma_f32 v[240:241], v[240:241], v[158:159], v[156:157] op_sel:[0,0,1] op_sel_hi:[1,0,1]
v_pk_mul_f32 v[230:231], v[60:61], v[230:231]
v_pk_mul_f32 v[232:233], v[62:63], v[232:233]
v_pk_mul_f32 v[234:235], v[76:77], v[234:235]
v_pk_mul_f32 v[236:237], v[78:79], v[236:237]
v_pk_mul_f32 v[238:239], v[92:93], v[238:239]
v_pk_mul_f32 v[240:241], v[94:95], v[240:241]
v_exp_f32 v230, v230
v_exp_f32 v231, v231
v_exp_f32 v232, v232
v_exp_f32 v233, v233
v_exp_f32 v234, v234
v_exp_f32 v235, v235
v_exp_f32 v236, v236
v_exp_f32 v237, v237
v_exp_f32 v238, v238
v_exp_f32 v239, v239
v_exp_f32 v240, v240
v_exp_f32 v241, v241
v_pk_fma_f32 v[230:231], v[230:231], v[158:159], v[158:159] op_sel:[0,1,1]
v_pk_fma_f32 v[232:233], v[232:233], v[158:159], v[158:159] op_sel:[0,1,1]
v_pk_fma_f32 v[234:235], v[234:235], v[158:159], v[158:159] op_sel:[0,1,1]
v_pk_fma_f32 v[236:237], v[236:237], v[158:159], v[158:159] op_sel:[0,1,1]
v_pk_fma_f32 v[238:239], v[238:239], v[158:159], v[158:159] op_sel:[0,1,1]
v_pk_fma_f32 v[240:241], v[240:241], v[158:159], v[158:159] op_sel:[0,1,1]
v_rcp_f32 v230, v230
v_rcp_f32 v231, v231
v_rcp_f32 v232, v232
v_rcp_f32 v233, v233
v_rcp_f32 v234, v234
v_rcp_f32 v235, v235
v_rcp_f32 v236, v236
v_rcp_f32 v237, v237
v_rcp_f32 v238, v238
v_rcp_f32 v239, v239
v_rcp_f32 v240, v240
v_rcp_f32 v241, v241
v_pk_mul_f32 v[60:61], v[60:61], v[230:231]
v_pk_mul_f32 v[62:63], v[62:63], v[232:233]
v_pk_mul_f32 v[76:77], v[76:77], v[234:235]
v_pk_mul_f32 v[78:79], v[78:79], v[236:237]
v_pk_mul_f32 v[92:93], v[92:93], v[238:239]
v_pk_mul_f32 v[94:95], v[94:95], v[240:241]
v_pk_fma_f32 v[108:109], v[156:157], v[184:185], v[108:109] op_sel_hi:[0,1,1] neg_lo:[1,0,0] neg_hi:[1,0,0]
v_pk_fma_f32 v[110:111], v[156:157], v[186:187], v[110:111] op_sel_hi:[0,1,1] neg_lo:[1,0,0] neg_hi:[1,0,0]
v_pk_fma_f32 v[124:125], v[156:157], v[188:189], v[124:125] op_sel_hi:[0,1,1] neg_lo:[1,0,0] neg_hi:[1,0,0]
v_pk_fma_f32 v[126:127], v[156:157], v[190:191], v[126:127] op_sel_hi:[0,1,1] neg_lo:[1,0,0] neg_hi:[1,0,0]
v_pk_fma_f32 v[140:141], v[156:157], v[192:193], v[140:141] op_sel_hi:[0,1,1] neg_lo:[1,0,0] neg_hi:[1,0,0]
v_pk_fma_f32 v[142:143], v[156:157], v[194:195], v[142:143] op_sel_hi:[0,1,1] neg_lo:[1,0,0] neg_hi:[1,0,0]
v_pk_mul_f32 v[230:231], v[108:109], v[108:109]
v_pk_mul_f32 v[232:233], v[110:111], v[110:111]
v_pk_mul_f32 v[234:235], v[124:125], v[124:125]
v_pk_mul_f32 v[236:237], v[126:127], v[126:127]
v_pk_mul_f32 v[238:239], v[140:141], v[140:141]
v_pk_mul_f32 v[240:241], v[142:143], v[142:143]
v_pk_fma_f32 v[230:231], v[230:231], v[158:159], v[156:157] op_sel:[0,0,1] op_sel_hi:[1,0,1]
v_pk_fma_f32 v[232:233], v[232:233], v[158:159], v[156:157] op_sel:[0,0,1] op_sel_hi:[1,0,1]
v_pk_fma_f32 v[234:235], v[234:235], v[158:159], v[156:157] op_sel:[0,0,1] op_sel_hi:[1,0,1]
v_pk_fma_f32 v[236:237], v[236:237], v[158:159], v[156:157] op_sel:[0,0,1] op_sel_hi:[1,0,1]
v_pk_fma_f32 v[238:239], v[238:239], v[158:159], v[156:157] op_sel:[0,0,1] op_sel_hi:[1,0,1]
v_pk_fma_f32 v[240:241], v[240:241], v[158:159], v[156:157] op_sel:[0,0,1] op_sel_hi:[1,0,1]
v_pk_mul_f32 v[230:231], v[108:109], v[230:231]
v_pk_mul_f32 v[232:233], v[110:111], v[232:233]
v_pk_mul_f32 v[234:235], v[124:125], v[234:235]
v_pk_mul_f32 v[236:237], v[126:127], v[236:237]
v_pk_mul_f32 v[238:239], v[140:141], v[238:239]
v_pk_mul_f32 v[240:241], v[142:143], v[240:241]
v_exp_f32 v230, v230
v_exp_f32 v231, v231
v_exp_f32 v232, v232
v_exp_f32 v233, v233
v_exp_f32 v234, v234
v_exp_f32 v235, v235
v_exp_f32 v236, v236
v_exp_f32 v237, v237
v_exp_f32 v238, v238
v_exp_f32 v239, v239
v_exp_f32 v240, v240
v_exp_f32 v241, v241
v_pk_fma_f32 v[230:231], v[230:231], v[158:159], v[158:159] op_sel:[0,1,1]
v_pk_fma_f32 v[232:233], v[232:233], v[158:159], v[158:159] op_sel:[0,1,1]
v_pk_fma_f32 v[234:235], v[234:235], v[158:159], v[158:159] op_sel:[0,1,1]
v_pk_fma_f32 v[236:237], v[236:237], v[158:159], v[158:159] op_sel:[0,1,1]
v_pk_fma_f32 v[238:239], v[238:239], v[158:159], v[158:159] op_sel:[0,1,1]
v_pk_fma_f32 v[240:241], v[240:241], v[158:159], v[158:159] op_sel:[0,1,1]
v_rcp_f32 v230, v230
v_rcp_f32 v231, v231
v_rcp_f32 v232, v232
v_rcp_f32 v233, v233
v_rcp_f32 v234, v234
v_rcp_f32 v235, v235
v_rcp_f32 v236, v236
v_rcp_f32 v237, v237
v_rcp_f32 v238, v238
v_rcp_f32 v239, v239
v_rcp_f32 v240, v240
v_rcp_f32 v241, v241
v_pk_mul_f32 v[108:109], v[108:109], v[230:231]
v_pk_mul_f32 v[110:111], v[110:111], v[232:233]
v_pk_mul_f32 v[124:125], v[124:125], v[234:235]
v_pk_mul_f32 v[126:127], v[126:127], v[236:237]
v_pk_mul_f32 v[140:141], v[140:141], v[238:239]
v_pk_mul_f32 v[142:143], v[142:143], v[240:241]
s_and_b32 s61, s43, 1
s_cmp_lg_u32 s61, 0
s_cbranch_scc1 K3_h3odd
v_cvt_pk_bf16_f32 v230, v0, v1
v_cvt_pk_bf16_f32 v231, v2, v3
v_cvt_pk_bf16_f32 v232, v16, v17
v_cvt_pk_bf16_f32 v233, v18, v19
v_cvt_pk_bf16_f32 v234, v32, v33
v_cvt_pk_bf16_f32 v235, v34, v35
v_cvt_pk_bf16_f32 v236, v48, v49
v_cvt_pk_bf16_f32 v237, v50, v51
v_accvgpr_write_b32 a192, v230
v_accvgpr_write_b32 a193, v231
v_accvgpr_write_b32 a194, v232
v_accvgpr_write_b32 a195, v233
v_accvgpr_write_b32 a196, v234
v_accvgpr_write_b32 a197, v235
v_accvgpr_write_b32 a198, v236
v_accvgpr_write_b32 a199, v237
v_cvt_pk_bf16_f32 v238, v64, v65
v_cvt_pk_bf16_f32 v239, v66, v67
v_cvt_pk_bf16_f32 v240, v80, v81
v_cvt_pk_bf16_f32 v241, v82, v83
v_cvt_pk_bf16_f32 v230, v96, v97
v_cvt_pk_bf16_f32 v231, v98, v99
v_cvt_pk_bf16_f32 v232, v112, v113
v_cvt_pk_bf16_f32 v233, v114, v115
v_accvgpr_write_b32 a200, v238
v_accvgpr_write_b32 a201, v239
v_accvgpr_write_b32 a202, v240
v_accvgpr_write_b32 a203, v241
v_accvgpr_write_b32 a204, v230
v_accvgpr_write_b32 a205, v231
v_accvgpr_write_b32 a206, v232
v_accvgpr_write_b32 a207, v233
v_cvt_pk_bf16_f32 v242, v128, v129
v_cvt_pk_bf16_f32 v243, v130, v131
v_accvgpr_write_b32 a100, v242
v_accvgpr_write_b32 a101, v243
v_cvt_pk_bf16_f32 v230, v4, v5
v_cvt_pk_bf16_f32 v231, v6, v7
v_cvt_pk_bf16_f32 v232, v20, v21
v_cvt_pk_bf16_f32 v233, v22, v23
v_cvt_pk_bf16_f32 v234, v36, v37
v_cvt_pk_bf16_f32 v235, v38, v39
v_cvt_pk_bf16_f32 v236, v52, v53
v_cvt_pk_bf16_f32 v237, v54, v55
v_accvgpr_write_b32 a208, v230
v_accvgpr_write_b32 a209, v231
v_accvgpr_write_b32 a210, v232
v_accvgpr_write_b32 a211, v233
v_accvgpr_write_b32 a212, v234
v_accvgpr_write_b32 a213, v235
v_accvgpr_write_b32 a214, v236
v_accvgpr_write_b32 a215, v237
v_cvt_pk_bf16_f32 v238, v68, v69
v_cvt_pk_bf16_f32 v239, v70, v71
v_cvt_pk_bf16_f32 v240, v84, v85
v_cvt_pk_bf16_f32 v241, v86, v87
v_cvt_pk_bf16_f32 v230, v100, v101
v_cvt_pk_bf16_f32 v231, v102, v103
v_cvt_pk_bf16_f32 v232, v116, v117
v_cvt_pk_bf16_f32 v233, v118, v119
v_accvgpr_write_b32 a216, v238
v_accvgpr_write_b32 a217, v239
v_accvgpr_write_b32 a218, v240
v_accvgpr_write_b32 a219, v241
v_accvgpr_write_b32 a220, v230
v_accvgpr_write_b32 a221, v231
v_accvgpr_write_b32 a222, v232
v_accvgpr_write_b32 a223, v233
v_cvt_pk_bf16_f32 v242, v132, v133
v_cvt_pk_bf16_f32 v243, v134, v135
v_accvgpr_write_b32 a102, v242
v_accvgpr_write_b32 a103, v243
v_cvt_pk_bf16_f32 v230, v8, v9
v_cvt_pk_bf16_f32 v231, v10, v11
v_cvt_pk_bf16_f32 v232, v24, v25
v_cvt_pk_bf16_f32 v233, v26, v27
v_cvt_pk_bf16_f32 v234, v40, v41
v_cvt_pk_bf16_f32 v235, v42, v43
v_cvt_pk_bf16_f32 v236, v56, v57
v_cvt_pk_bf16_f32 v237, v58, v59
v_accvgpr_write_b32 a224, v230
v_accvgpr_write_b32 a225, v231
v_accvgpr_write_b32 a226, v232
v_accvgpr_write_b32 a227, v233
v_accvgpr_write_b32 a228, v234
v_accvgpr_write_b32 a229, v235
v_accvgpr_write_b32 a230, v236
v_accvgpr_write_b32 a231, v237
v_cvt_pk_bf16_f32 v238, v72, v73
v_cvt_pk_bf16_f32 v239, v74, v75
v_cvt_pk_bf16_f32 v240, v88, v89
v_cvt_pk_bf16_f32 v241, v90, v91
v_cvt_pk_bf16_f32 v230, v104, v105
v_cvt_pk_bf16_f32 v231, v106, v107
v_cvt_pk_bf16_f32 v232, v120, v121
v_cvt_pk_bf16_f32 v233, v122, v123
v_accvgpr_write_b32 a232, v238
v_accvgpr_write_b32 a233, v239
v_accvgpr_write_b32 a234, v240
v_accvgpr_write_b32 a235, v241
v_accvgpr_write_b32 a236, v230
v_accvgpr_write_b32 a237, v231
v_accvgpr_write_b32 a238, v232
v_accvgpr_write_b32 a239, v233
v_cvt_pk_bf16_f32 v242, v136, v137
v_cvt_pk_bf16_f32 v243, v138, v139
v_accvgpr_write_b32 a104, v242
v_accvgpr_write_b32 a105, v243
v_cvt_pk_bf16_f32 v230, v12, v13
v_cvt_pk_bf16_f32 v231, v14, v15
v_cvt_pk_bf16_f32 v232, v28, v29
v_cvt_pk_bf16_f32 v233, v30, v31
v_cvt_pk_bf16_f32 v234, v44, v45
v_cvt_pk_bf16_f32 v235, v46, v47
v_cvt_pk_bf16_f32 v236, v60, v61
v_cvt_pk_bf16_f32 v237, v62, v63
v_accvgpr_write_b32 a240, v230
v_accvgpr_write_b32 a241, v231
v_accvgpr_write_b32 a242, v232
v_accvgpr_write_b32 a243, v233
v_accvgpr_write_b32 a244, v234
v_accvgpr_write_b32 a245, v235
v_accvgpr_write_b32 a246, v236
v_accvgpr_write_b32 a247, v237
v_cvt_pk_bf16_f32 v238, v76, v77
v_cvt_pk_bf16_f32 v239, v78, v79
v_cvt_pk_bf16_f32 v240, v92, v93
v_cvt_pk_bf16_f32 v241, v94, v95
v_cvt_pk_bf16_f32 v230, v108, v109
v_cvt_pk_bf16_f32 v231, v110, v111
v_cvt_pk_bf16_f32 v232, v124, v125
v_cvt_pk_bf16_f32 v233, v126, v127
v_accvgpr_write_b32 a248, v238
v_accvgpr_write_b32 a249, v239
v_accvgpr_write_b32 a250, v240
v_accvgpr_write_b32 a251, v241
v_accvgpr_write_b32 a252, v230
v_accvgpr_write_b32 a253, v231
v_accvgpr_write_b32 a254, v232
v_accvgpr_write_b32 a255, v233
v_cvt_pk_bf16_f32 v242, v140, v141
v_cvt_pk_bf16_f32 v243, v142, v143
v_accvgpr_write_b32 a106, v242
v_accvgpr_write_b32 a107, v243
s_branch K3_h3done
K3_h3odd:
v_cvt_pk_bf16_f32 v230, v16, v17
v_cvt_pk_bf16_f32 v231, v18, v19
v_cvt_pk_bf16_f32 v232, v32, v33
v_cvt_pk_bf16_f32 v233, v34, v35
v_cvt_pk_bf16_f32 v234, v48, v49
v_cvt_pk_bf16_f32 v235, v50, v51
v_cvt_pk_bf16_f32 v236, v64, v65
v_cvt_pk_bf16_f32 v237, v66, v67
v_accvgpr_write_b32 a192, v230
v_accvgpr_write_b32 a193, v231
v_accvgpr_write_b32 a194, v232
v_accvgpr_write_b32 a195, v233
v_accvgpr_write_b32 a196, v234
v_accvgpr_write_b32 a197, v235
v_accvgpr_write_b32 a198, v236
v_accvgpr_write_b32 a199, v237
v_cvt_pk_bf16_f32 v238, v80, v81
v_cvt_pk_bf16_f32 v239, v82, v83
v_cvt_pk_bf16_f32 v240, v96, v97
v_cvt_pk_bf16_f32 v241, v98, v99
v_cvt_pk_bf16_f32 v230, v112, v113
v_cvt_pk_bf16_f32 v231, v114, v115
v_cvt_pk_bf16_f32 v232, v128, v129
v_cvt_pk_bf16_f32 v233, v130, v131
v_accvgpr_write_b32 a200, v238
v_accvgpr_write_b32 a201, v239
v_accvgpr_write_b32 a202, v240
v_accvgpr_write_b32 a203, v241
v_accvgpr_write_b32 a204, v230
v_accvgpr_write_b32 a205, v231
v_accvgpr_write_b32 a206, v232
v_accvgpr_write_b32 a207, v233
v_cvt_pk_bf16_f32 v242, v0, v1
v_cvt_pk_bf16_f32 v243, v2, v3
v_accvgpr_write_b32 a100, v242
v_accvgpr_write_b32 a101, v243
v_cvt_pk_bf16_f32 v230, v20, v21
v_cvt_pk_bf16_f32 v231, v22, v23
v_cvt_pk_bf16_f32 v232, v36, v37
v_cvt_pk_bf16_f32 v233, v38, v39
v_cvt_pk_bf16_f32 v234, v52, v53
v_cvt_pk_bf16_f32 v235, v54, v55
v_cvt_pk_bf16_f32 v236, v68, v69
v_cvt_pk_bf16_f32 v237, v70, v71
v_accvgpr_write_b32 a208, v230
v_accvgpr_write_b32 a209, v231
v_accvgpr_write_b32 a210, v232
v_accvgpr_write_b32 a211, v233
v_accvgpr_write_b32 a212, v234
v_accvgpr_write_b32 a213, v235
v_accvgpr_write_b32 a214, v236
v_accvgpr_write_b32 a215, v237
v_cvt_pk_bf16_f32 v238, v84, v85
v_cvt_pk_bf16_f32 v239, v86, v87
v_cvt_pk_bf16_f32 v240, v100, v101
v_cvt_pk_bf16_f32 v241, v102, v103
v_cvt_pk_bf16_f32 v230, v116, v117
v_cvt_pk_bf16_f32 v231, v118, v119
v_cvt_pk_bf16_f32 v232, v132, v133
v_cvt_pk_bf16_f32 v233, v134, v135
v_accvgpr_write_b32 a216, v238
v_accvgpr_write_b32 a217, v239
v_accvgpr_write_b32 a218, v240
v_accvgpr_write_b32 a219, v241
v_accvgpr_write_b32 a220, v230
v_accvgpr_write_b32 a221, v231
v_accvgpr_write_b32 a222, v232
v_accvgpr_write_b32 a223, v233
v_cvt_pk_bf16_f32 v242, v4, v5
v_cvt_pk_bf16_f32 v243, v6, v7
v_accvgpr_write_b32 a102, v242
v_accvgpr_write_b32 a103, v243
v_cvt_pk_bf16_f32 v230, v24, v25
v_cvt_pk_bf16_f32 v231, v26, v27
v_cvt_pk_bf16_f32 v232, v40, v41
v_cvt_pk_bf16_f32 v233, v42, v43
v_cvt_pk_bf16_f32 v234, v56, v57
v_cvt_pk_bf16_f32 v235, v58, v59
v_cvt_pk_bf16_f32 v236, v72, v73
v_cvt_pk_bf16_f32 v237, v74, v75
v_accvgpr_write_b32 a224, v230
v_accvgpr_write_b32 a225, v231
v_accvgpr_write_b32 a226, v232
v_accvgpr_write_b32 a227, v233
v_accvgpr_write_b32 a228, v234
v_accvgpr_write_b32 a229, v235
v_accvgpr_write_b32 a230, v236
v_accvgpr_write_b32 a231, v237
v_cvt_pk_bf16_f32 v238, v88, v89
v_cvt_pk_bf16_f32 v239, v90, v91
v_cvt_pk_bf16_f32 v240, v104, v105
v_cvt_pk_bf16_f32 v241, v106, v107
v_cvt_pk_bf16_f32 v230, v120, v121
v_cvt_pk_bf16_f32 v231, v122, v123
v_cvt_pk_bf16_f32 v232, v136, v137
v_cvt_pk_bf16_f32 v233, v138, v139
v_accvgpr_write_b32 a232, v238
v_accvgpr_write_b32 a233, v239
v_accvgpr_write_b32 a234, v240
v_accvgpr_write_b32 a235, v241
v_accvgpr_write_b32 a236, v230
v_accvgpr_write_b32 a237, v231
v_accvgpr_write_b32 a238, v232
v_accvgpr_write_b32 a239, v233
v_cvt_pk_bf16_f32 v242, v8, v9
v_cvt_pk_bf16_f32 v243, v10, v11
v_accvgpr_write_b32 a104, v242
v_accvgpr_write_b32 a105, v243
v_cvt_pk_bf16_f32 v230, v28, v29
v_cvt_pk_bf16_f32 v231, v30, v31
v_cvt_pk_bf16_f32 v232, v44, v45
v_cvt_pk_bf16_f32 v233, v46, v47
v_cvt_pk_bf16_f32 v234, v60, v61
v_cvt_pk_bf16_f32 v235, v62, v63
v_cvt_pk_bf16_f32 v236, v76, v77
v_cvt_pk_bf16_f32 v237, v78, v79
v_accvgpr_write_b32 a240, v230
v_accvgpr_write_b32 a241, v231
v_accvgpr_write_b32 a242, v232
v_accvgpr_write_b32 a243, v233
v_accvgpr_write_b32 a244, v234
v_accvgpr_write_b32 a245, v235
v_accvgpr_write_b32 a246, v236
v_accvgpr_write_b32 a247, v237
v_cvt_pk_bf16_f32 v238, v92, v93
v_cvt_pk_bf16_f32 v239, v94, v95
v_cvt_pk_bf16_f32 v240, v108, v109
v_cvt_pk_bf16_f32 v241, v110, v111
v_cvt_pk_bf16_f32 v230, v124, v125
v_cvt_pk_bf16_f32 v231, v126, v127
v_cvt_pk_bf16_f32 v232, v140, v141
v_cvt_pk_bf16_f32 v233, v142, v143
v_accvgpr_write_b32 a248, v238
v_accvgpr_write_b32 a249, v239
v_accvgpr_write_b32 a250, v240
v_accvgpr_write_b32 a251, v241
v_accvgpr_write_b32 a252, v230
v_accvgpr_write_b32 a253, v231
v_accvgpr_write_b32 a254, v232
v_accvgpr_write_b32 a255, v233
v_cvt_pk_bf16_f32 v242, v12, v13
v_cvt_pk_bf16_f32 v243, v14, v15
v_accvgpr_write_b32 a106, v242
v_accvgpr_write_b32 a107, v243
K3_h3done:
s_nop 0
v_and_b32 v252, 1, v253
v_lshlrev_b32 v252, 1, v252
v_lshrrev_b32 v251, 1, v253
v_or_b32 v252, v252, v251
v_add_u32 v251, 0, v252
v_xor_b32 v251, v251, v254
v_lshlrev_b32 v251, 4, v251
v_lshl_add_u32 v64, v254, 8, v251
v_add_u32 v68, 0x10000, v64
v_add_u32 v251, 4, v252
v_xor_b32 v251, v251, v254
v_lshlrev_b32 v251, 4, v251
v_lshl_add_u32 v65, v254, 8, v251
v_add_u32 v69, 0x10000, v65
v_add_u32 v251, 8, v252
v_xor_b32 v251, v251, v254
v_lshlrev_b32 v251, 4, v251
v_lshl_add_u32 v66, v254, 8, v251
v_add_u32 v70, 0x10000, v66
v_add_u32 v251, 12, v252
v_xor_b32 v251, v251, v254
v_lshlrev_b32 v251, 4, v251
v_lshl_add_u32 v67, v254, 8, v251
v_add_u32 v71, 0x10000, v67
v_lshrrev_b32 v252, 2, v254
v_lshl_add_u32 v252, v253, 2, v252
v_and_b32 v251, 7, v252
v_xor_b32 v251, 0, v251
v_lshlrev_b32 v251, 5, v251
v_lshl_add_u32 v251, v252, 8, v251
v_and_b32 v250, 3, v254
v_lshl_add_u32 v251, v250, 3, v251
v_add_u32 v72, 16384, v251
v_add_u32 v80, 0x14000, v251
v_and_b32 v251, 7, v252
v_xor_b32 v251, 1, v251
v_lshlrev_b32 v251, 5, v251
v_lshl_add_u32 v251, v252, 8, v251
v_and_b32 v250, 3, v254
v_lshl_add_u32 v251, v250, 3, v251
v_add_u32 v73, 16384, v251
v_add_u32 v81, 0x14000, v251
v_and_b32 v251, 7, v252
v_xor_b32 v251, 2, v251
v_lshlrev_b32 v251, 5, v251
v_lshl_add_u32 v251, v252, 8, v251
v_and_b32 v250, 3, v254
v_lshl_add_u32 v251, v250, 3, v251
v_add_u32 v74, 16384, v251
v_add_u32 v82, 0x14000, v251
v_and_b32 v251, 7, v252
v_xor_b32 v251, 3, v251
v_lshlrev_b32 v251, 5, v251
v_lshl_add_u32 v251, v252, 8, v251
v_and_b32 v250, 3, v254
v_lshl_add_u32 v251, v250, 3, v251
v_add_u32 v75, 16384, v251
v_add_u32 v83, 0x14000, v251
v_and_b32 v251, 7, v252
v_xor_b32 v251, 4, v251
v_lshlrev_b32 v251, 5, v251
v_lshl_add_u32 v251, v252, 8, v251
v_and_b32 v250, 3, v254
v_lshl_add_u32 v251, v250, 3, v251
v_add_u32 v76, 16384, v251
v_add_u32 v84, 0x14000, v251
v_and_b32 v251, 7, v252
v_xor_b32 v251, 5, v251
v_lshlrev_b32 v251, 5, v251
v_lshl_add_u32 v251, v252, 8, v251
v_and_b32 v250, 3, v254
v_lshl_add_u32 v251, v250, 3, v251
v_add_u32 v77, 16384, v251
v_add_u32 v85, 0x14000, v251
v_and_b32 v251, 7, v252
v_xor_b32 v251, 6, v251
v_lshlrev_b32 v251, 5, v251
v_lshl_add_u32 v251, v252, 8, v251
v_and_b32 v250, 3, v254
v_lshl_add_u32 v251, v250, 3, v251
v_add_u32 v78, 16384, v251
v_add_u32 v86, 0x14000, v251
v_and_b32 v251, 7, v252
v_xor_b32 v251, 7, v251
v_lshlrev_b32 v251, 5, v251
v_lshl_add_u32 v251, v252, 8, v251
v_and_b32 v250, 3, v254
v_lshl_add_u32 v251, v250, 3, v251
v_add_u32 v79, 16384, v251
v_add_u32 v87, 0x14000, v251
v_mov_b32 v252, 0x3f803f80
v_mov_b32 v251, 0
v_cmp_eq_u32 vcc, 0, v254
s_nop 1
v_cndmask_b32 v252, v251, v252
v_accvgpr_write_b32 a96, v252
v_accvgpr_write_b32 a97, v252
v_accvgpr_write_b32 a98, v252
v_accvgpr_write_b32 a99, v252
s_waitcnt vmcnt(8)
s_barrier
ds_read_b128 a[0:3], v68
ds_read_b128 a[4:7], v69
ds_read_b128 a[8:11], v70
ds_read_b128 a[12:15], v71
ds_read_b128 a[16:19], v68 offset:4096
ds_read_b128 a[20:23], v69 offset:4096
ds_read_b128 a[24:27], v70 offset:4096
ds_read_b128 a[28:31], v71 offset:4096
s_waitcnt lgkmcnt(0)
s_lshl_b32 s56, s2, 2
s_add_u32 s56, s56, s40
s_mov_b32 s76, s62
s_mov_b32 s77, s63
s_mov_b32 s78, 0x480000
s_mov_b32 s79, 0x20000
s_mov_b32 s96, s100
s_mov_b32 s97, s101
s_mov_b32 s98, 0x510000
s_mov_b32 s99, 0x20000
s_mul_i32 s45, s56, 4608
s_mul_i32 s46, s56, 5248
v_lshlrev_b32 v252, 7, v255
v_mov_b32 v251, 0x70000000
v_cmp_gt_u32 vcc, 6, v255
s_nop 1
v_cndmask_b32 v92, v251, v252
v_cmp_gt_u32 vcc, 6, v255
s_nop 1
v_cndmask_b32 v94, v251, v252
s_lshr_b32 s58, s43, 3
s_lshl_b32 s57, s44, 2
s_add_u32 s58, s58, s57
s_add_u32 s58, s58, 88
s_lshl_b32 s58, s58, 7
s_lshl_b32 s60, s44, 4
s_lshl_b32 s61, s40, 2
s_add_u32 s60, s60, s61
s_mul_i32 s60, s60, 147456
s_mul_i32 s61, s43, 9
s_lshr_b32 s61, s61, 1
s_lshl_b32 s61, s61, 10
s_add_u32 s60, s60, s61
s_and_b32 s61, s43, 1
s_cmp_lg_u32 s61, 0
s_cselect_b32 s48, 8, 0x1000
s_add_u32 s48, s48, s60
s_lshl_b32 s61, s61, 10
s_add_u32 s47, s60, s61
s_mov_b32 s49, 0
s_lshl_b32 s60, s41, 19
s_add_u32 s60, s60, s55
v_lshlrev_b32 v88, 4, v255
s_getpc_b64 s[4:5]
M_pc_c:
s_add_u32 s4, s4, M_last-M_pc_c
s_addc_u32 s5, s5, 0
s_mov_b32 s6, K3_end-M_last
s_mov_b32 s7, 0x20000
s_lshr_b32 s59, s2, 3
s_lshl_b32 s59, s59, 2
s_add_u32 s59, s59, s40
v_mov_b32 v251, s59
s_mov_b32 s59, (K3_end-M_last+16383)/16384
v_mul_lo_u32 v251, s59, v251
v_add_u32 v251, v251, v255
v_lshlrev_b32 v251, 7, v251
v_cmp_gt_u32 vcc, s59, v255
v_mov_b32 v250, 0x70000000
s_nop 0
v_cndmask_b32 v89, v250, v251
v_mfma_f32_16x16x32_bf16 v[0:3], a[0:3], a[128:131], 0
v_mfma_f32_16x16x32_bf16 v[0:3], a[4:7], a[132:135], v[0:3]
ds_read_b64_tr_b16 a[32:33], v80
v_mfma_f32_16x16x32_bf16 v[0:3], a[8:11], a[136:139], v[0:3]
s_waitcnt lgkmcnt(1)
v_mfma_f32_16x16x32_bf16 v[0:3], a[12:15], a[140:143], v[0:3]
ds_read_b64_tr_b16 a[34:35], v80 offset:4096
v_mfma_f32_16x16x32_bf16 v[4:7], a[16:19], a[128:131], 0
v_mfma_f32_16x16x32_bf16 v[4:7], a[20:23], a[132:135], v[4:7]
ds_read_b64_tr_b16 a[36:37], v81
v_mfma_f32_16x16x32_bf16 v[4:7], a[24:27], a[136:139], v[4:7]
v_mfma_f32_16x16x32_bf16 v[4:7], a[28:31], a[140:143], v[4:7]
ds_read_b64_tr_b16 a[38:39], v81 offset:4096
s_nop 1
s_nop 1
ds_read_b64_tr_b16 a[40:41], v82
s_nop 1
ds_read_b64_tr_b16 a[42:43], v82 offset:4096
s_nop 1
v_exp_f32 v0, v0
s_nop 1
ds_read_b64_tr_b16 a[44:45], v83
s_nop 1
v_exp_f32 v1, v1
s_nop 1
ds_read_b64_tr_b16 a[46:47], v83 offset:4096
v_cvt_pk_bf16_f32 v32, v0, v1
s_nop 1
v_exp_f32 v2, v2
s_nop 1
s_waitcnt lgkmcnt(4)
ds_read_b64_tr_b16 a[48:49], v84
v_mfma_f32_16x16x32_bf16 v[8:11], a[0:3], a[144:147], 0
v_exp_f32 v3, v3
v_mfma_f32_16x16x32_bf16 v[8:11], a[4:7], a[148:151], v[8:11]
ds_read_b64_tr_b16 a[50:51], v84 offset:4096
v_cvt_pk_bf16_f32 v33, v2, v3
v_mfma_f32_16x16x32_bf16 v[8:11], a[8:11], a[152:155], v[8:11]
v_exp_f32 v4, v4
v_mfma_f32_16x16x32_bf16 v[8:11], a[12:15], a[156:159], v[8:11]
ds_read_b64_tr_b16 a[52:53], v85
v_mfma_f32_16x16x32_bf16 v[12:15], a[16:19], a[144:147], 0
v_exp_f32 v5, v5
v_mfma_f32_16x16x32_bf16 v[12:15], a[20:23], a[148:151], v[12:15]
ds_read_b64_tr_b16 a[54:55], v85 offset:4096
v_cvt_pk_bf16_f32 v34, v4, v5
v_mfma_f32_16x16x32_bf16 v[12:15], a[24:27], a[152:155], v[12:15]
v_exp_f32 v6, v6
v_mfma_f32_16x16x32_bf16 v[12:15], a[28:31], a[156:159], v[12:15]
ds_read_b64_tr_b16 a[56:57], v86
s_nop 1
v_exp_f32 v7, v7
s_nop 1
ds_read_b64_tr_b16 a[58:59], v86 offset:4096
v_cvt_pk_bf16_f32 v35, v6, v7
s_nop 1
ds_read_b64_tr_b16 a[60:61], v87
s_nop 1
v_exp_f32 v8, v8
s_nop 1
ds_read_b64_tr_b16 a[62:63], v87 offset:4096
s_nop 1
v_exp_f32 v9, v9
s_nop 1
v_cvt_pk_bf16_f32 v36, v8, v9
s_nop 1
s_add_u32 m0, s55, 0x0
v_exp_f32 v10, v10
s_nop 1
buffer_load_dwordx4 v224, s[20:23], s51 offen lds
v_mfma_f32_16x16x32_bf16 v[16:19], a[0:3], a[160:163], 0
v_exp_f32 v11, v11
v_mfma_f32_16x16x32_bf16 v[16:19], a[4:7], a[164:167], v[16:19]
v_cvt_pk_bf16_f32 v37, v10, v11
v_mfma_f32_16x16x32_bf16 v[16:19], a[8:11], a[168:171], v[16:19]
v_exp_f32 v12, v12
v_mfma_f32_16x16x32_bf16 v[16:19], a[12:15], a[172:175], v[16:19]
buffer_load_dwordx4 v225, s[20:23], s51 offen offset:1024 lds
v_mfma_f32_16x16x32_bf16 v[20:23], a[16:19], a[160:163], 0
v_exp_f32 v13, v13
v_mfma_f32_16x16x32_bf16 v[20:23], a[20:23], a[164:167], v[20:23]
s_waitcnt lgkmcnt(0)
v_cvt_pk_bf16_f32 v38, v12, v13
v_mfma_f32_16x16x32_bf16 v[20:23], a[24:27], a[168:171], v[20:23]
v_exp_f32 v14, v14
v_mfma_f32_16x16x32_bf16 v[20:23], a[28:31], a[172:175], v[20:23]
buffer_load_dwordx4 v226, s[20:23], s51 offen offset:2048 lds
v_mfma_f32_16x16x32_bf16 v[96:99], a[32:35], v[32:35], 0
v_exp_f32 v15, v15
v_mfma_f32_16x16x32_bf16 v[100:103], a[36:39], v[32:35], 0
v_cvt_pk_bf16_f32 v39, v14, v15
v_mfma_f32_16x16x32_bf16 v[104:107], a[40:43], v[32:35], 0
buffer_store_dwordx4 a[192:195], v88, s[28:31], s47 offen sc1
v_mfma_f32_16x16x32_bf16 v[108:111], a[44:47], v[32:35], 0
v_exp_f32 v16, v16
v_mfma_f32_16x16x32_bf16 v[112:115], a[48:51], v[32:35], 0
buffer_load_dwordx4 v227, s[20:23], s51 offen offset:3072 lds
v_mfma_f32_16x16x32_bf16 v[116:119], a[52:55], v[32:35], 0
s_add_u32 s51, s51, 16384
v_exp_f32 v17, v17
v_mfma_f32_16x16x32_bf16 v[120:123], a[56:59], v[32:35], 0
v_cvt_pk_bf16_f32 v40, v16, v17
v_mfma_f32_16x16x32_bf16 v[124:127], a[60:63], v[32:35], 0
v_exp_f32 v18, v18
v_mfma_f32_16x16x32_bf16 v[48:51], a[96:99], v[32:35], 0
v_mfma_f32_16x16x32_bf16 v[24:27], a[0:3], a[176:179], 0
v_exp_f32 v19, v19
v_mfma_f32_16x16x32_bf16 v[24:27], a[4:7], a[180:183], v[24:27]
ds_read_b128 a[0:3], v68 offset:8192
v_cvt_pk_bf16_f32 v41, v18, v19
v_mfma_f32_16x16x32_bf16 v[24:27], a[8:11], a[184:187], v[24:27]
v_exp_f32 v20, v20
v_mfma_f32_16x16x32_bf16 v[24:27], a[12:15], a[188:191], v[24:27]
ds_read_b128 a[4:7], v69 offset:8192
v_mfma_f32_16x16x32_bf16 v[28:31], a[16:19], a[176:179], 0
v_exp_f32 v21, v21
v_mfma_f32_16x16x32_bf16 v[28:31], a[20:23], a[180:183], v[28:31]
ds_read_b128 a[8:11], v70 offset:8192
v_cvt_pk_bf16_f32 v42, v20, v21
v_mfma_f32_16x16x32_bf16 v[28:31], a[24:27], a[184:187], v[28:31]
v_exp_f32 v22, v22
v_mfma_f32_16x16x32_bf16 v[28:31], a[28:31], a[188:191], v[28:31]
ds_read_b128 a[12:15], v71 offset:8192
v_mfma_f32_16x16x32_bf16 v[128:131], a[32:35], v[36:39], 0
v_exp_f32 v23, v23
v_mfma_f32_16x16x32_bf16 v[132:135], a[36:39], v[36:39], 0
ds_read_b128 a[16:19], v68 offset:12288
v_cvt_pk_bf16_f32 v43, v22, v23
v_mfma_f32_16x16x32_bf16 v[136:139], a[40:43], v[36:39], 0
ds_read_b128 a[20:23], v69 offset:12288
v_mfma_f32_16x16x32_bf16 v[140:143], a[44:47], v[36:39], 0
v_exp_f32 v24, v24
v_mfma_f32_16x16x32_bf16 v[144:147], a[48:51], v[36:39], 0
ds_read_b128 a[24:27], v70 offset:12288
v_mfma_f32_16x16x32_bf16 v[148:151], a[52:55], v[36:39], 0
v_exp_f32 v25, v25
v_mfma_f32_16x16x32_bf16 v[152:155], a[56:59], v[36:39], 0
ds_read_b128 a[28:31], v71 offset:12288
v_cvt_pk_bf16_f32 v44, v24, v25
v_mfma_f32_16x16x32_bf16 v[156:159], a[60:63], v[36:39], 0
s_waitcnt lgkmcnt(3)
v_exp_f32 v26, v26
v_mfma_f32_16x16x32_bf16 v[52:55], a[96:99], v[36:39], 0
buffer_store_dwordx4 a[196:199], v88, s[28:31], s47 offen offset:1024 sc1
v_mfma_f32_16x16x32_bf16 v[0:3], a[0:3], a[128:131], 0
s_add_u32 s46, s46, 768
v_exp_f32 v27, v27
v_mfma_f32_16x16x32_bf16 v[0:3], a[4:7], a[132:135], v[0:3]
ds_read_b64_tr_b16 a[64:65], v80 offset:8192
v_cvt_pk_bf16_f32 v45, v26, v27
v_mfma_f32_16x16x32_bf16 v[0:3], a[8:11], a[136:139], v[0:3]
s_waitcnt lgkmcnt(1)
v_exp_f32 v28, v28
v_mfma_f32_16x16x32_bf16 v[0:3], a[12:15], a[140:143], v[0:3]
ds_read_b64_tr_b16 a[66:67], v80 offset:12288
v_mfma_f32_16x16x32_bf16 v[4:7], a[16:19], a[128:131], 0
v_exp_f32 v29, v29
v_mfma_f32_16x16x32_bf16 v[4:7], a[20:23], a[132:135], v[4:7]
ds_read_b64_tr_b16 a[68:69], v81 offset:8192
v_cvt_pk_bf16_f32 v46, v28, v29
v_mfma_f32_16x16x32_bf16 v[4:7], a[24:27], a[136:139], v[4:7]
v_exp_f32 v30, v30
v_mfma_f32_16x16x32_bf16 v[4:7], a[28:31], a[140:143], v[4:7]
ds_read_b64_tr_b16 a[70:71], v81 offset:12288
v_mfma_f32_16x16x32_bf16 v[160:163], a[32:35], v[40:43], 0
v_exp_f32 v31, v31
v_mfma_f32_16x16x32_bf16 v[164:167], a[36:39], v[40:43], 0
ds_read_b64_tr_b16 a[72:73], v82 offset:8192
v_cvt_pk_bf16_f32 v47, v30, v31
v_mfma_f32_16x16x32_bf16 v[168:171], a[40:43], v[40:43], 0
ds_read_b64_tr_b16 a[74:75], v82 offset:12288
v_mfma_f32_16x16x32_bf16 v[172:175], a[44:47], v[40:43], 0
v_exp_f32 v0, v0
v_mfma_f32_16x16x32_bf16 v[176:179], a[48:51], v[40:43], 0
ds_read_b64_tr_b16 a[76:77], v83 offset:8192
v_mfma_f32_16x16x32_bf16 v[180:183], a[52:55], v[40:43], 0
v_exp_f32 v1, v1
v_mfma_f32_16x16x32_bf16 v[184:187], a[56:59], v[40:43], 0
ds_read_b64_tr_b16 a[78:79], v83 offset:12288
v_cvt_pk_bf16_f32 v32, v0, v1
v_mfma_f32_16x16x32_bf16 v[188:191], a[60:63], v[40:43], 0
v_exp_f32 v2, v2
v_mfma_f32_16x16x32_bf16 v[56:59], a[96:99], v[40:43], 0
s_waitcnt lgkmcnt(4)
ds_read_b64_tr_b16 a[80:81], v84 offset:8192
v_mfma_f32_16x16x32_bf16 v[8:11], a[0:3], a[144:147], 0
v_exp_f32 v3, v3
v_mfma_f32_16x16x32_bf16 v[8:11], a[4:7], a[148:151], v[8:11]
ds_read_b64_tr_b16 a[82:83], v84 offset:12288
v_cvt_pk_bf16_f32 v33, v2, v3
v_mfma_f32_16x16x32_bf16 v[8:11], a[8:11], a[152:155], v[8:11]
v_exp_f32 v4, v4
v_mfma_f32_16x16x32_bf16 v[8:11], a[12:15], a[156:159], v[8:11]
ds_read_b64_tr_b16 a[84:85], v85 offset:8192
v_mfma_f32_16x16x32_bf16 v[12:15], a[16:19], a[144:147], 0
v_exp_f32 v5, v5
v_mfma_f32_16x16x32_bf16 v[12:15], a[20:23], a[148:151], v[12:15]
ds_read_b64_tr_b16 a[86:87], v85 offset:12288
v_cvt_pk_bf16_f32 v34, v4, v5
v_mfma_f32_16x16x32_bf16 v[12:15], a[24:27], a[152:155], v[12:15]
v_exp_f32 v6, v6
v_mfma_f32_16x16x32_bf16 v[12:15], a[28:31], a[156:159], v[12:15]
ds_read_b64_tr_b16 a[88:89], v86 offset:8192
v_mfma_f32_16x16x32_bf16 v[192:195], a[32:35], v[44:47], 0
v_exp_f32 v7, v7
v_mfma_f32_16x16x32_bf16 v[196:199], a[36:39], v[44:47], 0
ds_read_b64_tr_b16 a[90:91], v86 offset:12288
v_cvt_pk_bf16_f32 v35, v6, v7
v_mfma_f32_16x16x32_bf16 v[200:203], a[40:43], v[44:47], 0
ds_read_b64_tr_b16 a[92:93], v87 offset:8192
v_mfma_f32_16x16x32_bf16 v[204:207], a[44:47], v[44:47], 0
v_exp_f32 v8, v8
v_mfma_f32_16x16x32_bf16 v[208:211], a[48:51], v[44:47], 0
ds_read_b64_tr_b16 a[94:95], v87 offset:12288
v_mfma_f32_16x16x32_bf16 v[212:215], a[52:55], v[44:47], 0
v_exp_f32 v9, v9
v_mfma_f32_16x16x32_bf16 v[216:219], a[56:59], v[44:47], 0
v_cvt_pk_bf16_f32 v36, v8, v9
v_mfma_f32_16x16x32_bf16 v[220:223], a[60:63], v[44:47], 0
s_add_u32 m0, s55, 0x4000
v_exp_f32 v10, v10
v_mfma_f32_16x16x32_bf16 v[60:63], a[96:99], v[44:47], 0
buffer_load_dwordx4 v228, s[24:27], s52 offen lds
v_mfma_f32_16x16x32_bf16 v[16:19], a[0:3], a[160:163], 0
v_exp_f32 v11, v11
v_mfma_f32_16x16x32_bf16 v[16:19], a[4:7], a[164:167], v[16:19]
v_cvt_pk_bf16_f32 v37, v10, v11
v_mfma_f32_16x16x32_bf16 v[16:19], a[8:11], a[168:171], v[16:19]
v_exp_f32 v12, v12
v_mfma_f32_16x16x32_bf16 v[16:19], a[12:15], a[172:175], v[16:19]
buffer_load_dwordx4 v229, s[24:27], s52 offen offset:1024 lds
v_mfma_f32_16x16x32_bf16 v[20:23], a[16:19], a[160:163], 0
v_exp_f32 v13, v13
v_mfma_f32_16x16x32_bf16 v[20:23], a[20:23], a[164:167], v[20:23]
s_waitcnt lgkmcnt(0)
v_cvt_pk_bf16_f32 v38, v12, v13
v_mfma_f32_16x16x32_bf16 v[20:23], a[24:27], a[168:171], v[20:23]
v_exp_f32 v14, v14
v_mfma_f32_16x16x32_bf16 v[20:23], a[28:31], a[172:175], v[20:23]
buffer_load_dwordx4 v228, s[24:27], s52 offen offset:2048 lds
v_mfma_f32_16x16x32_bf16 v[96:99], a[64:67], v[32:35], v[96:99]
v_exp_f32 v15, v15
v_mfma_f32_16x16x32_bf16 v[100:103], a[68:71], v[32:35], v[100:103]
v_cvt_pk_bf16_f32 v39, v14, v15
v_mfma_f32_16x16x32_bf16 v[104:107], a[72:75], v[32:35], v[104:107]
buffer_store_dwordx4 a[200:203], v88, s[28:31], s47 offen offset:2048 sc1
v_mfma_f32_16x16x32_bf16 v[108:111], a[76:79], v[32:35], v[108:111]
v_exp_f32 v16, v16
v_mfma_f32_16x16x32_bf16 v[112:115], a[80:83], v[32:35], v[112:115]
buffer_load_dwordx4 v229, s[24:27], s52 offen offset:3072 lds
v_mfma_f32_16x16x32_bf16 v[116:119], a[84:87], v[32:35], v[116:119]
s_add_u32 s52, s52, 16384
v_exp_f32 v17, v17
v_mfma_f32_16x16x32_bf16 v[120:123], a[88:91], v[32:35], v[120:123]
v_cvt_pk_bf16_f32 v40, v16, v17
v_mfma_f32_16x16x32_bf16 v[124:127], a[92:95], v[32:35], v[124:127]
s_waitcnt vmcnt(11)
v_exp_f32 v18, v18
v_mfma_f32_16x16x32_bf16 v[48:51], a[96:99], v[32:35], v[48:51]
s_barrier
buffer_load_dword v93, v92, s[76:79], s45 offen
v_mfma_f32_16x16x32_bf16 v[24:27], a[0:3], a[176:179], 0
v_exp_f32 v19, v19
v_mfma_f32_16x16x32_bf16 v[24:27], a[4:7], a[180:183], v[24:27]
ds_read_b128 a[0:3], v68 offset:32768
v_cvt_pk_bf16_f32 v41, v18, v19
v_mfma_f32_16x16x32_bf16 v[24:27], a[8:11], a[184:187], v[24:27]
v_exp_f32 v20, v20
v_mfma_f32_16x16x32_bf16 v[24:27], a[12:15], a[188:191], v[24:27]
ds_read_b128 a[4:7], v69 offset:32768
v_mfma_f32_16x16x32_bf16 v[28:31], a[16:19], a[176:179], 0
v_exp_f32 v21, v21
v_mfma_f32_16x16x32_bf16 v[28:31], a[20:23], a[180:183], v[28:31]
ds_read_b128 a[8:11], v70 offset:32768
v_cvt_pk_bf16_f32 v42, v20, v21
v_mfma_f32_16x16x32_bf16 v[28:31], a[24:27], a[184:187], v[28:31]
v_exp_f32 v22, v22
v_mfma_f32_16x16x32_bf16 v[28:31], a[28:31], a[188:191], v[28:31]
ds_read_b128 a[12:15], v71 offset:32768
v_mfma_f32_16x16x32_bf16 v[128:131], a[64:67], v[36:39], v[128:131]
v_exp_f32 v23, v23
v_mfma_f32_16x16x32_bf16 v[132:135], a[68:71], v[36:39], v[132:135]
ds_read_b128 a[16:19], v68 offset:36864
v_cvt_pk_bf16_f32 v43, v22, v23
v_mfma_f32_16x16x32_bf16 v[136:139], a[72:75], v[36:39], v[136:139]
ds_read_b128 a[20:23], v69 offset:36864
v_mfma_f32_16x16x32_bf16 v[140:143], a[76:79], v[36:39], v[140:143]
v_exp_f32 v24, v24
v_mfma_f32_16x16x32_bf16 v[144:147], a[80:83], v[36:39], v[144:147]
ds_read_b128 a[24:27], v70 offset:36864
v_mfma_f32_16x16x32_bf16 v[148:151], a[84:87], v[36:39], v[148:151]
s_add_u32 s45, s45, 768
v_exp_f32 v25, v25
v_mfma_f32_16x16x32_bf16 v[152:155], a[88:91], v[36:39], v[152:155]
ds_read_b128 a[28:31], v71 offset:36864
v_cvt_pk_bf16_f32 v44, v24, v25
v_mfma_f32_16x16x32_bf16 v[156:159], a[92:95], v[36:39], v[156:159]
s_waitcnt lgkmcnt(3)
v_exp_f32 v26, v26
v_mfma_f32_16x16x32_bf16 v[52:55], a[96:99], v[36:39], v[52:55]
buffer_load_dword v95, v94, s[96:99], s46 offen
v_mfma_f32_16x16x32_bf16 v[0:3], a[0:3], a[128:131], 0
v_exp_f32 v27, v27
v_mfma_f32_16x16x32_bf16 v[0:3], a[4:7], a[132:135], v[0:3]
ds_read_b64_tr_b16 a[32:33], v80 offset:32768
v_cvt_pk_bf16_f32 v45, v26, v27
v_mfma_f32_16x16x32_bf16 v[0:3], a[8:11], a[136:139], v[0:3]
s_waitcnt lgkmcnt(1)
v_exp_f32 v28, v28
v_mfma_f32_16x16x32_bf16 v[0:3], a[12:15], a[140:143], v[0:3]
ds_read_b64_tr_b16 a[34:35], v80 offset:36864
v_mfma_f32_16x16x32_bf16 v[4:7], a[16:19], a[128:131], 0
v_exp_f32 v29, v29
v_mfma_f32_16x16x32_bf16 v[4:7], a[20:23], a[132:135], v[4:7]
ds_read_b64_tr_b16 a[36:37], v81 offset:32768
v_cvt_pk_bf16_f32 v46, v28, v29
v_mfma_f32_16x16x32_bf16 v[4:7], a[24:27], a[136:139], v[4:7]
v_exp_f32 v30, v30
v_mfma_f32_16x16x32_bf16 v[4:7], a[28:31], a[140:143], v[4:7]
ds_read_b64_tr_b16 a[38:39], v81 offset:36864
v_mfma_f32_16x16x32_bf16 v[160:163], a[64:67], v[40:43], v[160:163]
v_exp_f32 v31, v31
v_mfma_f32_16x16x32_bf16 v[164:167], a[68:71], v[40:43], v[164:167]
ds_read_b64_tr_b16 a[40:41], v82 offset:32768
v_cvt_pk_bf16_f32 v47, v30, v31
v_mfma_f32_16x16x32_bf16 v[168:171], a[72:75], v[40:43], v[168:171]
ds_read_b64_tr_b16 a[42:43], v82 offset:36864
v_mfma_f32_16x16x32_bf16 v[172:175], a[76:79], v[40:43], v[172:175]
v_exp_f32 v0, v0
v_mfma_f32_16x16x32_bf16 v[176:179], a[80:83], v[40:43], v[176:179]
ds_read_b64_tr_b16 a[44:45], v83 offset:32768
v_mfma_f32_16x16x32_bf16 v[180:183], a[84:87], v[40:43], v[180:183]
v_exp_f32 v1, v1
v_mfma_f32_16x16x32_bf16 v[184:187], a[88:91], v[40:43], v[184:187]
ds_read_b64_tr_b16 a[46:47], v83 offset:36864
v_cvt_pk_bf16_f32 v32, v0, v1
v_mfma_f32_16x16x32_bf16 v[188:191], a[92:95], v[40:43], v[188:191]
v_exp_f32 v2, v2
v_mfma_f32_16x16x32_bf16 v[56:59], a[96:99], v[40:43], v[56:59]
s_waitcnt lgkmcnt(4)
ds_read_b64_tr_b16 a[48:49], v84 offset:32768
v_mfma_f32_16x16x32_bf16 v[8:11], a[0:3], a[144:147], 0
v_exp_f32 v3, v3
v_mfma_f32_16x16x32_bf16 v[8:11], a[4:7], a[148:151], v[8:11]
ds_read_b64_tr_b16 a[50:51], v84 offset:36864
v_cvt_pk_bf16_f32 v33, v2, v3
v_mfma_f32_16x16x32_bf16 v[8:11], a[8:11], a[152:155], v[8:11]
v_exp_f32 v4, v4
v_mfma_f32_16x16x32_bf16 v[8:11], a[12:15], a[156:159], v[8:11]
ds_read_b64_tr_b16 a[52:53], v85 offset:32768
v_mfma_f32_16x16x32_bf16 v[12:15], a[16:19], a[144:147], 0
v_exp_f32 v5, v5
v_mfma_f32_16x16x32_bf16 v[12:15], a[20:23], a[148:151], v[12:15]
ds_read_b64_tr_b16 a[54:55], v85 offset:36864
v_cvt_pk_bf16_f32 v34, v4, v5
v_mfma_f32_16x16x32_bf16 v[12:15], a[24:27], a[152:155], v[12:15]
v_exp_f32 v6, v6
v_mfma_f32_16x16x32_bf16 v[12:15], a[28:31], a[156:159], v[12:15]
ds_read_b64_tr_b16 a[56:57], v86 offset:32768
v_mfma_f32_16x16x32_bf16 v[192:195], a[64:67], v[44:47], v[192:195]
v_exp_f32 v7, v7
v_mfma_f32_16x16x32_bf16 v[196:199], a[68:71], v[44:47], v[196:199]
ds_read_b64_tr_b16 a[58:59], v86 offset:36864
v_cvt_pk_bf16_f32 v35, v6, v7
v_mfma_f32_16x16x32_bf16 v[200:203], a[72:75], v[44:47], v[200:203]
ds_read_b64_tr_b16 a[60:61], v87 offset:32768
v_mfma_f32_16x16x32_bf16 v[204:207], a[76:79], v[44:47], v[204:207]
v_exp_f32 v8, v8
v_mfma_f32_16x16x32_bf16 v[208:211], a[80:83], v[44:47], v[208:211]
ds_read_b64_tr_b16 a[62:63], v87 offset:36864
v_mfma_f32_16x16x32_bf16 v[212:215], a[84:87], v[44:47], v[212:215]
v_exp_f32 v9, v9
v_mfma_f32_16x16x32_bf16 v[216:219], a[88:91], v[44:47], v[216:219]
v_cvt_pk_bf16_f32 v36, v8, v9
v_mfma_f32_16x16x32_bf16 v[220:223], a[92:95], v[44:47], v[220:223]
s_add_u32 m0, s55, 0x8000
v_exp_f32 v10, v10
v_mfma_f32_16x16x32_bf16 v[60:63], a[96:99], v[44:47], v[60:63]
buffer_load_dwordx4 v224, s[20:23], s51 offen lds
v_mfma_f32_16x16x32_bf16 v[16:19], a[0:3], a[160:163], 0
v_exp_f32 v11, v11
v_mfma_f32_16x16x32_bf16 v[16:19], a[4:7], a[164:167], v[16:19]
v_cvt_pk_bf16_f32 v37, v10, v11
v_mfma_f32_16x16x32_bf16 v[16:19], a[8:11], a[168:171], v[16:19]
v_exp_f32 v12, v12
v_mfma_f32_16x16x32_bf16 v[16:19], a[12:15], a[172:175], v[16:19]
buffer_load_dwordx4 v225, s[20:23], s51 offen offset:1024 lds
v_mfma_f32_16x16x32_bf16 v[20:23], a[16:19], a[160:163], 0
v_exp_f32 v13, v13
v_mfma_f32_16x16x32_bf16 v[20:23], a[20:23], a[164:167], v[20:23]
s_waitcnt lgkmcnt(0)
v_cvt_pk_bf16_f32 v38, v12, v13
v_mfma_f32_16x16x32_bf16 v[20:23], a[24:27], a[168:171], v[20:23]
v_exp_f32 v14, v14
v_mfma_f32_16x16x32_bf16 v[20:23], a[28:31], a[172:175], v[20:23]
buffer_load_dwordx4 v226, s[20:23], s51 offen offset:2048 lds
v_mfma_f32_16x16x32_bf16 v[96:99], a[32:35], v[32:35], v[96:99]
v_exp_f32 v15, v15
v_mfma_f32_16x16x32_bf16 v[100:103], a[36:39], v[32:35], v[100:103]
v_cvt_pk_bf16_f32 v39, v14, v15
v_mfma_f32_16x16x32_bf16 v[104:107], a[40:43], v[32:35], v[104:107]
buffer_store_dwordx4 a[204:207], v88, s[28:31], s47 offen offset:3072 sc1
v_mfma_f32_16x16x32_bf16 v[108:111], a[44:47], v[32:35], v[108:111]
v_exp_f32 v16, v16
v_mfma_f32_16x16x32_bf16 v[112:115], a[48:51], v[32:35], v[112:115]
buffer_load_dwordx4 v227, s[20:23], s51 offen offset:3072 lds
v_mfma_f32_16x16x32_bf16 v[116:119], a[52:55], v[32:35], v[116:119]
s_add_u32 s51, s51, 16384
v_exp_f32 v17, v17
v_mfma_f32_16x16x32_bf16 v[120:123], a[56:59], v[32:35], v[120:123]
v_cvt_pk_bf16_f32 v40, v16, v17
v_mfma_f32_16x16x32_bf16 v[124:127], a[60:63], v[32:35], v[124:127]
v_exp_f32 v18, v18
v_mfma_f32_16x16x32_bf16 v[48:51], a[96:99], v[32:35], v[48:51]
v_mfma_f32_16x16x32_bf16 v[24:27], a[0:3], a[176:179], 0
v_exp_f32 v19, v19
v_mfma_f32_16x16x32_bf16 v[24:27], a[4:7], a[180:183], v[24:27]
ds_read_b128 a[0:3], v68 offset:40960
v_cvt_pk_bf16_f32 v41, v18, v19
v_mfma_f32_16x16x32_bf16 v[24:27], a[8:11], a[184:187], v[24:27]
v_exp_f32 v20, v20
v_mfma_f32_16x16x32_bf16 v[24:27], a[12:15], a[188:191], v[24:27]
ds_read_b128 a[4:7], v69 offset:40960
v_mfma_f32_16x16x32_bf16 v[28:31], a[16:19], a[176:179], 0
v_exp_f32 v21, v21
v_mfma_f32_16x16x32_bf16 v[28:31], a[20:23], a[180:183], v[28:31]
ds_read_b128 a[8:11], v70 offset:40960
v_cvt_pk_bf16_f32 v42, v20, v21
v_mfma_f32_16x16x32_bf16 v[28:31], a[24:27], a[184:187], v[28:31]
v_exp_f32 v22, v22
v_mfma_f32_16x16x32_bf16 v[28:31], a[28:31], a[188:191], v[28:31]
ds_read_b128 a[12:15], v71 offset:40960
v_mfma_f32_16x16x32_bf16 v[128:131], a[32:35], v[36:39], v[128:131]
v_exp_f32 v23, v23
v_mfma_f32_16x16x32_bf16 v[132:135], a[36:39], v[36:39], v[132:135]
ds_read_b128 a[16:19], v68 offset:45056
v_cvt_pk_bf16_f32 v43, v22, v23
v_mfma_f32_16x16x32_bf16 v[136:139], a[40:43], v[36:39], v[136:139]
ds_read_b128 a[20:23], v69 offset:45056
v_mfma_f32_16x16x32_bf16 v[140:143], a[44:47], v[36:39], v[140:143]
v_exp_f32 v24, v24
v_mfma_f32_16x16x32_bf16 v[144:147], a[48:51], v[36:39], v[144:147]
ds_read_b128 a[24:27], v70 offset:45056
v_mfma_f32_16x16x32_bf16 v[148:151], a[52:55], v[36:39], v[148:151]
v_exp_f32 v25, v25
v_mfma_f32_16x16x32_bf16 v[152:155], a[56:59], v[36:39], v[152:155]
ds_read_b128 a[28:31], v71 offset:45056
v_cvt_pk_bf16_f32 v44, v24, v25
v_mfma_f32_16x16x32_bf16 v[156:159], a[60:63], v[36:39], v[156:159]
s_waitcnt lgkmcnt(3)
v_exp_f32 v26, v26
v_mfma_f32_16x16x32_bf16 v[52:55], a[96:99], v[36:39], v[52:55]
buffer_store_dwordx2 a[100:101], v88, s[28:31], s48 offen sc1
v_mfma_f32_16x16x32_bf16 v[0:3], a[0:3], a[128:131], 0
v_exp_f32 v27, v27
v_mfma_f32_16x16x32_bf16 v[0:3], a[4:7], a[132:135], v[0:3]
ds_read_b64_tr_b16 a[64:65], v80 offset:40960
v_cvt_pk_bf16_f32 v45, v26, v27
v_mfma_f32_16x16x32_bf16 v[0:3], a[8:11], a[136:139], v[0:3]
s_waitcnt lgkmcnt(1)
v_exp_f32 v28, v28
v_mfma_f32_16x16x32_bf16 v[0:3], a[12:15], a[140:143], v[0:3]
ds_read_b64_tr_b16 a[66:67], v80 offset:45056
v_mfma_f32_16x16x32_bf16 v[4:7], a[16:19], a[128:131], 0
v_exp_f32 v29, v29
v_mfma_f32_16x16x32_bf16 v[4:7], a[20:23], a[132:135], v[4:7]
ds_read_b64_tr_b16 a[68:69], v81 offset:40960
v_cvt_pk_bf16_f32 v46, v28, v29
v_mfma_f32_16x16x32_bf16 v[4:7], a[24:27], a[136:139], v[4:7]
v_exp_f32 v30, v30
v_mfma_f32_16x16x32_bf16 v[4:7], a[28:31], a[140:143], v[4:7]
ds_read_b64_tr_b16 a[70:71], v81 offset:45056
v_mfma_f32_16x16x32_bf16 v[160:163], a[32:35], v[40:43], v[160:163]
v_exp_f32 v31, v31
v_mfma_f32_16x16x32_bf16 v[164:167], a[36:39], v[40:43], v[164:167]
ds_read_b64_tr_b16 a[72:73], v82 offset:40960
v_cvt_pk_bf16_f32 v47, v30, v31
v_mfma_f32_16x16x32_bf16 v[168:171], a[40:43], v[40:43], v[168:171]
ds_read_b64_tr_b16 a[74:75], v82 offset:45056
v_mfma_f32_16x16x32_bf16 v[172:175], a[44:47], v[40:43], v[172:175]
v_exp_f32 v0, v0
v_mfma_f32_16x16x32_bf16 v[176:179], a[48:51], v[40:43], v[176:179]
ds_read_b64_tr_b16 a[76:77], v83 offset:40960
v_mfma_f32_16x16x32_bf16 v[180:183], a[52:55], v[40:43], v[180:183]
v_exp_f32 v1, v1
v_mfma_f32_16x16x32_bf16 v[184:187], a[56:59], v[40:43], v[184:187]
ds_read_b64_tr_b16 a[78:79], v83 offset:45056
v_cvt_pk_bf16_f32 v32, v0, v1
v_mfma_f32_16x16x32_bf16 v[188:191], a[60:63], v[40:43], v[188:191]
v_exp_f32 v2, v2
v_mfma_f32_16x16x32_bf16 v[56:59], a[96:99], v[40:43], v[56:59]
s_waitcnt lgkmcnt(4)
ds_read_b64_tr_b16 a[80:81], v84 offset:40960
v_mfma_f32_16x16x32_bf16 v[8:11], a[0:3], a[144:147], 0
v_exp_f32 v3, v3
v_mfma_f32_16x16x32_bf16 v[8:11], a[4:7], a[148:151], v[8:11]
ds_read_b64_tr_b16 a[82:83], v84 offset:45056
v_cvt_pk_bf16_f32 v33, v2, v3
v_mfma_f32_16x16x32_bf16 v[8:11], a[8:11], a[152:155], v[8:11]
v_exp_f32 v4, v4
v_mfma_f32_16x16x32_bf16 v[8:11], a[12:15], a[156:159], v[8:11]
ds_read_b64_tr_b16 a[84:85], v85 offset:40960
v_mfma_f32_16x16x32_bf16 v[12:15], a[16:19], a[144:147], 0
v_exp_f32 v5, v5
v_mfma_f32_16x16x32_bf16 v[12:15], a[20:23], a[148:151], v[12:15]
ds_read_b64_tr_b16 a[86:87], v85 offset:45056
v_cvt_pk_bf16_f32 v34, v4, v5
v_mfma_f32_16x16x32_bf16 v[12:15], a[24:27], a[152:155], v[12:15]
v_exp_f32 v6, v6
v_mfma_f32_16x16x32_bf16 v[12:15], a[28:31], a[156:159], v[12:15]
ds_read_b64_tr_b16 a[88:89], v86 offset:40960
v_mfma_f32_16x16x32_bf16 v[192:195], a[32:35], v[44:47], v[192:195]
v_exp_f32 v7, v7
v_mfma_f32_16x16x32_bf16 v[196:199], a[36:39], v[44:47], v[196:199]
ds_read_b64_tr_b16 a[90:91], v86 offset:45056
v_cvt_pk_bf16_f32 v35, v6, v7
v_mfma_f32_16x16x32_bf16 v[200:203], a[40:43], v[44:47], v[200:203]
ds_read_b64_tr_b16 a[92:93], v87 offset:40960
v_mfma_f32_16x16x32_bf16 v[204:207], a[44:47], v[44:47], v[204:207]
v_exp_f32 v8, v8
v_mfma_f32_16x16x32_bf16 v[208:211], a[48:51], v[44:47], v[208:211]
ds_read_b64_tr_b16 a[94:95], v87 offset:45056
v_mfma_f32_16x16x32_bf16 v[212:215], a[52:55], v[44:47], v[212:215]
v_exp_f32 v9, v9
v_mfma_f32_16x16x32_bf16 v[216:219], a[56:59], v[44:47], v[216:219]
v_cvt_pk_bf16_f32 v36, v8, v9
v_mfma_f32_16x16x32_bf16 v[220:223], a[60:63], v[44:47], v[220:223]
s_add_u32 m0, s55, 0xc000
v_exp_f32 v10, v10
v_mfma_f32_16x16x32_bf16 v[60:63], a[96:99], v[44:47], v[60:63]
buffer_load_dwordx4 v228, s[24:27], s52 offen lds
v_mfma_f32_16x16x32_bf16 v[16:19], a[0:3], a[160:163], 0
v_exp_f32 v11, v11
v_mfma_f32_16x16x32_bf16 v[16:19], a[4:7], a[164:167], v[16:19]
v_cvt_pk_bf16_f32 v37, v10, v11
v_mfma_f32_16x16x32_bf16 v[16:19], a[8:11], a[168:171], v[16:19]
v_exp_f32 v12, v12
v_mfma_f32_16x16x32_bf16 v[16:19], a[12:15], a[172:175], v[16:19]
buffer_load_dwordx4 v229, s[24:27], s52 offen offset:1024 lds
v_mfma_f32_16x16x32_bf16 v[20:23], a[16:19], a[160:163], 0
v_exp_f32 v13, v13
v_mfma_f32_16x16x32_bf16 v[20:23], a[20:23], a[164:167], v[20:23]
s_waitcnt lgkmcnt(0)
v_cvt_pk_bf16_f32 v38, v12, v13
v_mfma_f32_16x16x32_bf16 v[20:23], a[24:27], a[168:171], v[20:23]
v_exp_f32 v14, v14
v_mfma_f32_16x16x32_bf16 v[20:23], a[28:31], a[172:175], v[20:23]
buffer_load_dwordx4 v228, s[24:27], s52 offen offset:2048 lds
v_mfma_f32_16x16x32_bf16 v[96:99], a[64:67], v[32:35], v[96:99]
v_exp_f32 v15, v15
v_mfma_f32_16x16x32_bf16 v[100:103], a[68:71], v[32:35], v[100:103]
v_cvt_pk_bf16_f32 v39, v14, v15
v_mfma_f32_16x16x32_bf16 v[104:107], a[72:75], v[32:35], v[104:107]
v_mfma_f32_16x16x32_bf16 v[108:111], a[76:79], v[32:35], v[108:111]
v_exp_f32 v16, v16
v_mfma_f32_16x16x32_bf16 v[112:115], a[80:83], v[32:35], v[112:115]
buffer_load_dwordx4 v229, s[24:27], s52 offen offset:3072 lds
v_mfma_f32_16x16x32_bf16 v[116:119], a[84:87], v[32:35], v[116:119]
s_add_u32 s52, s52, 16384
v_exp_f32 v17, v17
v_mfma_f32_16x16x32_bf16 v[120:123], a[88:91], v[32:35], v[120:123]
v_cvt_pk_bf16_f32 v40, v16, v17
v_mfma_f32_16x16x32_bf16 v[124:127], a[92:95], v[32:35], v[124:127]
s_waitcnt vmcnt(12)
v_exp_f32 v18, v18
v_mfma_f32_16x16x32_bf16 v[48:51], a[96:99], v[32:35], v[48:51]
s_barrier
v_mfma_f32_16x16x32_bf16 v[24:27], a[0:3], a[176:179], 0
v_exp_f32 v19, v19
v_mfma_f32_16x16x32_bf16 v[24:27], a[4:7], a[180:183], v[24:27]
ds_read_b128 a[0:3], v64
v_cvt_pk_bf16_f32 v41, v18, v19
v_mfma_f32_16x16x32_bf16 v[24:27], a[8:11], a[184:187], v[24:27]
v_exp_f32 v20, v20
v_mfma_f32_16x16x32_bf16 v[24:27], a[12:15], a[188:191], v[24:27]
ds_read_b128 a[4:7], v65
v_mfma_f32_16x16x32_bf16 v[28:31], a[16:19], a[176:179], 0
v_exp_f32 v21, v21
v_mfma_f32_16x16x32_bf16 v[28:31], a[20:23], a[180:183], v[28:31]
ds_read_b128 a[8:11], v66
v_cvt_pk_bf16_f32 v42, v20, v21
v_mfma_f32_16x16x32_bf16 v[28:31], a[24:27], a[184:187], v[28:31]
v_exp_f32 v22, v22
v_mfma_f32_16x16x32_bf16 v[28:31], a[28:31], a[188:191], v[28:31]
ds_read_b128 a[12:15], v67
v_mfma_f32_16x16x32_bf16 v[128:131], a[64:67], v[36:39], v[128:131]
v_exp_f32 v23, v23
v_mfma_f32_16x16x32_bf16 v[132:135], a[68:71], v[36:39], v[132:135]
ds_read_b128 a[16:19], v64 offset:4096
v_cvt_pk_bf16_f32 v43, v22, v23
v_mfma_f32_16x16x32_bf16 v[136:139], a[72:75], v[36:39], v[136:139]
ds_read_b128 a[20:23], v65 offset:4096
v_mfma_f32_16x16x32_bf16 v[140:143], a[76:79], v[36:39], v[140:143]
v_exp_f32 v24, v24
v_mfma_f32_16x16x32_bf16 v[144:147], a[80:83], v[36:39], v[144:147]
ds_read_b128 a[24:27], v66 offset:4096
v_mfma_f32_16x16x32_bf16 v[148:151], a[84:87], v[36:39], v[148:151]
v_exp_f32 v25, v25
v_mfma_f32_16x16x32_bf16 v[152:155], a[88:91], v[36:39], v[152:155]
ds_read_b128 a[28:31], v67 offset:4096
v_cvt_pk_bf16_f32 v44, v24, v25
v_mfma_f32_16x16x32_bf16 v[156:159], a[92:95], v[36:39], v[156:159]
s_waitcnt lgkmcnt(3)
v_exp_f32 v26, v26
v_mfma_f32_16x16x32_bf16 v[52:55], a[96:99], v[36:39], v[52:55]
v_mfma_f32_16x16x32_bf16 v[0:3], a[0:3], a[128:131], 0
v_exp_f32 v27, v27
v_mfma_f32_16x16x32_bf16 v[0:3], a[4:7], a[132:135], v[0:3]
ds_read_b64_tr_b16 a[32:33], v72
v_cvt_pk_bf16_f32 v45, v26, v27
v_mfma_f32_16x16x32_bf16 v[0:3], a[8:11], a[136:139], v[0:3]
s_waitcnt lgkmcnt(1)
v_exp_f32 v28, v28
v_mfma_f32_16x16x32_bf16 v[0:3], a[12:15], a[140:143], v[0:3]
ds_read_b64_tr_b16 a[34:35], v72 offset:4096
v_accvgpr_mov_b32 a192, a208
v_mfma_f32_16x16x32_bf16 v[4:7], a[16:19], a[128:131], 0
v_exp_f32 v29, v29
v_mfma_f32_16x16x32_bf16 v[4:7], a[20:23], a[132:135], v[4:7]
ds_read_b64_tr_b16 a[36:37], v73
v_cvt_pk_bf16_f32 v46, v28, v29
v_mfma_f32_16x16x32_bf16 v[4:7], a[24:27], a[136:139], v[4:7]
v_exp_f32 v30, v30
v_mfma_f32_16x16x32_bf16 v[4:7], a[28:31], a[140:143], v[4:7]
ds_read_b64_tr_b16 a[38:39], v73 offset:4096
v_accvgpr_mov_b32 a193, a209
v_mfma_f32_16x16x32_bf16 v[160:163], a[64:67], v[40:43], v[160:163]
v_exp_f32 v31, v31
v_mfma_f32_16x16x32_bf16 v[164:167], a[68:71], v[40:43], v[164:167]
ds_read_b64_tr_b16 a[40:41], v74
v_cvt_pk_bf16_f32 v47, v30, v31
v_mfma_f32_16x16x32_bf16 v[168:171], a[72:75], v[40:43], v[168:171]
ds_read_b64_tr_b16 a[42:43], v74 offset:4096
v_accvgpr_mov_b32 a194, a210
v_mfma_f32_16x16x32_bf16 v[172:175], a[76:79], v[40:43], v[172:175]
v_exp_f32 v0, v0
v_mfma_f32_16x16x32_bf16 v[176:179], a[80:83], v[40:43], v[176:179]
ds_read_b64_tr_b16 a[44:45], v75
v_accvgpr_mov_b32 a195, a211
v_mfma_f32_16x16x32_bf16 v[180:183], a[84:87], v[40:43], v[180:183]
v_exp_f32 v1, v1
v_mfma_f32_16x16x32_bf16 v[184:187], a[88:91], v[40:43], v[184:187]
ds_read_b64_tr_b16 a[46:47], v75 offset:4096
v_cvt_pk_bf16_f32 v32, v0, v1
v_mfma_f32_16x16x32_bf16 v[188:191], a[92:95], v[40:43], v[188:191]
v_exp_f32 v2, v2
v_mfma_f32_16x16x32_bf16 v[56:59], a[96:99], v[40:43], v[56:59]
s_waitcnt lgkmcnt(4)
ds_read_b64_tr_b16 a[48:49], v76
v_accvgpr_mov_b32 a196, a212
v_mfma_f32_16x16x32_bf16 v[8:11], a[0:3], a[144:147], 0
v_exp_f32 v3, v3
v_mfma_f32_16x16x32_bf16 v[8:11], a[4:7], a[148:151], v[8:11]
ds_read_b64_tr_b16 a[50:51], v76 offset:4096
v_cvt_pk_bf16_f32 v33, v2, v3
v_mfma_f32_16x16x32_bf16 v[8:11], a[8:11], a[152:155], v[8:11]
v_exp_f32 v4, v4
v_mfma_f32_16x16x32_bf16 v[8:11], a[12:15], a[156:159], v[8:11]
ds_read_b64_tr_b16 a[52:53], v77
v_accvgpr_mov_b32 a197, a213
v_mfma_f32_16x16x32_bf16 v[12:15], a[16:19], a[144:147], 0
v_exp_f32 v5, v5
v_mfma_f32_16x16x32_bf16 v[12:15], a[20:23], a[148:151], v[12:15]
ds_read_b64_tr_b16 a[54:55], v77 offset:4096
v_cvt_pk_bf16_f32 v34, v4, v5
v_mfma_f32_16x16x32_bf16 v[12:15], a[24:27], a[152:155], v[12:15]
v_exp_f32 v6, v6
v_mfma_f32_16x16x32_bf16 v[12:15], a[28:31], a[156:159], v[12:15]
ds_read_b64_tr_b16 a[56:57], v78
v_accvgpr_mov_b32 a198, a214
v_mfma_f32_16x16x32_bf16 v[192:195], a[64:67], v[44:47], v[192:195]
v_exp_f32 v7, v7
v_mfma_f32_16x16x32_bf16 v[196:199], a[68:71], v[44:47], v[196:199]
ds_read_b64_tr_b16 a[58:59], v78 offset:4096
v_cvt_pk_bf16_f32 v35, v6, v7
v_mfma_f32_16x16x32_bf16 v[200:203], a[72:75], v[44:47], v[200:203]
ds_read_b64_tr_b16 a[60:61], v79
v_accvgpr_mov_b32 a199, a215
v_mfma_f32_16x16x32_bf16 v[204:207], a[76:79], v[44:47], v[204:207]
v_exp_f32 v8, v8
v_mfma_f32_16x16x32_bf16 v[208:211], a[80:83], v[44:47], v[208:211]
ds_read_b64_tr_b16 a[62:63], v79 offset:4096
v_accvgpr_mov_b32 a200, a216
v_mfma_f32_16x16x32_bf16 v[212:215], a[84:87], v[44:47], v[212:215]
v_exp_f32 v9, v9
v_mfma_f32_16x16x32_bf16 v[216:219], a[88:91], v[44:47], v[216:219]
v_cvt_pk_bf16_f32 v36, v8, v9
v_mfma_f32_16x16x32_bf16 v[220:223], a[92:95], v[44:47], v[220:223]
s_add_u32 m0, s55, 0x10000
v_exp_f32 v10, v10
v_mfma_f32_16x16x32_bf16 v[60:63], a[96:99], v[44:47], v[60:63]
buffer_load_dwordx4 v224, s[20:23], s51 offen lds
v_mfma_f32_16x16x32_bf16 v[16:19], a[0:3], a[160:163], 0
v_exp_f32 v11, v11
v_mfma_f32_16x16x32_bf16 v[16:19], a[4:7], a[164:167], v[16:19]
v_cvt_pk_bf16_f32 v37, v10, v11
v_mfma_f32_16x16x32_bf16 v[16:19], a[8:11], a[168:171], v[16:19]
v_exp_f32 v12, v12
v_mfma_f32_16x16x32_bf16 v[16:19], a[12:15], a[172:175], v[16:19]
buffer_load_dwordx4 v225, s[20:23], s51 offen offset:1024 lds
v_mfma_f32_16x16x32_bf16 v[20:23], a[16:19], a[160:163], 0
v_exp_f32 v13, v13
v_mfma_f32_16x16x32_bf16 v[20:23], a[20:23], a[164:167], v[20:23]
s_waitcnt lgkmcnt(0)
v_cvt_pk_bf16_f32 v38, v12, v13
v_mfma_f32_16x16x32_bf16 v[20:23], a[24:27], a[168:171], v[20:23]
v_exp_f32 v14, v14
v_mfma_f32_16x16x32_bf16 v[20:23], a[28:31], a[172:175], v[20:23]
buffer_load_dwordx4 v226, s[20:23], s51 offen offset:2048 lds
v_mfma_f32_16x16x32_bf16 v[96:99], a[32:35], v[32:35], v[96:99]
v_exp_f32 v15, v15
v_mfma_f32_16x16x32_bf16 v[100:103], a[36:39], v[32:35], v[100:103]
v_cvt_pk_bf16_f32 v39, v14, v15
v_mfma_f32_16x16x32_bf16 v[104:107], a[40:43], v[32:35], v[104:107]
v_accvgpr_mov_b32 a205, a221
v_mfma_f32_16x16x32_bf16 v[108:111], a[44:47], v[32:35], v[108:111]
v_exp_f32 v16, v16
v_mfma_f32_16x16x32_bf16 v[112:115], a[48:51], v[32:35], v[112:115]
buffer_load_dwordx4 v227, s[20:23], s51 offen offset:3072 lds
v_mfma_f32_16x16x32_bf16 v[116:119], a[52:55], v[32:35], v[116:119]
s_add_u32 s51, s51, 16384
v_exp_f32 v17, v17
v_mfma_f32_16x16x32_bf16 v[120:123], a[56:59], v[32:35], v[120:123]
v_cvt_pk_bf16_f32 v40, v16, v17
v_mfma_f32_16x16x32_bf16 v[124:127], a[60:63], v[32:35], v[124:127]
v_exp_f32 v18, v18
v_mfma_f32_16x16x32_bf16 v[48:51], a[96:99], v[32:35], v[48:51]
v_mfma_f32_16x16x32_bf16 v[24:27], a[0:3], a[176:179], 0
v_exp_f32 v19, v19
v_mfma_f32_16x16x32_bf16 v[24:27], a[4:7], a[180:183], v[24:27]
ds_read_b128 a[0:3], v64 offset:8192
v_cvt_pk_bf16_f32 v41, v18, v19
v_mfma_f32_16x16x32_bf16 v[24:27], a[8:11], a[184:187], v[24:27]
v_exp_f32 v20, v20
v_mfma_f32_16x16x32_bf16 v[24:27], a[12:15], a[188:191], v[24:27]
ds_read_b128 a[4:7], v65 offset:8192
v_accvgpr_mov_b32 a201, a217
v_mfma_f32_16x16x32_bf16 v[28:31], a[16:19], a[176:179], 0
v_exp_f32 v21, v21
v_mfma_f32_16x16x32_bf16 v[28:31], a[20:23], a[180:183], v[28:31]
ds_read_b128 a[8:11], v66 offset:8192
v_cvt_pk_bf16_f32 v42, v20, v21
v_mfma_f32_16x16x32_bf16 v[28:31], a[24:27], a[184:187], v[28:31]
v_exp_f32 v22, v22
v_mfma_f32_16x16x32_bf16 v[28:31], a[28:31], a[188:191], v[28:31]
ds_read_b128 a[12:15], v67 offset:8192
v_accvgpr_mov_b32 a202, a218
v_mfma_f32_16x16x32_bf16 v[128:131], a[32:35], v[36:39], v[128:131]
v_exp_f32 v23, v23
v_mfma_f32_16x16x32_bf16 v[132:135], a[36:39], v[36:39], v[132:135]
ds_read_b128 a[16:19], v64 offset:12288
v_cvt_pk_bf16_f32 v43, v22, v23
v_mfma_f32_16x16x32_bf16 v[136:139], a[40:43], v[36:39], v[136:139]
ds_read_b128 a[20:23], v65 offset:12288
v_accvgpr_mov_b32 a203, a219
v_mfma_f32_16x16x32_bf16 v[140:143], a[44:47], v[36:39], v[140:143]
v_exp_f32 v24, v24
v_mfma_f32_16x16x32_bf16 v[144:147], a[48:51], v[36:39], v[144:147]
ds_read_b128 a[24:27], v66 offset:12288
v_accvgpr_mov_b32 a204, a220
v_mfma_f32_16x16x32_bf16 v[148:151], a[52:55], v[36:39], v[148:151]
v_exp_f32 v25, v25
v_mfma_f32_16x16x32_bf16 v[152:155], a[56:59], v[36:39], v[152:155]
ds_read_b128 a[28:31], v67 offset:12288
v_cvt_pk_bf16_f32 v44, v24, v25
v_mfma_f32_16x16x32_bf16 v[156:159], a[60:63], v[36:39], v[156:159]
s_waitcnt lgkmcnt(3)
v_exp_f32 v26, v26
v_mfma_f32_16x16x32_bf16 v[52:55], a[96:99], v[36:39], v[52:55]
v_mfma_f32_16x16x32_bf16 v[0:3], a[0:3], a[128:131], 0
v_exp_f32 v27, v27
v_mfma_f32_16x16x32_bf16 v[0:3], a[4:7], a[132:135], v[0:3]
ds_read_b64_tr_b16 a[64:65], v72 offset:8192
v_cvt_pk_bf16_f32 v45, v26, v27
v_mfma_f32_16x16x32_bf16 v[0:3], a[8:11], a[136:139], v[0:3]
s_waitcnt lgkmcnt(1)
v_exp_f32 v28, v28
v_mfma_f32_16x16x32_bf16 v[0:3], a[12:15], a[140:143], v[0:3]
ds_read_b64_tr_b16 a[66:67], v72 offset:12288
v_accvgpr_mov_b32 a206, a222
v_mfma_f32_16x16x32_bf16 v[4:7], a[16:19], a[128:131], 0
v_exp_f32 v29, v29
v_mfma_f32_16x16x32_bf16 v[4:7], a[20:23], a[132:135], v[4:7]
ds_read_b64_tr_b16 a[68:69], v73 offset:8192
v_cvt_pk_bf16_f32 v46, v28, v29
v_mfma_f32_16x16x32_bf16 v[4:7], a[24:27], a[136:139], v[4:7]
v_exp_f32 v30, v30
v_mfma_f32_16x16x32_bf16 v[4:7], a[28:31], a[140:143], v[4:7]
ds_read_b64_tr_b16 a[70:71], v73 offset:12288
v_accvgpr_mov_b32 a207, a223
v_mfma_f32_16x16x32_bf16 v[160:163], a[32:35], v[40:43], v[160:163]
v_exp_f32 v31, v31
v_mfma_f32_16x16x32_bf16 v[164:167], a[36:39], v[40:43], v[164:167]
ds_read_b64_tr_b16 a[72:73], v74 offset:8192
v_cvt_pk_bf16_f32 v47, v30, v31
v_mfma_f32_16x16x32_bf16 v[168:171], a[40:43], v[40:43], v[168:171]
ds_read_b64_tr_b16 a[74:75], v74 offset:12288
v_accvgpr_mov_b32 a100, a102
v_mfma_f32_16x16x32_bf16 v[172:175], a[44:47], v[40:43], v[172:175]
v_exp_f32 v0, v0
v_mfma_f32_16x16x32_bf16 v[176:179], a[48:51], v[40:43], v[176:179]
ds_read_b64_tr_b16 a[76:77], v75 offset:8192
v_accvgpr_mov_b32 a101, a103
v_mfma_f32_16x16x32_bf16 v[180:183], a[52:55], v[40:43], v[180:183]
v_exp_f32 v1, v1
v_mfma_f32_16x16x32_bf16 v[184:187], a[56:59], v[40:43], v[184:187]
ds_read_b64_tr_b16 a[78:79], v75 offset:12288
v_cvt_pk_bf16_f32 v32, v0, v1
v_mfma_f32_16x16x32_bf16 v[188:191], a[60:63], v[40:43], v[188:191]
v_exp_f32 v2, v2
v_mfma_f32_16x16x32_bf16 v[56:59], a[96:99], v[40:43], v[56:59]
s_waitcnt lgkmcnt(4)
ds_read_b64_tr_b16 a[80:81], v76 offset:8192
v_accvgpr_mov_b32 a208, a224
v_mfma_f32_16x16x32_bf16 v[8:11], a[0:3], a[144:147], 0
v_exp_f32 v3, v3
v_mfma_f32_16x16x32_bf16 v[8:11], a[4:7], a[148:151], v[8:11]
ds_read_b64_tr_b16 a[82:83], v76 offset:12288
v_cvt_pk_bf16_f32 v33, v2, v3
v_mfma_f32_16x16x32_bf16 v[8:11], a[8:11], a[152:155], v[8:11]
v_exp_f32 v4, v4
v_mfma_f32_16x16x32_bf16 v[8:11], a[12:15], a[156:159], v[8:11]
ds_read_b64_tr_b16 a[84:85], v77 offset:8192
v_accvgpr_mov_b32 a209, a225
v_mfma_f32_16x16x32_bf16 v[12:15], a[16:19], a[144:147], 0
v_exp_f32 v5, v5
v_mfma_f32_16x16x32_bf16 v[12:15], a[20:23], a[148:151], v[12:15]
ds_read_b64_tr_b16 a[86:87], v77 offset:12288
v_cvt_pk_bf16_f32 v34, v4, v5
v_mfma_f32_16x16x32_bf16 v[12:15], a[24:27], a[152:155], v[12:15]
v_exp_f32 v6, v6
v_mfma_f32_16x16x32_bf16 v[12:15], a[28:31], a[156:159], v[12:15]
ds_read_b64_tr_b16 a[88:89], v78 offset:8192
v_accvgpr_mov_b32 a210, a226
v_mfma_f32_16x16x32_bf16 v[192:195], a[32:35], v[44:47], v[192:195]
v_exp_f32 v7, v7
v_mfma_f32_16x16x32_bf16 v[196:199], a[36:39], v[44:47], v[196:199]
ds_read_b64_tr_b16 a[90:91], v78 offset:12288
v_cvt_pk_bf16_f32 v35, v6, v7
v_mfma_f32_16x16x32_bf16 v[200:203], a[40:43], v[44:47], v[200:203]
ds_read_b64_tr_b16 a[92:93], v79 offset:8192
v_accvgpr_mov_b32 a211, a227
v_mfma_f32_16x16x32_bf16 v[204:207], a[44:47], v[44:47], v[204:207]
v_exp_f32 v8, v8
v_mfma_f32_16x16x32_bf16 v[208:211], a[48:51], v[44:47], v[208:211]
ds_read_b64_tr_b16 a[94:95], v79 offset:12288
v_accvgpr_mov_b32 a212, a228
v_mfma_f32_16x16x32_bf16 v[212:215], a[52:55], v[44:47], v[212:215]
v_exp_f32 v9, v9
v_mfma_f32_16x16x32_bf16 v[216:219], a[56:59], v[44:47], v[216:219]
v_cvt_pk_bf16_f32 v36, v8, v9
v_mfma_f32_16x16x32_bf16 v[220:223], a[60:63], v[44:47], v[220:223]
s_add_u32 m0, s55, 0x14000
v_exp_f32 v10, v10
v_mfma_f32_16x16x32_bf16 v[60:63], a[96:99], v[44:47], v[60:63]
buffer_load_dwordx4 v228, s[24:27], s52 offen lds
v_mfma_f32_16x16x32_bf16 v[16:19], a[0:3], a[160:163], 0
v_exp_f32 v11, v11
v_mfma_f32_16x16x32_bf16 v[16:19], a[4:7], a[164:167], v[16:19]
v_cvt_pk_bf16_f32 v37, v10, v11
v_mfma_f32_16x16x32_bf16 v[16:19], a[8:11], a[168:171], v[16:19]
v_exp_f32 v12, v12
v_mfma_f32_16x16x32_bf16 v[16:19], a[12:15], a[172:175], v[16:19]
buffer_load_dwordx4 v229, s[24:27], s52 offen offset:1024 lds
v_mfma_f32_16x16x32_bf16 v[20:23], a[16:19], a[160:163], 0
v_exp_f32 v13, v13
v_mfma_f32_16x16x32_bf16 v[20:23], a[20:23], a[164:167], v[20:23]
s_waitcnt lgkmcnt(0)
v_cvt_pk_bf16_f32 v38, v12, v13
v_mfma_f32_16x16x32_bf16 v[20:23], a[24:27], a[168:171], v[20:23]
v_exp_f32 v14, v14
v_mfma_f32_16x16x32_bf16 v[20:23], a[28:31], a[172:175], v[20:23]
buffer_load_dwordx4 v228, s[24:27], s52 offen offset:2048 lds
v_mfma_f32_16x16x32_bf16 v[96:99], a[64:67], v[32:35], v[96:99]
v_exp_f32 v15, v15
v_mfma_f32_16x16x32_bf16 v[100:103], a[68:71], v[32:35], v[100:103]
v_cvt_pk_bf16_f32 v39, v14, v15
v_mfma_f32_16x16x32_bf16 v[104:107], a[72:75], v[32:35], v[104:107]
v_accvgpr_mov_b32 a217, a233
v_mfma_f32_16x16x32_bf16 v[108:111], a[76:79], v[32:35], v[108:111]
v_exp_f32 v16, v16
v_mfma_f32_16x16x32_bf16 v[112:115], a[80:83], v[32:35], v[112:115]
buffer_load_dwordx4 v229, s[24:27], s52 offen offset:3072 lds
v_mfma_f32_16x16x32_bf16 v[116:119], a[84:87], v[32:35], v[116:119]
s_add_u32 s52, s52, 16384
v_exp_f32 v17, v17
v_mfma_f32_16x16x32_bf16 v[120:123], a[88:91], v[32:35], v[120:123]
v_cvt_pk_bf16_f32 v40, v16, v17
v_mfma_f32_16x16x32_bf16 v[124:127], a[92:95], v[32:35], v[124:127]
s_waitcnt vmcnt(8)
v_exp_f32 v18, v18
v_mfma_f32_16x16x32_bf16 v[48:51], a[96:99], v[32:35], v[48:51]
s_barrier
v_mfma_f32_16x16x32_bf16 v[24:27], a[0:3], a[176:179], 0
v_exp_f32 v19, v19
v_mfma_f32_16x16x32_bf16 v[24:27], a[4:7], a[180:183], v[24:27]
ds_read_b128 a[0:3], v64 offset:32768
v_cvt_pk_bf16_f32 v41, v18, v19
v_mfma_f32_16x16x32_bf16 v[24:27], a[8:11], a[184:187], v[24:27]
v_exp_f32 v20, v20
v_mfma_f32_16x16x32_bf16 v[24:27], a[12:15], a[188:191], v[24:27]
ds_read_b128 a[4:7], v65 offset:32768
v_accvgpr_mov_b32 a213, a229
v_mfma_f32_16x16x32_bf16 v[28:31], a[16:19], a[176:179], 0
v_exp_f32 v21, v21
v_mfma_f32_16x16x32_bf16 v[28:31], a[20:23], a[180:183], v[28:31]
ds_read_b128 a[8:11], v66 offset:32768
v_cvt_pk_bf16_f32 v42, v20, v21
v_mfma_f32_16x16x32_bf16 v[28:31], a[24:27], a[184:187], v[28:31]
v_exp_f32 v22, v22
v_mfma_f32_16x16x32_bf16 v[28:31], a[28:31], a[188:191], v[28:31]
ds_read_b128 a[12:15], v67 offset:32768
v_accvgpr_mov_b32 a214, a230
v_mfma_f32_16x16x32_bf16 v[128:131], a[64:67], v[36:39], v[128:131]
v_exp_f32 v23, v23
v_mfma_f32_16x16x32_bf16 v[132:135], a[68:71], v[36:39], v[132:135]
ds_read_b128 a[16:19], v64 offset:36864
v_cvt_pk_bf16_f32 v43, v22, v23
v_mfma_f32_16x16x32_bf16 v[136:139], a[72:75], v[36:39], v[136:139]
ds_read_b128 a[20:23], v65 offset:36864
v_accvgpr_mov_b32 a215, a231
v_mfma_f32_16x16x32_bf16 v[140:143], a[76:79], v[36:39], v[140:143]
v_exp_f32 v24, v24
v_mfma_f32_16x16x32_bf16 v[144:147], a[80:83], v[36:39], v[144:147]
ds_read_b128 a[24:27], v66 offset:36864
v_accvgpr_mov_b32 a216, a232
v_mfma_f32_16x16x32_bf16 v[148:151], a[84:87], v[36:39], v[148:151]
v_exp_f32 v25, v25
v_mfma_f32_16x16x32_bf16 v[152:155], a[88:91], v[36:39], v[152:155]
ds_read_b128 a[28:31], v67 offset:36864
v_cvt_pk_bf16_f32 v44, v24, v25
v_mfma_f32_16x16x32_bf16 v[156:159], a[92:95], v[36:39], v[156:159]
s_waitcnt lgkmcnt(3)
v_exp_f32 v26, v26
v_mfma_f32_16x16x32_bf16 v[52:55], a[96:99], v[36:39], v[52:55]
v_mfma_f32_16x16x32_bf16 v[0:3], a[0:3], a[128:131], 0
v_exp_f32 v27, v27
v_mfma_f32_16x16x32_bf16 v[0:3], a[4:7], a[132:135], v[0:3]
ds_read_b64_tr_b16 a[32:33], v72 offset:32768
v_cvt_pk_bf16_f32 v45, v26, v27
v_mfma_f32_16x16x32_bf16 v[0:3], a[8:11], a[136:139], v[0:3]
s_waitcnt lgkmcnt(1)
v_exp_f32 v28, v28
v_mfma_f32_16x16x32_bf16 v[0:3], a[12:15], a[140:143], v[0:3]
ds_read_b64_tr_b16 a[34:35], v72 offset:36864
v_accvgpr_mov_b32 a218, a234
v_mfma_f32_16x16x32_bf16 v[4:7], a[16:19], a[128:131], 0
v_exp_f32 v29, v29
v_mfma_f32_16x16x32_bf16 v[4:7], a[20:23], a[132:135], v[4:7]
ds_read_b64_tr_b16 a[36:37], v73 offset:32768
v_cvt_pk_bf16_f32 v46, v28, v29
v_mfma_f32_16x16x32_bf16 v[4:7], a[24:27], a[136:139], v[4:7]
v_exp_f32 v30, v30
v_mfma_f32_16x16x32_bf16 v[4:7], a[28:31], a[140:143], v[4:7]
ds_read_b64_tr_b16 a[38:39], v73 offset:36864
v_accvgpr_mov_b32 a219, a235
v_mfma_f32_16x16x32_bf16 v[160:163], a[64:67], v[40:43], v[160:163]
v_exp_f32 v31, v31
v_mfma_f32_16x16x32_bf16 v[164:167], a[68:71], v[40:43], v[164:167]
ds_read_b64_tr_b16 a[40:41], v74 offset:32768
v_cvt_pk_bf16_f32 v47, v30, v31
v_mfma_f32_16x16x32_bf16 v[168:171], a[72:75], v[40:43], v[168:171]
ds_read_b64_tr_b16 a[42:43], v74 offset:36864
v_accvgpr_mov_b32 a220, a236
v_mfma_f32_16x16x32_bf16 v[172:175], a[76:79], v[40:43], v[172:175]
v_exp_f32 v0, v0
v_mfma_f32_16x16x32_bf16 v[176:179], a[80:83], v[40:43], v[176:179]
ds_read_b64_tr_b16 a[44:45], v75 offset:32768
v_accvgpr_mov_b32 a221, a237
v_mfma_f32_16x16x32_bf16 v[180:183], a[84:87], v[40:43], v[180:183]
v_exp_f32 v1, v1
v_mfma_f32_16x16x32_bf16 v[184:187], a[88:91], v[40:43], v[184:187]
ds_read_b64_tr_b16 a[46:47], v75 offset:36864
v_cvt_pk_bf16_f32 v32, v0, v1
v_mfma_f32_16x16x32_bf16 v[188:191], a[92:95], v[40:43], v[188:191]
v_exp_f32 v2, v2
v_mfma_f32_16x16x32_bf16 v[56:59], a[96:99], v[40:43], v[56:59]
s_waitcnt lgkmcnt(4)
ds_read_b64_tr_b16 a[48:49], v76 offset:32768
v_accvgpr_mov_b32 a222, a238
v_mfma_f32_16x16x32_bf16 v[8:11], a[0:3], a[144:147], 0
v_exp_f32 v3, v3
v_mfma_f32_16x16x32_bf16 v[8:11], a[4:7], a[148:151], v[8:11]
ds_read_b64_tr_b16 a[50:51], v76 offset:36864
v_cvt_pk_bf16_f32 v33, v2, v3
v_mfma_f32_16x16x32_bf16 v[8:11], a[8:11], a[152:155], v[8:11]
v_exp_f32 v4, v4
v_mfma_f32_16x16x32_bf16 v[8:11], a[12:15], a[156:159], v[8:11]
ds_read_b64_tr_b16 a[52:53], v77 offset:32768
v_accvgpr_mov_b32 a223, a239
v_mfma_f32_16x16x32_bf16 v[12:15], a[16:19], a[144:147], 0
v_exp_f32 v5, v5
v_mfma_f32_16x16x32_bf16 v[12:15], a[20:23], a[148:151], v[12:15]
ds_read_b64_tr_b16 a[54:55], v77 offset:36864
v_cvt_pk_bf16_f32 v34, v4, v5
v_mfma_f32_16x16x32_bf16 v[12:15], a[24:27], a[152:155], v[12:15]
v_exp_f32 v6, v6
v_mfma_f32_16x16x32_bf16 v[12:15], a[28:31], a[156:159], v[12:15]
ds_read_b64_tr_b16 a[56:57], v78 offset:32768
v_accvgpr_mov_b32 a102, a104
v_mfma_f32_16x16x32_bf16 v[192:195], a[64:67], v[44:47], v[192:195]
v_exp_f32 v7, v7
v_mfma_f32_16x16x32_bf16 v[196:199], a[68:71], v[44:47], v[196:199]
ds_read_b64_tr_b16 a[58:59], v78 offset:36864
v_cvt_pk_bf16_f32 v35, v6, v7
v_mfma_f32_16x16x32_bf16 v[200:203], a[72:75], v[44:47], v[200:203]
ds_read_b64_tr_b16 a[60:61], v79 offset:32768
v_accvgpr_mov_b32 a103, a105
v_mfma_f32_16x16x32_bf16 v[204:207], a[76:79], v[44:47], v[204:207]
v_exp_f32 v8, v8
v_mfma_f32_16x16x32_bf16 v[208:211], a[80:83], v[44:47], v[208:211]
ds_read_b64_tr_b16 a[62:63], v79 offset:36864
v_accvgpr_mov_b32 a224, a240
v_mfma_f32_16x16x32_bf16 v[212:215], a[84:87], v[44:47], v[212:215]
v_exp_f32 v9, v9
v_mfma_f32_16x16x32_bf16 v[216:219], a[88:91], v[44:47], v[216:219]
v_cvt_pk_bf16_f32 v36, v8, v9
v_mfma_f32_16x16x32_bf16 v[220:223], a[92:95], v[44:47], v[220:223]
s_add_u32 m0, s55, 0x18000
v_exp_f32 v10, v10
v_mfma_f32_16x16x32_bf16 v[60:63], a[96:99], v[44:47], v[60:63]
buffer_load_dwordx4 v224, s[20:23], s51 offen lds
v_mfma_f32_16x16x32_bf16 v[16:19], a[0:3], a[160:163], 0
v_exp_f32 v11, v11
v_mfma_f32_16x16x32_bf16 v[16:19], a[4:7], a[164:167], v[16:19]
v_cvt_pk_bf16_f32 v37, v10, v11
v_mfma_f32_16x16x32_bf16 v[16:19], a[8:11], a[168:171], v[16:19]
v_exp_f32 v12, v12
v_mfma_f32_16x16x32_bf16 v[16:19], a[12:15], a[172:175], v[16:19]
buffer_load_dwordx4 v225, s[20:23], s51 offen offset:1024 lds
v_mfma_f32_16x16x32_bf16 v[20:23], a[16:19], a[160:163], 0
v_exp_f32 v13, v13
v_mfma_f32_16x16x32_bf16 v[20:23], a[20:23], a[164:167], v[20:23]
s_waitcnt lgkmcnt(0)
v_cvt_pk_bf16_f32 v38, v12, v13
v_mfma_f32_16x16x32_bf16 v[20:23], a[24:27], a[168:171], v[20:23]
v_exp_f32 v14, v14
v_mfma_f32_16x16x32_bf16 v[20:23], a[28:31], a[172:175], v[20:23]
buffer_load_dwordx4 v226, s[20:23], s51 offen offset:2048 lds
v_mfma_f32_16x16x32_bf16 v[96:99], a[32:35], v[32:35], v[96:99]
v_exp_f32 v15, v15
v_mfma_f32_16x16x32_bf16 v[100:103], a[36:39], v[32:35], v[100:103]
v_cvt_pk_bf16_f32 v39, v14, v15
v_mfma_f32_16x16x32_bf16 v[104:107], a[40:43], v[32:35], v[104:107]
v_accvgpr_mov_b32 a229, a245
v_mfma_f32_16x16x32_bf16 v[108:111], a[44:47], v[32:35], v[108:111]
v_exp_f32 v16, v16
v_mfma_f32_16x16x32_bf16 v[112:115], a[48:51], v[32:35], v[112:115]
buffer_load_dwordx4 v227, s[20:23], s51 offen offset:3072 lds
v_mfma_f32_16x16x32_bf16 v[116:119], a[52:55], v[32:35], v[116:119]
s_add_u32 s51, s51, 16384
v_exp_f32 v17, v17
v_mfma_f32_16x16x32_bf16 v[120:123], a[56:59], v[32:35], v[120:123]
v_cvt_pk_bf16_f32 v40, v16, v17
v_mfma_f32_16x16x32_bf16 v[124:127], a[60:63], v[32:35], v[124:127]
v_exp_f32 v18, v18
v_mfma_f32_16x16x32_bf16 v[48:51], a[96:99], v[32:35], v[48:51]
v_mfma_f32_16x16x32_bf16 v[24:27], a[0:3], a[176:179], 0
v_exp_f32 v19, v19
v_mfma_f32_16x16x32_bf16 v[24:27], a[4:7], a[180:183], v[24:27]
ds_read_b128 a[0:3], v64 offset:40960
v_cvt_pk_bf16_f32 v41, v18, v19
v_mfma_f32_16x16x32_bf16 v[24:27], a[8:11], a[184:187], v[24:27]
v_exp_f32 v20, v20
v_mfma_f32_16x16x32_bf16 v[24:27], a[12:15], a[188:191], v[24:27]
ds_read_b128 a[4:7], v65 offset:40960
v_accvgpr_mov_b32 a225, a241
v_mfma_f32_16x16x32_bf16 v[28:31], a[16:19], a[176:179], 0
v_exp_f32 v21, v21
v_mfma_f32_16x16x32_bf16 v[28:31], a[20:23], a[180:183], v[28:31]
ds_read_b128 a[8:11], v66 offset:40960
v_cvt_pk_bf16_f32 v42, v20, v21
v_mfma_f32_16x16x32_bf16 v[28:31], a[24:27], a[184:187], v[28:31]
v_exp_f32 v22, v22
v_mfma_f32_16x16x32_bf16 v[28:31], a[28:31], a[188:191], v[28:31]
ds_read_b128 a[12:15], v67 offset:40960
v_accvgpr_mov_b32 a226, a242
v_mfma_f32_16x16x32_bf16 v[128:131], a[32:35], v[36:39], v[128:131]
v_exp_f32 v23, v23
v_mfma_f32_16x16x32_bf16 v[132:135], a[36:39], v[36:39], v[132:135]
ds_read_b128 a[16:19], v64 offset:45056
v_cvt_pk_bf16_f32 v43, v22, v23
v_mfma_f32_16x16x32_bf16 v[136:139], a[40:43], v[36:39], v[136:139]
ds_read_b128 a[20:23], v65 offset:45056
v_accvgpr_mov_b32 a227, a243
v_mfma_f32_16x16x32_bf16 v[140:143], a[44:47], v[36:39], v[140:143]
v_exp_f32 v24, v24
v_mfma_f32_16x16x32_bf16 v[144:147], a[48:51], v[36:39], v[144:147]
ds_read_b128 a[24:27], v66 offset:45056
v_accvgpr_mov_b32 a228, a244
v_mfma_f32_16x16x32_bf16 v[148:151], a[52:55], v[36:39], v[148:151]
v_exp_f32 v25, v25
v_mfma_f32_16x16x32_bf16 v[152:155], a[56:59], v[36:39], v[152:155]
ds_read_b128 a[28:31], v67 offset:45056
v_cvt_pk_bf16_f32 v44, v24, v25
v_mfma_f32_16x16x32_bf16 v[156:159], a[60:63], v[36:39], v[156:159]
s_waitcnt lgkmcnt(3)
v_exp_f32 v26, v26
v_mfma_f32_16x16x32_bf16 v[52:55], a[96:99], v[36:39], v[52:55]
v_mfma_f32_16x16x32_bf16 v[0:3], a[0:3], a[128:131], 0
s_add_u32 s47, s47, 0x24000
v_exp_f32 v27, v27
v_mfma_f32_16x16x32_bf16 v[0:3], a[4:7], a[132:135], v[0:3]
ds_read_b64_tr_b16 a[64:65], v72 offset:40960
v_cvt_pk_bf16_f32 v45, v26, v27
v_mfma_f32_16x16x32_bf16 v[0:3], a[8:11], a[136:139], v[0:3]
s_waitcnt lgkmcnt(1)
v_exp_f32 v28, v28
v_mfma_f32_16x16x32_bf16 v[0:3], a[12:15], a[140:143], v[0:3]
ds_read_b64_tr_b16 a[66:67], v72 offset:45056
v_accvgpr_mov_b32 a230, a246
v_mfma_f32_16x16x32_bf16 v[4:7], a[16:19], a[128:131], 0
s_add_u32 s48, s48, 0x24000
v_exp_f32 v29, v29
v_mfma_f32_16x16x32_bf16 v[4:7], a[20:23], a[132:135], v[4:7]
ds_read_b64_tr_b16 a[68:69], v73 offset:40960
v_cvt_pk_bf16_f32 v46, v28, v29
v_mfma_f32_16x16x32_bf16 v[4:7], a[24:27], a[136:139], v[4:7]
s_add_u32 s49, s49, 1
v_exp_f32 v30, v30
v_mfma_f32_16x16x32_bf16 v[4:7], a[28:31], a[140:143], v[4:7]
ds_read_b64_tr_b16 a[70:71], v73 offset:45056
v_accvgpr_mov_b32 a231, a247
v_mfma_f32_16x16x32_bf16 v[160:163], a[32:35], v[40:43], v[160:163]
s_cmp_ge_u32 s49, 4
s_cselect_b32 s47, 0x70000000, s47
s_cselect_b32 s48, 0x70000000, s48
v_exp_f32 v31, v31
v_mfma_f32_16x16x32_bf16 v[164:167], a[36:39], v[40:43], v[164:167]
ds_read_b64_tr_b16 a[72:73], v74 offset:40960
v_cvt_pk_bf16_f32 v47, v30, v31
v_mfma_f32_16x16x32_bf16 v[168:171], a[40:43], v[40:43], v[168:171]
ds_read_b64_tr_b16 a[74:75], v74 offset:45056
v_accvgpr_mov_b32 a232, a248
v_mfma_f32_16x16x32_bf16 v[172:175], a[44:47], v[40:43], v[172:175]
v_exp_f32 v0, v0
v_mfma_f32_16x16x32_bf16 v[176:179], a[48:51], v[40:43], v[176:179]
ds_read_b64_tr_b16 a[76:77], v75 offset:40960
v_accvgpr_mov_b32 a233, a249
v_mfma_f32_16x16x32_bf16 v[180:183], a[52:55], v[40:43], v[180:183]
v_exp_f32 v1, v1
v_mfma_f32_16x16x32_bf16 v[184:187], a[56:59], v[40:43], v[184:187]
ds_read_b64_tr_b16 a[78:79], v75 offset:45056
v_cvt_pk_bf16_f32 v32, v0, v1
v_mfma_f32_16x16x32_bf16 v[188:191], a[60:63], v[40:43], v[188:191]
v_exp_f32 v2, v2
v_mfma_f32_16x16x32_bf16 v[56:59], a[96:99], v[40:43], v[56:59]
s_waitcnt lgkmcnt(4)
ds_read_b64_tr_b16 a[80:81], v76 offset:40960
v_accvgpr_mov_b32 a234, a250
v_mfma_f32_16x16x32_bf16 v[8:11], a[0:3], a[144:147], 0
v_exp_f32 v3, v3
v_mfma_f32_16x16x32_bf16 v[8:11], a[4:7], a[148:151], v[8:11]
ds_read_b64_tr_b16 a[82:83], v76 offset:45056
v_cvt_pk_bf16_f32 v33, v2, v3
v_mfma_f32_16x16x32_bf16 v[8:11], a[8:11], a[152:155], v[8:11]
v_exp_f32 v4, v4
v_mfma_f32_16x16x32_bf16 v[8:11], a[12:15], a[156:159], v[8:11]
ds_read_b64_tr_b16 a[84:85], v77 offset:40960
v_accvgpr_mov_b32 a235, a251
v_mfma_f32_16x16x32_bf16 v[12:15], a[16:19], a[144:147], 0
v_exp_f32 v5, v5
v_mfma_f32_16x16x32_bf16 v[12:15], a[20:23], a[148:151], v[12:15]
ds_read_b64_tr_b16 a[86:87], v77 offset:45056
v_cvt_pk_bf16_f32 v34, v4, v5
v_mfma_f32_16x16x32_bf16 v[12:15], a[24:27], a[152:155], v[12:15]
v_exp_f32 v6, v6
v_mfma_f32_16x16x32_bf16 v[12:15], a[28:31], a[156:159], v[12:15]
ds_read_b64_tr_b16 a[88:89], v78 offset:40960
v_accvgpr_mov_b32 a236, a252
v_mfma_f32_16x16x32_bf16 v[192:195], a[32:35], v[44:47], v[192:195]
v_exp_f32 v7, v7
v_mfma_f32_16x16x32_bf16 v[196:199], a[36:39], v[44:47], v[196:199]
ds_read_b64_tr_b16 a[90:91], v78 offset:45056
v_cvt_pk_bf16_f32 v35, v6, v7
v_mfma_f32_16x16x32_bf16 v[200:203], a[40:43], v[44:47], v[200:203]
ds_read_b64_tr_b16 a[92:93], v79 offset:40960
v_accvgpr_mov_b32 a237, a253
v_mfma_f32_16x16x32_bf16 v[204:207], a[44:47], v[44:47], v[204:207]
v_exp_f32 v8, v8
v_mfma_f32_16x16x32_bf16 v[208:211], a[48:51], v[44:47], v[208:211]
ds_read_b64_tr_b16 a[94:95], v79 offset:45056
v_accvgpr_mov_b32 a238, a254
v_mfma_f32_16x16x32_bf16 v[212:215], a[52:55], v[44:47], v[212:215]
v_exp_f32 v9, v9
v_mfma_f32_16x16x32_bf16 v[216:219], a[56:59], v[44:47], v[216:219]
v_cvt_pk_bf16_f32 v36, v8, v9
v_mfma_f32_16x16x32_bf16 v[220:223], a[60:63], v[44:47], v[220:223]
s_add_u32 m0, s55, 0x1c000
v_exp_f32 v10, v10
v_mfma_f32_16x16x32_bf16 v[60:63], a[96:99], v[44:47], v[60:63]
buffer_load_dwordx4 v228, s[24:27], s52 offen lds
v_mfma_f32_16x16x32_bf16 v[16:19], a[0:3], a[160:163], 0
v_exp_f32 v11, v11
v_mfma_f32_16x16x32_bf16 v[16:19], a[4:7], a[164:167], v[16:19]
v_cvt_pk_bf16_f32 v37, v10, v11
v_mfma_f32_16x16x32_bf16 v[16:19], a[8:11], a[168:171], v[16:19]
v_exp_f32 v12, v12
v_mfma_f32_16x16x32_bf16 v[16:19], a[12:15], a[172:175], v[16:19]
buffer_load_dwordx4 v229, s[24:27], s52 offen offset:1024 lds
v_mfma_f32_16x16x32_bf16 v[20:23], a[16:19], a[160:163], 0
v_exp_f32 v13, v13
v_mfma_f32_16x16x32_bf16 v[20:23], a[20:23], a[164:167], v[20:23]
s_waitcnt lgkmcnt(0)
v_cvt_pk_bf16_f32 v38, v12, v13
v_mfma_f32_16x16x32_bf16 v[20:23], a[24:27], a[168:171], v[20:23]
v_exp_f32 v14, v14
v_mfma_f32_16x16x32_bf16 v[20:23], a[28:31], a[172:175], v[20:23]
buffer_load_dwordx4 v228, s[24:27], s52 offen offset:2048 lds
v_mfma_f32_16x16x32_bf16 v[96:99], a[64:67], v[32:35], v[96:99]
v_exp_f32 v15, v15
v_mfma_f32_16x16x32_bf16 v[100:103], a[68:71], v[32:35], v[100:103]
v_cvt_pk_bf16_f32 v39, v14, v15
v_mfma_f32_16x16x32_bf16 v[104:107], a[72:75], v[32:35], v[104:107]
v_mfma_f32_16x16x32_bf16 v[108:111], a[76:79], v[32:35], v[108:111]
v_exp_f32 v16, v16
v_mfma_f32_16x16x32_bf16 v[112:115], a[80:83], v[32:35], v[112:115]
buffer_load_dwordx4 v229, s[24:27], s52 offen offset:3072 lds
v_mfma_f32_16x16x32_bf16 v[116:119], a[84:87], v[32:35], v[116:119]
s_add_u32 s52, s52, 16384
v_exp_f32 v17, v17
v_mfma_f32_16x16x32_bf16 v[120:123], a[88:91], v[32:35], v[120:123]
v_cvt_pk_bf16_f32 v40, v16, v17
v_mfma_f32_16x16x32_bf16 v[124:127], a[92:95], v[32:35], v[124:127]
s_waitcnt vmcnt(8)
v_exp_f32 v18, v18
v_mfma_f32_16x16x32_bf16 v[48:51], a[96:99], v[32:35], v[48:51]
s_barrier
v_mfma_f32_16x16x32_bf16 v[24:27], a[0:3], a[176:179], 0
v_exp_f32 v19, v19
v_mfma_f32_16x16x32_bf16 v[24:27], a[4:7], a[180:183], v[24:27]
ds_read_b128 a[0:3], v68
v_cvt_pk_bf16_f32 v41, v18, v19
v_mfma_f32_16x16x32_bf16 v[24:27], a[8:11], a[184:187], v[24:27]
v_exp_f32 v20, v20
v_mfma_f32_16x16x32_bf16 v[24:27], a[12:15], a[188:191], v[24:27]
ds_read_b128 a[4:7], v69
v_accvgpr_mov_b32 a239, a255
v_mfma_f32_16x16x32_bf16 v[28:31], a[16:19], a[176:179], 0
v_exp_f32 v21, v21
v_mfma_f32_16x16x32_bf16 v[28:31], a[20:23], a[180:183], v[28:31]
ds_read_b128 a[8:11], v70
v_cvt_pk_bf16_f32 v42, v20, v21
v_mfma_f32_16x16x32_bf16 v[28:31], a[24:27], a[184:187], v[28:31]
v_exp_f32 v22, v22
v_mfma_f32_16x16x32_bf16 v[28:31], a[28:31], a[188:191], v[28:31]
ds_read_b128 a[12:15], v71
v_accvgpr_mov_b32 a104, a106
v_mfma_f32_16x16x32_bf16 v[128:131], a[64:67], v[36:39], v[128:131]
v_exp_f32 v23, v23
v_mfma_f32_16x16x32_bf16 v[132:135], a[68:71], v[36:39], v[132:135]
ds_read_b128 a[16:19], v68 offset:4096
v_cvt_pk_bf16_f32 v43, v22, v23
v_mfma_f32_16x16x32_bf16 v[136:139], a[72:75], v[36:39], v[136:139]
ds_read_b128 a[20:23], v69 offset:4096
v_accvgpr_mov_b32 a105, a107
v_mfma_f32_16x16x32_bf16 v[140:143], a[76:79], v[36:39], v[140:143]
v_exp_f32 v24, v24
v_mfma_f32_16x16x32_bf16 v[144:147], a[80:83], v[36:39], v[144:147]
ds_read_b128 a[24:27], v70 offset:4096
v_mfma_f32_16x16x32_bf16 v[148:151], a[84:87], v[36:39], v[148:151]
v_exp_f32 v25, v25
v_mfma_f32_16x16x32_bf16 v[152:155], a[88:91], v[36:39], v[152:155]
ds_read_b128 a[28:31], v71 offset:4096
v_cvt_pk_bf16_f32 v44, v24, v25
v_mfma_f32_16x16x32_bf16 v[156:159], a[92:95], v[36:39], v[156:159]
s_waitcnt lgkmcnt(3)
v_exp_f32 v26, v26
v_mfma_f32_16x16x32_bf16 v[52:55], a[96:99], v[36:39], v[52:55]
s_mov_b32 s59, 0
K3_loop:
v_mfma_f32_16x16x32_bf16 v[0:3], a[0:3], a[128:131], 0
v_exp_f32 v27, v27
v_mfma_f32_16x16x32_bf16 v[0:3], a[4:7], a[132:135], v[0:3]
ds_read_b64_tr_b16 a[32:33], v80
v_cvt_pk_bf16_f32 v45, v26, v27
v_mfma_f32_16x16x32_bf16 v[0:3], a[8:11], a[136:139], v[0:3]
s_waitcnt lgkmcnt(1)
v_exp_f32 v28, v28
v_mfma_f32_16x16x32_bf16 v[0:3], a[12:15], a[140:143], v[0:3]
ds_read_b64_tr_b16 a[34:35], v80 offset:4096
v_mfma_f32_16x16x32_bf16 v[4:7], a[16:19], a[128:131], 0
v_exp_f32 v29, v29
v_mfma_f32_16x16x32_bf16 v[4:7], a[20:23], a[132:135], v[4:7]
ds_read_b64_tr_b16 a[36:37], v81
v_cvt_pk_bf16_f32 v46, v28, v29
v_mfma_f32_16x16x32_bf16 v[4:7], a[24:27], a[136:139], v[4:7]
v_exp_f32 v30, v30
v_mfma_f32_16x16x32_bf16 v[4:7], a[28:31], a[140:143], v[4:7]
ds_read_b64_tr_b16 a[38:39], v81 offset:4096
v_mfma_f32_16x16x32_bf16 v[160:163], a[64:67], v[40:43], v[160:163]
v_exp_f32 v31, v31
v_mfma_f32_16x16x32_bf16 v[164:167], a[68:71], v[40:43], v[164:167]
ds_read_b64_tr_b16 a[40:41], v82
v_cvt_pk_bf16_f32 v47, v30, v31
v_mfma_f32_16x16x32_bf16 v[168:171], a[72:75], v[40:43], v[168:171]
ds_read_b64_tr_b16 a[42:43], v82 offset:4096
v_mfma_f32_16x16x32_bf16 v[172:175], a[76:79], v[40:43], v[172:175]
v_exp_f32 v0, v0
v_mfma_f32_16x16x32_bf16 v[176:179], a[80:83], v[40:43], v[176:179]
ds_read_b64_tr_b16 a[44:45], v83
v_mfma_f32_16x16x32_bf16 v[180:183], a[84:87], v[40:43], v[180:183]
v_exp_f32 v1, v1
v_mfma_f32_16x16x32_bf16 v[184:187], a[88:91], v[40:43], v[184:187]
ds_read_b64_tr_b16 a[46:47], v83 offset:4096
v_cvt_pk_bf16_f32 v32, v0, v1
v_mfma_f32_16x16x32_bf16 v[188:191], a[92:95], v[40:43], v[188:191]
v_exp_f32 v2, v2
v_mfma_f32_16x16x32_bf16 v[56:59], a[96:99], v[40:43], v[56:59]
s_waitcnt lgkmcnt(4)
ds_read_b64_tr_b16 a[48:49], v84
v_mfma_f32_16x16x32_bf16 v[8:11], a[0:3], a[144:147], 0
v_exp_f32 v3, v3
v_mfma_f32_16x16x32_bf16 v[8:11], a[4:7], a[148:151], v[8:11]
ds_read_b64_tr_b16 a[50:51], v84 offset:4096
v_cvt_pk_bf16_f32 v33, v2, v3
v_mfma_f32_16x16x32_bf16 v[8:11], a[8:11], a[152:155], v[8:11]
v_exp_f32 v4, v4
v_mfma_f32_16x16x32_bf16 v[8:11], a[12:15], a[156:159], v[8:11]
ds_read_b64_tr_b16 a[52:53], v85
v_mfma_f32_16x16x32_bf16 v[12:15], a[16:19], a[144:147], 0
v_exp_f32 v5, v5
v_mfma_f32_16x16x32_bf16 v[12:15], a[20:23], a[148:151], v[12:15]
ds_read_b64_tr_b16 a[54:55], v85 offset:4096
v_cvt_pk_bf16_f32 v34, v4, v5
v_mfma_f32_16x16x32_bf16 v[12:15], a[24:27], a[152:155], v[12:15]
v_exp_f32 v6, v6
v_mfma_f32_16x16x32_bf16 v[12:15], a[28:31], a[156:159], v[12:15]
ds_read_b64_tr_b16 a[56:57], v86
v_mfma_f32_16x16x32_bf16 v[192:195], a[64:67], v[44:47], v[192:195]
v_exp_f32 v7, v7
v_mfma_f32_16x16x32_bf16 v[196:199], a[68:71], v[44:47], v[196:199]
ds_read_b64_tr_b16 a[58:59], v86 offset:4096
v_cvt_pk_bf16_f32 v35, v6, v7
v_mfma_f32_16x16x32_bf16 v[200:203], a[72:75], v[44:47], v[200:203]
ds_read_b64_tr_b16 a[60:61], v87
v_mfma_f32_16x16x32_bf16 v[204:207], a[76:79], v[44:47], v[204:207]
v_exp_f32 v8, v8
v_mfma_f32_16x16x32_bf16 v[208:211], a[80:83], v[44:47], v[208:211]
ds_read_b64_tr_b16 a[62:63], v87 offset:4096
v_mfma_f32_16x16x32_bf16 v[212:215], a[84:87], v[44:47], v[212:215]
v_exp_f32 v9, v9
v_mfma_f32_16x16x32_bf16 v[216:219], a[88:91], v[44:47], v[216:219]
v_cvt_pk_bf16_f32 v36, v8, v9
v_mfma_f32_16x16x32_bf16 v[220:223], a[92:95], v[44:47], v[220:223]
s_add_u32 m0, s55, 0x0
v_exp_f32 v10, v10
v_mfma_f32_16x16x32_bf16 v[60:63], a[96:99], v[44:47], v[60:63]
buffer_load_dwordx4 v224, s[20:23], s51 offen lds
v_mfma_f32_16x16x32_bf16 v[16:19], a[0:3], a[160:163], 0
v_exp_f32 v11, v11
v_mfma_f32_16x16x32_bf16 v[16:19], a[4:7], a[164:167], v[16:19]
v_cvt_pk_bf16_f32 v37, v10, v11
v_mfma_f32_16x16x32_bf16 v[16:19], a[8:11], a[168:171], v[16:19]
v_exp_f32 v12, v12
v_mfma_f32_16x16x32_bf16 v[16:19], a[12:15], a[172:175], v[16:19]
buffer_load_dwordx4 v225, s[20:23], s51 offen offset:1024 lds
v_mfma_f32_16x16x32_bf16 v[20:23], a[16:19], a[160:163], 0
v_exp_f32 v13, v13
v_mfma_f32_16x16x32_bf16 v[20:23], a[20:23], a[164:167], v[20:23]
s_waitcnt lgkmcnt(0)
v_cvt_pk_bf16_f32 v38, v12, v13
v_mfma_f32_16x16x32_bf16 v[20:23], a[24:27], a[168:171], v[20:23]
v_exp_f32 v14, v14
v_mfma_f32_16x16x32_bf16 v[20:23], a[28:31], a[172:175], v[20:23]
buffer_load_dwordx4 v226, s[20:23], s51 offen offset:2048 lds
v_mfma_f32_16x16x32_bf16 v[96:99], a[32:35], v[32:35], v[96:99]
v_exp_f32 v15, v15
v_mfma_f32_16x16x32_bf16 v[100:103], a[36:39], v[32:35], v[100:103]
v_cvt_pk_bf16_f32 v39, v14, v15
v_mfma_f32_16x16x32_bf16 v[104:107], a[40:43], v[32:35], v[104:107]
buffer_store_dwordx4 a[192:195], v88, s[28:31], s47 offen sc1
v_mfma_f32_16x16x32_bf16 v[108:111], a[44:47], v[32:35], v[108:111]
v_exp_f32 v16, v16
v_mfma_f32_16x16x32_bf16 v[112:115], a[48:51], v[32:35], v[112:115]
buffer_load_dwordx4 v227, s[20:23], s51 offen offset:3072 lds
v_mfma_f32_16x16x32_bf16 v[116:119], a[52:55], v[32:35], v[116:119]
s_add_u32 s51, s51, 16384
v_exp_f32 v17, v17
v_mfma_f32_16x16x32_bf16 v[120:123], a[56:59], v[32:35], v[120:123]
v_cvt_pk_bf16_f32 v40, v16, v17
v_mfma_f32_16x16x32_bf16 v[124:127], a[60:63], v[32:35], v[124:127]
v_exp_f32 v18, v18
v_mfma_f32_16x16x32_bf16 v[48:51], a[96:99], v[32:35], v[48:51]
v_mfma_f32_16x16x32_bf16 v[24:27], a[0:3], a[176:179], 0
v_exp_f32 v19, v19
v_mfma_f32_16x16x32_bf16 v[24:27], a[4:7], a[180:183], v[24:27]
ds_read_b128 a[0:3], v68 offset:8192
v_cvt_pk_bf16_f32 v41, v18, v19
v_mfma_f32_16x16x32_bf16 v[24:27], a[8:11], a[184:187], v[24:27]
v_exp_f32 v20, v20
v_mfma_f32_16x16x32_bf16 v[24:27], a[12:15], a[188:191], v[24:27]
ds_read_b128 a[4:7], v69 offset:8192
v_mfma_f32_16x16x32_bf16 v[28:31], a[16:19], a[176:179], 0
v_exp_f32 v21, v21
v_mfma_f32_16x16x32_bf16 v[28:31], a[20:23], a[180:183], v[28:31]
ds_read_b128 a[8:11], v70 offset:8192
v_cvt_pk_bf16_f32 v42, v20, v21
v_mfma_f32_16x16x32_bf16 v[28:31], a[24:27], a[184:187], v[28:31]
v_exp_f32 v22, v22
v_mfma_f32_16x16x32_bf16 v[28:31], a[28:31], a[188:191], v[28:31]
ds_read_b128 a[12:15], v71 offset:8192
v_mfma_f32_16x16x32_bf16 v[128:131], a[32:35], v[36:39], v[128:131]
v_exp_f32 v23, v23
v_mfma_f32_16x16x32_bf16 v[132:135], a[36:39], v[36:39], v[132:135]
ds_read_b128 a[16:19], v68 offset:12288
v_cvt_pk_bf16_f32 v43, v22, v23
v_mfma_f32_16x16x32_bf16 v[136:139], a[40:43], v[36:39], v[136:139]
ds_read_b128 a[20:23], v69 offset:12288
v_mfma_f32_16x16x32_bf16 v[140:143], a[44:47], v[36:39], v[140:143]
v_exp_f32 v24, v24
v_mfma_f32_16x16x32_bf16 v[144:147], a[48:51], v[36:39], v[144:147]
ds_read_b128 a[24:27], v70 offset:12288
v_mfma_f32_16x16x32_bf16 v[148:151], a[52:55], v[36:39], v[148:151]
v_exp_f32 v25, v25
v_mfma_f32_16x16x32_bf16 v[152:155], a[56:59], v[36:39], v[152:155]
ds_read_b128 a[28:31], v71 offset:12288
v_cvt_pk_bf16_f32 v44, v24, v25
v_mfma_f32_16x16x32_bf16 v[156:159], a[60:63], v[36:39], v[156:159]
s_waitcnt lgkmcnt(3)
v_exp_f32 v26, v26
v_mfma_f32_16x16x32_bf16 v[52:55], a[96:99], v[36:39], v[52:55]
buffer_store_dwordx4 a[196:199], v88, s[28:31], s47 offen offset:1024 sc1
v_mfma_f32_16x16x32_bf16 v[0:3], a[0:3], a[128:131], 0
s_add_u32 s46, s46, 768
v_exp_f32 v27, v27
v_mfma_f32_16x16x32_bf16 v[0:3], a[4:7], a[132:135], v[0:3]
ds_read_b64_tr_b16 a[64:65], v80 offset:8192
v_cvt_pk_bf16_f32 v45, v26, v27
v_mfma_f32_16x16x32_bf16 v[0:3], a[8:11], a[136:139], v[0:3]
s_waitcnt lgkmcnt(1)
v_exp_f32 v28, v28
v_mfma_f32_16x16x32_bf16 v[0:3], a[12:15], a[140:143], v[0:3]
ds_read_b64_tr_b16 a[66:67], v80 offset:12288
v_mfma_f32_16x16x32_bf16 v[4:7], a[16:19], a[128:131], 0
v_exp_f32 v29, v29
v_mfma_f32_16x16x32_bf16 v[4:7], a[20:23], a[132:135], v[4:7]
ds_read_b64_tr_b16 a[68:69], v81 offset:8192
v_cvt_pk_bf16_f32 v46, v28, v29
v_mfma_f32_16x16x32_bf16 v[4:7], a[24:27], a[136:139], v[4:7]
v_exp_f32 v30, v30
v_mfma_f32_16x16x32_bf16 v[4:7], a[28:31], a[140:143], v[4:7]
ds_read_b64_tr_b16 a[70:71], v81 offset:12288
v_mfma_f32_16x16x32_bf16 v[160:163], a[32:35], v[40:43], v[160:163]
v_exp_f32 v31, v31
v_mfma_f32_16x16x32_bf16 v[164:167], a[36:39], v[40:43], v[164:167]
ds_read_b64_tr_b16 a[72:73], v82 offset:8192
v_cvt_pk_bf16_f32 v47, v30, v31
v_mfma_f32_16x16x32_bf16 v[168:171], a[40:43], v[40:43], v[168:171]
ds_read_b64_tr_b16 a[74:75], v82 offset:12288
v_mfma_f32_16x16x32_bf16 v[172:175], a[44:47], v[40:43], v[172:175]
v_exp_f32 v0, v0
v_mfma_f32_16x16x32_bf16 v[176:179], a[48:51], v[40:43], v[176:179]
ds_read_b64_tr_b16 a[76:77], v83 offset:8192
v_mfma_f32_16x16x32_bf16 v[180:183], a[52:55], v[40:43], v[180:183]
v_exp_f32 v1, v1
v_mfma_f32_16x16x32_bf16 v[184:187], a[56:59], v[40:43], v[184:187]
ds_read_b64_tr_b16 a[78:79], v83 offset:12288
v_cvt_pk_bf16_f32 v32, v0, v1
v_mfma_f32_16x16x32_bf16 v[188:191], a[60:63], v[40:43], v[188:191]
v_exp_f32 v2, v2
v_mfma_f32_16x16x32_bf16 v[56:59], a[96:99], v[40:43], v[56:59]
s_waitcnt lgkmcnt(4)
ds_read_b64_tr_b16 a[80:81], v84 offset:8192
v_mfma_f32_16x16x32_bf16 v[8:11], a[0:3], a[144:147], 0
v_exp_f32 v3, v3
v_mfma_f32_16x16x32_bf16 v[8:11], a[4:7], a[148:151], v[8:11]
ds_read_b64_tr_b16 a[82:83], v84 offset:12288
v_cvt_pk_bf16_f32 v33, v2, v3
v_mfma_f32_16x16x32_bf16 v[8:11], a[8:11], a[152:155], v[8:11]
v_exp_f32 v4, v4
v_mfma_f32_16x16x32_bf16 v[8:11], a[12:15], a[156:159], v[8:11]
ds_read_b64_tr_b16 a[84:85], v85 offset:8192
v_mfma_f32_16x16x32_bf16 v[12:15], a[16:19], a[144:147], 0
v_exp_f32 v5, v5
v_mfma_f32_16x16x32_bf16 v[12:15], a[20:23], a[148:151], v[12:15]
ds_read_b64_tr_b16 a[86:87], v85 offset:12288
v_cvt_pk_bf16_f32 v34, v4, v5
v_mfma_f32_16x16x32_bf16 v[12:15], a[24:27], a[152:155], v[12:15]
v_exp_f32 v6, v6
v_mfma_f32_16x16x32_bf16 v[12:15], a[28:31], a[156:159], v[12:15]
ds_read_b64_tr_b16 a[88:89], v86 offset:8192
v_mfma_f32_16x16x32_bf16 v[192:195], a[32:35], v[44:47], v[192:195]
v_exp_f32 v7, v7
v_mfma_f32_16x16x32_bf16 v[196:199], a[36:39], v[44:47], v[196:199]
ds_read_b64_tr_b16 a[90:91], v86 offset:12288
v_cvt_pk_bf16_f32 v35, v6, v7
v_mfma_f32_16x16x32_bf16 v[200:203], a[40:43], v[44:47], v[200:203]
ds_read_b64_tr_b16 a[92:93], v87 offset:8192
v_mfma_f32_16x16x32_bf16 v[204:207], a[44:47], v[44:47], v[204:207]
v_exp_f32 v8, v8
v_mfma_f32_16x16x32_bf16 v[208:211], a[48:51], v[44:47], v[208:211]
ds_read_b64_tr_b16 a[94:95], v87 offset:12288
v_mfma_f32_16x16x32_bf16 v[212:215], a[52:55], v[44:47], v[212:215]
v_exp_f32 v9, v9
v_mfma_f32_16x16x32_bf16 v[216:219], a[56:59], v[44:47], v[216:219]
v_cvt_pk_bf16_f32 v36, v8, v9
v_mfma_f32_16x16x32_bf16 v[220:223], a[60:63], v[44:47], v[220:223]
s_add_u32 m0, s55, 0x4000
v_exp_f32 v10, v10
v_mfma_f32_16x16x32_bf16 v[60:63], a[96:99], v[44:47], v[60:63]
buffer_load_dwordx4 v228, s[24:27], s52 offen lds
v_mfma_f32_16x16x32_bf16 v[16:19], a[0:3], a[160:163], 0
v_exp_f32 v11, v11
v_mfma_f32_16x16x32_bf16 v[16:19], a[4:7], a[164:167], v[16:19]
v_cvt_pk_bf16_f32 v37, v10, v11
v_mfma_f32_16x16x32_bf16 v[16:19], a[8:11], a[168:171], v[16:19]
v_exp_f32 v12, v12
v_mfma_f32_16x16x32_bf16 v[16:19], a[12:15], a[172:175], v[16:19]
buffer_load_dwordx4 v229, s[24:27], s52 offen offset:1024 lds
v_mfma_f32_16x16x32_bf16 v[20:23], a[16:19], a[160:163], 0
v_exp_f32 v13, v13
v_mfma_f32_16x16x32_bf16 v[20:23], a[20:23], a[164:167], v[20:23]
s_waitcnt lgkmcnt(0)
v_cvt_pk_bf16_f32 v38, v12, v13
v_mfma_f32_16x16x32_bf16 v[20:23], a[24:27], a[168:171], v[20:23]
v_exp_f32 v14, v14
v_mfma_f32_16x16x32_bf16 v[20:23], a[28:31], a[172:175], v[20:23]
buffer_load_dwordx4 v228, s[24:27], s52 offen offset:2048 lds
v_mfma_f32_16x16x32_bf16 v[96:99], a[64:67], v[32:35], v[96:99]
v_exp_f32 v15, v15
v_mfma_f32_16x16x32_bf16 v[100:103], a[68:71], v[32:35], v[100:103]
v_cvt_pk_bf16_f32 v39, v14, v15
v_mfma_f32_16x16x32_bf16 v[104:107], a[72:75], v[32:35], v[104:107]
buffer_store_dwordx4 a[200:203], v88, s[28:31], s47 offen offset:2048 sc1
v_mfma_f32_16x16x32_bf16 v[108:111], a[76:79], v[32:35], v[108:111]
v_exp_f32 v16, v16
v_mfma_f32_16x16x32_bf16 v[112:115], a[80:83], v[32:35], v[112:115]
buffer_load_dwordx4 v229, s[24:27], s52 offen offset:3072 lds
v_mfma_f32_16x16x32_bf16 v[116:119], a[84:87], v[32:35], v[116:119]
s_add_u32 s52, s52, 16384
v_exp_f32 v17, v17
v_mfma_f32_16x16x32_bf16 v[120:123], a[88:91], v[32:35], v[120:123]
v_cvt_pk_bf16_f32 v40, v16, v17
v_mfma_f32_16x16x32_bf16 v[124:127], a[92:95], v[32:35], v[124:127]
s_waitcnt vmcnt(11)
v_exp_f32 v18, v18
v_mfma_f32_16x16x32_bf16 v[48:51], a[96:99], v[32:35], v[48:51]
s_barrier
buffer_load_dword v93, v92, s[76:79], s45 offen
v_mfma_f32_16x16x32_bf16 v[24:27], a[0:3], a[176:179], 0
v_exp_f32 v19, v19
v_mfma_f32_16x16x32_bf16 v[24:27], a[4:7], a[180:183], v[24:27]
ds_read_b128 a[0:3], v68 offset:32768
v_cvt_pk_bf16_f32 v41, v18, v19
v_mfma_f32_16x16x32_bf16 v[24:27], a[8:11], a[184:187], v[24:27]
v_exp_f32 v20, v20
v_mfma_f32_16x16x32_bf16 v[24:27], a[12:15], a[188:191], v[24:27]
ds_read_b128 a[4:7], v69 offset:32768
v_mfma_f32_16x16x32_bf16 v[28:31], a[16:19], a[176:179], 0
v_exp_f32 v21, v21
v_mfma_f32_16x16x32_bf16 v[28:31], a[20:23], a[180:183], v[28:31]
ds_read_b128 a[8:11], v70 offset:32768
v_cvt_pk_bf16_f32 v42, v20, v21
v_mfma_f32_16x16x32_bf16 v[28:31], a[24:27], a[184:187], v[28:31]
v_exp_f32 v22, v22
v_mfma_f32_16x16x32_bf16 v[28:31], a[28:31], a[188:191], v[28:31]
ds_read_b128 a[12:15], v71 offset:32768
v_mfma_f32_16x16x32_bf16 v[128:131], a[64:67], v[36:39], v[128:131]
v_exp_f32 v23, v23
v_mfma_f32_16x16x32_bf16 v[132:135], a[68:71], v[36:39], v[132:135]
ds_read_b128 a[16:19], v68 offset:36864
v_cvt_pk_bf16_f32 v43, v22, v23
v_mfma_f32_16x16x32_bf16 v[136:139], a[72:75], v[36:39], v[136:139]
ds_read_b128 a[20:23], v69 offset:36864
v_mfma_f32_16x16x32_bf16 v[140:143], a[76:79], v[36:39], v[140:143]
v_exp_f32 v24, v24
v_mfma_f32_16x16x32_bf16 v[144:147], a[80:83], v[36:39], v[144:147]
ds_read_b128 a[24:27], v70 offset:36864
v_mfma_f32_16x16x32_bf16 v[148:151], a[84:87], v[36:39], v[148:151]
s_add_u32 s45, s45, 768
v_exp_f32 v25, v25
v_mfma_f32_16x16x32_bf16 v[152:155], a[88:91], v[36:39], v[152:155]
ds_read_b128 a[28:31], v71 offset:36864
v_cvt_pk_bf16_f32 v44, v24, v25
v_mfma_f32_16x16x32_bf16 v[156:159], a[92:95], v[36:39], v[156:159]
s_waitcnt lgkmcnt(3)
v_exp_f32 v26, v26
v_mfma_f32_16x16x32_bf16 v[52:55], a[96:99], v[36:39], v[52:55]
buffer_load_dword v95, v94, s[96:99], s46 offen
v_mfma_f32_16x16x32_bf16 v[0:3], a[0:3], a[128:131], 0
v_exp_f32 v27, v27
v_mfma_f32_16x16x32_bf16 v[0:3], a[4:7], a[132:135], v[0:3]
ds_read_b64_tr_b16 a[32:33], v80 offset:32768
v_cvt_pk_bf16_f32 v45, v26, v27
v_mfma_f32_16x16x32_bf16 v[0:3], a[8:11], a[136:139], v[0:3]
s_waitcnt lgkmcnt(1)
v_exp_f32 v28, v28
v_mfma_f32_16x16x32_bf16 v[0:3], a[12:15], a[140:143], v[0:3]
ds_read_b64_tr_b16 a[34:35], v80 offset:36864
v_mfma_f32_16x16x32_bf16 v[4:7], a[16:19], a[128:131], 0
v_exp_f32 v29, v29
v_mfma_f32_16x16x32_bf16 v[4:7], a[20:23], a[132:135], v[4:7]
ds_read_b64_tr_b16 a[36:37], v81 offset:32768
v_cvt_pk_bf16_f32 v46, v28, v29
v_mfma_f32_16x16x32_bf16 v[4:7], a[24:27], a[136:139], v[4:7]
v_exp_f32 v30, v30
v_mfma_f32_16x16x32_bf16 v[4:7], a[28:31], a[140:143], v[4:7]
ds_read_b64_tr_b16 a[38:39], v81 offset:36864
v_mfma_f32_16x16x32_bf16 v[160:163], a[64:67], v[40:43], v[160:163]
v_exp_f32 v31, v31
v_mfma_f32_16x16x32_bf16 v[164:167], a[68:71], v[40:43], v[164:167]
ds_read_b64_tr_b16 a[40:41], v82 offset:32768
v_cvt_pk_bf16_f32 v47, v30, v31
v_mfma_f32_16x16x32_bf16 v[168:171], a[72:75], v[40:43], v[168:171]
ds_read_b64_tr_b16 a[42:43], v82 offset:36864
v_mfma_f32_16x16x32_bf16 v[172:175], a[76:79], v[40:43], v[172:175]
v_exp_f32 v0, v0
v_mfma_f32_16x16x32_bf16 v[176:179], a[80:83], v[40:43], v[176:179]
ds_read_b64_tr_b16 a[44:45], v83 offset:32768
v_mfma_f32_16x16x32_bf16 v[180:183], a[84:87], v[40:43], v[180:183]
v_exp_f32 v1, v1
v_mfma_f32_16x16x32_bf16 v[184:187], a[88:91], v[40:43], v[184:187]
ds_read_b64_tr_b16 a[46:47], v83 offset:36864
v_cvt_pk_bf16_f32 v32, v0, v1
v_mfma_f32_16x16x32_bf16 v[188:191], a[92:95], v[40:43], v[188:191]
v_exp_f32 v2, v2
v_mfma_f32_16x16x32_bf16 v[56:59], a[96:99], v[40:43], v[56:59]
s_waitcnt lgkmcnt(4)
ds_read_b64_tr_b16 a[48:49], v84 offset:32768
v_mfma_f32_16x16x32_bf16 v[8:11], a[0:3], a[144:147], 0
v_exp_f32 v3, v3
v_mfma_f32_16x16x32_bf16 v[8:11], a[4:7], a[148:151], v[8:11]
ds_read_b64_tr_b16 a[50:51], v84 offset:36864
v_cvt_pk_bf16_f32 v33, v2, v3
v_mfma_f32_16x16x32_bf16 v[8:11], a[8:11], a[152:155], v[8:11]
v_exp_f32 v4, v4
v_mfma_f32_16x16x32_bf16 v[8:11], a[12:15], a[156:159], v[8:11]
ds_read_b64_tr_b16 a[52:53], v85 offset:32768
v_mfma_f32_16x16x32_bf16 v[12:15], a[16:19], a[144:147], 0
v_exp_f32 v5, v5
v_mfma_f32_16x16x32_bf16 v[12:15], a[20:23], a[148:151], v[12:15]
ds_read_b64_tr_b16 a[54:55], v85 offset:36864
v_cvt_pk_bf16_f32 v34, v4, v5
v_mfma_f32_16x16x32_bf16 v[12:15], a[24:27], a[152:155], v[12:15]
v_exp_f32 v6, v6
v_mfma_f32_16x16x32_bf16 v[12:15], a[28:31], a[156:159], v[12:15]
ds_read_b64_tr_b16 a[56:57], v86 offset:32768
v_mfma_f32_16x16x32_bf16 v[192:195], a[64:67], v[44:47], v[192:195]
v_exp_f32 v7, v7
v_mfma_f32_16x16x32_bf16 v[196:199], a[68:71], v[44:47], v[196:199]
ds_read_b64_tr_b16 a[58:59], v86 offset:36864
v_cvt_pk_bf16_f32 v35, v6, v7
v_mfma_f32_16x16x32_bf16 v[200:203], a[72:75], v[44:47], v[200:203]
ds_read_b64_tr_b16 a[60:61], v87 offset:32768
v_mfma_f32_16x16x32_bf16 v[204:207], a[76:79], v[44:47], v[204:207]
v_exp_f32 v8, v8
v_mfma_f32_16x16x32_bf16 v[208:211], a[80:83], v[44:47], v[208:211]
ds_read_b64_tr_b16 a[62:63], v87 offset:36864
v_mfma_f32_16x16x32_bf16 v[212:215], a[84:87], v[44:47], v[212:215]
v_exp_f32 v9, v9
v_mfma_f32_16x16x32_bf16 v[216:219], a[88:91], v[44:47], v[216:219]
v_cvt_pk_bf16_f32 v36, v8, v9
v_mfma_f32_16x16x32_bf16 v[220:223], a[92:95], v[44:47], v[220:223]
s_add_u32 m0, s55, 0x8000
v_exp_f32 v10, v10
v_mfma_f32_16x16x32_bf16 v[60:63], a[96:99], v[44:47], v[60:63]
buffer_load_dwordx4 v224, s[20:23], s51 offen lds
v_mfma_f32_16x16x32_bf16 v[16:19], a[0:3], a[160:163], 0
v_exp_f32 v11, v11
v_mfma_f32_16x16x32_bf16 v[16:19], a[4:7], a[164:167], v[16:19]
v_cvt_pk_bf16_f32 v37, v10, v11
v_mfma_f32_16x16x32_bf16 v[16:19], a[8:11], a[168:171], v[16:19]
v_exp_f32 v12, v12
v_mfma_f32_16x16x32_bf16 v[16:19], a[12:15], a[172:175], v[16:19]
buffer_load_dwordx4 v225, s[20:23], s51 offen offset:1024 lds
v_mfma_f32_16x16x32_bf16 v[20:23], a[16:19], a[160:163], 0
v_exp_f32 v13, v13
v_mfma_f32_16x16x32_bf16 v[20:23], a[20:23], a[164:167], v[20:23]
s_waitcnt lgkmcnt(0)
v_cvt_pk_bf16_f32 v38, v12, v13
v_mfma_f32_16x16x32_bf16 v[20:23], a[24:27], a[168:171], v[20:23]
v_exp_f32 v14, v14
v_mfma_f32_16x16x32_bf16 v[20:23], a[28:31], a[172:175], v[20:23]
buffer_load_dwordx4 v226, s[20:23], s51 offen offset:2048 lds
v_mfma_f32_16x16x32_bf16 v[96:99], a[32:35], v[32:35], v[96:99]
v_exp_f32 v15, v15
v_mfma_f32_16x16x32_bf16 v[100:103], a[36:39], v[32:35], v[100:103]
v_cvt_pk_bf16_f32 v39, v14, v15
v_mfma_f32_16x16x32_bf16 v[104:107], a[40:43], v[32:35], v[104:107]
buffer_store_dwordx4 a[204:207], v88, s[28:31], s47 offen offset:3072 sc1
v_mfma_f32_16x16x32_bf16 v[108:111], a[44:47], v[32:35], v[108:111]
v_exp_f32 v16, v16
v_mfma_f32_16x16x32_bf16 v[112:115], a[48:51], v[32:35], v[112:115]
buffer_load_dwordx4 v227, s[20:23], s51 offen offset:3072 lds
v_mfma_f32_16x16x32_bf16 v[116:119], a[52:55], v[32:35], v[116:119]
s_add_u32 s51, s51, 16384
v_exp_f32 v17, v17
v_mfma_f32_16x16x32_bf16 v[120:123], a[56:59], v[32:35], v[120:123]
v_cvt_pk_bf16_f32 v40, v16, v17
v_mfma_f32_16x16x32_bf16 v[124:127], a[60:63], v[32:35], v[124:127]
v_exp_f32 v18, v18
v_mfma_f32_16x16x32_bf16 v[48:51], a[96:99], v[32:35], v[48:51]
v_mfma_f32_16x16x32_bf16 v[24:27], a[0:3], a[176:179], 0
v_exp_f32 v19, v19
v_mfma_f32_16x16x32_bf16 v[24:27], a[4:7], a[180:183], v[24:27]
ds_read_b128 a[0:3], v68 offset:40960
v_cvt_pk_bf16_f32 v41, v18, v19
v_mfma_f32_16x16x32_bf16 v[24:27], a[8:11], a[184:187], v[24:27]
v_exp_f32 v20, v20
v_mfma_f32_16x16x32_bf16 v[24:27], a[12:15], a[188:191], v[24:27]
ds_read_b128 a[4:7], v69 offset:40960
v_mfma_f32_16x16x32_bf16 v[28:31], a[16:19], a[176:179], 0
v_exp_f32 v21, v21
v_mfma_f32_16x16x32_bf16 v[28:31], a[20:23], a[180:183], v[28:31]
ds_read_b128 a[8:11], v70 offset:40960
v_cvt_pk_bf16_f32 v42, v20, v21
v_mfma_f32_16x16x32_bf16 v[28:31], a[24:27], a[184:187], v[28:31]
v_exp_f32 v22, v22
v_mfma_f32_16x16x32_bf16 v[28:31], a[28:31], a[188:191], v[28:31]
ds_read_b128 a[12:15], v71 offset:40960
v_mfma_f32_16x16x32_bf16 v[128:131], a[32:35], v[36:39], v[128:131]
v_exp_f32 v23, v23
v_mfma_f32_16x16x32_bf16 v[132:135], a[36:39], v[36:39], v[132:135]
ds_read_b128 a[16:19], v68 offset:45056
v_cvt_pk_bf16_f32 v43, v22, v23
v_mfma_f32_16x16x32_bf16 v[136:139], a[40:43], v[36:39], v[136:139]
ds_read_b128 a[20:23], v69 offset:45056
v_mfma_f32_16x16x32_bf16 v[140:143], a[44:47], v[36:39], v[140:143]
v_exp_f32 v24, v24
v_mfma_f32_16x16x32_bf16 v[144:147], a[48:51], v[36:39], v[144:147]
ds_read_b128 a[24:27], v70 offset:45056
v_mfma_f32_16x16x32_bf16 v[148:151], a[52:55], v[36:39], v[148:151]
v_exp_f32 v25, v25
v_mfma_f32_16x16x32_bf16 v[152:155], a[56:59], v[36:39], v[152:155]
ds_read_b128 a[28:31], v71 offset:45056
v_cvt_pk_bf16_f32 v44, v24, v25
v_mfma_f32_16x16x32_bf16 v[156:159], a[60:63], v[36:39], v[156:159]
s_waitcnt lgkmcnt(3)
v_exp_f32 v26, v26
v_mfma_f32_16x16x32_bf16 v[52:55], a[96:99], v[36:39], v[52:55]
buffer_store_dwordx2 a[100:101], v88, s[28:31], s48 offen sc1
v_mfma_f32_16x16x32_bf16 v[0:3], a[0:3], a[128:131], 0
v_exp_f32 v27, v27
v_mfma_f32_16x16x32_bf16 v[0:3], a[4:7], a[132:135], v[0:3]
ds_read_b64_tr_b16 a[64:65], v80 offset:40960
v_cvt_pk_bf16_f32 v45, v26, v27
v_mfma_f32_16x16x32_bf16 v[0:3], a[8:11], a[136:139], v[0:3]
s_waitcnt lgkmcnt(1)
v_exp_f32 v28, v28
v_mfma_f32_16x16x32_bf16 v[0:3], a[12:15], a[140:143], v[0:3]
ds_read_b64_tr_b16 a[66:67], v80 offset:45056
v_mfma_f32_16x16x32_bf16 v[4:7], a[16:19], a[128:131], 0
v_exp_f32 v29, v29
v_mfma_f32_16x16x32_bf16 v[4:7], a[20:23], a[132:135], v[4:7]
ds_read_b64_tr_b16 a[68:69], v81 offset:40960
v_cvt_pk_bf16_f32 v46, v28, v29
v_mfma_f32_16x16x32_bf16 v[4:7], a[24:27], a[136:139], v[4:7]
v_exp_f32 v30, v30
v_mfma_f32_16x16x32_bf16 v[4:7], a[28:31], a[140:143], v[4:7]
ds_read_b64_tr_b16 a[70:71], v81 offset:45056
v_mfma_f32_16x16x32_bf16 v[160:163], a[32:35], v[40:43], v[160:163]
v_exp_f32 v31, v31
v_mfma_f32_16x16x32_bf16 v[164:167], a[36:39], v[40:43], v[164:167]
ds_read_b64_tr_b16 a[72:73], v82 offset:40960
v_cvt_pk_bf16_f32 v47, v30, v31
v_mfma_f32_16x16x32_bf16 v[168:171], a[40:43], v[40:43], v[168:171]
ds_read_b64_tr_b16 a[74:75], v82 offset:45056
v_mfma_f32_16x16x32_bf16 v[172:175], a[44:47], v[40:43], v[172:175]
v_exp_f32 v0, v0
v_mfma_f32_16x16x32_bf16 v[176:179], a[48:51], v[40:43], v[176:179]
ds_read_b64_tr_b16 a[76:77], v83 offset:40960
v_mfma_f32_16x16x32_bf16 v[180:183], a[52:55], v[40:43], v[180:183]
v_exp_f32 v1, v1
v_mfma_f32_16x16x32_bf16 v[184:187], a[56:59], v[40:43], v[184:187]
ds_read_b64_tr_b16 a[78:79], v83 offset:45056
v_cvt_pk_bf16_f32 v32, v0, v1
v_mfma_f32_16x16x32_bf16 v[188:191], a[60:63], v[40:43], v[188:191]
v_exp_f32 v2, v2
v_mfma_f32_16x16x32_bf16 v[56:59], a[96:99], v[40:43], v[56:59]
s_waitcnt lgkmcnt(4)
ds_read_b64_tr_b16 a[80:81], v84 offset:40960
v_mfma_f32_16x16x32_bf16 v[8:11], a[0:3], a[144:147], 0
v_exp_f32 v3, v3
v_mfma_f32_16x16x32_bf16 v[8:11], a[4:7], a[148:151], v[8:11]
ds_read_b64_tr_b16 a[82:83], v84 offset:45056
v_cvt_pk_bf16_f32 v33, v2, v3
v_mfma_f32_16x16x32_bf16 v[8:11], a[8:11], a[152:155], v[8:11]
v_exp_f32 v4, v4
v_mfma_f32_16x16x32_bf16 v[8:11], a[12:15], a[156:159], v[8:11]
ds_read_b64_tr_b16 a[84:85], v85 offset:40960
v_mfma_f32_16x16x32_bf16 v[12:15], a[16:19], a[144:147], 0
v_exp_f32 v5, v5
v_mfma_f32_16x16x32_bf16 v[12:15], a[20:23], a[148:151], v[12:15]
ds_read_b64_tr_b16 a[86:87], v85 offset:45056
v_cvt_pk_bf16_f32 v34, v4, v5
v_mfma_f32_16x16x32_bf16 v[12:15], a[24:27], a[152:155], v[12:15]
v_exp_f32 v6, v6
v_mfma_f32_16x16x32_bf16 v[12:15], a[28:31], a[156:159], v[12:15]
ds_read_b64_tr_b16 a[88:89], v86 offset:40960
v_mfma_f32_16x16x32_bf16 v[192:195], a[32:35], v[44:47], v[192:195]
v_exp_f32 v7, v7
v_mfma_f32_16x16x32_bf16 v[196:199], a[36:39], v[44:47], v[196:199]
ds_read_b64_tr_b16 a[90:91], v86 offset:45056
v_cvt_pk_bf16_f32 v35, v6, v7
v_mfma_f32_16x16x32_bf16 v[200:203], a[40:43], v[44:47], v[200:203]
ds_read_b64_tr_b16 a[92:93], v87 offset:40960
v_mfma_f32_16x16x32_bf16 v[204:207], a[44:47], v[44:47], v[204:207]
v_exp_f32 v8, v8
v_mfma_f32_16x16x32_bf16 v[208:211], a[48:51], v[44:47], v[208:211]
ds_read_b64_tr_b16 a[94:95], v87 offset:45056
v_mfma_f32_16x16x32_bf16 v[212:215], a[52:55], v[44:47], v[212:215]
v_exp_f32 v9, v9
v_mfma_f32_16x16x32_bf16 v[216:219], a[56:59], v[44:47], v[216:219]
v_cvt_pk_bf16_f32 v36, v8, v9
v_mfma_f32_16x16x32_bf16 v[220:223], a[60:63], v[44:47], v[220:223]
s_add_u32 m0, s55, 0xc000
v_exp_f32 v10, v10
v_mfma_f32_16x16x32_bf16 v[60:63], a[96:99], v[44:47], v[60:63]
buffer_load_dwordx4 v228, s[24:27], s52 offen lds
v_mfma_f32_16x16x32_bf16 v[16:19], a[0:3], a[160:163], 0
v_exp_f32 v11, v11
v_mfma_f32_16x16x32_bf16 v[16:19], a[4:7], a[164:167], v[16:19]
v_cvt_pk_bf16_f32 v37, v10, v11
v_mfma_f32_16x16x32_bf16 v[16:19], a[8:11], a[168:171], v[16:19]
v_exp_f32 v12, v12
v_mfma_f32_16x16x32_bf16 v[16:19], a[12:15], a[172:175], v[16:19]
buffer_load_dwordx4 v229, s[24:27], s52 offen offset:1024 lds
v_mfma_f32_16x16x32_bf16 v[20:23], a[16:19], a[160:163], 0
v_exp_f32 v13, v13
v_mfma_f32_16x16x32_bf16 v[20:23], a[20:23], a[164:167], v[20:23]
s_waitcnt lgkmcnt(0)
v_cvt_pk_bf16_f32 v38, v12, v13
v_mfma_f32_16x16x32_bf16 v[20:23], a[24:27], a[168:171], v[20:23]
v_exp_f32 v14, v14
v_mfma_f32_16x16x32_bf16 v[20:23], a[28:31], a[172:175], v[20:23]
buffer_load_dwordx4 v228, s[24:27], s52 offen offset:2048 lds
v_mfma_f32_16x16x32_bf16 v[96:99], a[64:67], v[32:35], v[96:99]
v_exp_f32 v15, v15
v_mfma_f32_16x16x32_bf16 v[100:103], a[68:71], v[32:35], v[100:103]
v_cvt_pk_bf16_f32 v39, v14, v15
v_mfma_f32_16x16x32_bf16 v[104:107], a[72:75], v[32:35], v[104:107]
v_mfma_f32_16x16x32_bf16 v[108:111], a[76:79], v[32:35], v[108:111]
v_exp_f32 v16, v16
v_mfma_f32_16x16x32_bf16 v[112:115], a[80:83], v[32:35], v[112:115]
buffer_load_dwordx4 v229, s[24:27], s52 offen offset:3072 lds
v_mfma_f32_16x16x32_bf16 v[116:119], a[84:87], v[32:35], v[116:119]
s_add_u32 s52, s52, 16384
v_exp_f32 v17, v17
v_mfma_f32_16x16x32_bf16 v[120:123], a[88:91], v[32:35], v[120:123]
v_cvt_pk_bf16_f32 v40, v16, v17
v_mfma_f32_16x16x32_bf16 v[124:127], a[92:95], v[32:35], v[124:127]
s_waitcnt vmcnt(12)
v_exp_f32 v18, v18
v_mfma_f32_16x16x32_bf16 v[48:51], a[96:99], v[32:35], v[48:51]
s_barrier
buffer_load_dword v90, v89, s[4:7], 0 offen
v_mfma_f32_16x16x32_bf16 v[24:27], a[0:3], a[176:179], 0
v_exp_f32 v19, v19
v_mfma_f32_16x16x32_bf16 v[24:27], a[4:7], a[180:183], v[24:27]
ds_read_b128 a[0:3], v64
v_cvt_pk_bf16_f32 v41, v18, v19
v_mfma_f32_16x16x32_bf16 v[24:27], a[8:11], a[184:187], v[24:27]
v_exp_f32 v20, v20
v_mfma_f32_16x16x32_bf16 v[24:27], a[12:15], a[188:191], v[24:27]
ds_read_b128 a[4:7], v65
v_mfma_f32_16x16x32_bf16 v[28:31], a[16:19], a[176:179], 0
v_exp_f32 v21, v21
v_mfma_f32_16x16x32_bf16 v[28:31], a[20:23], a[180:183], v[28:31]
ds_read_b128 a[8:11], v66
v_cvt_pk_bf16_f32 v42, v20, v21
v_mfma_f32_16x16x32_bf16 v[28:31], a[24:27], a[184:187], v[28:31]
v_exp_f32 v22, v22
v_mfma_f32_16x16x32_bf16 v[28:31], a[28:31], a[188:191], v[28:31]
ds_read_b128 a[12:15], v67
v_mfma_f32_16x16x32_bf16 v[128:131], a[64:67], v[36:39], v[128:131]
v_exp_f32 v23, v23
v_mfma_f32_16x16x32_bf16 v[132:135], a[68:71], v[36:39], v[132:135]
ds_read_b128 a[16:19], v64 offset:4096
v_cvt_pk_bf16_f32 v43, v22, v23
v_mfma_f32_16x16x32_bf16 v[136:139], a[72:75], v[36:39], v[136:139]
ds_read_b128 a[20:23], v65 offset:4096
v_mfma_f32_16x16x32_bf16 v[140:143], a[76:79], v[36:39], v[140:143]
v_exp_f32 v24, v24
v_mfma_f32_16x16x32_bf16 v[144:147], a[80:83], v[36:39], v[144:147]
ds_read_b128 a[24:27], v66 offset:4096
v_mfma_f32_16x16x32_bf16 v[148:151], a[84:87], v[36:39], v[148:151]
v_exp_f32 v25, v25
v_mfma_f32_16x16x32_bf16 v[152:155], a[88:91], v[36:39], v[152:155]
ds_read_b128 a[28:31], v67 offset:4096
v_cvt_pk_bf16_f32 v44, v24, v25
v_mfma_f32_16x16x32_bf16 v[156:159], a[92:95], v[36:39], v[156:159]
s_waitcnt lgkmcnt(3)
v_exp_f32 v26, v26
v_mfma_f32_16x16x32_bf16 v[52:55], a[96:99], v[36:39], v[52:55]
v_mfma_f32_16x16x32_bf16 v[0:3], a[0:3], a[128:131], 0
v_exp_f32 v27, v27
v_mfma_f32_16x16x32_bf16 v[0:3], a[4:7], a[132:135], v[0:3]
ds_read_b64_tr_b16 a[32:33], v72
v_cvt_pk_bf16_f32 v45, v26, v27
v_mfma_f32_16x16x32_bf16 v[0:3], a[8:11], a[136:139], v[0:3]
s_waitcnt lgkmcnt(1)
v_exp_f32 v28, v28
v_mfma_f32_16x16x32_bf16 v[0:3], a[12:15], a[140:143], v[0:3]
ds_read_b64_tr_b16 a[34:35], v72 offset:4096
v_accvgpr_mov_b32 a192, a208
v_mfma_f32_16x16x32_bf16 v[4:7], a[16:19], a[128:131], 0
v_exp_f32 v29, v29
v_mfma_f32_16x16x32_bf16 v[4:7], a[20:23], a[132:135], v[4:7]
ds_read_b64_tr_b16 a[36:37], v73
v_cvt_pk_bf16_f32 v46, v28, v29
v_mfma_f32_16x16x32_bf16 v[4:7], a[24:27], a[136:139], v[4:7]
v_exp_f32 v30, v30
v_mfma_f32_16x16x32_bf16 v[4:7], a[28:31], a[140:143], v[4:7]
ds_read_b64_tr_b16 a[38:39], v73 offset:4096
v_accvgpr_mov_b32 a193, a209
v_mfma_f32_16x16x32_bf16 v[160:163], a[64:67], v[40:43], v[160:163]
v_exp_f32 v31, v31
v_mfma_f32_16x16x32_bf16 v[164:167], a[68:71], v[40:43], v[164:167]
ds_read_b64_tr_b16 a[40:41], v74
v_cvt_pk_bf16_f32 v47, v30, v31
v_mfma_f32_16x16x32_bf16 v[168:171], a[72:75], v[40:43], v[168:171]
ds_read_b64_tr_b16 a[42:43], v74 offset:4096
v_accvgpr_mov_b32 a194, a210
v_mfma_f32_16x16x32_bf16 v[172:175], a[76:79], v[40:43], v[172:175]
v_exp_f32 v0, v0
v_mfma_f32_16x16x32_bf16 v[176:179], a[80:83], v[40:43], v[176:179]
ds_read_b64_tr_b16 a[44:45], v75
v_accvgpr_mov_b32 a195, a211
v_mfma_f32_16x16x32_bf16 v[180:183], a[84:87], v[40:43], v[180:183]
v_exp_f32 v1, v1
v_mfma_f32_16x16x32_bf16 v[184:187], a[88:91], v[40:43], v[184:187]
ds_read_b64_tr_b16 a[46:47], v75 offset:4096
v_cvt_pk_bf16_f32 v32, v0, v1
v_mfma_f32_16x16x32_bf16 v[188:191], a[92:95], v[40:43], v[188:191]
v_exp_f32 v2, v2
v_mfma_f32_16x16x32_bf16 v[56:59], a[96:99], v[40:43], v[56:59]
s_waitcnt lgkmcnt(4)
ds_read_b64_tr_b16 a[48:49], v76
v_accvgpr_mov_b32 a196, a212
v_mfma_f32_16x16x32_bf16 v[8:11], a[0:3], a[144:147], 0
v_exp_f32 v3, v3
v_mfma_f32_16x16x32_bf16 v[8:11], a[4:7], a[148:151], v[8:11]
ds_read_b64_tr_b16 a[50:51], v76 offset:4096
v_cvt_pk_bf16_f32 v33, v2, v3
v_mfma_f32_16x16x32_bf16 v[8:11], a[8:11], a[152:155], v[8:11]
v_exp_f32 v4, v4
v_mfma_f32_16x16x32_bf16 v[8:11], a[12:15], a[156:159], v[8:11]
ds_read_b64_tr_b16 a[52:53], v77
v_accvgpr_mov_b32 a197, a213
v_mfma_f32_16x16x32_bf16 v[12:15], a[16:19], a[144:147], 0
v_exp_f32 v5, v5
v_mfma_f32_16x16x32_bf16 v[12:15], a[20:23], a[148:151], v[12:15]
ds_read_b64_tr_b16 a[54:55], v77 offset:4096
v_cvt_pk_bf16_f32 v34, v4, v5
v_mfma_f32_16x16x32_bf16 v[12:15], a[24:27], a[152:155], v[12:15]
v_exp_f32 v6, v6
v_mfma_f32_16x16x32_bf16 v[12:15], a[28:31], a[156:159], v[12:15]
ds_read_b64_tr_b16 a[56:57], v78
v_accvgpr_mov_b32 a198, a214
v_mfma_f32_16x16x32_bf16 v[192:195], a[64:67], v[44:47], v[192:195]
v_exp_f32 v7, v7
v_mfma_f32_16x16x32_bf16 v[196:199], a[68:71], v[44:47], v[196:199]
ds_read_b64_tr_b16 a[58:59], v78 offset:4096
v_cvt_pk_bf16_f32 v35, v6, v7
v_mfma_f32_16x16x32_bf16 v[200:203], a[72:75], v[44:47], v[200:203]
ds_read_b64_tr_b16 a[60:61], v79
v_accvgpr_mov_b32 a199, a215
v_mfma_f32_16x16x32_bf16 v[204:207], a[76:79], v[44:47], v[204:207]
s_cmp_eq_u32 s59, 6
s_cselect_b32 s51, 0x70000000, s51
v_exp_f32 v8, v8
v_mfma_f32_16x16x32_bf16 v[208:211], a[80:83], v[44:47], v[208:211]
ds_read_b64_tr_b16 a[62:63], v79 offset:4096
v_accvgpr_mov_b32 a200, a216
v_mfma_f32_16x16x32_bf16 v[212:215], a[84:87], v[44:47], v[212:215]
v_exp_f32 v9, v9
v_mfma_f32_16x16x32_bf16 v[216:219], a[88:91], v[44:47], v[216:219]
v_cvt_pk_bf16_f32 v36, v8, v9
v_mfma_f32_16x16x32_bf16 v[220:223], a[92:95], v[44:47], v[220:223]
s_add_u32 m0, s55, 0x10000
v_exp_f32 v10, v10
v_mfma_f32_16x16x32_bf16 v[60:63], a[96:99], v[44:47], v[60:63]
buffer_load_dwordx4 v224, s[20:23], s51 offen lds
v_mfma_f32_16x16x32_bf16 v[16:19], a[0:3], a[160:163], 0
v_exp_f32 v11, v11
v_mfma_f32_16x16x32_bf16 v[16:19], a[4:7], a[164:167], v[16:19]
v_cvt_pk_bf16_f32 v37, v10, v11
v_mfma_f32_16x16x32_bf16 v[16:19], a[8:11], a[168:171], v[16:19]
v_exp_f32 v12, v12
v_mfma_f32_16x16x32_bf16 v[16:19], a[12:15], a[172:175], v[16:19]
buffer_load_dwordx4 v225, s[20:23], s51 offen offset:1024 lds
v_mfma_f32_16x16x32_bf16 v[20:23], a[16:19], a[160:163], 0
v_exp_f32 v13, v13
v_mfma_f32_16x16x32_bf16 v[20:23], a[20:23], a[164:167], v[20:23]
s_waitcnt lgkmcnt(0)
v_cvt_pk_bf16_f32 v38, v12, v13
v_mfma_f32_16x16x32_bf16 v[20:23], a[24:27], a[168:171], v[20:23]
v_exp_f32 v14, v14
v_mfma_f32_16x16x32_bf16 v[20:23], a[28:31], a[172:175], v[20:23]
buffer_load_dwordx4 v226, s[20:23], s51 offen offset:2048 lds
v_mfma_f32_16x16x32_bf16 v[96:99], a[32:35], v[32:35], v[96:99]
v_exp_f32 v15, v15
v_mfma_f32_16x16x32_bf16 v[100:103], a[36:39], v[32:35], v[100:103]
v_cvt_pk_bf16_f32 v39, v14, v15
v_mfma_f32_16x16x32_bf16 v[104:107], a[40:43], v[32:35], v[104:107]
v_accvgpr_mov_b32 a205, a221
v_mfma_f32_16x16x32_bf16 v[108:111], a[44:47], v[32:35], v[108:111]
v_exp_f32 v16, v16
v_mfma_f32_16x16x32_bf16 v[112:115], a[48:51], v[32:35], v[112:115]
buffer_load_dwordx4 v227, s[20:23], s51 offen offset:3072 lds
v_mfma_f32_16x16x32_bf16 v[116:119], a[52:55], v[32:35], v[116:119]
s_add_u32 s51, s51, 16384
v_exp_f32 v17, v17
v_mfma_f32_16x16x32_bf16 v[120:123], a[56:59], v[32:35], v[120:123]
v_cvt_pk_bf16_f32 v40, v16, v17
v_mfma_f32_16x16x32_bf16 v[124:127], a[60:63], v[32:35], v[124:127]
v_exp_f32 v18, v18
v_mfma_f32_16x16x32_bf16 v[48:51], a[96:99], v[32:35], v[48:51]
v_mfma_f32_16x16x32_bf16 v[24:27], a[0:3], a[176:179], 0
v_exp_f32 v19, v19
v_mfma_f32_16x16x32_bf16 v[24:27], a[4:7], a[180:183], v[24:27]
ds_read_b128 a[0:3], v64 offset:8192
v_cvt_pk_bf16_f32 v41, v18, v19
v_mfma_f32_16x16x32_bf16 v[24:27], a[8:11], a[184:187], v[24:27]
v_exp_f32 v20, v20
v_mfma_f32_16x16x32_bf16 v[24:27], a[12:15], a[188:191], v[24:27]
ds_read_b128 a[4:7], v65 offset:8192
v_accvgpr_mov_b32 a201, a217
v_mfma_f32_16x16x32_bf16 v[28:31], a[16:19], a[176:179], 0
v_exp_f32 v21, v21
v_mfma_f32_16x16x32_bf16 v[28:31], a[20:23], a[180:183], v[28:31]
ds_read_b128 a[8:11], v66 offset:8192
v_cvt_pk_bf16_f32 v42, v20, v21
v_mfma_f32_16x16x32_bf16 v[28:31], a[24:27], a[184:187], v[28:31]
v_exp_f32 v22, v22
v_mfma_f32_16x16x32_bf16 v[28:31], a[28:31], a[188:191], v[28:31]
ds_read_b128 a[12:15], v67 offset:8192
v_accvgpr_mov_b32 a202, a218
v_mfma_f32_16x16x32_bf16 v[128:131], a[32:35], v[36:39], v[128:131]
v_exp_f32 v23, v23
v_mfma_f32_16x16x32_bf16 v[132:135], a[36:39], v[36:39], v[132:135]
ds_read_b128 a[16:19], v64 offset:12288
v_cvt_pk_bf16_f32 v43, v22, v23
v_mfma_f32_16x16x32_bf16 v[136:139], a[40:43], v[36:39], v[136:139]
ds_read_b128 a[20:23], v65 offset:12288
v_accvgpr_mov_b32 a203, a219
v_mfma_f32_16x16x32_bf16 v[140:143], a[44:47], v[36:39], v[140:143]
v_exp_f32 v24, v24
v_mfma_f32_16x16x32_bf16 v[144:147], a[48:51], v[36:39], v[144:147]
ds_read_b128 a[24:27], v66 offset:12288
v_accvgpr_mov_b32 a204, a220
v_mfma_f32_16x16x32_bf16 v[148:151], a[52:55], v[36:39], v[148:151]
v_exp_f32 v25, v25
v_mfma_f32_16x16x32_bf16 v[152:155], a[56:59], v[36:39], v[152:155]
ds_read_b128 a[28:31], v67 offset:12288
v_cvt_pk_bf16_f32 v44, v24, v25
v_mfma_f32_16x16x32_bf16 v[156:159], a[60:63], v[36:39], v[156:159]
s_waitcnt lgkmcnt(3)
v_exp_f32 v26, v26
v_mfma_f32_16x16x32_bf16 v[52:55], a[96:99], v[36:39], v[52:55]
v_mfma_f32_16x16x32_bf16 v[0:3], a[0:3], a[128:131], 0
v_exp_f32 v27, v27
v_mfma_f32_16x16x32_bf16 v[0:3], a[4:7], a[132:135], v[0:3]
ds_read_b64_tr_b16 a[64:65], v72 offset:8192
v_cvt_pk_bf16_f32 v45, v26, v27
v_mfma_f32_16x16x32_bf16 v[0:3], a[8:11], a[136:139], v[0:3]
s_waitcnt lgkmcnt(1)
v_exp_f32 v28, v28
v_mfma_f32_16x16x32_bf16 v[0:3], a[12:15], a[140:143], v[0:3]
ds_read_b64_tr_b16 a[66:67], v72 offset:12288
v_accvgpr_mov_b32 a206, a222
v_mfma_f32_16x16x32_bf16 v[4:7], a[16:19], a[128:131], 0
v_exp_f32 v29, v29
v_mfma_f32_16x16x32_bf16 v[4:7], a[20:23], a[132:135], v[4:7]
ds_read_b64_tr_b16 a[68:69], v73 offset:8192
v_cvt_pk_bf16_f32 v46, v28, v29
v_mfma_f32_16x16x32_bf16 v[4:7], a[24:27], a[136:139], v[4:7]
v_exp_f32 v30, v30
v_mfma_f32_16x16x32_bf16 v[4:7], a[28:31], a[140:143], v[4:7]
ds_read_b64_tr_b16 a[70:71], v73 offset:12288
v_accvgpr_mov_b32 a207, a223
v_mfma_f32_16x16x32_bf16 v[160:163], a[32:35], v[40:43], v[160:163]
v_exp_f32 v31, v31
v_mfma_f32_16x16x32_bf16 v[164:167], a[36:39], v[40:43], v[164:167]
ds_read_b64_tr_b16 a[72:73], v74 offset:8192
v_cvt_pk_bf16_f32 v47, v30, v31
v_mfma_f32_16x16x32_bf16 v[168:171], a[40:43], v[40:43], v[168:171]
ds_read_b64_tr_b16 a[74:75], v74 offset:12288
v_accvgpr_mov_b32 a100, a102
v_mfma_f32_16x16x32_bf16 v[172:175], a[44:47], v[40:43], v[172:175]
v_exp_f32 v0, v0
v_mfma_f32_16x16x32_bf16 v[176:179], a[48:51], v[40:43], v[176:179]
ds_read_b64_tr_b16 a[76:77], v75 offset:8192
v_accvgpr_mov_b32 a101, a103
v_mfma_f32_16x16x32_bf16 v[180:183], a[52:55], v[40:43], v[180:183]
v_exp_f32 v1, v1
v_mfma_f32_16x16x32_bf16 v[184:187], a[56:59], v[40:43], v[184:187]
ds_read_b64_tr_b16 a[78:79], v75 offset:12288
v_cvt_pk_bf16_f32 v32, v0, v1
v_mfma_f32_16x16x32_bf16 v[188:191], a[60:63], v[40:43], v[188:191]
v_exp_f32 v2, v2
v_mfma_f32_16x16x32_bf16 v[56:59], a[96:99], v[40:43], v[56:59]
s_waitcnt lgkmcnt(4)
ds_read_b64_tr_b16 a[80:81], v76 offset:8192
v_accvgpr_mov_b32 a208, a224
v_mfma_f32_16x16x32_bf16 v[8:11], a[0:3], a[144:147], 0
v_exp_f32 v3, v3
v_mfma_f32_16x16x32_bf16 v[8:11], a[4:7], a[148:151], v[8:11]
ds_read_b64_tr_b16 a[82:83], v76 offset:12288
v_cvt_pk_bf16_f32 v33, v2, v3
v_mfma_f32_16x16x32_bf16 v[8:11], a[8:11], a[152:155], v[8:11]
v_exp_f32 v4, v4
v_mfma_f32_16x16x32_bf16 v[8:11], a[12:15], a[156:159], v[8:11]
ds_read_b64_tr_b16 a[84:85], v77 offset:8192
v_accvgpr_mov_b32 a209, a225
v_mfma_f32_16x16x32_bf16 v[12:15], a[16:19], a[144:147], 0
v_exp_f32 v5, v5
v_mfma_f32_16x16x32_bf16 v[12:15], a[20:23], a[148:151], v[12:15]
ds_read_b64_tr_b16 a[86:87], v77 offset:12288
v_cvt_pk_bf16_f32 v34, v4, v5
v_mfma_f32_16x16x32_bf16 v[12:15], a[24:27], a[152:155], v[12:15]
v_exp_f32 v6, v6
v_mfma_f32_16x16x32_bf16 v[12:15], a[28:31], a[156:159], v[12:15]
ds_read_b64_tr_b16 a[88:89], v78 offset:8192
v_accvgpr_mov_b32 a210, a226
v_mfma_f32_16x16x32_bf16 v[192:195], a[32:35], v[44:47], v[192:195]
v_exp_f32 v7, v7
v_mfma_f32_16x16x32_bf16 v[196:199], a[36:39], v[44:47], v[196:199]
ds_read_b64_tr_b16 a[90:91], v78 offset:12288
v_cvt_pk_bf16_f32 v35, v6, v7
v_mfma_f32_16x16x32_bf16 v[200:203], a[40:43], v[44:47], v[200:203]
ds_read_b64_tr_b16 a[92:93], v79 offset:8192
v_accvgpr_mov_b32 a211, a227
v_mfma_f32_16x16x32_bf16 v[204:207], a[44:47], v[44:47], v[204:207]
s_cmp_eq_u32 s59, 6
s_cselect_b32 s52, 0x70000000, s52
v_exp_f32 v8, v8
v_mfma_f32_16x16x32_bf16 v[208:211], a[48:51], v[44:47], v[208:211]
ds_read_b64_tr_b16 a[94:95], v79 offset:12288
v_accvgpr_mov_b32 a212, a228
v_mfma_f32_16x16x32_bf16 v[212:215], a[52:55], v[44:47], v[212:215]
v_exp_f32 v9, v9
v_mfma_f32_16x16x32_bf16 v[216:219], a[56:59], v[44:47], v[216:219]
v_cvt_pk_bf16_f32 v36, v8, v9
v_mfma_f32_16x16x32_bf16 v[220:223], a[60:63], v[44:47], v[220:223]
s_add_u32 m0, s55, 0x14000
v_exp_f32 v10, v10
v_mfma_f32_16x16x32_bf16 v[60:63], a[96:99], v[44:47], v[60:63]
buffer_load_dwordx4 v228, s[24:27], s52 offen lds
v_mfma_f32_16x16x32_bf16 v[16:19], a[0:3], a[160:163], 0
v_exp_f32 v11, v11
v_mfma_f32_16x16x32_bf16 v[16:19], a[4:7], a[164:167], v[16:19]
v_cvt_pk_bf16_f32 v37, v10, v11
v_mfma_f32_16x16x32_bf16 v[16:19], a[8:11], a[168:171], v[16:19]
v_exp_f32 v12, v12
v_mfma_f32_16x16x32_bf16 v[16:19], a[12:15], a[172:175], v[16:19]
buffer_load_dwordx4 v229, s[24:27], s52 offen offset:1024 lds
v_mfma_f32_16x16x32_bf16 v[20:23], a[16:19], a[160:163], 0
v_exp_f32 v13, v13
v_mfma_f32_16x16x32_bf16 v[20:23], a[20:23], a[164:167], v[20:23]
s_waitcnt lgkmcnt(0)
v_cvt_pk_bf16_f32 v38, v12, v13
v_mfma_f32_16x16x32_bf16 v[20:23], a[24:27], a[168:171], v[20:23]
v_exp_f32 v14, v14
v_mfma_f32_16x16x32_bf16 v[20:23], a[28:31], a[172:175], v[20:23]
buffer_load_dwordx4 v228, s[24:27], s52 offen offset:2048 lds
v_mfma_f32_16x16x32_bf16 v[96:99], a[64:67], v[32:35], v[96:99]
v_exp_f32 v15, v15
v_mfma_f32_16x16x32_bf16 v[100:103], a[68:71], v[32:35], v[100:103]
v_cvt_pk_bf16_f32 v39, v14, v15
v_mfma_f32_16x16x32_bf16 v[104:107], a[72:75], v[32:35], v[104:107]
v_accvgpr_mov_b32 a217, a233
v_mfma_f32_16x16x32_bf16 v[108:111], a[76:79], v[32:35], v[108:111]
v_exp_f32 v16, v16
v_mfma_f32_16x16x32_bf16 v[112:115], a[80:83], v[32:35], v[112:115]
buffer_load_dwordx4 v229, s[24:27], s52 offen offset:3072 lds
v_mfma_f32_16x16x32_bf16 v[116:119], a[84:87], v[32:35], v[116:119]
s_add_u32 s52, s52, 16384
v_exp_f32 v17, v17
v_mfma_f32_16x16x32_bf16 v[120:123], a[88:91], v[32:35], v[120:123]
v_cvt_pk_bf16_f32 v40, v16, v17
v_mfma_f32_16x16x32_bf16 v[124:127], a[92:95], v[32:35], v[124:127]
s_waitcnt vmcnt(9)
v_exp_f32 v18, v18
v_mfma_f32_16x16x32_bf16 v[48:51], a[96:99], v[32:35], v[48:51]
s_barrier
v_mfma_f32_16x16x32_bf16 v[24:27], a[0:3], a[176:179], 0
v_exp_f32 v19, v19
v_mfma_f32_16x16x32_bf16 v[24:27], a[4:7], a[180:183], v[24:27]
ds_read_b128 a[0:3], v64 offset:32768
v_cvt_pk_bf16_f32 v41, v18, v19
v_mfma_f32_16x16x32_bf16 v[24:27], a[8:11], a[184:187], v[24:27]
v_exp_f32 v20, v20
v_mfma_f32_16x16x32_bf16 v[24:27], a[12:15], a[188:191], v[24:27]
ds_read_b128 a[4:7], v65 offset:32768
v_accvgpr_mov_b32 a213, a229
v_mfma_f32_16x16x32_bf16 v[28:31], a[16:19], a[176:179], 0
v_exp_f32 v21, v21
v_mfma_f32_16x16x32_bf16 v[28:31], a[20:23], a[180:183], v[28:31]
ds_read_b128 a[8:11], v66 offset:32768
v_cvt_pk_bf16_f32 v42, v20, v21
v_mfma_f32_16x16x32_bf16 v[28:31], a[24:27], a[184:187], v[28:31]
v_exp_f32 v22, v22
v_mfma_f32_16x16x32_bf16 v[28:31], a[28:31], a[188:191], v[28:31]
ds_read_b128 a[12:15], v67 offset:32768
v_accvgpr_mov_b32 a214, a230
v_mfma_f32_16x16x32_bf16 v[128:131], a[64:67], v[36:39], v[128:131]
v_exp_f32 v23, v23
v_mfma_f32_16x16x32_bf16 v[132:135], a[68:71], v[36:39], v[132:135]
ds_read_b128 a[16:19], v64 offset:36864
v_cvt_pk_bf16_f32 v43, v22, v23
v_mfma_f32_16x16x32_bf16 v[136:139], a[72:75], v[36:39], v[136:139]
ds_read_b128 a[20:23], v65 offset:36864
v_accvgpr_mov_b32 a215, a231
v_mfma_f32_16x16x32_bf16 v[140:143], a[76:79], v[36:39], v[140:143]
v_exp_f32 v24, v24
v_mfma_f32_16x16x32_bf16 v[144:147], a[80:83], v[36:39], v[144:147]
ds_read_b128 a[24:27], v66 offset:36864
v_accvgpr_mov_b32 a216, a232
v_mfma_f32_16x16x32_bf16 v[148:151], a[84:87], v[36:39], v[148:151]
v_exp_f32 v25, v25
v_mfma_f32_16x16x32_bf16 v[152:155], a[88:91], v[36:39], v[152:155]
ds_read_b128 a[28:31], v67 offset:36864
v_cvt_pk_bf16_f32 v44, v24, v25
v_mfma_f32_16x16x32_bf16 v[156:159], a[92:95], v[36:39], v[156:159]
s_waitcnt lgkmcnt(3)
v_exp_f32 v26, v26
v_mfma_f32_16x16x32_bf16 v[52:55], a[96:99], v[36:39], v[52:55]
v_mfma_f32_16x16x32_bf16 v[0:3], a[0:3], a[128:131], 0
v_exp_f32 v27, v27
v_mfma_f32_16x16x32_bf16 v[0:3], a[4:7], a[132:135], v[0:3]
ds_read_b64_tr_b16 a[32:33], v72 offset:32768
v_cvt_pk_bf16_f32 v45, v26, v27
v_mfma_f32_16x16x32_bf16 v[0:3], a[8:11], a[136:139], v[0:3]
s_waitcnt lgkmcnt(1)
v_exp_f32 v28, v28
v_mfma_f32_16x16x32_bf16 v[0:3], a[12:15], a[140:143], v[0:3]
ds_read_b64_tr_b16 a[34:35], v72 offset:36864
v_accvgpr_mov_b32 a218, a234
v_mfma_f32_16x16x32_bf16 v[4:7], a[16:19], a[128:131], 0
v_exp_f32 v29, v29
v_mfma_f32_16x16x32_bf16 v[4:7], a[20:23], a[132:135], v[4:7]
ds_read_b64_tr_b16 a[36:37], v73 offset:32768
v_cvt_pk_bf16_f32 v46, v28, v29
v_mfma_f32_16x16x32_bf16 v[4:7], a[24:27], a[136:139], v[4:7]
v_exp_f32 v30, v30
v_mfma_f32_16x16x32_bf16 v[4:7], a[28:31], a[140:143], v[4:7]
ds_read_b64_tr_b16 a[38:39], v73 offset:36864
v_accvgpr_mov_b32 a219, a235
v_mfma_f32_16x16x32_bf16 v[160:163], a[64:67], v[40:43], v[160:163]
v_exp_f32 v31, v31
v_mfma_f32_16x16x32_bf16 v[164:167], a[68:71], v[40:43], v[164:167]
ds_read_b64_tr_b16 a[40:41], v74 offset:32768
v_cvt_pk_bf16_f32 v47, v30, v31
v_mfma_f32_16x16x32_bf16 v[168:171], a[72:75], v[40:43], v[168:171]
ds_read_b64_tr_b16 a[42:43], v74 offset:36864
v_accvgpr_mov_b32 a220, a236
v_mfma_f32_16x16x32_bf16 v[172:175], a[76:79], v[40:43], v[172:175]
v_exp_f32 v0, v0
v_mfma_f32_16x16x32_bf16 v[176:179], a[80:83], v[40:43], v[176:179]
ds_read_b64_tr_b16 a[44:45], v75 offset:32768
v_accvgpr_mov_b32 a221, a237
v_mfma_f32_16x16x32_bf16 v[180:183], a[84:87], v[40:43], v[180:183]
v_exp_f32 v1, v1
v_mfma_f32_16x16x32_bf16 v[184:187], a[88:91], v[40:43], v[184:187]
ds_read_b64_tr_b16 a[46:47], v75 offset:36864
v_cvt_pk_bf16_f32 v32, v0, v1
v_mfma_f32_16x16x32_bf16 v[188:191], a[92:95], v[40:43], v[188:191]
v_exp_f32 v2, v2
v_mfma_f32_16x16x32_bf16 v[56:59], a[96:99], v[40:43], v[56:59]
s_waitcnt lgkmcnt(4)
ds_read_b64_tr_b16 a[48:49], v76 offset:32768
v_accvgpr_mov_b32 a222, a238
v_mfma_f32_16x16x32_bf16 v[8:11], a[0:3], a[144:147], 0
v_exp_f32 v3, v3
v_mfma_f32_16x16x32_bf16 v[8:11], a[4:7], a[148:151], v[8:11]
ds_read_b64_tr_b16 a[50:51], v76 offset:36864
v_cvt_pk_bf16_f32 v33, v2, v3
v_mfma_f32_16x16x32_bf16 v[8:11], a[8:11], a[152:155], v[8:11]
v_exp_f32 v4, v4
v_mfma_f32_16x16x32_bf16 v[8:11], a[12:15], a[156:159], v[8:11]
ds_read_b64_tr_b16 a[52:53], v77 offset:32768
v_accvgpr_mov_b32 a223, a239
v_mfma_f32_16x16x32_bf16 v[12:15], a[16:19], a[144:147], 0
v_exp_f32 v5, v5
v_mfma_f32_16x16x32_bf16 v[12:15], a[20:23], a[148:151], v[12:15]
ds_read_b64_tr_b16 a[54:55], v77 offset:36864
v_cvt_pk_bf16_f32 v34, v4, v5
v_mfma_f32_16x16x32_bf16 v[12:15], a[24:27], a[152:155], v[12:15]
v_exp_f32 v6, v6
v_mfma_f32_16x16x32_bf16 v[12:15], a[28:31], a[156:159], v[12:15]
ds_read_b64_tr_b16 a[56:57], v78 offset:32768
v_accvgpr_mov_b32 a102, a104
v_mfma_f32_16x16x32_bf16 v[192:195], a[64:67], v[44:47], v[192:195]
v_exp_f32 v7, v7
v_mfma_f32_16x16x32_bf16 v[196:199], a[68:71], v[44:47], v[196:199]
ds_read_b64_tr_b16 a[58:59], v78 offset:36864
v_cvt_pk_bf16_f32 v35, v6, v7
v_mfma_f32_16x16x32_bf16 v[200:203], a[72:75], v[44:47], v[200:203]
ds_read_b64_tr_b16 a[60:61], v79 offset:32768
v_accvgpr_mov_b32 a103, a105
v_mfma_f32_16x16x32_bf16 v[204:207], a[76:79], v[44:47], v[204:207]
v_exp_f32 v8, v8
v_mfma_f32_16x16x32_bf16 v[208:211], a[80:83], v[44:47], v[208:211]
ds_read_b64_tr_b16 a[62:63], v79 offset:36864
v_accvgpr_mov_b32 a224, a240
v_mfma_f32_16x16x32_bf16 v[212:215], a[84:87], v[44:47], v[212:215]
v_exp_f32 v9, v9
v_mfma_f32_16x16x32_bf16 v[216:219], a[88:91], v[44:47], v[216:219]
v_cvt_pk_bf16_f32 v36, v8, v9
v_mfma_f32_16x16x32_bf16 v[220:223], a[92:95], v[44:47], v[220:223]
s_add_u32 m0, s55, 0x18000
v_exp_f32 v10, v10
v_mfma_f32_16x16x32_bf16 v[60:63], a[96:99], v[44:47], v[60:63]
buffer_load_dwordx4 v224, s[20:23], s51 offen lds
v_mfma_f32_16x16x32_bf16 v[16:19], a[0:3], a[160:163], 0
v_exp_f32 v11, v11
v_mfma_f32_16x16x32_bf16 v[16:19], a[4:7], a[164:167], v[16:19]
v_cvt_pk_bf16_f32 v37, v10, v11
v_mfma_f32_16x16x32_bf16 v[16:19], a[8:11], a[168:171], v[16:19]
v_exp_f32 v12, v12
v_mfma_f32_16x16x32_bf16 v[16:19], a[12:15], a[172:175], v[16:19]
buffer_load_dwordx4 v225, s[20:23], s51 offen offset:1024 lds
v_mfma_f32_16x16x32_bf16 v[20:23], a[16:19], a[160:163], 0
v_exp_f32 v13, v13
v_mfma_f32_16x16x32_bf16 v[20:23], a[20:23], a[164:167], v[20:23]
s_waitcnt lgkmcnt(0)
v_cvt_pk_bf16_f32 v38, v12, v13
v_mfma_f32_16x16x32_bf16 v[20:23], a[24:27], a[168:171], v[20:23]
v_exp_f32 v14, v14
v_mfma_f32_16x16x32_bf16 v[20:23], a[28:31], a[172:175], v[20:23]
buffer_load_dwordx4 v226, s[20:23], s51 offen offset:2048 lds
v_mfma_f32_16x16x32_bf16 v[96:99], a[32:35], v[32:35], v[96:99]
v_exp_f32 v15, v15
v_mfma_f32_16x16x32_bf16 v[100:103], a[36:39], v[32:35], v[100:103]
v_cvt_pk_bf16_f32 v39, v14, v15
v_mfma_f32_16x16x32_bf16 v[104:107], a[40:43], v[32:35], v[104:107]
v_accvgpr_mov_b32 a229, a245
v_mfma_f32_16x16x32_bf16 v[108:111], a[44:47], v[32:35], v[108:111]
v_exp_f32 v16, v16
v_mfma_f32_16x16x32_bf16 v[112:115], a[48:51], v[32:35], v[112:115]
buffer_load_dwordx4 v227, s[20:23], s51 offen offset:3072 lds
v_mfma_f32_16x16x32_bf16 v[116:119], a[52:55], v[32:35], v[116:119]
s_add_u32 s51, s51, 16384
v_exp_f32 v17, v17
v_mfma_f32_16x16x32_bf16 v[120:123], a[56:59], v[32:35], v[120:123]
v_cvt_pk_bf16_f32 v40, v16, v17
v_mfma_f32_16x16x32_bf16 v[124:127], a[60:63], v[32:35], v[124:127]
v_exp_f32 v18, v18
v_mfma_f32_16x16x32_bf16 v[48:51], a[96:99], v[32:35], v[48:51]
v_mfma_f32_16x16x32_bf16 v[24:27], a[0:3], a[176:179], 0
v_exp_f32 v19, v19
v_mfma_f32_16x16x32_bf16 v[24:27], a[4:7], a[180:183], v[24:27]
ds_read_b128 a[0:3], v64 offset:40960
v_cvt_pk_bf16_f32 v41, v18, v19
v_mfma_f32_16x16x32_bf16 v[24:27], a[8:11], a[184:187], v[24:27]
v_exp_f32 v20, v20
v_mfma_f32_16x16x32_bf16 v[24:27], a[12:15], a[188:191], v[24:27]
ds_read_b128 a[4:7], v65 offset:40960
v_accvgpr_mov_b32 a225, a241
v_mfma_f32_16x16x32_bf16 v[28:31], a[16:19], a[176:179], 0
v_exp_f32 v21, v21
v_mfma_f32_16x16x32_bf16 v[28:31], a[20:23], a[180:183], v[28:31]
ds_read_b128 a[8:11], v66 offset:40960
v_cvt_pk_bf16_f32 v42, v20, v21
v_mfma_f32_16x16x32_bf16 v[28:31], a[24:27], a[184:187], v[28:31]
v_exp_f32 v22, v22
v_mfma_f32_16x16x32_bf16 v[28:31], a[28:31], a[188:191], v[28:31]
ds_read_b128 a[12:15], v67 offset:40960
v_accvgpr_mov_b32 a226, a242
v_mfma_f32_16x16x32_bf16 v[128:131], a[32:35], v[36:39], v[128:131]
v_exp_f32 v23, v23
v_mfma_f32_16x16x32_bf16 v[132:135], a[36:39], v[36:39], v[132:135]
ds_read_b128 a[16:19], v64 offset:45056
v_cvt_pk_bf16_f32 v43, v22, v23
v_mfma_f32_16x16x32_bf16 v[136:139], a[40:43], v[36:39], v[136:139]
ds_read_b128 a[20:23], v65 offset:45056
v_accvgpr_mov_b32 a227, a243
v_mfma_f32_16x16x32_bf16 v[140:143], a[44:47], v[36:39], v[140:143]
v_exp_f32 v24, v24
v_mfma_f32_16x16x32_bf16 v[144:147], a[48:51], v[36:39], v[144:147]
ds_read_b128 a[24:27], v66 offset:45056
v_accvgpr_mov_b32 a228, a244
v_mfma_f32_16x16x32_bf16 v[148:151], a[52:55], v[36:39], v[148:151]
v_exp_f32 v25, v25
v_mfma_f32_16x16x32_bf16 v[152:155], a[56:59], v[36:39], v[152:155]
ds_read_b128 a[28:31], v67 offset:45056
v_cvt_pk_bf16_f32 v44, v24, v25
v_mfma_f32_16x16x32_bf16 v[156:159], a[60:63], v[36:39], v[156:159]
s_waitcnt lgkmcnt(3)
v_exp_f32 v26, v26
v_mfma_f32_16x16x32_bf16 v[52:55], a[96:99], v[36:39], v[52:55]
v_mfma_f32_16x16x32_bf16 v[0:3], a[0:3], a[128:131], 0
s_add_u32 s47, s47, 0x24000
v_exp_f32 v27, v27
v_mfma_f32_16x16x32_bf16 v[0:3], a[4:7], a[132:135], v[0:3]
ds_read_b64_tr_b16 a[64:65], v72 offset:40960
v_cvt_pk_bf16_f32 v45, v26, v27
v_mfma_f32_16x16x32_bf16 v[0:3], a[8:11], a[136:139], v[0:3]
s_waitcnt lgkmcnt(1)
v_exp_f32 v28, v28
v_mfma_f32_16x16x32_bf16 v[0:3], a[12:15], a[140:143], v[0:3]
ds_read_b64_tr_b16 a[66:67], v72 offset:45056
v_accvgpr_mov_b32 a230, a246
v_mfma_f32_16x16x32_bf16 v[4:7], a[16:19], a[128:131], 0
s_add_u32 s48, s48, 0x24000
v_exp_f32 v29, v29
v_mfma_f32_16x16x32_bf16 v[4:7], a[20:23], a[132:135], v[4:7]
ds_read_b64_tr_b16 a[68:69], v73 offset:40960
v_cvt_pk_bf16_f32 v46, v28, v29
v_mfma_f32_16x16x32_bf16 v[4:7], a[24:27], a[136:139], v[4:7]
s_add_u32 s49, s49, 1
v_exp_f32 v30, v30
v_mfma_f32_16x16x32_bf16 v[4:7], a[28:31], a[140:143], v[4:7]
ds_read_b64_tr_b16 a[70:71], v73 offset:45056
v_accvgpr_mov_b32 a231, a247
v_mfma_f32_16x16x32_bf16 v[160:163], a[32:35], v[40:43], v[160:163]
s_cmp_ge_u32 s49, 4
s_cselect_b32 s47, 0x70000000, s47
s_cselect_b32 s48, 0x70000000, s48
v_exp_f32 v31, v31
v_mfma_f32_16x16x32_bf16 v[164:167], a[36:39], v[40:43], v[164:167]
ds_read_b64_tr_b16 a[72:73], v74 offset:40960
v_cvt_pk_bf16_f32 v47, v30, v31
v_mfma_f32_16x16x32_bf16 v[168:171], a[40:43], v[40:43], v[168:171]
ds_read_b64_tr_b16 a[74:75], v74 offset:45056
v_accvgpr_mov_b32 a232, a248
v_mfma_f32_16x16x32_bf16 v[172:175], a[44:47], v[40:43], v[172:175]
v_exp_f32 v0, v0
v_mfma_f32_16x16x32_bf16 v[176:179], a[48:51], v[40:43], v[176:179]
ds_read_b64_tr_b16 a[76:77], v75 offset:40960
v_accvgpr_mov_b32 a233, a249
v_mfma_f32_16x16x32_bf16 v[180:183], a[52:55], v[40:43], v[180:183]
v_exp_f32 v1, v1
v_mfma_f32_16x16x32_bf16 v[184:187], a[56:59], v[40:43], v[184:187]
ds_read_b64_tr_b16 a[78:79], v75 offset:45056
v_cvt_pk_bf16_f32 v32, v0, v1
v_mfma_f32_16x16x32_bf16 v[188:191], a[60:63], v[40:43], v[188:191]
v_exp_f32 v2, v2
v_mfma_f32_16x16x32_bf16 v[56:59], a[96:99], v[40:43], v[56:59]
s_waitcnt lgkmcnt(4)
ds_read_b64_tr_b16 a[80:81], v76 offset:40960
v_accvgpr_mov_b32 a234, a250
v_mfma_f32_16x16x32_bf16 v[8:11], a[0:3], a[144:147], 0
v_exp_f32 v3, v3
v_mfma_f32_16x16x32_bf16 v[8:11], a[4:7], a[148:151], v[8:11]
ds_read_b64_tr_b16 a[82:83], v76 offset:45056
v_cvt_pk_bf16_f32 v33, v2, v3
v_mfma_f32_16x16x32_bf16 v[8:11], a[8:11], a[152:155], v[8:11]
v_exp_f32 v4, v4
v_mfma_f32_16x16x32_bf16 v[8:11], a[12:15], a[156:159], v[8:11]
ds_read_b64_tr_b16 a[84:85], v77 offset:40960
v_accvgpr_mov_b32 a235, a251
v_mfma_f32_16x16x32_bf16 v[12:15], a[16:19], a[144:147], 0
v_exp_f32 v5, v5
v_mfma_f32_16x16x32_bf16 v[12:15], a[20:23], a[148:151], v[12:15]
ds_read_b64_tr_b16 a[86:87], v77 offset:45056
v_cvt_pk_bf16_f32 v34, v4, v5
v_mfma_f32_16x16x32_bf16 v[12:15], a[24:27], a[152:155], v[12:15]
v_exp_f32 v6, v6
v_mfma_f32_16x16x32_bf16 v[12:15], a[28:31], a[156:159], v[12:15]
ds_read_b64_tr_b16 a[88:89], v78 offset:40960
v_accvgpr_mov_b32 a236, a252
v_mfma_f32_16x16x32_bf16 v[192:195], a[32:35], v[44:47], v[192:195]
v_exp_f32 v7, v7
v_mfma_f32_16x16x32_bf16 v[196:199], a[36:39], v[44:47], v[196:199]
ds_read_b64_tr_b16 a[90:91], v78 offset:45056
v_cvt_pk_bf16_f32 v35, v6, v7
v_mfma_f32_16x16x32_bf16 v[200:203], a[40:43], v[44:47], v[200:203]
ds_read_b64_tr_b16 a[92:93], v79 offset:40960
v_accvgpr_mov_b32 a237, a253
v_mfma_f32_16x16x32_bf16 v[204:207], a[44:47], v[44:47], v[204:207]
v_exp_f32 v8, v8
v_mfma_f32_16x16x32_bf16 v[208:211], a[48:51], v[44:47], v[208:211]
ds_read_b64_tr_b16 a[94:95], v79 offset:45056
v_accvgpr_mov_b32 a238, a254
v_mfma_f32_16x16x32_bf16 v[212:215], a[52:55], v[44:47], v[212:215]
v_exp_f32 v9, v9
v_mfma_f32_16x16x32_bf16 v[216:219], a[56:59], v[44:47], v[216:219]
v_cvt_pk_bf16_f32 v36, v8, v9
v_mfma_f32_16x16x32_bf16 v[220:223], a[60:63], v[44:47], v[220:223]
s_add_u32 m0, s55, 0x1c000
v_exp_f32 v10, v10
v_mfma_f32_16x16x32_bf16 v[60:63], a[96:99], v[44:47], v[60:63]
buffer_load_dwordx4 v228, s[24:27], s52 offen lds
v_mfma_f32_16x16x32_bf16 v[16:19], a[0:3], a[160:163], 0
v_exp_f32 v11, v11
v_mfma_f32_16x16x32_bf16 v[16:19], a[4:7], a[164:167], v[16:19]
v_cvt_pk_bf16_f32 v37, v10, v11
v_mfma_f32_16x16x32_bf16 v[16:19], a[8:11], a[168:171], v[16:19]
v_exp_f32 v12, v12
v_mfma_f32_16x16x32_bf16 v[16:19], a[12:15], a[172:175], v[16:19]
buffer_load_dwordx4 v229, s[24:27], s52 offen offset:1024 lds
v_mfma_f32_16x16x32_bf16 v[20:23], a[16:19], a[160:163], 0
v_exp_f32 v13, v13
v_mfma_f32_16x16x32_bf16 v[20:23], a[20:23], a[164:167], v[20:23]
s_waitcnt lgkmcnt(0)
v_cvt_pk_bf16_f32 v38, v12, v13
v_mfma_f32_16x16x32_bf16 v[20:23], a[24:27], a[168:171], v[20:23]
v_exp_f32 v14, v14
v_mfma_f32_16x16x32_bf16 v[20:23], a[28:31], a[172:175], v[20:23]
buffer_load_dwordx4 v228, s[24:27], s52 offen offset:2048 lds
v_mfma_f32_16x16x32_bf16 v[96:99], a[64:67], v[32:35], v[96:99]
v_exp_f32 v15, v15
v_mfma_f32_16x16x32_bf16 v[100:103], a[68:71], v[32:35], v[100:103]
v_cvt_pk_bf16_f32 v39, v14, v15
v_mfma_f32_16x16x32_bf16 v[104:107], a[72:75], v[32:35], v[104:107]
v_mfma_f32_16x16x32_bf16 v[108:111], a[76:79], v[32:35], v[108:111]
v_exp_f32 v16, v16
v_mfma_f32_16x16x32_bf16 v[112:115], a[80:83], v[32:35], v[112:115]
buffer_load_dwordx4 v229, s[24:27], s52 offen offset:3072 lds
v_mfma_f32_16x16x32_bf16 v[116:119], a[84:87], v[32:35], v[116:119]
s_add_u32 s52, s52, 16384
v_exp_f32 v17, v17
v_mfma_f32_16x16x32_bf16 v[120:123], a[88:91], v[32:35], v[120:123]
v_cvt_pk_bf16_f32 v40, v16, v17
v_mfma_f32_16x16x32_bf16 v[124:127], a[92:95], v[32:35], v[124:127]
s_waitcnt vmcnt(8)
v_exp_f32 v18, v18
v_mfma_f32_16x16x32_bf16 v[48:51], a[96:99], v[32:35], v[48:51]
s_barrier
v_mfma_f32_16x16x32_bf16 v[24:27], a[0:3], a[176:179], 0
v_exp_f32 v19, v19
v_mfma_f32_16x16x32_bf16 v[24:27], a[4:7], a[180:183], v[24:27]
ds_read_b128 a[0:3], v68
v_cvt_pk_bf16_f32 v41, v18, v19
v_mfma_f32_16x16x32_bf16 v[24:27], a[8:11], a[184:187], v[24:27]
v_exp_f32 v20, v20
v_mfma_f32_16x16x32_bf16 v[24:27], a[12:15], a[188:191], v[24:27]
ds_read_b128 a[4:7], v69
v_accvgpr_mov_b32 a239, a255
v_mfma_f32_16x16x32_bf16 v[28:31], a[16:19], a[176:179], 0
v_exp_f32 v21, v21
v_mfma_f32_16x16x32_bf16 v[28:31], a[20:23], a[180:183], v[28:31]
ds_read_b128 a[8:11], v70
v_cvt_pk_bf16_f32 v42, v20, v21
v_mfma_f32_16x16x32_bf16 v[28:31], a[24:27], a[184:187], v[28:31]
v_exp_f32 v22, v22
v_mfma_f32_16x16x32_bf16 v[28:31], a[28:31], a[188:191], v[28:31]
ds_read_b128 a[12:15], v71
v_accvgpr_mov_b32 a104, a106
v_mfma_f32_16x16x32_bf16 v[128:131], a[64:67], v[36:39], v[128:131]
v_exp_f32 v23, v23
v_mfma_f32_16x16x32_bf16 v[132:135], a[68:71], v[36:39], v[132:135]
ds_read_b128 a[16:19], v68 offset:4096
v_cvt_pk_bf16_f32 v43, v22, v23
v_mfma_f32_16x16x32_bf16 v[136:139], a[72:75], v[36:39], v[136:139]
ds_read_b128 a[20:23], v69 offset:4096
v_accvgpr_mov_b32 a105, a107
v_mfma_f32_16x16x32_bf16 v[140:143], a[76:79], v[36:39], v[140:143]
v_exp_f32 v24, v24
v_mfma_f32_16x16x32_bf16 v[144:147], a[80:83], v[36:39], v[144:147]
ds_read_b128 a[24:27], v70 offset:4096
v_mfma_f32_16x16x32_bf16 v[148:151], a[84:87], v[36:39], v[148:151]
v_exp_f32 v25, v25
v_mfma_f32_16x16x32_bf16 v[152:155], a[88:91], v[36:39], v[152:155]
ds_read_b128 a[28:31], v71 offset:4096
v_cvt_pk_bf16_f32 v44, v24, v25
v_mfma_f32_16x16x32_bf16 v[156:159], a[92:95], v[36:39], v[156:159]
s_waitcnt lgkmcnt(3)
v_exp_f32 v26, v26
v_mfma_f32_16x16x32_bf16 v[52:55], a[96:99], v[36:39], v[52:55]
s_cmp_lg_u32 s59, 3
s_cbranch_scc1 M_noh3
s_cmp_lg_u32 s40, 0
s_cbranch_scc1 L_nosig_h3
s_mov_b64 exec, 1
v_mov_b32 v250, 1
v_mov_b32 v251, 0
s_nop 0
buffer_atomic_add v250, v251, s[72:75], s58 offen
s_mov_b64 exec, -1
L_nosig_h3:
M_noh3:
s_add_u32 s59, s59, 1
s_cmp_lt_u32 s59, 7
s_cbranch_scc1 K3_loop
M_last:
v_exp_f32 v27, v27
s_nop 0
v_cvt_pk_bf16_f32 v45, v26, v27
s_nop 0
v_exp_f32 v28, v28
s_nop 0
s_nop 0
v_exp_f32 v29, v29
s_nop 0
v_cvt_pk_bf16_f32 v46, v28, v29
s_nop 0
v_exp_f32 v30, v30
s_nop 0
s_nop 0
v_exp_f32 v31, v31
s_nop 0
v_cvt_pk_bf16_f32 v47, v30, v31
s_nop 0
s_nop 1
v_mfma_f32_16x16x32_bf16 v[160:163], a[64:67], v[40:43], v[160:163]
v_mfma_f32_16x16x32_bf16 v[164:167], a[68:71], v[40:43], v[164:167]
v_mfma_f32_16x16x32_bf16 v[168:171], a[72:75], v[40:43], v[168:171]
v_mfma_f32_16x16x32_bf16 v[172:175], a[76:79], v[40:43], v[172:175]
v_mfma_f32_16x16x32_bf16 v[176:179], a[80:83], v[40:43], v[176:179]
v_mfma_f32_16x16x32_bf16 v[180:183], a[84:87], v[40:43], v[180:183]
v_mfma_f32_16x16x32_bf16 v[184:187], a[88:91], v[40:43], v[184:187]
v_mfma_f32_16x16x32_bf16 v[188:191], a[92:95], v[40:43], v[188:191]
v_mfma_f32_16x16x32_bf16 v[56:59], a[96:99], v[40:43], v[56:59]
v_mfma_f32_16x16x32_bf16 v[192:195], a[64:67], v[44:47], v[192:195]
v_mfma_f32_16x16x32_bf16 v[196:199], a[68:71], v[44:47], v[196:199]
v_mfma_f32_16x16x32_bf16 v[200:203], a[72:75], v[44:47], v[200:203]
v_mfma_f32_16x16x32_bf16 v[204:207], a[76:79], v[44:47], v[204:207]
v_mfma_f32_16x16x32_bf16 v[208:211], a[80:83], v[44:47], v[208:211]
v_mfma_f32_16x16x32_bf16 v[212:215], a[84:87], v[44:47], v[212:215]
v_mfma_f32_16x16x32_bf16 v[216:219], a[88:91], v[44:47], v[216:219]
v_mfma_f32_16x16x32_bf16 v[220:223], a[92:95], v[44:47], v[220:223]
v_mfma_f32_16x16x32_bf16 v[60:63], a[96:99], v[44:47], v[60:63]
s_nop 7
s_load_dwordx2 s[64:65], s[0:1], 32
s_load_dwordx2 s[66:67], s[0:1], 72
s_load_dwordx2 s[68:69], s[0:1], 0
s_load_dwordx2 s[62:63], s[0:1], 80
s_lshr_b32 s79, s2, 5
s_lshl_b32 s79, s79, 2
s_and_b32 s97, s2, 3
s_add_u32 s79, s79, s97
s_lshl_b32 s79, s79, 7
s_add_u32 s79, s79, 11264
s_bfe_u32 s97, s2, 0x10002
v_mov_b32 v248, 0
buffer_load_dword v239, v248, s[72:75], s79 offen sc1
v_lshlrev_b32 v252, 2, v254
ds_bpermute_b32 v48, v252, v48
ds_bpermute_b32 v52, v252, v52
ds_bpermute_b32 v56, v252, v56
ds_bpermute_b32 v60, v252, v60
s_waitcnt lgkmcnt(0)
v_mov_b32 v249, 0
v_mov_b32 v240, 0
v_mov_b32 v241, 0
v_mov_b32 v242, 0
v_mov_b32 v243, 0
v_mov_b32 v251, 0x21800000
v_mov_b32 v250, 0x71800000
v_cmp_ge_f32 vcc, v48, v251
v_cmp_le_f32 s[98:99], v48, v250
s_nop 3
s_and_b64 vcc, vcc, s[98:99]
s_nop 0
v_mov_b32 v251, 0x7fc00000
s_nop 0
v_cndmask_b32 v250, v251, v249
v_mov_b32 v249, v250
v_rcp_f32 v246, v48
s_nop 0
v_pk_mul_f32 v[96:97], v[96:97], v[246:247] op_sel_hi:[1,0]
v_pk_mul_f32 v[98:99], v[98:99], v[246:247] op_sel_hi:[1,0]
v_pk_fma_f32 v[242:243], v[96:97], v[240:241], v[242:243]
v_pk_fma_f32 v[242:243], v[98:99], v[240:241], v[242:243]
v_pk_mul_f32 v[100:101], v[100:101], v[246:247] op_sel_hi:[1,0]
v_pk_mul_f32 v[102:103], v[102:103], v[246:247] op_sel_hi:[1,0]
v_pk_fma_f32 v[242:243], v[100:101], v[240:241], v[242:243]
v_pk_fma_f32 v[242:243], v[102:103], v[240:241], v[242:243]
v_pk_mul_f32 v[104:105], v[104:105], v[246:247] op_sel_hi:[1,0]
v_pk_mul_f32 v[106:107], v[106:107], v[246:247] op_sel_hi:[1,0]
v_pk_fma_f32 v[242:243], v[104:105], v[240:241], v[242:243]
v_pk_fma_f32 v[242:243], v[106:107], v[240:241], v[242:243]
v_pk_mul_f32 v[108:109], v[108:109], v[246:247] op_sel_hi:[1,0]
v_pk_mul_f32 v[110:111], v[110:111], v[246:247] op_sel_hi:[1,0]
v_pk_fma_f32 v[242:243], v[108:109], v[240:241], v[242:243]
v_pk_fma_f32 v[242:243], v[110:111], v[240:241], v[242:243]
v_pk_mul_f32 v[112:113], v[112:113], v[246:247] op_sel_hi:[1,0]
v_pk_mul_f32 v[114:115], v[114:115], v[246:247] op_sel_hi:[1,0]
v_pk_fma_f32 v[242:243], v[112:113], v[240:241], v[242:243]
v_pk_fma_f32 v[242:243], v[114:115], v[240:241], v[242:243]
v_pk_mul_f32 v[116:117], v[116:117], v[246:247] op_sel_hi:[1,0]
v_pk_mul_f32 v[118:119], v[118:119], v[246:247] op_sel_hi:[1,0]
v_pk_fma_f32 v[242:243], v[116:117], v[240:241], v[242:243]
v_pk_fma_f32 v[242:243], v[118:119], v[240:241], v[242:243]
v_pk_mul_f32 v[120:121], v[120:121], v[246:247] op_sel_hi:[1,0]
v_pk_mul_f32 v[122:123], v[122:123], v[246:247] op_sel_hi:[1,0]
v_pk_fma_f32 v[242:243], v[120:121], v[240:241], v[242:243]
v_pk_fma_f32 v[242:243], v[122:123], v[240:241], v[242:243]
v_pk_mul_f32 v[124:125], v[124:125], v[246:247] op_sel_hi:[1,0]
v_pk_mul_f32 v[126:127], v[126:127], v[246:247] op_sel_hi:[1,0]
v_pk_fma_f32 v[242:243], v[124:125], v[240:241], v[242:243]
v_pk_fma_f32 v[242:243], v[126:127], v[240:241], v[242:243]
v_mov_b32 v251, 0x21800000
v_mov_b32 v250, 0x71800000
v_cmp_ge_f32 vcc, v52, v251
v_cmp_le_f32 s[98:99], v52, v250
s_nop 3
s_and_b64 vcc, vcc, s[98:99]
s_nop 0
v_mov_b32 v251, 0x7fc00000
s_nop 0
v_cndmask_b32 v250, v251, v249
v_mov_b32 v249, v250
v_rcp_f32 v246, v52
s_nop 0
v_pk_mul_f32 v[128:129], v[128:129], v[246:247] op_sel_hi:[1,0]
v_pk_mul_f32 v[130:131], v[130:131], v[246:247] op_sel_hi:[1,0]
v_pk_fma_f32 v[242:243], v[128:129], v[240:241], v[242:243]
v_pk_fma_f32 v[242:243], v[130:131], v[240:241], v[242:243]
v_pk_mul_f32 v[132:133], v[132:133], v[246:247] op_sel_hi:[1,0]
v_pk_mul_f32 v[134:135], v[134:135], v[246:247] op_sel_hi:[1,0]
v_pk_fma_f32 v[242:243], v[132:133], v[240:241], v[242:243]
v_pk_fma_f32 v[242:243], v[134:135], v[240:241], v[242:243]
v_pk_mul_f32 v[136:137], v[136:137], v[246:247] op_sel_hi:[1,0]
v_pk_mul_f32 v[138:139], v[138:139], v[246:247] op_sel_hi:[1,0]
v_pk_fma_f32 v[242:243], v[136:137], v[240:241], v[242:243]
v_pk_fma_f32 v[242:243], v[138:139], v[240:241], v[242:243]
v_pk_mul_f32 v[140:141], v[140:141], v[246:247] op_sel_hi:[1,0]
v_pk_mul_f32 v[142:143], v[142:143], v[246:247] op_sel_hi:[1,0]
v_pk_fma_f32 v[242:243], v[140:141], v[240:241], v[242:243]
v_pk_fma_f32 v[242:243], v[142:143], v[240:241], v[242:243]
v_pk_mul_f32 v[144:145], v[144:145], v[246:247] op_sel_hi:[1,0]
v_pk_mul_f32 v[146:147], v[146:147], v[246:247] op_sel_hi:[1,0]
v_pk_fma_f32 v[242:243], v[144:145], v[240:241], v[242:243]
v_pk_fma_f32 v[242:243], v[146:147], v[240:241], v[242:243]
v_pk_mul_f32 v[148:149], v[148:149], v[246:247] op_sel_hi:[1,0]
v_pk_mul_f32 v[150:151], v[150:151], v[246:247] op_sel_hi:[1,0]
v_pk_fma_f32 v[242:243], v[148:149], v[240:241], v[242:243]
v_pk_fma_f32 v[242:243], v[150:151], v[240:241], v[242:243]
v_pk_mul_f32 v[152:153], v[152:153], v[246:247] op_sel_hi:[1,0]
v_pk_mul_f32 v[154:155], v[154:155], v[246:247] op_sel_hi:[1,0]
v_pk_fma_f32 v[242:243], v[152:153], v[240:241], v[242:243]
v_pk_fma_f32 v[242:243], v[154:155], v[240:241], v[242:243]
v_pk_mul_f32 v[156:157], v[156:157], v[246:247] op_sel_hi:[1,0]
v_pk_mul_f32 v[158:159], v[158:159], v[246:247] op_sel_hi:[1,0]
v_pk_fma_f32 v[242:243], v[156:157], v[240:241], v[242:243]
v_pk_fma_f32 v[242:243], v[158:159], v[240:241], v[242:243]
v_mov_b32 v251, 0x21800000
v_mov_b32 v250, 0x71800000
v_cmp_ge_f32 vcc, v56, v251
v_cmp_le_f32 s[98:99], v56, v250
s_nop 3
s_and_b64 vcc, vcc, s[98:99]
s_nop 0
v_mov_b32 v251, 0x7fc00000
s_nop 0
v_cndmask_b32 v250, v251, v249
v_mov_b32 v249, v250
v_rcp_f32 v246, v56
s_nop 0
v_pk_mul_f32 v[160:161], v[160:161], v[246:247] op_sel_hi:[1,0]
v_pk_mul_f32 v[162:163], v[162:163], v[246:247] op_sel_hi:[1,0]
v_pk_fma_f32 v[242:243], v[160:161], v[240:241], v[242:243]
v_pk_fma_f32 v[242:243], v[162:163], v[240:241], v[242:243]
v_pk_mul_f32 v[164:165], v[164:165], v[246:247] op_sel_hi:[1,0]
v_pk_mul_f32 v[166:167], v[166:167], v[246:247] op_sel_hi:[1,0]
v_pk_fma_f32 v[242:243], v[164:165], v[240:241], v[242:243]
v_pk_fma_f32 v[242:243], v[166:167], v[240:241], v[242:243]
v_pk_mul_f32 v[168:169], v[168:169], v[246:247] op_sel_hi:[1,0]
v_pk_mul_f32 v[170:171], v[170:171], v[246:247] op_sel_hi:[1,0]
v_pk_fma_f32 v[242:243], v[168:169], v[240:241], v[242:243]
v_pk_fma_f32 v[242:243], v[170:171], v[240:241], v[242:243]
v_pk_mul_f32 v[172:173], v[172:173], v[246:247] op_sel_hi:[1,0]
v_pk_mul_f32 v[174:175], v[174:175], v[246:247] op_sel_hi:[1,0]
v_pk_fma_f32 v[242:243], v[172:173], v[240:241], v[242:243]
v_pk_fma_f32 v[242:243], v[174:175], v[240:241], v[242:243]
v_pk_mul_f32 v[176:177], v[176:177], v[246:247] op_sel_hi:[1,0]
v_pk_mul_f32 v[178:179], v[178:179], v[246:247] op_sel_hi:[1,0]
v_pk_fma_f32 v[242:243], v[176:177], v[240:241], v[242:243]
v_pk_fma_f32 v[242:243], v[178:179], v[240:241], v[242:243]
v_pk_mul_f32 v[180:181], v[180:181], v[246:247] op_sel_hi:[1,0]
v_pk_mul_f32 v[182:183], v[182:183], v[246:247] op_sel_hi:[1,0]
v_pk_fma_f32 v[242:243], v[180:181], v[240:241], v[242:243]
v_pk_fma_f32 v[242:243], v[182:183], v[240:241], v[242:243]
v_pk_mul_f32 v[184:185], v[184:185], v[246:247] op_sel_hi:[1,0]
v_pk_mul_f32 v[186:187], v[186:187], v[246:247] op_sel_hi:[1,0]
v_pk_fma_f32 v[242:243], v[184:185], v[240:241], v[242:243]
v_pk_fma_f32 v[242:243], v[186:187], v[240:241], v[242:243]
v_pk_mul_f32 v[188:189], v[188:189], v[246:247] op_sel_hi:[1,0]
v_pk_mul_f32 v[190:191], v[190:191], v[246:247] op_sel_hi:[1,0]
v_pk_fma_f32 v[242:243], v[188:189], v[240:241], v[242:243]
v_pk_fma_f32 v[242:243], v[190:191], v[240:241], v[242:243]
v_mov_b32 v251, 0x21800000
v_mov_b32 v250, 0x71800000
v_cmp_ge_f32 vcc, v60, v251
v_cmp_le_f32 s[98:99], v60, v250
s_nop 3
s_and_b64 vcc, vcc, s[98:99]
s_nop 0
v_mov_b32 v251, 0x7fc00000
s_nop 0
v_cndmask_b32 v250, v251, v249
v_mov_b32 v249, v250
v_rcp_f32 v246, v60
s_nop 0
v_pk_mul_f32 v[192:193], v[192:193], v[246:247] op_sel_hi:[1,0]
v_pk_mul_f32 v[194:195], v[194:195], v[246:247] op_sel_hi:[1,0]
v_pk_fma_f32 v[242:243], v[192:193], v[240:241], v[242:243]
v_pk_fma_f32 v[242:243], v[194:195], v[240:241], v[242:243]
v_pk_mul_f32 v[196:197], v[196:197], v[246:247] op_sel_hi:[1,0]
v_pk_mul_f32 v[198:199], v[198:199], v[246:247] op_sel_hi:[1,0]
v_pk_fma_f32 v[242:243], v[196:197], v[240:241], v[242:243]
v_pk_fma_f32 v[242:243], v[198:199], v[240:241], v[242:243]
v_pk_mul_f32 v[200:201], v[200:201], v[246:247] op_sel_hi:[1,0]
v_pk_mul_f32 v[202:203], v[202:203], v[246:247] op_sel_hi:[1,0]
v_pk_fma_f32 v[242:243], v[200:201], v[240:241], v[242:243]
v_pk_fma_f32 v[242:243], v[202:203], v[240:241], v[242:243]
v_pk_mul_f32 v[204:205], v[204:205], v[246:247] op_sel_hi:[1,0]
v_pk_mul_f32 v[206:207], v[206:207], v[246:247] op_sel_hi:[1,0]
v_pk_fma_f32 v[242:243], v[204:205], v[240:241], v[242:243]
v_pk_fma_f32 v[242:243], v[206:207], v[240:241], v[242:243]
v_pk_mul_f32 v[208:209], v[208:209], v[246:247] op_sel_hi:[1,0]
v_pk_mul_f32 v[210:211], v[210:211], v[246:247] op_sel_hi:[1,0]
v_pk_fma_f32 v[242:243], v[208:209], v[240:241], v[242:243]
v_pk_fma_f32 v[242:243], v[210:211], v[240:241], v[242:243]
v_pk_mul_f32 v[212:213], v[212:213], v[246:247] op_sel_hi:[1,0]
v_pk_mul_f32 v[214:215], v[214:215], v[246:247] op_sel_hi:[1,0]
v_pk_fma_f32 v[242:243], v[212:213], v[240:241], v[242:243]
v_pk_fma_f32 v[242:243], v[214:215], v[240:241], v[242:243]
v_pk_mul_f32 v[216:217], v[216:217], v[246:247] op_sel_hi:[1,0]
v_pk_mul_f32 v[218:219], v[218:219], v[246:247] op_sel_hi:[1,0]
v_pk_fma_f32 v[242:243], v[216:217], v[240:241], v[242:243]
v_pk_fma_f32 v[242:243], v[218:219], v[240:241], v[242:243]
v_pk_mul_f32 v[220:221], v[220:221], v[246:247] op_sel_hi:[1,0]
v_pk_mul_f32 v[222:223], v[222:223], v[246:247] op_sel_hi:[1,0]
v_pk_fma_f32 v[242:243], v[220:221], v[240:241], v[242:243]
v_pk_fma_f32 v[242:243], v[222:223], v[240:241], v[242:243]
v_add_f32 v249, v249, v242
v_add_f32 v249, v249, v243
v_cmp_u_f32 vcc, v249, v249
s_nop 3
s_cmp_lg_u64 vcc, 0
s_cselect_b32 s56, 1, 0
v_mov_b32 v252, s56
s_lshl_b32 s57, s40, 2
s_add_u32 s57, s57, 0x20000
v_mov_b32 v251, s57
ds_write_b32 v251, v252
s_lshl_b32 s56, s42, 3
s_lshl_b32 s57, s40, 1
s_add_u32 s56, s56, s57
s_mul_i32 s56, s56, 132096
s_lshl_b32 s57, s41, 13
s_add_u32 s76, s56, s57
s_lshr_b32 s77, s42, 1
s_lshl_b32 s77, s77, 2
s_lshr_b32 s78, s41, 2
s_add_u32 s77, s77, s78
s_add_u32 s77, s77, 88
s_lshl_b32 s77, s77, 7
s_add_u32 s36, s70, 0x1800000
s_addc_u32 s37, s71, 0
s_mov_b32 s38, 0x1020000
s_mov_b32 s39, 0x20000
v_lshlrev_b32 v91, 4, v255
s_add_u32 s61, s76, 0x0
v_cvt_pk_bf16_f32 v96, v96, v97
v_cvt_pk_bf16_f32 v97, v98, v99
v_cvt_pk_bf16_f32 v98, v100, v101
v_cvt_pk_bf16_f32 v99, v102, v103
buffer_store_dwordx4 v[96:99], v91, s[36:39], s61 offen sc1
v_cvt_pk_bf16_f32 v104, v104, v105
v_cvt_pk_bf16_f32 v105, v106, v107
v_cvt_pk_bf16_f32 v106, v108, v109
v_cvt_pk_bf16_f32 v107, v110, v111
buffer_store_dwordx4 v[104:107], v91, s[36:39], s61 offen offset:1024 sc1
v_cvt_pk_bf16_f32 v112, v112, v113
v_cvt_pk_bf16_f32 v113, v114, v115
v_cvt_pk_bf16_f32 v114, v116, v117
v_cvt_pk_bf16_f32 v115, v118, v119
buffer_store_dwordx4 v[112:115], v91, s[36:39], s61 offen offset:2048 sc1
v_cvt_pk_bf16_f32 v120, v120, v121
v_cvt_pk_bf16_f32 v121, v122, v123
v_cvt_pk_bf16_f32 v122, v124, v125
v_cvt_pk_bf16_f32 v123, v126, v127
buffer_store_dwordx4 v[120:123], v91, s[36:39], s61 offen offset:3072 sc1
s_add_u32 s61, s76, 0x20400
v_cvt_pk_bf16_f32 v128, v128, v129
v_cvt_pk_bf16_f32 v129, v130, v131
v_cvt_pk_bf16_f32 v130, v132, v133
v_cvt_pk_bf16_f32 v131, v134, v135
buffer_store_dwordx4 v[128:131], v91, s[36:39], s61 offen sc1
v_cvt_pk_bf16_f32 v136, v136, v137
v_cvt_pk_bf16_f32 v137, v138, v139
v_cvt_pk_bf16_f32 v138, v140, v141
v_cvt_pk_bf16_f32 v139, v142, v143
buffer_store_dwordx4 v[136:139], v91, s[36:39], s61 offen offset:1024 sc1
v_cvt_pk_bf16_f32 v144, v144, v145
v_cvt_pk_bf16_f32 v145, v146, v147
v_cvt_pk_bf16_f32 v146, v148, v149
v_cvt_pk_bf16_f32 v147, v150, v151
buffer_store_dwordx4 v[144:147], v91, s[36:39], s61 offen offset:2048 sc1
v_cvt_pk_bf16_f32 v152, v152, v153
v_cvt_pk_bf16_f32 v153, v154, v155
v_cvt_pk_bf16_f32 v154, v156, v157
v_cvt_pk_bf16_f32 v155, v158, v159
buffer_store_dwordx4 v[152:155], v91, s[36:39], s61 offen offset:3072 sc1
s_add_u32 s61, s76, 0x1000
v_cvt_pk_bf16_f32 v160, v160, v161
v_cvt_pk_bf16_f32 v161, v162, v163
v_cvt_pk_bf16_f32 v162, v164, v165
v_cvt_pk_bf16_f32 v163, v166, v167
buffer_store_dwordx4 v[160:163], v91, s[36:39], s61 offen sc1
v_cvt_pk_bf16_f32 v168, v168, v169
v_cvt_pk_bf16_f32 v169, v170, v171
v_cvt_pk_bf16_f32 v170, v172, v173
v_cvt_pk_bf16_f32 v171, v174, v175
buffer_store_dwordx4 v[168:171], v91, s[36:39], s61 offen offset:1024 sc1
v_cvt_pk_bf16_f32 v176, v176, v177
v_cvt_pk_bf16_f32 v177, v178, v179
v_cvt_pk_bf16_f32 v178, v180, v181
v_cvt_pk_bf16_f32 v179, v182, v183
buffer_store_dwordx4 v[176:179], v91, s[36:39], s61 offen offset:2048 sc1
v_cvt_pk_bf16_f32 v184, v184, v185
v_cvt_pk_bf16_f32 v185, v186, v187
v_cvt_pk_bf16_f32 v186, v188, v189
v_cvt_pk_bf16_f32 v187, v190, v191
buffer_store_dwordx4 v[184:187], v91, s[36:39], s61 offen offset:3072 sc1
s_add_u32 s61, s76, 0x21400
v_cvt_pk_bf16_f32 v192, v192, v193
v_cvt_pk_bf16_f32 v193, v194, v195
v_cvt_pk_bf16_f32 v194, v196, v197
v_cvt_pk_bf16_f32 v195, v198, v199
buffer_store_dwordx4 v[192:195], v91, s[36:39], s61 offen sc1
v_cvt_pk_bf16_f32 v200, v200, v201
v_cvt_pk_bf16_f32 v201, v202, v203
v_cvt_pk_bf16_f32 v202, v204, v205
v_cvt_pk_bf16_f32 v203, v206, v207
buffer_store_dwordx4 v[200:203], v91, s[36:39], s61 offen offset:1024 sc1
v_cvt_pk_bf16_f32 v208, v208, v209
v_cvt_pk_bf16_f32 v209, v210, v211
v_cvt_pk_bf16_f32 v210, v212, v213
v_cvt_pk_bf16_f32 v211, v214, v215
buffer_store_dwordx4 v[208:211], v91, s[36:39], s61 offen offset:2048 sc1
v_cvt_pk_bf16_f32 v216, v216, v217
v_cvt_pk_bf16_f32 v217, v218, v219
v_cvt_pk_bf16_f32 v218, v220, v221
v_cvt_pk_bf16_f32 v219, v222, v223
buffer_store_dwordx4 v[216:219], v91, s[36:39], s61 offen offset:3072 sc1
s_waitcnt vmcnt(16)
s_waitcnt lgkmcnt(0)
s_barrier
v_mov_b32 v251, 0x20000
ds_read_b128 v[244:247], v251
s_waitcnt lgkmcnt(0)
v_or_b32 v244, v244, v245
v_or_b32 v246, v246, v247
v_or_b32 v244, v244, v246
s_nop 0
v_readfirstlane_b32 s56, v244
s_nop 3
s_cmp_eq_u32 s56, 0
s_cbranch_scc1 K3_store
s_waitcnt vmcnt(0)
v_mov_b32 v48, 0
v_mov_b32 v49, 0
v_pk_mov_b32 v[96:97], v[48:49], v[48:49]
v_pk_mov_b32 v[98:99], v[48:49], v[48:49]
v_pk_mov_b32 v[100:101], v[48:49], v[48:49]
v_pk_mov_b32 v[102:103], v[48:49], v[48:49]
v_pk_mov_b32 v[104:105], v[48:49], v[48:49]
v_pk_mov_b32 v[106:107], v[48:49], v[48:49]
v_pk_mov_b32 v[108:109], v[48:49], v[48:49]
v_pk_mov_b32 v[110:111], v[48:49], v[48:49]
v_pk_mov_b32 v[112:113], v[48:49], v[48:49]
v_pk_mov_b32 v[114:115], v[48:49], v[48:49]
v_pk_mov_b32 v[116:117], v[48:49], v[48:49]
v_pk_mov_b32 v[118:119], v[48:49], v[48:49]
v_pk_mov_b32 v[120:121], v[48:49], v[48:49]
v_pk_mov_b32 v[122:123], v[48:49], v[48:49]
v_pk_mov_b32 v[124:125], v[48:49], v[48:49]
v_pk_mov_b32 v[126:127], v[48:49], v[48:49]
v_pk_mov_b32 v[128:129], v[48:49], v[48:49]
v_pk_mov_b32 v[130:131], v[48:49], v[48:49]
v_pk_mov_b32 v[132:133], v[48:49], v[48:49]
v_pk_mov_b32 v[134:135], v[48:49], v[48:49]
v_pk_mov_b32 v[136:137], v[48:49], v[48:49]
v_pk_mov_b32 v[138:139], v[48:49], v[48:49]
v_pk_mov_b32 v[140:141], v[48:49], v[48:49]
v_pk_mov_b32 v[142:143], v[48:49], v[48:49]
v_pk_mov_b32 v[144:145], v[48:49], v[48:49]
v_pk_mov_b32 v[146:147], v[48:49], v[48:49]
v_pk_mov_b32 v[148:149], v[48:49], v[48:49]
v_pk_mov_b32 v[150:151], v[48:49], v[48:49]
v_pk_mov_b32 v[152:153], v[48:49], v[48:49]
v_pk_mov_b32 v[154:155], v[48:49], v[48:49]
v_pk_mov_b32 v[156:157], v[48:49], v[48:49]
v_pk_mov_b32 v[158:159], v[48:49], v[48:49]
v_pk_mov_b32 v[160:161], v[48:49], v[48:49]
v_pk_mov_b32 v[162:163], v[48:49], v[48:49]
v_pk_mov_b32 v[164:165], v[48:49], v[48:49]
v_pk_mov_b32 v[166:167], v[48:49], v[48:49]
v_pk_mov_b32 v[168:169], v[48:49], v[48:49]
v_pk_mov_b32 v[170:171], v[48:49], v[48:49]
v_pk_mov_b32 v[172:173], v[48:49], v[48:49]
v_pk_mov_b32 v[174:175], v[48:49], v[48:49]
v_pk_mov_b32 v[176:177], v[48:49], v[48:49]
v_pk_mov_b32 v[178:179], v[48:49], v[48:49]
v_pk_mov_b32 v[180:181], v[48:49], v[48:49]
v_pk_mov_b32 v[182:183], v[48:49], v[48:49]
v_pk_mov_b32 v[184:185], v[48:49], v[48:49]
v_pk_mov_b32 v[186:187], v[48:49], v[48:49]
v_pk_mov_b32 v[188:189], v[48:49], v[48:49]
v_pk_mov_b32 v[190:191], v[48:49], v[48:49]
v_pk_mov_b32 v[192:193], v[48:49], v[48:49]
v_pk_mov_b32 v[194:195], v[48:49], v[48:49]
v_pk_mov_b32 v[196:197], v[48:49], v[48:49]
v_pk_mov_b32 v[198:199], v[48:49], v[48:49]
v_pk_mov_b32 v[200:201], v[48:49], v[48:49]
v_pk_mov_b32 v[202:203], v[48:49], v[48:49]
v_pk_mov_b32 v[204:205], v[48:49], v[48:49]
v_pk_mov_b32 v[206:207], v[48:49], v[48:49]
v_pk_mov_b32 v[208:209], v[48:49], v[48:49]
v_pk_mov_b32 v[210:211], v[48:49], v[48:49]
v_pk_mov_b32 v[212:213], v[48:49], v[48:49]
v_pk_mov_b32 v[214:215], v[48:49], v[48:49]
v_pk_mov_b32 v[216:217], v[48:49], v[48:49]
v_pk_mov_b32 v[218:219], v[48:49], v[48:49]
v_pk_mov_b32 v[220:221], v[48:49], v[48:49]
v_pk_mov_b32 v[222:223], v[48:49], v[48:49]
v_pk_mov_b32 v[50:51], v[48:49], v[48:49]
v_pk_mov_b32 v[52:53], v[48:49], v[48:49]
v_pk_mov_b32 v[54:55], v[48:49], v[48:49]
v_pk_mov_b32 v[56:57], v[48:49], v[48:49]
v_pk_mov_b32 v[58:59], v[48:49], v[48:49]
v_pk_mov_b32 v[60:61], v[48:49], v[48:49]
v_pk_mov_b32 v[62:63], v[48:49], v[48:49]
v_mov_b32 v88, 0xff7fffff
v_mov_b32 v89, 0xff7fffff
v_mov_b32 v90, 0xff7fffff
v_mov_b32 v91, 0xff7fffff
s_mov_b32 s51, s60
s_mov_b32 s52, s60
s_mov_b32 s59, 0
K3_slow:
s_barrier
s_add_u32 m0, s55, 0x0
s_nop 0
buffer_load_dwordx4 v224, s[20:23], s51 offen lds
buffer_load_dwordx4 v225, s[20:23], s51 offen offset:1024 lds
buffer_load_dwordx4 v226, s[20:23], s51 offen offset:2048 lds
buffer_load_dwordx4 v227, s[20:23], s51 offen offset:3072 lds
s_add_u32 m0, s55, 0x4000
s_nop 0
buffer_load_dwordx4 v228, s[24:27], s52 offen lds
buffer_load_dwordx4 v229, s[24:27], s52 offen offset:1024 lds
buffer_load_dwordx4 v228, s[24:27], s52 offen offset:2048 lds
buffer_load_dwordx4 v229, s[24:27], s52 offen offset:3072 lds
s_add_u32 s51, s51, 16384
s_add_u32 s52, s52, 16384
s_waitcnt vmcnt(0)
s_barrier
ds_read_b128 a[0:3], v64
ds_read_b128 a[4:7], v65
ds_read_b128 a[8:11], v66
ds_read_b128 a[12:15], v67
ds_read_b128 a[16:19], v64 offset:4096
ds_read_b128 a[20:23], v65 offset:4096
ds_read_b128 a[24:27], v66 offset:4096
ds_read_b128 a[28:31], v67 offset:4096
s_waitcnt lgkmcnt(0)
v_mfma_f32_16x16x32_bf16 v[0:3], a[0:3], a[128:131], 0
v_mfma_f32_16x16x32_bf16 v[0:3], a[4:7], a[132:135], v[0:3]
v_mfma_f32_16x16x32_bf16 v[0:3], a[8:11], a[136:139], v[0:3]
v_mfma_f32_16x16x32_bf16 v[0:3], a[12:15], a[140:143], v[0:3]
v_mfma_f32_16x16x32_bf16 v[4:7], a[16:19], a[128:131], 0
v_mfma_f32_16x16x32_bf16 v[4:7], a[20:23], a[132:135], v[4:7]
v_mfma_f32_16x16x32_bf16 v[4:7], a[24:27], a[136:139], v[4:7]
v_mfma_f32_16x16x32_bf16 v[4:7], a[28:31], a[140:143], v[4:7]
v_mfma_f32_16x16x32_bf16 v[8:11], a[0:3], a[144:147], 0
v_mfma_f32_16x16x32_bf16 v[8:11], a[4:7], a[148:151], v[8:11]
v_mfma_f32_16x16x32_bf16 v[8:11], a[8:11], a[152:155], v[8:11]
v_mfma_f32_16x16x32_bf16 v[8:11], a[12:15], a[156:159], v[8:11]
v_mfma_f32_16x16x32_bf16 v[12:15], a[16:19], a[144:147], 0
v_mfma_f32_16x16x32_bf16 v[12:15], a[20:23], a[148:151], v[12:15]
v_mfma_f32_16x16x32_bf16 v[12:15], a[24:27], a[152:155], v[12:15]
v_mfma_f32_16x16x32_bf16 v[12:15], a[28:31], a[156:159], v[12:15]
v_mfma_f32_16x16x32_bf16 v[16:19], a[0:3], a[160:163], 0
v_mfma_f32_16x16x32_bf16 v[16:19], a[4:7], a[164:167], v[16:19]
v_mfma_f32_16x16x32_bf16 v[16:19], a[8:11], a[168:171], v[16:19]
v_mfma_f32_16x16x32_bf16 v[16:19], a[12:15], a[172:175], v[16:19]
v_mfma_f32_16x16x32_bf16 v[20:23], a[16:19], a[160:163], 0
v_mfma_f32_16x16x32_bf16 v[20:23], a[20:23], a[164:167], v[20:23]
v_mfma_f32_16x16x32_bf16 v[20:23], a[24:27], a[168:171], v[20:23]
v_mfma_f32_16x16x32_bf16 v[20:23], a[28:31], a[172:175], v[20:23]
v_mfma_f32_16x16x32_bf16 v[24:27], a[0:3], a[176:179], 0
v_mfma_f32_16x16x32_bf16 v[24:27], a[4:7], a[180:183], v[24:27]
v_mfma_f32_16x16x32_bf16 v[24:27], a[8:11], a[184:187], v[24:27]
v_mfma_f32_16x16x32_bf16 v[24:27], a[12:15], a[188:191], v[24:27]
v_mfma_f32_16x16x32_bf16 v[28:31], a[16:19], a[176:179], 0
v_mfma_f32_16x16x32_bf16 v[28:31], a[20:23], a[180:183], v[28:31]
v_mfma_f32_16x16x32_bf16 v[28:31], a[24:27], a[184:187], v[28:31]
v_mfma_f32_16x16x32_bf16 v[28:31], a[28:31], a[188:191], v[28:31]
ds_read_b64_tr_b16 a[32:33], v72
ds_read_b64_tr_b16 a[34:35], v72 offset:4096
ds_read_b64_tr_b16 a[36:37], v73
ds_read_b64_tr_b16 a[38:39], v73 offset:4096
ds_read_b64_tr_b16 a[40:41], v74
ds_read_b64_tr_b16 a[42:43], v74 offset:4096
ds_read_b64_tr_b16 a[44:45], v75
ds_read_b64_tr_b16 a[46:47], v75 offset:4096
s_waitcnt lgkmcnt(0)
ds_read_b64_tr_b16 a[48:49], v76
ds_read_b64_tr_b16 a[50:51], v76 offset:4096
ds_read_b64_tr_b16 a[52:53], v77
ds_read_b64_tr_b16 a[54:55], v77 offset:4096
ds_read_b64_tr_b16 a[56:57], v78
ds_read_b64_tr_b16 a[58:59], v78 offset:4096
ds_read_b64_tr_b16 a[60:61], v79
ds_read_b64_tr_b16 a[62:63], v79 offset:4096
s_nop 7
v_max3_f32 v252, v0, v1, v2
v_max3_f32 v252, v252, v3, v4
v_max3_f32 v252, v252, v5, v6
v_max_f32 v252, v252, v7
v_mov_b32 v251, v252
s_nop 1
v_permlane32_swap_b32 v251, v252
s_nop 1
v_max_f32 v252, v252, v251
v_mov_b32 v251, v252
s_nop 1
v_permlane16_swap_b32 v251, v252
s_nop 1
v_max_f32 v252, v252, v251
v_max_f32 v252, v252, v88
v_sub_f32 v251, v88, v252
v_exp_f32 v251, v251
v_mov_b32 v88, v252
v_sub_f32 v0, v0, v252
v_sub_f32 v1, v1, v252
v_sub_f32 v2, v2, v252
v_sub_f32 v3, v3, v252
v_sub_f32 v4, v4, v252
v_sub_f32 v5, v5, v252
v_sub_f32 v6, v6, v252
v_sub_f32 v7, v7, v252
v_exp_f32 v0, v0
v_exp_f32 v1, v1
v_exp_f32 v2, v2
v_exp_f32 v3, v3
v_exp_f32 v4, v4
v_exp_f32 v5, v5
v_exp_f32 v6, v6
v_exp_f32 v7, v7
s_nop 0
v_cvt_pk_bf16_f32 v32, v0, v1
v_cvt_pk_bf16_f32 v33, v2, v3
v_cvt_pk_bf16_f32 v34, v4, v5
v_cvt_pk_bf16_f32 v35, v6, v7
v_mul_f32 v96, v96, v251
v_mul_f32 v97, v97, v251
v_mul_f32 v98, v98, v251
v_mul_f32 v99, v99, v251
v_mul_f32 v100, v100, v251
v_mul_f32 v101, v101, v251
v_mul_f32 v102, v102, v251
v_mul_f32 v103, v103, v251
v_mul_f32 v104, v104, v251
v_mul_f32 v105, v105, v251
v_mul_f32 v106, v106, v251
v_mul_f32 v107, v107, v251
v_mul_f32 v108, v108, v251
v_mul_f32 v109, v109, v251
v_mul_f32 v110, v110, v251
v_mul_f32 v111, v111, v251
v_mul_f32 v112, v112, v251
v_mul_f32 v113, v113, v251
v_mul_f32 v114, v114, v251
v_mul_f32 v115, v115, v251
v_mul_f32 v116, v116, v251
v_mul_f32 v117, v117, v251
v_mul_f32 v118, v118, v251
v_mul_f32 v119, v119, v251
v_mul_f32 v120, v120, v251
v_mul_f32 v121, v121, v251
v_mul_f32 v122, v122, v251
v_mul_f32 v123, v123, v251
v_mul_f32 v124, v124, v251
v_mul_f32 v125, v125, v251
v_mul_f32 v126, v126, v251
v_mul_f32 v127, v127, v251
v_mul_f32 v48, v48, v251
v_mul_f32 v49, v49, v251
v_mul_f32 v50, v50, v251
v_mul_f32 v51, v51, v251
v_max3_f32 v252, v8, v9, v10
v_max3_f32 v252, v252, v11, v12
v_max3_f32 v252, v252, v13, v14
v_max_f32 v252, v252, v15
v_mov_b32 v251, v252
s_nop 1
v_permlane32_swap_b32 v251, v252
s_nop 1
v_max_f32 v252, v252, v251
v_mov_b32 v251, v252
s_nop 1
v_permlane16_swap_b32 v251, v252
s_nop 1
v_max_f32 v252, v252, v251
v_max_f32 v252, v252, v89
v_sub_f32 v251, v89, v252
v_exp_f32 v251, v251
v_mov_b32 v89, v252
v_sub_f32 v8, v8, v252
v_sub_f32 v9, v9, v252
v_sub_f32 v10, v10, v252
v_sub_f32 v11, v11, v252
v_sub_f32 v12, v12, v252
v_sub_f32 v13, v13, v252
v_sub_f32 v14, v14, v252
v_sub_f32 v15, v15, v252
v_exp_f32 v8, v8
v_exp_f32 v9, v9
v_exp_f32 v10, v10
v_exp_f32 v11, v11
v_exp_f32 v12, v12
v_exp_f32 v13, v13
v_exp_f32 v14, v14
v_exp_f32 v15, v15
s_nop 0
v_cvt_pk_bf16_f32 v36, v8, v9
v_cvt_pk_bf16_f32 v37, v10, v11
v_cvt_pk_bf16_f32 v38, v12, v13
v_cvt_pk_bf16_f32 v39, v14, v15
v_mul_f32 v128, v128, v251
v_mul_f32 v129, v129, v251
v_mul_f32 v130, v130, v251
v_mul_f32 v131, v131, v251
v_mul_f32 v132, v132, v251
v_mul_f32 v133, v133, v251
v_mul_f32 v134, v134, v251
v_mul_f32 v135, v135, v251
v_mul_f32 v136, v136, v251
v_mul_f32 v137, v137, v251
v_mul_f32 v138, v138, v251
v_mul_f32 v139, v139, v251
v_mul_f32 v140, v140, v251
v_mul_f32 v141, v141, v251
v_mul_f32 v142, v142, v251
v_mul_f32 v143, v143, v251
v_mul_f32 v144, v144, v251
v_mul_f32 v145, v145, v251
v_mul_f32 v146, v146, v251
v_mul_f32 v147, v147, v251
v_mul_f32 v148, v148, v251
v_mul_f32 v149, v149, v251
v_mul_f32 v150, v150, v251
v_mul_f32 v151, v151, v251
v_mul_f32 v152, v152, v251
v_mul_f32 v153, v153, v251
v_mul_f32 v154, v154, v251
v_mul_f32 v155, v155, v251
v_mul_f32 v156, v156, v251
v_mul_f32 v157, v157, v251
v_mul_f32 v158, v158, v251
v_mul_f32 v159, v159, v251
v_mul_f32 v52, v52, v251
v_mul_f32 v53, v53, v251
v_mul_f32 v54, v54, v251
v_mul_f32 v55, v55, v251
v_max3_f32 v252, v16, v17, v18
v_max3_f32 v252, v252, v19, v20
v_max3_f32 v252, v252, v21, v22
v_max_f32 v252, v252, v23
v_mov_b32 v251, v252
s_nop 1
v_permlane32_swap_b32 v251, v252
s_nop 1
v_max_f32 v252, v252, v251
v_mov_b32 v251, v252
s_nop 1
v_permlane16_swap_b32 v251, v252
s_nop 1
v_max_f32 v252, v252, v251
v_max_f32 v252, v252, v90
v_sub_f32 v251, v90, v252
v_exp_f32 v251, v251
v_mov_b32 v90, v252
v_sub_f32 v16, v16, v252
v_sub_f32 v17, v17, v252
v_sub_f32 v18, v18, v252
v_sub_f32 v19, v19, v252
v_sub_f32 v20, v20, v252
v_sub_f32 v21, v21, v252
v_sub_f32 v22, v22, v252
v_sub_f32 v23, v23, v252
v_exp_f32 v16, v16
v_exp_f32 v17, v17
v_exp_f32 v18, v18
v_exp_f32 v19, v19
v_exp_f32 v20, v20
v_exp_f32 v21, v21
v_exp_f32 v22, v22
v_exp_f32 v23, v23
s_nop 0
v_cvt_pk_bf16_f32 v40, v16, v17
v_cvt_pk_bf16_f32 v41, v18, v19
v_cvt_pk_bf16_f32 v42, v20, v21
v_cvt_pk_bf16_f32 v43, v22, v23
v_mul_f32 v160, v160, v251
v_mul_f32 v161, v161, v251
v_mul_f32 v162, v162, v251
v_mul_f32 v163, v163, v251
v_mul_f32 v164, v164, v251
v_mul_f32 v165, v165, v251
v_mul_f32 v166, v166, v251
v_mul_f32 v167, v167, v251
v_mul_f32 v168, v168, v251
v_mul_f32 v169, v169, v251
v_mul_f32 v170, v170, v251
v_mul_f32 v171, v171, v251
v_mul_f32 v172, v172, v251
v_mul_f32 v173, v173, v251
v_mul_f32 v174, v174, v251
v_mul_f32 v175, v175, v251
v_mul_f32 v176, v176, v251
v_mul_f32 v177, v177, v251
v_mul_f32 v178, v178, v251
v_mul_f32 v179, v179, v251
v_mul_f32 v180, v180, v251
v_mul_f32 v181, v181, v251
v_mul_f32 v182, v182, v251
v_mul_f32 v183, v183, v251
v_mul_f32 v184, v184, v251
v_mul_f32 v185, v185, v251
v_mul_f32 v186, v186, v251
v_mul_f32 v187, v187, v251
v_mul_f32 v188, v188, v251
v_mul_f32 v189, v189, v251
v_mul_f32 v190, v190, v251
v_mul_f32 v191, v191, v251
v_mul_f32 v56, v56, v251
v_mul_f32 v57, v57, v251
v_mul_f32 v58, v58, v251
v_mul_f32 v59, v59, v251
v_max3_f32 v252, v24, v25, v26
v_max3_f32 v252, v252, v27, v28
v_max3_f32 v252, v252, v29, v30
v_max_f32 v252, v252, v31
v_mov_b32 v251, v252
s_nop 1
v_permlane32_swap_b32 v251, v252
s_nop 1
v_max_f32 v252, v252, v251
v_mov_b32 v251, v252
s_nop 1
v_permlane16_swap_b32 v251, v252
s_nop 1
v_max_f32 v252, v252, v251
v_max_f32 v252, v252, v91
v_sub_f32 v251, v91, v252
v_exp_f32 v251, v251
v_mov_b32 v91, v252
v_sub_f32 v24, v24, v252
v_sub_f32 v25, v25, v252
v_sub_f32 v26, v26, v252
v_sub_f32 v27, v27, v252
v_sub_f32 v28, v28, v252
v_sub_f32 v29, v29, v252
v_sub_f32 v30, v30, v252
v_sub_f32 v31, v31, v252
v_exp_f32 v24, v24
v_exp_f32 v25, v25
v_exp_f32 v26, v26
v_exp_f32 v27, v27
v_exp_f32 v28, v28
v_exp_f32 v29, v29
v_exp_f32 v30, v30
v_exp_f32 v31, v31
s_nop 0
v_cvt_pk_bf16_f32 v44, v24, v25
v_cvt_pk_bf16_f32 v45, v26, v27
v_cvt_pk_bf16_f32 v46, v28, v29
v_cvt_pk_bf16_f32 v47, v30, v31
v_mul_f32 v192, v192, v251
v_mul_f32 v193, v193, v251
v_mul_f32 v194, v194, v251
v_mul_f32 v195, v195, v251
v_mul_f32 v196, v196, v251
v_mul_f32 v197, v197, v251
v_mul_f32 v198, v198, v251
v_mul_f32 v199, v199, v251
v_mul_f32 v200, v200, v251
v_mul_f32 v201, v201, v251
v_mul_f32 v202, v202, v251
v_mul_f32 v203, v203, v251
v_mul_f32 v204, v204, v251
v_mul_f32 v205, v205, v251
v_mul_f32 v206, v206, v251
v_mul_f32 v207, v207, v251
v_mul_f32 v208, v208, v251
v_mul_f32 v209, v209, v251
v_mul_f32 v210, v210, v251
v_mul_f32 v211, v211, v251
v_mul_f32 v212, v212, v251
v_mul_f32 v213, v213, v251
v_mul_f32 v214, v214, v251
v_mul_f32 v215, v215, v251
v_mul_f32 v216, v216, v251
v_mul_f32 v217, v217, v251
v_mul_f32 v218, v218, v251
v_mul_f32 v219, v219, v251
v_mul_f32 v220, v220, v251
v_mul_f32 v221, v221, v251
v_mul_f32 v222, v222, v251
v_mul_f32 v223, v223, v251
v_mul_f32 v60, v60, v251
v_mul_f32 v61, v61, v251
v_mul_f32 v62, v62, v251
v_mul_f32 v63, v63, v251
s_waitcnt lgkmcnt(0)
s_nop 1
v_mfma_f32_16x16x32_bf16 v[96:99], a[32:35], v[32:35], v[96:99]
v_mfma_f32_16x16x32_bf16 v[100:103], a[36:39], v[32:35], v[100:103]
v_mfma_f32_16x16x32_bf16 v[104:107], a[40:43], v[32:35], v[104:107]
v_mfma_f32_16x16x32_bf16 v[108:111], a[44:47], v[32:35], v[108:111]
v_mfma_f32_16x16x32_bf16 v[112:115], a[48:51], v[32:35], v[112:115]
v_mfma_f32_16x16x32_bf16 v[116:119], a[52:55], v[32:35], v[116:119]
v_mfma_f32_16x16x32_bf16 v[120:123], a[56:59], v[32:35], v[120:123]
v_mfma_f32_16x16x32_bf16 v[124:127], a[60:63], v[32:35], v[124:127]
v_mfma_f32_16x16x32_bf16 v[48:51], a[96:99], v[32:35], v[48:51]
v_mfma_f32_16x16x32_bf16 v[128:131], a[32:35], v[36:39], v[128:131]
v_mfma_f32_16x16x32_bf16 v[132:135], a[36:39], v[36:39], v[132:135]
v_mfma_f32_16x16x32_bf16 v[136:139], a[40:43], v[36:39], v[136:139]
v_mfma_f32_16x16x32_bf16 v[140:143], a[44:47], v[36:39], v[140:143]
v_mfma_f32_16x16x32_bf16 v[144:147], a[48:51], v[36:39], v[144:147]
v_mfma_f32_16x16x32_bf16 v[148:151], a[52:55], v[36:39], v[148:151]
v_mfma_f32_16x16x32_bf16 v[152:155], a[56:59], v[36:39], v[152:155]
v_mfma_f32_16x16x32_bf16 v[156:159], a[60:63], v[36:39], v[156:159]
v_mfma_f32_16x16x32_bf16 v[52:55], a[96:99], v[36:39], v[52:55]
v_mfma_f32_16x16x32_bf16 v[160:163], a[32:35], v[40:43], v[160:163]
v_mfma_f32_16x16x32_bf16 v[164:167], a[36:39], v[40:43], v[164:167]
v_mfma_f32_16x16x32_bf16 v[168:171], a[40:43], v[40:43], v[168:171]
v_mfma_f32_16x16x32_bf16 v[172:175], a[44:47], v[40:43], v[172:175]
v_mfma_f32_16x16x32_bf16 v[176:179], a[48:51], v[40:43], v[176:179]
v_mfma_f32_16x16x32_bf16 v[180:183], a[52:55], v[40:43], v[180:183]
v_mfma_f32_16x16x32_bf16 v[184:187], a[56:59], v[40:43], v[184:187]
v_mfma_f32_16x16x32_bf16 v[188:191], a[60:63], v[40:43], v[188:191]
v_mfma_f32_16x16x32_bf16 v[56:59], a[96:99], v[40:43], v[56:59]
v_mfma_f32_16x16x32_bf16 v[192:195], a[32:35], v[44:47], v[192:195]
v_mfma_f32_16x16x32_bf16 v[196:199], a[36:39], v[44:47], v[196:199]
v_mfma_f32_16x16x32_bf16 v[200:203], a[40:43], v[44:47], v[200:203]
v_mfma_f32_16x16x32_bf16 v[204:207], a[44:47], v[44:47], v[204:207]
v_mfma_f32_16x16x32_bf16 v[208:211], a[48:51], v[44:47], v[208:211]
v_mfma_f32_16x16x32_bf16 v[212:215], a[52:55], v[44:47], v[212:215]
v_mfma_f32_16x16x32_bf16 v[216:219], a[56:59], v[44:47], v[216:219]
v_mfma_f32_16x16x32_bf16 v[220:223], a[60:63], v[44:47], v[220:223]
v_mfma_f32_16x16x32_bf16 v[60:63], a[96:99], v[44:47], v[60:63]
s_nop 7
ds_read_b128 a[0:3], v64 offset:8192
ds_read_b128 a[4:7], v65 offset:8192
ds_read_b128 a[8:11], v66 offset:8192
ds_read_b128 a[12:15], v67 offset:8192
ds_read_b128 a[16:19], v64 offset:12288
ds_read_b128 a[20:23], v65 offset:12288
ds_read_b128 a[24:27], v66 offset:12288
ds_read_b128 a[28:31], v67 offset:12288
s_waitcnt lgkmcnt(0)
v_mfma_f32_16x16x32_bf16 v[0:3], a[0:3], a[128:131], 0
v_mfma_f32_16x16x32_bf16 v[0:3], a[4:7], a[132:135], v[0:3]
v_mfma_f32_16x16x32_bf16 v[0:3], a[8:11], a[136:139], v[0:3]
v_mfma_f32_16x16x32_bf16 v[0:3], a[12:15], a[140:143], v[0:3]
v_mfma_f32_16x16x32_bf16 v[4:7], a[16:19], a[128:131], 0
v_mfma_f32_16x16x32_bf16 v[4:7], a[20:23], a[132:135], v[4:7]
v_mfma_f32_16x16x32_bf16 v[4:7], a[24:27], a[136:139], v[4:7]
v_mfma_f32_16x16x32_bf16 v[4:7], a[28:31], a[140:143], v[4:7]
v_mfma_f32_16x16x32_bf16 v[8:11], a[0:3], a[144:147], 0
v_mfma_f32_16x16x32_bf16 v[8:11], a[4:7], a[148:151], v[8:11]
v_mfma_f32_16x16x32_bf16 v[8:11], a[8:11], a[152:155], v[8:11]
v_mfma_f32_16x16x32_bf16 v[8:11], a[12:15], a[156:159], v[8:11]
v_mfma_f32_16x16x32_bf16 v[12:15], a[16:19], a[144:147], 0
v_mfma_f32_16x16x32_bf16 v[12:15], a[20:23], a[148:151], v[12:15]
v_mfma_f32_16x16x32_bf16 v[12:15], a[24:27], a[152:155], v[12:15]
v_mfma_f32_16x16x32_bf16 v[12:15], a[28:31], a[156:159], v[12:15]
v_mfma_f32_16x16x32_bf16 v[16:19], a[0:3], a[160:163], 0
v_mfma_f32_16x16x32_bf16 v[16:19], a[4:7], a[164:167], v[16:19]
v_mfma_f32_16x16x32_bf16 v[16:19], a[8:11], a[168:171], v[16:19]
v_mfma_f32_16x16x32_bf16 v[16:19], a[12:15], a[172:175], v[16:19]
v_mfma_f32_16x16x32_bf16 v[20:23], a[16:19], a[160:163], 0
v_mfma_f32_16x16x32_bf16 v[20:23], a[20:23], a[164:167], v[20:23]
v_mfma_f32_16x16x32_bf16 v[20:23], a[24:27], a[168:171], v[20:23]
v_mfma_f32_16x16x32_bf16 v[20:23], a[28:31], a[172:175], v[20:23]
v_mfma_f32_16x16x32_bf16 v[24:27], a[0:3], a[176:179], 0
v_mfma_f32_16x16x32_bf16 v[24:27], a[4:7], a[180:183], v[24:27]
v_mfma_f32_16x16x32_bf16 v[24:27], a[8:11], a[184:187], v[24:27]
v_mfma_f32_16x16x32_bf16 v[24:27], a[12:15], a[188:191], v[24:27]
v_mfma_f32_16x16x32_bf16 v[28:31], a[16:19], a[176:179], 0
v_mfma_f32_16x16x32_bf16 v[28:31], a[20:23], a[180:183], v[28:31]
v_mfma_f32_16x16x32_bf16 v[28:31], a[24:27], a[184:187], v[28:31]
v_mfma_f32_16x16x32_bf16 v[28:31], a[28:31], a[188:191], v[28:31]
ds_read_b64_tr_b16 a[32:33], v72 offset:8192
ds_read_b64_tr_b16 a[34:35], v72 offset:12288
ds_read_b64_tr_b16 a[36:37], v73 offset:8192
ds_read_b64_tr_b16 a[38:39], v73 offset:12288
ds_read_b64_tr_b16 a[40:41], v74 offset:8192
ds_read_b64_tr_b16 a[42:43], v74 offset:12288
ds_read_b64_tr_b16 a[44:45], v75 offset:8192
ds_read_b64_tr_b16 a[46:47], v75 offset:12288
s_waitcnt lgkmcnt(0)
ds_read_b64_tr_b16 a[48:49], v76 offset:8192
ds_read_b64_tr_b16 a[50:51], v76 offset:12288
ds_read_b64_tr_b16 a[52:53], v77 offset:8192
ds_read_b64_tr_b16 a[54:55], v77 offset:12288
ds_read_b64_tr_b16 a[56:57], v78 offset:8192
ds_read_b64_tr_b16 a[58:59], v78 offset:12288
ds_read_b64_tr_b16 a[60:61], v79 offset:8192
ds_read_b64_tr_b16 a[62:63], v79 offset:12288
s_nop 7
v_max3_f32 v252, v0, v1, v2
v_max3_f32 v252, v252, v3, v4
v_max3_f32 v252, v252, v5, v6
v_max_f32 v252, v252, v7
v_mov_b32 v251, v252
s_nop 1
v_permlane32_swap_b32 v251, v252
s_nop 1
v_max_f32 v252, v252, v251
v_mov_b32 v251, v252
s_nop 1
v_permlane16_swap_b32 v251, v252
s_nop 1
v_max_f32 v252, v252, v251
v_max_f32 v252, v252, v88
v_sub_f32 v251, v88, v252
v_exp_f32 v251, v251
v_mov_b32 v88, v252
v_sub_f32 v0, v0, v252
v_sub_f32 v1, v1, v252
v_sub_f32 v2, v2, v252
v_sub_f32 v3, v3, v252
v_sub_f32 v4, v4, v252
v_sub_f32 v5, v5, v252
v_sub_f32 v6, v6, v252
v_sub_f32 v7, v7, v252
v_exp_f32 v0, v0
v_exp_f32 v1, v1
v_exp_f32 v2, v2
v_exp_f32 v3, v3
v_exp_f32 v4, v4
v_exp_f32 v5, v5
v_exp_f32 v6, v6
v_exp_f32 v7, v7
s_nop 0
v_cvt_pk_bf16_f32 v32, v0, v1
v_cvt_pk_bf16_f32 v33, v2, v3
v_cvt_pk_bf16_f32 v34, v4, v5
v_cvt_pk_bf16_f32 v35, v6, v7
v_mul_f32 v96, v96, v251
v_mul_f32 v97, v97, v251
v_mul_f32 v98, v98, v251
v_mul_f32 v99, v99, v251
v_mul_f32 v100, v100, v251
v_mul_f32 v101, v101, v251
v_mul_f32 v102, v102, v251
v_mul_f32 v103, v103, v251
v_mul_f32 v104, v104, v251
v_mul_f32 v105, v105, v251
v_mul_f32 v106, v106, v251
v_mul_f32 v107, v107, v251
v_mul_f32 v108, v108, v251
v_mul_f32 v109, v109, v251
v_mul_f32 v110, v110, v251
v_mul_f32 v111, v111, v251
v_mul_f32 v112, v112, v251
v_mul_f32 v113, v113, v251
v_mul_f32 v114, v114, v251
v_mul_f32 v115, v115, v251
v_mul_f32 v116, v116, v251
v_mul_f32 v117, v117, v251
v_mul_f32 v118, v118, v251
v_mul_f32 v119, v119, v251
v_mul_f32 v120, v120, v251
v_mul_f32 v121, v121, v251
v_mul_f32 v122, v122, v251
v_mul_f32 v123, v123, v251
v_mul_f32 v124, v124, v251
v_mul_f32 v125, v125, v251
v_mul_f32 v126, v126, v251
v_mul_f32 v127, v127, v251
v_mul_f32 v48, v48, v251
v_mul_f32 v49, v49, v251
v_mul_f32 v50, v50, v251
v_mul_f32 v51, v51, v251
v_max3_f32 v252, v8, v9, v10
v_max3_f32 v252, v252, v11, v12
v_max3_f32 v252, v252, v13, v14
v_max_f32 v252, v252, v15
v_mov_b32 v251, v252
s_nop 1
v_permlane32_swap_b32 v251, v252
s_nop 1
v_max_f32 v252, v252, v251
v_mov_b32 v251, v252
s_nop 1
v_permlane16_swap_b32 v251, v252
s_nop 1
v_max_f32 v252, v252, v251
v_max_f32 v252, v252, v89
v_sub_f32 v251, v89, v252
v_exp_f32 v251, v251
v_mov_b32 v89, v252
v_sub_f32 v8, v8, v252
v_sub_f32 v9, v9, v252
v_sub_f32 v10, v10, v252
v_sub_f32 v11, v11, v252
v_sub_f32 v12, v12, v252
v_sub_f32 v13, v13, v252
v_sub_f32 v14, v14, v252
v_sub_f32 v15, v15, v252
v_exp_f32 v8, v8
v_exp_f32 v9, v9
v_exp_f32 v10, v10
v_exp_f32 v11, v11
v_exp_f32 v12, v12
v_exp_f32 v13, v13
v_exp_f32 v14, v14
v_exp_f32 v15, v15
s_nop 0
v_cvt_pk_bf16_f32 v36, v8, v9
v_cvt_pk_bf16_f32 v37, v10, v11
v_cvt_pk_bf16_f32 v38, v12, v13
v_cvt_pk_bf16_f32 v39, v14, v15
v_mul_f32 v128, v128, v251
v_mul_f32 v129, v129, v251
v_mul_f32 v130, v130, v251
v_mul_f32 v131, v131, v251
v_mul_f32 v132, v132, v251
v_mul_f32 v133, v133, v251
v_mul_f32 v134, v134, v251
v_mul_f32 v135, v135, v251
v_mul_f32 v136, v136, v251
v_mul_f32 v137, v137, v251
v_mul_f32 v138, v138, v251
v_mul_f32 v139, v139, v251
v_mul_f32 v140, v140, v251
v_mul_f32 v141, v141, v251
v_mul_f32 v142, v142, v251
v_mul_f32 v143, v143, v251
v_mul_f32 v144, v144, v251
v_mul_f32 v145, v145, v251
v_mul_f32 v146, v146, v251
v_mul_f32 v147, v147, v251
v_mul_f32 v148, v148, v251
v_mul_f32 v149, v149, v251
v_mul_f32 v150, v150, v251
v_mul_f32 v151, v151, v251
v_mul_f32 v152, v152, v251
v_mul_f32 v153, v153, v251
v_mul_f32 v154, v154, v251
v_mul_f32 v155, v155, v251
v_mul_f32 v156, v156, v251
v_mul_f32 v157, v157, v251
v_mul_f32 v158, v158, v251
v_mul_f32 v159, v159, v251
v_mul_f32 v52, v52, v251
v_mul_f32 v53, v53, v251
v_mul_f32 v54, v54, v251
v_mul_f32 v55, v55, v251
v_max3_f32 v252, v16, v17, v18
v_max3_f32 v252, v252, v19, v20
v_max3_f32 v252, v252, v21, v22
v_max_f32 v252, v252, v23
v_mov_b32 v251, v252
s_nop 1
v_permlane32_swap_b32 v251, v252
s_nop 1
v_max_f32 v252, v252, v251
v_mov_b32 v251, v252
s_nop 1
v_permlane16_swap_b32 v251, v252
s_nop 1
v_max_f32 v252, v252, v251
v_max_f32 v252, v252, v90
v_sub_f32 v251, v90, v252
v_exp_f32 v251, v251
v_mov_b32 v90, v252
v_sub_f32 v16, v16, v252
v_sub_f32 v17, v17, v252
v_sub_f32 v18, v18, v252
v_sub_f32 v19, v19, v252
v_sub_f32 v20, v20, v252
v_sub_f32 v21, v21, v252
v_sub_f32 v22, v22, v252
v_sub_f32 v23, v23, v252
v_exp_f32 v16, v16
v_exp_f32 v17, v17
v_exp_f32 v18, v18
v_exp_f32 v19, v19
v_exp_f32 v20, v20
v_exp_f32 v21, v21
v_exp_f32 v22, v22
v_exp_f32 v23, v23
s_nop 0
v_cvt_pk_bf16_f32 v40, v16, v17
v_cvt_pk_bf16_f32 v41, v18, v19
v_cvt_pk_bf16_f32 v42, v20, v21
v_cvt_pk_bf16_f32 v43, v22, v23
v_mul_f32 v160, v160, v251
v_mul_f32 v161, v161, v251
v_mul_f32 v162, v162, v251
v_mul_f32 v163, v163, v251
v_mul_f32 v164, v164, v251
v_mul_f32 v165, v165, v251
v_mul_f32 v166, v166, v251
v_mul_f32 v167, v167, v251
v_mul_f32 v168, v168, v251
v_mul_f32 v169, v169, v251
v_mul_f32 v170, v170, v251
v_mul_f32 v171, v171, v251
v_mul_f32 v172, v172, v251
v_mul_f32 v173, v173, v251
v_mul_f32 v174, v174, v251
v_mul_f32 v175, v175, v251
v_mul_f32 v176, v176, v251
v_mul_f32 v177, v177, v251
v_mul_f32 v178, v178, v251
v_mul_f32 v179, v179, v251
v_mul_f32 v180, v180, v251
v_mul_f32 v181, v181, v251
v_mul_f32 v182, v182, v251
v_mul_f32 v183, v183, v251
v_mul_f32 v184, v184, v251
v_mul_f32 v185, v185, v251
v_mul_f32 v186, v186, v251
v_mul_f32 v187, v187, v251
v_mul_f32 v188, v188, v251
v_mul_f32 v189, v189, v251
v_mul_f32 v190, v190, v251
v_mul_f32 v191, v191, v251
v_mul_f32 v56, v56, v251
v_mul_f32 v57, v57, v251
v_mul_f32 v58, v58, v251
v_mul_f32 v59, v59, v251
v_max3_f32 v252, v24, v25, v26
v_max3_f32 v252, v252, v27, v28
v_max3_f32 v252, v252, v29, v30
v_max_f32 v252, v252, v31
v_mov_b32 v251, v252
s_nop 1
v_permlane32_swap_b32 v251, v252
s_nop 1
v_max_f32 v252, v252, v251
v_mov_b32 v251, v252
s_nop 1
v_permlane16_swap_b32 v251, v252
s_nop 1
v_max_f32 v252, v252, v251
v_max_f32 v252, v252, v91
v_sub_f32 v251, v91, v252
v_exp_f32 v251, v251
v_mov_b32 v91, v252
v_sub_f32 v24, v24, v252
v_sub_f32 v25, v25, v252
v_sub_f32 v26, v26, v252
v_sub_f32 v27, v27, v252
v_sub_f32 v28, v28, v252
v_sub_f32 v29, v29, v252
v_sub_f32 v30, v30, v252
v_sub_f32 v31, v31, v252
v_exp_f32 v24, v24
v_exp_f32 v25, v25
v_exp_f32 v26, v26
v_exp_f32 v27, v27
v_exp_f32 v28, v28
v_exp_f32 v29, v29
v_exp_f32 v30, v30
v_exp_f32 v31, v31
s_nop 0
v_cvt_pk_bf16_f32 v44, v24, v25
v_cvt_pk_bf16_f32 v45, v26, v27
v_cvt_pk_bf16_f32 v46, v28, v29
v_cvt_pk_bf16_f32 v47, v30, v31
v_mul_f32 v192, v192, v251
v_mul_f32 v193, v193, v251
v_mul_f32 v194, v194, v251
v_mul_f32 v195, v195, v251
v_mul_f32 v196, v196, v251
v_mul_f32 v197, v197, v251
v_mul_f32 v198, v198, v251
v_mul_f32 v199, v199, v251
v_mul_f32 v200, v200, v251
v_mul_f32 v201, v201, v251
v_mul_f32 v202, v202, v251
v_mul_f32 v203, v203, v251
v_mul_f32 v204, v204, v251
v_mul_f32 v205, v205, v251
v_mul_f32 v206, v206, v251
v_mul_f32 v207, v207, v251
v_mul_f32 v208, v208, v251
v_mul_f32 v209, v209, v251
v_mul_f32 v210, v210, v251
v_mul_f32 v211, v211, v251
v_mul_f32 v212, v212, v251
v_mul_f32 v213, v213, v251
v_mul_f32 v214, v214, v251
v_mul_f32 v215, v215, v251
v_mul_f32 v216, v216, v251
v_mul_f32 v217, v217, v251
v_mul_f32 v218, v218, v251
v_mul_f32 v219, v219, v251
v_mul_f32 v220, v220, v251
v_mul_f32 v221, v221, v251
v_mul_f32 v222, v222, v251
v_mul_f32 v223, v223, v251
v_mul_f32 v60, v60, v251
v_mul_f32 v61, v61, v251
v_mul_f32 v62, v62, v251
v_mul_f32 v63, v63, v251
s_waitcnt lgkmcnt(0)
s_nop 1
v_mfma_f32_16x16x32_bf16 v[96:99], a[32:35], v[32:35], v[96:99]
v_mfma_f32_16x16x32_bf16 v[100:103], a[36:39], v[32:35], v[100:103]
v_mfma_f32_16x16x32_bf16 v[104:107], a[40:43], v[32:35], v[104:107]
v_mfma_f32_16x16x32_bf16 v[108:111], a[44:47], v[32:35], v[108:111]
v_mfma_f32_16x16x32_bf16 v[112:115], a[48:51], v[32:35], v[112:115]
v_mfma_f32_16x16x32_bf16 v[116:119], a[52:55], v[32:35], v[116:119]
v_mfma_f32_16x16x32_bf16 v[120:123], a[56:59], v[32:35], v[120:123]
v_mfma_f32_16x16x32_bf16 v[124:127], a[60:63], v[32:35], v[124:127]
v_mfma_f32_16x16x32_bf16 v[48:51], a[96:99], v[32:35], v[48:51]
v_mfma_f32_16x16x32_bf16 v[128:131], a[32:35], v[36:39], v[128:131]
v_mfma_f32_16x16x32_bf16 v[132:135], a[36:39], v[36:39], v[132:135]
v_mfma_f32_16x16x32_bf16 v[136:139], a[40:43], v[36:39], v[136:139]
v_mfma_f32_16x16x32_bf16 v[140:143], a[44:47], v[36:39], v[140:143]
v_mfma_f32_16x16x32_bf16 v[144:147], a[48:51], v[36:39], v[144:147]
v_mfma_f32_16x16x32_bf16 v[148:151], a[52:55], v[36:39], v[148:151]
v_mfma_f32_16x16x32_bf16 v[152:155], a[56:59], v[36:39], v[152:155]
v_mfma_f32_16x16x32_bf16 v[156:159], a[60:63], v[36:39], v[156:159]
v_mfma_f32_16x16x32_bf16 v[52:55], a[96:99], v[36:39], v[52:55]
v_mfma_f32_16x16x32_bf16 v[160:163], a[32:35], v[40:43], v[160:163]
v_mfma_f32_16x16x32_bf16 v[164:167], a[36:39], v[40:43], v[164:167]
v_mfma_f32_16x16x32_bf16 v[168:171], a[40:43], v[40:43], v[168:171]
v_mfma_f32_16x16x32_bf16 v[172:175], a[44:47], v[40:43], v[172:175]
v_mfma_f32_16x16x32_bf16 v[176:179], a[48:51], v[40:43], v[176:179]
v_mfma_f32_16x16x32_bf16 v[180:183], a[52:55], v[40:43], v[180:183]
v_mfma_f32_16x16x32_bf16 v[184:187], a[56:59], v[40:43], v[184:187]
v_mfma_f32_16x16x32_bf16 v[188:191], a[60:63], v[40:43], v[188:191]
v_mfma_f32_16x16x32_bf16 v[56:59], a[96:99], v[40:43], v[56:59]
v_mfma_f32_16x16x32_bf16 v[192:195], a[32:35], v[44:47], v[192:195]
v_mfma_f32_16x16x32_bf16 v[196:199], a[36:39], v[44:47], v[196:199]
v_mfma_f32_16x16x32_bf16 v[200:203], a[40:43], v[44:47], v[200:203]
v_mfma_f32_16x16x32_bf16 v[204:207], a[44:47], v[44:47], v[204:207]
v_mfma_f32_16x16x32_bf16 v[208:211], a[48:51], v[44:47], v[208:211]
v_mfma_f32_16x16x32_bf16 v[212:215], a[52:55], v[44:47], v[212:215]
v_mfma_f32_16x16x32_bf16 v[216:219], a[56:59], v[44:47], v[216:219]
v_mfma_f32_16x16x32_bf16 v[220:223], a[60:63], v[44:47], v[220:223]
v_mfma_f32_16x16x32_bf16 v[60:63], a[96:99], v[44:47], v[60:63]
s_nop 7
s_add_u32 s59, s59, 1
s_cmp_lt_u32 s59, 32
s_cbranch_scc1 K3_slow
s_nop 7
v_lshlrev_b32 v252, 2, v254
ds_bpermute_b32 v48, v252, v48
ds_bpermute_b32 v52, v252, v52
ds_bpermute_b32 v56, v252, v56
ds_bpermute_b32 v60, v252, v60
s_waitcnt lgkmcnt(0)
v_rcp_f32 v246, v48
s_nop 0
v_pk_mul_f32 v[96:97], v[96:97], v[246:247] op_sel_hi:[1,0]
v_pk_mul_f32 v[98:99], v[98:99], v[246:247] op_sel_hi:[1,0]
v_pk_mul_f32 v[100:101], v[100:101], v[246:247] op_sel_hi:[1,0]
v_pk_mul_f32 v[102:103], v[102:103], v[246:247] op_sel_hi:[1,0]
v_pk_mul_f32 v[104:105], v[104:105], v[246:247] op_sel_hi:[1,0]
v_pk_mul_f32 v[106:107], v[106:107], v[246:247] op_sel_hi:[1,0]
v_pk_mul_f32 v[108:109], v[108:109], v[246:247] op_sel_hi:[1,0]
v_pk_mul_f32 v[110:111], v[110:111], v[246:247] op_sel_hi:[1,0]
v_pk_mul_f32 v[112:113], v[112:113], v[246:247] op_sel_hi:[1,0]
v_pk_mul_f32 v[114:115], v[114:115], v[246:247] op_sel_hi:[1,0]
v_pk_mul_f32 v[116:117], v[116:117], v[246:247] op_sel_hi:[1,0]
v_pk_mul_f32 v[118:119], v[118:119], v[246:247] op_sel_hi:[1,0]
v_pk_mul_f32 v[120:121], v[120:121], v[246:247] op_sel_hi:[1,0]
v_pk_mul_f32 v[122:123], v[122:123], v[246:247] op_sel_hi:[1,0]
v_pk_mul_f32 v[124:125], v[124:125], v[246:247] op_sel_hi:[1,0]
v_pk_mul_f32 v[126:127], v[126:127], v[246:247] op_sel_hi:[1,0]
v_rcp_f32 v246, v52
s_nop 0
v_pk_mul_f32 v[128:129], v[128:129], v[246:247] op_sel_hi:[1,0]
v_pk_mul_f32 v[130:131], v[130:131], v[246:247] op_sel_hi:[1,0]
v_pk_mul_f32 v[132:133], v[132:133], v[246:247] op_sel_hi:[1,0]
v_pk_mul_f32 v[134:135], v[134:135], v[246:247] op_sel_hi:[1,0]
v_pk_mul_f32 v[136:137], v[136:137], v[246:247] op_sel_hi:[1,0]
v_pk_mul_f32 v[138:139], v[138:139], v[246:247] op_sel_hi:[1,0]
v_pk_mul_f32 v[140:141], v[140:141], v[246:247] op_sel_hi:[1,0]
v_pk_mul_f32 v[142:143], v[142:143], v[246:247] op_sel_hi:[1,0]
v_pk_mul_f32 v[144:145], v[144:145], v[246:247] op_sel_hi:[1,0]
v_pk_mul_f32 v[146:147], v[146:147], v[246:247] op_sel_hi:[1,0]
v_pk_mul_f32 v[148:149], v[148:149], v[246:247] op_sel_hi:[1,0]
v_pk_mul_f32 v[150:151], v[150:151], v[246:247] op_sel_hi:[1,0]
v_pk_mul_f32 v[152:153], v[152:153], v[246:247] op_sel_hi:[1,0]
v_pk_mul_f32 v[154:155], v[154:155], v[246:247] op_sel_hi:[1,0]
v_pk_mul_f32 v[156:157], v[156:157], v[246:247] op_sel_hi:[1,0]
v_pk_mul_f32 v[158:159], v[158:159], v[246:247] op_sel_hi:[1,0]
v_rcp_f32 v246, v56
s_nop 0
v_pk_mul_f32 v[160:161], v[160:161], v[246:247] op_sel_hi:[1,0]
v_pk_mul_f32 v[162:163], v[162:163], v[246:247] op_sel_hi:[1,0]
v_pk_mul_f32 v[164:165], v[164:165], v[246:247] op_sel_hi:[1,0]
v_pk_mul_f32 v[166:167], v[166:167], v[246:247] op_sel_hi:[1,0]
v_pk_mul_f32 v[168:169], v[168:169], v[246:247] op_sel_hi:[1,0]
v_pk_mul_f32 v[170:171], v[170:171], v[246:247] op_sel_hi:[1,0]
v_pk_mul_f32 v[172:173], v[172:173], v[246:247] op_sel_hi:[1,0]
v_pk_mul_f32 v[174:175], v[174:175], v[246:247] op_sel_hi:[1,0]
v_pk_mul_f32 v[176:177], v[176:177], v[246:247] op_sel_hi:[1,0]
v_pk_mul_f32 v[178:179], v[178:179], v[246:247] op_sel_hi:[1,0]
v_pk_mul_f32 v[180:181], v[180:181], v[246:247] op_sel_hi:[1,0]
v_pk_mul_f32 v[182:183], v[182:183], v[246:247] op_sel_hi:[1,0]
v_pk_mul_f32 v[184:185], v[184:185], v[246:247] op_sel_hi:[1,0]
v_pk_mul_f32 v[186:187], v[186:187], v[246:247] op_sel_hi:[1,0]
v_pk_mul_f32 v[188:189], v[188:189], v[246:247] op_sel_hi:[1,0]
v_pk_mul_f32 v[190:191], v[190:191], v[246:247] op_sel_hi:[1,0]
v_rcp_f32 v246, v60
s_nop 0
v_pk_mul_f32 v[192:193], v[192:193], v[246:247] op_sel_hi:[1,0]
v_pk_mul_f32 v[194:195], v[194:195], v[246:247] op_sel_hi:[1,0]
v_pk_mul_f32 v[196:197], v[196:197], v[246:247] op_sel_hi:[1,0]
v_pk_mul_f32 v[198:199], v[198:199], v[246:247] op_sel_hi:[1,0]
v_pk_mul_f32 v[200:201], v[200:201], v[246:247] op_sel_hi:[1,0]
v_pk_mul_f32 v[202:203], v[202:203], v[246:247] op_sel_hi:[1,0]
v_pk_mul_f32 v[204:205], v[204:205], v[246:247] op_sel_hi:[1,0]
v_pk_mul_f32 v[206:207], v[206:207], v[246:247] op_sel_hi:[1,0]
v_pk_mul_f32 v[208:209], v[208:209], v[246:247] op_sel_hi:[1,0]
v_pk_mul_f32 v[210:211], v[210:211], v[246:247] op_sel_hi:[1,0]
v_pk_mul_f32 v[212:213], v[212:213], v[246:247] op_sel_hi:[1,0]
v_pk_mul_f32 v[214:215], v[214:215], v[246:247] op_sel_hi:[1,0]
v_pk_mul_f32 v[216:217], v[216:217], v[246:247] op_sel_hi:[1,0]
v_pk_mul_f32 v[218:219], v[218:219], v[246:247] op_sel_hi:[1,0]
v_pk_mul_f32 v[220:221], v[220:221], v[246:247] op_sel_hi:[1,0]
v_pk_mul_f32 v[222:223], v[222:223], v[246:247] op_sel_hi:[1,0]
v_lshlrev_b32 v91, 4, v255
s_add_u32 s61, s76, 0x0
v_cvt_pk_bf16_f32 v96, v96, v97
v_cvt_pk_bf16_f32 v97, v98, v99
v_cvt_pk_bf16_f32 v98, v100, v101
v_cvt_pk_bf16_f32 v99, v102, v103
buffer_store_dwordx4 v[96:99], v91, s[36:39], s61 offen sc1
v_cvt_pk_bf16_f32 v104, v104, v105
v_cvt_pk_bf16_f32 v105, v106, v107
v_cvt_pk_bf16_f32 v106, v108, v109
v_cvt_pk_bf16_f32 v107, v110, v111
buffer_store_dwordx4 v[104:107], v91, s[36:39], s61 offen offset:1024 sc1
v_cvt_pk_bf16_f32 v112, v112, v113
v_cvt_pk_bf16_f32 v113, v114, v115
v_cvt_pk_bf16_f32 v114, v116, v117
v_cvt_pk_bf16_f32 v115, v118, v119
buffer_store_dwordx4 v[112:115], v91, s[36:39], s61 offen offset:2048 sc1
v_cvt_pk_bf16_f32 v120, v120, v121
v_cvt_pk_bf16_f32 v121, v122, v123
v_cvt_pk_bf16_f32 v122, v124, v125
v_cvt_pk_bf16_f32 v123, v126, v127
buffer_store_dwordx4 v[120:123], v91, s[36:39], s61 offen offset:3072 sc1
s_add_u32 s61, s76, 0x20400
v_cvt_pk_bf16_f32 v128, v128, v129
v_cvt_pk_bf16_f32 v129, v130, v131
v_cvt_pk_bf16_f32 v130, v132, v133
v_cvt_pk_bf16_f32 v131, v134, v135
buffer_store_dwordx4 v[128:131], v91, s[36:39], s61 offen sc1
v_cvt_pk_bf16_f32 v136, v136, v137
v_cvt_pk_bf16_f32 v137, v138, v139
v_cvt_pk_bf16_f32 v138, v140, v141
v_cvt_pk_bf16_f32 v139, v142, v143
buffer_store_dwordx4 v[136:139], v91, s[36:39], s61 offen offset:1024 sc1
v_cvt_pk_bf16_f32 v144, v144, v145
v_cvt_pk_bf16_f32 v145, v146, v147
v_cvt_pk_bf16_f32 v146, v148, v149
v_cvt_pk_bf16_f32 v147, v150, v151
buffer_store_dwordx4 v[144:147], v91, s[36:39], s61 offen offset:2048 sc1
v_cvt_pk_bf16_f32 v152, v152, v153
v_cvt_pk_bf16_f32 v153, v154, v155
v_cvt_pk_bf16_f32 v154, v156, v157
v_cvt_pk_bf16_f32 v155, v158, v159
buffer_store_dwordx4 v[152:155], v91, s[36:39], s61 offen offset:3072 sc1
s_add_u32 s61, s76, 0x1000
v_cvt_pk_bf16_f32 v160, v160, v161
v_cvt_pk_bf16_f32 v161, v162, v163
v_cvt_pk_bf16_f32 v162, v164, v165
v_cvt_pk_bf16_f32 v163, v166, v167
buffer_store_dwordx4 v[160:163], v91, s[36:39], s61 offen sc1
v_cvt_pk_bf16_f32 v168, v168, v169
v_cvt_pk_bf16_f32 v169, v170, v171
v_cvt_pk_bf16_f32 v170, v172, v173
v_cvt_pk_bf16_f32 v171, v174, v175
buffer_store_dwordx4 v[168:171], v91, s[36:39], s61 offen offset:1024 sc1
v_cvt_pk_bf16_f32 v176, v176, v177
v_cvt_pk_bf16_f32 v177, v178, v179
v_cvt_pk_bf16_f32 v178, v180, v181
v_cvt_pk_bf16_f32 v179, v182, v183
buffer_store_dwordx4 v[176:179], v91, s[36:39], s61 offen offset:2048 sc1
v_cvt_pk_bf16_f32 v184, v184, v185
v_cvt_pk_bf16_f32 v185, v186, v187
v_cvt_pk_bf16_f32 v186, v188, v189
v_cvt_pk_bf16_f32 v187, v190, v191
buffer_store_dwordx4 v[184:187], v91, s[36:39], s61 offen offset:3072 sc1
s_add_u32 s61, s76, 0x21400
v_cvt_pk_bf16_f32 v192, v192, v193
v_cvt_pk_bf16_f32 v193, v194, v195
v_cvt_pk_bf16_f32 v194, v196, v197
v_cvt_pk_bf16_f32 v195, v198, v199
buffer_store_dwordx4 v[192:195], v91, s[36:39], s61 offen sc1
v_cvt_pk_bf16_f32 v200, v200, v201
v_cvt_pk_bf16_f32 v201, v202, v203
v_cvt_pk_bf16_f32 v202, v204, v205
v_cvt_pk_bf16_f32 v203, v206, v207
buffer_store_dwordx4 v[200:203], v91, s[36:39], s61 offen offset:1024 sc1
v_cvt_pk_bf16_f32 v208, v208, v209
v_cvt_pk_bf16_f32 v209, v210, v211
v_cvt_pk_bf16_f32 v210, v212, v213
v_cvt_pk_bf16_f32 v211, v214, v215
buffer_store_dwordx4 v[208:211], v91, s[36:39], s61 offen offset:2048 sc1
v_cvt_pk_bf16_f32 v216, v216, v217
v_cvt_pk_bf16_f32 v217, v218, v219
v_cvt_pk_bf16_f32 v218, v220, v221
v_cvt_pk_bf16_f32 v219, v222, v223
buffer_store_dwordx4 v[216:219], v91, s[36:39], s61 offen offset:3072 sc1
K3_store:
s_and_b32 s41, s2, 7
s_bfe_u32 s42, s2, 0x20003
s_lshr_b32 s43, s2, 5
s_mul_i32 s48, s40, 5120
v_lshlrev_b32 v252, 4, v255
v_add_u32 v252, 0, v252
s_mov_b32 s49, 0xe38e39
v_mul_hi_u32 v251, s49, v252
v_mul_u32_u24 v250, 288, v251
v_sub_u32 v250, v252, v250
v_mul_u32_u24 v251, 1152, v251
v_add_u32 v251, v251, v250
v_subrev_u32 v224, 0, v251
v_lshlrev_b32 v252, 4, v255
v_add_u32 v252, 1024, v252
s_mov_b32 s49, 0xe38e39
v_mul_hi_u32 v251, s49, v252
v_mul_u32_u24 v250, 288, v251
v_sub_u32 v250, v252, v250
v_mul_u32_u24 v251, 1152, v251
v_add_u32 v251, v251, v250
v_subrev_u32 v225, 1024, v251
v_lshlrev_b32 v252, 4, v255
v_add_u32 v252, 2048, v252
s_mov_b32 s49, 0xe38e39
v_mul_hi_u32 v251, s49, v252
v_mul_u32_u24 v250, 288, v251
v_sub_u32 v250, v252, v250
v_mul_u32_u24 v251, 1152, v251
v_add_u32 v251, v251, v250
v_subrev_u32 v226, 2048, v251
v_lshlrev_b32 v252, 4, v255
v_add_u32 v252, 3072, v252
s_mov_b32 s49, 0xe38e39
v_mul_hi_u32 v251, s49, v252
v_mul_u32_u24 v250, 288, v251
v_sub_u32 v250, v252, v250
v_mul_u32_u24 v251, 1152, v251
v_add_u32 v251, v251, v250
v_subrev_u32 v227, 3072, v251
v_lshlrev_b32 v252, 4, v255
v_add_u32 v252, 4096, v252
s_mov_b32 s49, 0xe38e39
v_mul_hi_u32 v251, s49, v252
v_mul_u32_u24 v250, 288, v251
v_sub_u32 v250, v252, v250
v_mul_u32_u24 v251, 1152, v251
v_add_u32 v251, v251, v250
v_subrev_u32 v228, 0, v251
v_cmp_gt_u32 vcc, 32, v255
v_mov_b32 v252, 0x70000000
s_nop 0
v_cndmask_b32 v228, v252, v228
v_lshrrev_b32 v252, 2, v254
v_lshl_add_u32 v252, v253, 2, v252
v_mul_u32_u24 v252, 288, v252
v_and_b32 v251, 3, v254
v_lshl_add_u32 v233, v251, 3, v252
v_add_u32 v234, 0x10000, v233
s_mul_i32 s44, s40, 18432
s_mul_i32 s50, s42, 288
s_add_u32 s44, s44, s50
s_lshl_b32 s52, s43, 4
s_lshl_b32 s49, s40, 2
s_add_u32 s52, s52, s49
s_lshl_b32 s59, s43, 2
s_add_u32 s59, s59, s42
s_lshl_b32 s59, s59, 7
s_add_u32 s59, s59, 15360
s_waitcnt lgkmcnt(0)
s_add_u32 s12, s70, 0x2900000
s_addc_u32 s13, s71, 0
s_mov_b32 s14, 0x1200000
s_mov_b32 s15, 0x20000
s_cmp_lg_u32 s97, 0
s_cbranch_scc1 KD_h2a
s_mov_b32 s4, s64
s_mov_b32 s5, s65
s_mov_b32 s6, 0x480000
s_mov_b32 s7, 0x20000
s_add_u32 s8, s70, 0x1800000
s_addc_u32 s9, s71, 0
s_mov_b32 s10, 0x1020000
s_mov_b32 s11, 0x20000
v_lshlrev_b32 v252, 4, v255
v_add_u32 v229, 0, v252
v_lshlrev_b32 v252, 4, v255
v_add_u32 v230, 132096, v252
v_lshlrev_b32 v252, 4, v255
v_add_u32 v231, 264192, v252
v_lshlrev_b32 v252, 4, v255
v_add_u32 v232, 396288, v252
s_mul_i32 s49, s41, 1179648
s_add_u32 s44, s44, s49
s_mul_i32 s47, s52, 132096
s_lshl_b32 s49, s41, 15
s_add_u32 s47, s47, s49
s_add_u32 m0, s48, 0x10000
s_nop 0
buffer_load_dwordx4 v224, s[4:7], s44 offen lds
buffer_load_dwordx4 v225, s[4:7], s44 offen offset:1024 lds
buffer_load_dwordx4 v226, s[4:7], s44 offen offset:2048 lds
buffer_load_dwordx4 v227, s[4:7], s44 offen offset:3072 lds
s_add_u32 m0, s48, 0x11000
s_nop 0
buffer_load_dwordx4 v228, s[4:7], s44 offen lds
s_add_u32 s44, s44, 73728
s_add_u32 m0, s48, 0x18000
s_nop 0
buffer_load_dwordx4 v224, s[4:7], s44 offen lds
buffer_load_dwordx4 v225, s[4:7], s44 offen offset:1024 lds
buffer_load_dwordx4 v226, s[4:7], s44 offen offset:2048 lds
buffer_load_dwordx4 v227, s[4:7], s44 offen offset:3072 lds
s_add_u32 m0, s48, 0x19000
s_nop 0
buffer_load_dwordx4 v228, s[4:7], s44 offen lds
s_add_u32 s44, s44, 73728
v_mov_b32 v246, 0
v_mov_b32 v247, 0
v_pk_mov_b32 v[0:1], v[246:247], v[246:247]
v_pk_mov_b32 v[2:3], v[246:247], v[246:247]
v_pk_mov_b32 v[4:5], v[246:247], v[246:247]
v_pk_mov_b32 v[6:7], v[246:247], v[246:247]
v_pk_mov_b32 v[8:9], v[246:247], v[246:247]
v_pk_mov_b32 v[10:11], v[246:247], v[246:247]
v_pk_mov_b32 v[12:13], v[246:247], v[246:247]
v_pk_mov_b32 v[14:15], v[246:247], v[246:247]
v_pk_mov_b32 v[16:17], v[246:247], v[246:247]
v_pk_mov_b32 v[18:19], v[246:247], v[246:247]
v_pk_mov_b32 v[20:21], v[246:247], v[246:247]
v_pk_mov_b32 v[22:23], v[246:247], v[246:247]
v_pk_mov_b32 v[24:25], v[246:247], v[246:247]
v_pk_mov_b32 v[26:27], v[246:247], v[246:247]
v_pk_mov_b32 v[28:29], v[246:247], v[246:247]
v_pk_mov_b32 v[30:31], v[246:247], v[246:247]
v_pk_mov_b32 v[32:33], v[246:247], v[246:247]
v_pk_mov_b32 v[34:35], v[246:247], v[246:247]
v_pk_mov_b32 v[36:37], v[246:247], v[246:247]
v_pk_mov_b32 v[38:39], v[246:247], v[246:247]
v_pk_mov_b32 v[40:41], v[246:247], v[246:247]
v_pk_mov_b32 v[42:43], v[246:247], v[246:247]
v_pk_mov_b32 v[44:45], v[246:247], v[246:247]
v_pk_mov_b32 v[46:47], v[246:247], v[246:247]
v_pk_mov_b32 v[48:49], v[246:247], v[246:247]
v_pk_mov_b32 v[50:51], v[246:247], v[246:247]
v_pk_mov_b32 v[52:53], v[246:247], v[246:247]
v_pk_mov_b32 v[54:55], v[246:247], v[246:247]
v_pk_mov_b32 v[56:57], v[246:247], v[246:247]
v_pk_mov_b32 v[58:59], v[246:247], v[246:247]
v_pk_mov_b32 v[60:61], v[246:247], v[246:247]
v_pk_mov_b32 v[62:63], v[246:247], v[246:247]
v_pk_mov_b32 v[64:65], v[246:247], v[246:247]
v_pk_mov_b32 v[66:67], v[246:247], v[246:247]
v_pk_mov_b32 v[68:69], v[246:247], v[246:247]
v_pk_mov_b32 v[70:71], v[246:247], v[246:247]
v_pk_mov_b32 v[72:73], v[246:247], v[246:247]
v_pk_mov_b32 v[74:75], v[246:247], v[246:247]
v_pk_mov_b32 v[76:77], v[246:247], v[246:247]
v_pk_mov_b32 v[78:79], v[246:247], v[246:247]
v_pk_mov_b32 v[80:81], v[246:247], v[246:247]
v_pk_mov_b32 v[82:83], v[246:247], v[246:247]
v_pk_mov_b32 v[84:85], v[246:247], v[246:247]
v_pk_mov_b32 v[86:87], v[246:247], v[246:247]
v_pk_mov_b32 v[88:89], v[246:247], v[246:247]
v_pk_mov_b32 v[90:91], v[246:247], v[246:247]
v_pk_mov_b32 v[92:93], v[246:247], v[246:247]
v_pk_mov_b32 v[94:95], v[246:247], v[246:247]
v_pk_mov_b32 v[96:97], v[246:247], v[246:247]
v_pk_mov_b32 v[98:99], v[246:247], v[246:247]
v_pk_mov_b32 v[100:101], v[246:247], v[246:247]
v_pk_mov_b32 v[102:103], v[246:247], v[246:247]
v_pk_mov_b32 v[104:105], v[246:247], v[246:247]
v_pk_mov_b32 v[106:107], v[246:247], v[246:247]
v_pk_mov_b32 v[108:109], v[246:247], v[246:247]
v_pk_mov_b32 v[110:111], v[246:247], v[246:247]
v_pk_mov_b32 v[112:113], v[246:247], v[246:247]
v_pk_mov_b32 v[114:115], v[246:247], v[246:247]
v_pk_mov_b32 v[116:117], v[246:247], v[246:247]
v_pk_mov_b32 v[118:119], v[246:247], v[246:247]
v_pk_mov_b32 v[120:121], v[246:247], v[246:247]
v_pk_mov_b32 v[122:123], v[246:247], v[246:247]
v_pk_mov_b32 v[124:125], v[246:247], v[246:247]
v_pk_mov_b32 v[126:127], v[246:247], v[246:247]
v_pk_mov_b32 v[128:129], v[246:247], v[246:247]
v_pk_mov_b32 v[130:131], v[246:247], v[246:247]
v_pk_mov_b32 v[132:133], v[246:247], v[246:247]
v_pk_mov_b32 v[134:135], v[246:247], v[246:247]
v_pk_mov_b32 v[136:137], v[246:247], v[246:247]
v_pk_mov_b32 v[138:139], v[246:247], v[246:247]
v_pk_mov_b32 v[140:141], v[246:247], v[246:247]
v_pk_mov_b32 v[142:143], v[246:247], v[246:247]
s_waitcnt vmcnt(10)
s_branch KD_a_done
KD_h2a:
s_mov_b32 s4, s66
s_mov_b32 s5, s67
s_mov_b32 s6, 0x510000
s_mov_b32 s7, 0x20000
s_add_u32 s8, s70, 0x600000
s_addc_u32 s9, s71, 0
s_mov_b32 s10, 0x1200000
s_mov_b32 s11, 0x20000
v_lshlrev_b32 v252, 4, v255
v_add_u32 v229, 0, v252
v_lshlrev_b32 v252, 4, v255
v_add_u32 v230, 147456, v252
v_lshlrev_b32 v252, 4, v255
v_add_u32 v231, 294912, v252
v_lshlrev_b32 v252, 4, v255
v_add_u32 v232, 442368, v252
s_sub_u32 s51, s41, 4
s_mul_i32 s49, s51, 1327104
s_add_u32 s44, s44, s49
s_mul_i32 s47, s52, 147456
s_mul_i32 s49, s51, 36864
s_add_u32 s47, s47, s49
s_waitcnt vmcnt(16)
s_cmp_lg_u32 s40, 0
s_cbranch_scc1 L_ok_h3
s_mov_b32 s49, 0
L_chk_h3:
v_readfirstlane_b32 s50, v239
s_nop 3
s_lshr_b32 s50, s50, 0
s_and_b32 s50, s50, 0xffff
s_cmp_ge_u32 s50, 8
s_cbranch_scc1 L_ok_h3
s_add_u32 s49, s49, 1
s_cmp_ge_u32 s49, 65536
s_cbranch_scc1 L_ok_h3
s_sleep 4
buffer_load_dword v239, v248, s[72:75], s79 offen sc1
s_waitcnt vmcnt(0)
s_branch L_chk_h3
L_ok_h3:
s_barrier
s_add_u32 m0, s48, 0x0
s_nop 0
buffer_load_dwordx4 v224, s[4:7], s44 offen lds
buffer_load_dwordx4 v225, s[4:7], s44 offen offset:1024 lds
buffer_load_dwordx4 v226, s[4:7], s44 offen offset:2048 lds
buffer_load_dwordx4 v227, s[4:7], s44 offen offset:3072 lds
s_add_u32 m0, s48, 0x1000
s_nop 0
buffer_load_dwordx4 v228, s[4:7], s44 offen lds
buffer_load_dwordx4 a[0:3], v229, s[8:11], s47 offen sc1
buffer_load_dwordx4 a[4:7], v229, s[8:11], s47 offen offset:1024 sc1
buffer_load_dwordx4 a[8:11], v230, s[8:11], s47 offen sc1
buffer_load_dwordx4 a[12:15], v230, s[8:11], s47 offen offset:1024 sc1
buffer_load_dwordx4 a[16:19], v231, s[8:11], s47 offen sc1
buffer_load_dwordx4 a[20:23], v231, s[8:11], s47 offen offset:1024 sc1
buffer_load_dwordx4 a[24:27], v232, s[8:11], s47 offen sc1
buffer_load_dwordx4 a[28:31], v232, s[8:11], s47 offen offset:1024 sc1
s_add_u32 s44, s44, 73728
s_add_u32 s47, s47, 2048
s_add_u32 m0, s48, 0x8000
s_nop 0
buffer_load_dwordx4 v224, s[4:7], s44 offen lds
buffer_load_dwordx4 v225, s[4:7], s44 offen offset:1024 lds
buffer_load_dwordx4 v226, s[4:7], s44 offen offset:2048 lds
buffer_load_dwordx4 v227, s[4:7], s44 offen offset:3072 lds
s_add_u32 m0, s48, 0x9000
s_nop 0
buffer_load_dwordx4 v228, s[4:7], s44 offen lds
buffer_load_dwordx4 a[32:35], v229, s[8:11], s47 offen sc1
buffer_load_dwordx4 a[36:39], v229, s[8:11], s47 offen offset:1024 sc1
buffer_load_dwordx4 a[40:43], v230, s[8:11], s47 offen sc1
buffer_load_dwordx4 a[44:47], v230, s[8:11], s47 offen offset:1024 sc1
buffer_load_dwordx4 a[48:51], v231, s[8:11], s47 offen sc1
buffer_load_dwordx4 a[52:55], v231, s[8:11], s47 offen offset:1024 sc1
buffer_load_dwordx4 a[56:59], v232, s[8:11], s47 offen sc1
buffer_load_dwordx4 a[60:63], v232, s[8:11], s47 offen offset:1024 sc1
s_add_u32 s44, s44, 73728
s_add_u32 s47, s47, 2048
v_mov_b32 v246, 0
v_mov_b32 v247, 0
v_pk_mov_b32 v[0:1], v[246:247], v[246:247]
v_pk_mov_b32 v[2:3], v[246:247], v[246:247]
v_pk_mov_b32 v[4:5], v[246:247], v[246:247]
v_pk_mov_b32 v[6:7], v[246:247], v[246:247]
v_pk_mov_b32 v[8:9], v[246:247], v[246:247]
v_pk_mov_b32 v[10:11], v[246:247], v[246:247]
v_pk_mov_b32 v[12:13], v[246:247], v[246:247]
v_pk_mov_b32 v[14:15], v[246:247], v[246:247]
v_pk_mov_b32 v[16:17], v[246:247], v[246:247]
v_pk_mov_b32 v[18:19], v[246:247], v[246:247]
v_pk_mov_b32 v[20:21], v[246:247], v[246:247]
v_pk_mov_b32 v[22:23], v[246:247], v[246:247]
v_pk_mov_b32 v[24:25], v[246:247], v[246:247]
v_pk_mov_b32 v[26:27], v[246:247], v[246:247]
v_pk_mov_b32 v[28:29], v[246:247], v[246:247]
v_pk_mov_b32 v[30:31], v[246:247], v[246:247]
v_pk_mov_b32 v[32:33], v[246:247], v[246:247]
v_pk_mov_b32 v[34:35], v[246:247], v[246:247]
v_pk_mov_b32 v[36:37], v[246:247], v[246:247]
v_pk_mov_b32 v[38:39], v[246:247], v[246:247]
v_pk_mov_b32 v[40:41], v[246:247], v[246:247]
v_pk_mov_b32 v[42:43], v[246:247], v[246:247]
v_pk_mov_b32 v[44:45], v[246:247], v[246:247]
v_pk_mov_b32 v[46:47], v[246:247], v[246:247]
v_pk_mov_b32 v[48:49], v[246:247], v[246:247]
v_pk_mov_b32 v[50:51], v[246:247], v[246:247]
v_pk_mov_b32 v[52:53], v[246:247], v[246:247]
v_pk_mov_b32 v[54:55], v[246:247], v[246:247]
v_pk_mov_b32 v[56:57], v[246:247], v[246:247]
v_pk_mov_b32 v[58:59], v[246:247], v[246:247]
v_pk_mov_b32 v[60:61], v[246:247], v[246:247]
v_pk_mov_b32 v[62:63], v[246:247], v[246:247]
v_pk_mov_b32 v[64:65], v[246:247], v[246:247]
v_pk_mov_b32 v[66:67], v[246:247], v[246:247]
v_pk_mov_b32 v[68:69], v[246:247], v[246:247]
v_pk_mov_b32 v[70:71], v[246:247], v[246:247]
v_pk_mov_b32 v[72:73], v[246:247], v[246:247]
v_pk_mov_b32 v[74:75], v[246:247], v[246:247]
v_pk_mov_b32 v[76:77], v[246:247], v[246:247]
v_pk_mov_b32 v[78:79], v[246:247], v[246:247]
v_pk_mov_b32 v[80:81], v[246:247], v[246:247]
v_pk_mov_b32 v[82:83], v[246:247], v[246:247]
v_pk_mov_b32 v[84:85], v[246:247], v[246:247]
v_pk_mov_b32 v[86:87], v[246:247], v[246:247]
v_pk_mov_b32 v[88:89], v[246:247], v[246:247]
v_pk_mov_b32 v[90:91], v[246:247], v[246:247]
v_pk_mov_b32 v[92:93], v[246:247], v[246:247]
v_pk_mov_b32 v[94:95], v[246:247], v[246:247]
v_pk_mov_b32 v[96:97], v[246:247], v[246:247]
v_pk_mov_b32 v[98:99], v[246:247], v[246:247]
v_pk_mov_b32 v[100:101], v[246:247], v[246:247]
v_pk_mov_b32 v[102:103], v[246:247], v[246:247]
v_pk_mov_b32 v[104:105], v[246:247], v[246:247]
v_pk_mov_b32 v[106:107], v[246:247], v[246:247]
v_pk_mov_b32 v[108:109], v[246:247], v[246:247]
v_pk_mov_b32 v[110:111], v[246:247], v[246:247]
v_pk_mov_b32 v[112:113], v[246:247], v[246:247]
v_pk_mov_b32 v[114:115], v[246:247], v[246:247]
v_pk_mov_b32 v[116:117], v[246:247], v[246:247]
v_pk_mov_b32 v[118:119], v[246:247], v[246:247]
v_pk_mov_b32 v[120:121], v[246:247], v[246:247]
v_pk_mov_b32 v[122:123], v[246:247], v[246:247]
v_pk_mov_b32 v[124:125], v[246:247], v[246:247]
v_pk_mov_b32 v[126:127], v[246:247], v[246:247]
v_pk_mov_b32 v[128:129], v[246:247], v[246:247]
v_pk_mov_b32 v[130:131], v[246:247], v[246:247]
v_pk_mov_b32 v[132:133], v[246:247], v[246:247]
v_pk_mov_b32 v[134:135], v[246:247], v[246:247]
v_pk_mov_b32 v[136:137], v[246:247], v[246:247]
v_pk_mov_b32 v[138:139], v[246:247], v[246:247]
v_pk_mov_b32 v[140:141], v[246:247], v[246:247]
v_pk_mov_b32 v[142:143], v[246:247], v[246:247]
s_waitcnt vmcnt(26)
KD_a_done:
s_barrier
s_cmp_lg_u32 s40, 0
s_cbranch_scc1 L_nosig_o
s_mov_b64 exec, 1
v_mov_b32 v252, 0x10000
v_mov_b32 v251, 0
s_nop 0
buffer_atomic_add v252, v251, s[72:75], s77 offen
s_mov_b64 exec, -1
L_nosig_o:
s_cmp_lg_u32 s97, 0
s_cbranch_scc1 KD_h2b
s_cmp_lg_u32 s40, 0
s_cbranch_scc1 L_pd_o
s_mov_b32 s49, 0
L_pl_o:
buffer_load_dword v239, v248, s[72:75], s79 offen sc1
s_waitcnt vmcnt(0)
v_readfirstlane_b32 s50, v239
s_nop 3
s_lshr_b32 s50, s50, 16
s_and_b32 s50, s50, 0xffff
s_cmp_ge_u32 s50, 8
s_cbranch_scc1 L_pd_o
s_add_u32 s49, s49, 1
s_cmp_ge_u32 s49, 65536
s_cbranch_scc1 L_pd_o
s_sleep 2
s_branch L_pl_o
L_pd_o:
s_barrier
buffer_load_dwordx4 a[64:67], v229, s[8:11], s47 offen sc1
buffer_load_dwordx4 a[68:71], v229, s[8:11], s47 offen offset:1024 sc1
buffer_load_dwordx4 a[72:75], v230, s[8:11], s47 offen sc1
buffer_load_dwordx4 a[76:79], v230, s[8:11], s47 offen offset:1024 sc1
buffer_load_dwordx4 a[80:83], v231, s[8:11], s47 offen sc1
buffer_load_dwordx4 a[84:87], v231, s[8:11], s47 offen offset:1024 sc1
buffer_load_dwordx4 a[88:91], v232, s[8:11], s47 offen sc1
buffer_load_dwordx4 a[92:95], v232, s[8:11], s47 offen offset:1024 sc1
s_add_u32 s47, s47, 2048
buffer_load_dwordx4 a[96:99], v229, s[8:11], s47 offen sc1
buffer_load_dwordx4 a[100:103], v229, s[8:11], s47 offen offset:1024 sc1
buffer_load_dwordx4 a[104:107], v230, s[8:11], s47 offen sc1
buffer_load_dwordx4 a[108:111], v230, s[8:11], s47 offen offset:1024 sc1
buffer_load_dwordx4 a[112:115], v231, s[8:11], s47 offen sc1
buffer_load_dwordx4 a[116:119], v231, s[8:11], s47 offen offset:1024 sc1
buffer_load_dwordx4 a[120:123], v232, s[8:11], s47 offen sc1
buffer_load_dwordx4 a[124:127], v232, s[8:11], s47 offen offset:1024 sc1
s_add_u32 s47, s47, 2048
s_waitcnt vmcnt(16)
s_barrier
ds_read_b64_tr_b16 a[128:129], v234
ds_read_b64_tr_b16 a[130:131], v234 offset:5120
ds_read_b64_tr_b16 a[132:133], v234 offset:10240
ds_read_b64_tr_b16 a[134:135], v234 offset:15360
ds_read_b64_tr_b16 a[136:137], v234 offset:32
ds_read_b64_tr_b16 a[138:139], v234 offset:5152
ds_read_b64_tr_b16 a[140:141], v234 offset:10272
ds_read_b64_tr_b16 a[142:143], v234 offset:15392
s_waitcnt vmcnt(8)
s_waitcnt lgkmcnt(0)
s_branch KD_st2
KD_h2b:
s_waitcnt vmcnt(13)
s_barrier
ds_read_b64_tr_b16 a[128:129], v233
ds_read_b64_tr_b16 a[130:131], v233 offset:5120
ds_read_b64_tr_b16 a[132:133], v233 offset:10240
ds_read_b64_tr_b16 a[134:135], v233 offset:15360
ds_read_b64_tr_b16 a[136:137], v233 offset:32
ds_read_b64_tr_b16 a[138:139], v233 offset:5152
ds_read_b64_tr_b16 a[140:141], v233 offset:10272
ds_read_b64_tr_b16 a[142:143], v233 offset:15392
s_waitcnt lgkmcnt(4)
v_mfma_f32_16x16x32_bf16 v[0:3], a[128:131], a[0:3], v[0:3]
ds_read_b64_tr_b16 a[144:145], v233 offset:64
v_mfma_f32_16x16x32_bf16 v[0:3], a[132:135], a[4:7], v[0:3]
ds_read_b64_tr_b16 a[146:147], v233 offset:5184
v_mfma_f32_16x16x32_bf16 v[4:7], a[128:131], a[8:11], v[4:7]
ds_read_b64_tr_b16 a[148:149], v233 offset:10304
v_mfma_f32_16x16x32_bf16 v[4:7], a[132:135], a[12:15], v[4:7]
s_add_u32 m0, s48, 0x10000
ds_read_b64_tr_b16 a[150:151], v233 offset:15424
v_mfma_f32_16x16x32_bf16 v[8:11], a[128:131], a[16:19], v[8:11]
buffer_load_dwordx4 v224, s[4:7], s44 offen lds
v_mfma_f32_16x16x32_bf16 v[8:11], a[132:135], a[20:23], v[8:11]
v_mfma_f32_16x16x32_bf16 v[12:15], a[128:131], a[24:27], v[12:15]
buffer_load_dwordx4 v225, s[4:7], s44 offen offset:1024 lds
v_mfma_f32_16x16x32_bf16 v[12:15], a[132:135], a[28:31], v[12:15]
s_waitcnt lgkmcnt(4)
v_mfma_f32_16x16x32_bf16 v[16:19], a[136:139], a[0:3], v[16:19]
ds_read_b64_tr_b16 a[128:129], v233 offset:96
v_mfma_f32_16x16x32_bf16 v[16:19], a[140:143], a[4:7], v[16:19]
ds_read_b64_tr_b16 a[130:131], v233 offset:5216
v_mfma_f32_16x16x32_bf16 v[20:23], a[136:139], a[8:11], v[20:23]
ds_read_b64_tr_b16 a[132:133], v233 offset:10336
v_mfma_f32_16x16x32_bf16 v[20:23], a[140:143], a[12:15], v[20:23]
ds_read_b64_tr_b16 a[134:135], v233 offset:15456
v_mfma_f32_16x16x32_bf16 v[24:27], a[136:139], a[16:19], v[24:27]
buffer_load_dwordx4 v226, s[4:7], s44 offen offset:2048 lds
v_mfma_f32_16x16x32_bf16 v[24:27], a[140:143], a[20:23], v[24:27]
v_mfma_f32_16x16x32_bf16 v[28:31], a[136:139], a[24:27], v[28:31]
buffer_load_dwordx4 v227, s[4:7], s44 offen offset:3072 lds
v_mfma_f32_16x16x32_bf16 v[28:31], a[140:143], a[28:31], v[28:31]
s_waitcnt lgkmcnt(4)
v_mfma_f32_16x16x32_bf16 v[32:35], a[144:147], a[0:3], v[32:35]
ds_read_b64_tr_b16 a[136:137], v233 offset:128
v_mfma_f32_16x16x32_bf16 v[32:35], a[148:151], a[4:7], v[32:35]
ds_read_b64_tr_b16 a[138:139], v233 offset:5248
v_mfma_f32_16x16x32_bf16 v[36:39], a[144:147], a[8:11], v[36:39]
ds_read_b64_tr_b16 a[140:141], v233 offset:10368
v_mfma_f32_16x16x32_bf16 v[36:39], a[148:151], a[12:15], v[36:39]
ds_read_b64_tr_b16 a[142:143], v233 offset:15488
v_mfma_f32_16x16x32_bf16 v[40:43], a[144:147], a[16:19], v[40:43]
v_mfma_f32_16x16x32_bf16 v[40:43], a[148:151], a[20:23], v[40:43]
s_add_u32 m0, s48, 0x11000
v_mfma_f32_16x16x32_bf16 v[44:47], a[144:147], a[24:27], v[44:47]
buffer_load_dwordx4 v228, s[4:7], s44 offen lds
v_mfma_f32_16x16x32_bf16 v[44:47], a[148:151], a[28:31], v[44:47]
s_waitcnt lgkmcnt(4)
v_mfma_f32_16x16x32_bf16 v[48:51], a[128:131], a[0:3], v[48:51]
ds_read_b64_tr_b16 a[144:145], v233 offset:160
v_mfma_f32_16x16x32_bf16 v[48:51], a[132:135], a[4:7], v[48:51]
ds_read_b64_tr_b16 a[146:147], v233 offset:5280
v_mfma_f32_16x16x32_bf16 v[52:55], a[128:131], a[8:11], v[52:55]
ds_read_b64_tr_b16 a[148:149], v233 offset:10400
v_mfma_f32_16x16x32_bf16 v[52:55], a[132:135], a[12:15], v[52:55]
ds_read_b64_tr_b16 a[150:151], v233 offset:15520
v_mfma_f32_16x16x32_bf16 v[56:59], a[128:131], a[16:19], v[56:59]
buffer_load_dwordx4 a[64:67], v229, s[8:11], s47 offen sc1
v_mfma_f32_16x16x32_bf16 v[56:59], a[132:135], a[20:23], v[56:59]
v_mfma_f32_16x16x32_bf16 v[60:63], a[128:131], a[24:27], v[60:63]
buffer_load_dwordx4 a[68:71], v229, s[8:11], s47 offen offset:1024 sc1
v_mfma_f32_16x16x32_bf16 v[60:63], a[132:135], a[28:31], v[60:63]
s_waitcnt lgkmcnt(4)
v_mfma_f32_16x16x32_bf16 v[64:67], a[136:139], a[0:3], v[64:67]
ds_read_b64_tr_b16 a[128:129], v233 offset:192
v_mfma_f32_16x16x32_bf16 v[64:67], a[140:143], a[4:7], v[64:67]
ds_read_b64_tr_b16 a[130:131], v233 offset:5312
v_mfma_f32_16x16x32_bf16 v[68:71], a[136:139], a[8:11], v[68:71]
ds_read_b64_tr_b16 a[132:133], v233 offset:10432
v_mfma_f32_16x16x32_bf16 v[68:71], a[140:143], a[12:15], v[68:71]
ds_read_b64_tr_b16 a[134:135], v233 offset:15552
v_mfma_f32_16x16x32_bf16 v[72:75], a[136:139], a[16:19], v[72:75]
v_mfma_f32_16x16x32_bf16 v[72:75], a[140:143], a[20:23], v[72:75]
v_mfma_f32_16x16x32_bf16 v[76:79], a[136:139], a[24:27], v[76:79]
buffer_load_dwordx4 a[72:75], v230, s[8:11], s47 offen sc1
v_mfma_f32_16x16x32_bf16 v[76:79], a[140:143], a[28:31], v[76:79]
s_waitcnt lgkmcnt(4)
v_mfma_f32_16x16x32_bf16 v[80:83], a[144:147], a[0:3], v[80:83]
ds_read_b64_tr_b16 a[136:137], v233 offset:224
v_mfma_f32_16x16x32_bf16 v[80:83], a[148:151], a[4:7], v[80:83]
ds_read_b64_tr_b16 a[138:139], v233 offset:5344
v_mfma_f32_16x16x32_bf16 v[84:87], a[144:147], a[8:11], v[84:87]
ds_read_b64_tr_b16 a[140:141], v233 offset:10464
v_mfma_f32_16x16x32_bf16 v[84:87], a[148:151], a[12:15], v[84:87]
ds_read_b64_tr_b16 a[142:143], v233 offset:15584
v_mfma_f32_16x16x32_bf16 v[88:91], a[144:147], a[16:19], v[88:91]
buffer_load_dwordx4 a[76:79], v230, s[8:11], s47 offen offset:1024 sc1
v_mfma_f32_16x16x32_bf16 v[88:91], a[148:151], a[20:23], v[88:91]
v_mfma_f32_16x16x32_bf16 v[92:95], a[144:147], a[24:27], v[92:95]
buffer_load_dwordx4 a[80:83], v231, s[8:11], s47 offen sc1
v_mfma_f32_16x16x32_bf16 v[92:95], a[148:151], a[28:31], v[92:95]
s_waitcnt lgkmcnt(4)
v_mfma_f32_16x16x32_bf16 v[96:99], a[128:131], a[0:3], v[96:99]
ds_read_b64_tr_b16 a[144:145], v233 offset:256
v_mfma_f32_16x16x32_bf16 v[96:99], a[132:135], a[4:7], v[96:99]
ds_read_b64_tr_b16 a[146:147], v233 offset:5376
v_mfma_f32_16x16x32_bf16 v[100:103], a[128:131], a[8:11], v[100:103]
ds_read_b64_tr_b16 a[148:149], v233 offset:10496
v_mfma_f32_16x16x32_bf16 v[100:103], a[132:135], a[12:15], v[100:103]
ds_read_b64_tr_b16 a[150:151], v233 offset:15616
v_mfma_f32_16x16x32_bf16 v[104:107], a[128:131], a[16:19], v[104:107]
v_mfma_f32_16x16x32_bf16 v[104:107], a[132:135], a[20:23], v[104:107]
v_mfma_f32_16x16x32_bf16 v[108:111], a[128:131], a[24:27], v[108:111]
s_waitcnt vmcnt(10)
v_mfma_f32_16x16x32_bf16 v[108:111], a[132:135], a[28:31], v[108:111]
s_waitcnt lgkmcnt(4)
s_barrier
v_mfma_f32_16x16x32_bf16 v[112:115], a[136:139], a[0:3], v[112:115]
ds_read_b64_tr_b16 a[128:129], v233 offset:32768
v_mfma_f32_16x16x32_bf16 v[112:115], a[140:143], a[4:7], v[112:115]
ds_read_b64_tr_b16 a[130:131], v233 offset:37888
v_mfma_f32_16x16x32_bf16 v[116:119], a[136:139], a[8:11], v[116:119]
ds_read_b64_tr_b16 a[132:133], v233 offset:43008
v_mfma_f32_16x16x32_bf16 v[116:119], a[140:143], a[12:15], v[116:119]
ds_read_b64_tr_b16 a[134:135], v233 offset:48128
v_mfma_f32_16x16x32_bf16 v[120:123], a[136:139], a[16:19], v[120:123]
buffer_load_dwordx4 a[84:87], v231, s[8:11], s47 offen offset:1024 sc1
v_mfma_f32_16x16x32_bf16 v[120:123], a[140:143], a[20:23], v[120:123]
v_mfma_f32_16x16x32_bf16 v[124:127], a[136:139], a[24:27], v[124:127]
buffer_load_dwordx4 a[88:91], v232, s[8:11], s47 offen sc1
v_mfma_f32_16x16x32_bf16 v[124:127], a[140:143], a[28:31], v[124:127]
s_waitcnt lgkmcnt(4)
v_mfma_f32_16x16x32_bf16 v[128:131], a[144:147], a[0:3], v[128:131]
ds_read_b64_tr_b16 a[136:137], v233 offset:32800
v_mfma_f32_16x16x32_bf16 v[128:131], a[148:151], a[4:7], v[128:131]
ds_read_b64_tr_b16 a[138:139], v233 offset:37920
v_mfma_f32_16x16x32_bf16 v[132:135], a[144:147], a[8:11], v[132:135]
ds_read_b64_tr_b16 a[140:141], v233 offset:43040
v_mfma_f32_16x16x32_bf16 v[132:135], a[148:151], a[12:15], v[132:135]
ds_read_b64_tr_b16 a[142:143], v233 offset:48160
v_mfma_f32_16x16x32_bf16 v[136:139], a[144:147], a[16:19], v[136:139]
buffer_load_dwordx4 a[92:95], v232, s[8:11], s47 offen offset:1024 sc1
v_mfma_f32_16x16x32_bf16 v[136:139], a[148:151], a[20:23], v[136:139]
s_add_u32 s44, s44, 73728
s_add_u32 s47, s47, 2048
v_mfma_f32_16x16x32_bf16 v[140:143], a[144:147], a[24:27], v[140:143]
v_mfma_f32_16x16x32_bf16 v[140:143], a[148:151], a[28:31], v[140:143]
s_waitcnt lgkmcnt(4)
v_mfma_f32_16x16x32_bf16 v[0:3], a[128:131], a[32:35], v[0:3]
ds_read_b64_tr_b16 a[144:145], v233 offset:32832
v_mfma_f32_16x16x32_bf16 v[0:3], a[132:135], a[36:39], v[0:3]
ds_read_b64_tr_b16 a[146:147], v233 offset:37952
v_mfma_f32_16x16x32_bf16 v[4:7], a[128:131], a[40:43], v[4:7]
ds_read_b64_tr_b16 a[148:149], v233 offset:43072
v_mfma_f32_16x16x32_bf16 v[4:7], a[132:135], a[44:47], v[4:7]
s_add_u32 m0, s48, 0x18000
ds_read_b64_tr_b16 a[150:151], v233 offset:48192
v_mfma_f32_16x16x32_bf16 v[8:11], a[128:131], a[48:51], v[8:11]
buffer_load_dwordx4 v224, s[4:7], s44 offen lds
v_mfma_f32_16x16x32_bf16 v[8:11], a[132:135], a[52:55], v[8:11]
v_mfma_f32_16x16x32_bf16 v[12:15], a[128:131], a[56:59], v[12:15]
buffer_load_dwordx4 v225, s[4:7], s44 offen offset:1024 lds
v_mfma_f32_16x16x32_bf16 v[12:15], a[132:135], a[60:63], v[12:15]
s_waitcnt lgkmcnt(4)
v_mfma_f32_16x16x32_bf16 v[16:19], a[136:139], a[32:35], v[16:19]
ds_read_b64_tr_b16 a[128:129], v233 offset:32864
v_mfma_f32_16x16x32_bf16 v[16:19], a[140:143], a[36:39], v[16:19]
ds_read_b64_tr_b16 a[130:131], v233 offset:37984
v_mfma_f32_16x16x32_bf16 v[20:23], a[136:139], a[40:43], v[20:23]
ds_read_b64_tr_b16 a[132:133], v233 offset:43104
v_mfma_f32_16x16x32_bf16 v[20:23], a[140:143], a[44:47], v[20:23]
ds_read_b64_tr_b16 a[134:135], v233 offset:48224
v_mfma_f32_16x16x32_bf16 v[24:27], a[136:139], a[48:51], v[24:27]
buffer_load_dwordx4 v226, s[4:7], s44 offen offset:2048 lds
v_mfma_f32_16x16x32_bf16 v[24:27], a[140:143], a[52:55], v[24:27]
v_mfma_f32_16x16x32_bf16 v[28:31], a[136:139], a[56:59], v[28:31]
buffer_load_dwordx4 v227, s[4:7], s44 offen offset:3072 lds
v_mfma_f32_16x16x32_bf16 v[28:31], a[140:143], a[60:63], v[28:31]
s_waitcnt lgkmcnt(4)
v_mfma_f32_16x16x32_bf16 v[32:35], a[144:147], a[32:35], v[32:35]
ds_read_b64_tr_b16 a[136:137], v233 offset:32896
v_mfma_f32_16x16x32_bf16 v[32:35], a[148:151], a[36:39], v[32:35]
ds_read_b64_tr_b16 a[138:139], v233 offset:38016
v_mfma_f32_16x16x32_bf16 v[36:39], a[144:147], a[40:43], v[36:39]
ds_read_b64_tr_b16 a[140:141], v233 offset:43136
v_mfma_f32_16x16x32_bf16 v[36:39], a[148:151], a[44:47], v[36:39]
ds_read_b64_tr_b16 a[142:143], v233 offset:48256
v_mfma_f32_16x16x32_bf16 v[40:43], a[144:147], a[48:51], v[40:43]
v_mfma_f32_16x16x32_bf16 v[40:43], a[148:151], a[52:55], v[40:43]
s_add_u32 m0, s48, 0x19000
v_mfma_f32_16x16x32_bf16 v[44:47], a[144:147], a[56:59], v[44:47]
buffer_load_dwordx4 v228, s[4:7], s44 offen lds
v_mfma_f32_16x16x32_bf16 v[44:47], a[148:151], a[60:63], v[44:47]
s_waitcnt lgkmcnt(4)
v_mfma_f32_16x16x32_bf16 v[48:51], a[128:131], a[32:35], v[48:51]
ds_read_b64_tr_b16 a[144:145], v233 offset:32928
v_mfma_f32_16x16x32_bf16 v[48:51], a[132:135], a[36:39], v[48:51]
ds_read_b64_tr_b16 a[146:147], v233 offset:38048
v_mfma_f32_16x16x32_bf16 v[52:55], a[128:131], a[40:43], v[52:55]
ds_read_b64_tr_b16 a[148:149], v233 offset:43168
v_mfma_f32_16x16x32_bf16 v[52:55], a[132:135], a[44:47], v[52:55]
ds_read_b64_tr_b16 a[150:151], v233 offset:48288
v_mfma_f32_16x16x32_bf16 v[56:59], a[128:131], a[48:51], v[56:59]
buffer_load_dwordx4 a[96:99], v229, s[8:11], s47 offen sc1
v_mfma_f32_16x16x32_bf16 v[56:59], a[132:135], a[52:55], v[56:59]
v_mfma_f32_16x16x32_bf16 v[60:63], a[128:131], a[56:59], v[60:63]
buffer_load_dwordx4 a[100:103], v229, s[8:11], s47 offen offset:1024 sc1
v_mfma_f32_16x16x32_bf16 v[60:63], a[132:135], a[60:63], v[60:63]
s_waitcnt lgkmcnt(4)
v_mfma_f32_16x16x32_bf16 v[64:67], a[136:139], a[32:35], v[64:67]
ds_read_b64_tr_b16 a[128:129], v233 offset:32960
v_mfma_f32_16x16x32_bf16 v[64:67], a[140:143], a[36:39], v[64:67]
ds_read_b64_tr_b16 a[130:131], v233 offset:38080
v_mfma_f32_16x16x32_bf16 v[68:71], a[136:139], a[40:43], v[68:71]
ds_read_b64_tr_b16 a[132:133], v233 offset:43200
v_mfma_f32_16x16x32_bf16 v[68:71], a[140:143], a[44:47], v[68:71]
ds_read_b64_tr_b16 a[134:135], v233 offset:48320
v_mfma_f32_16x16x32_bf16 v[72:75], a[136:139], a[48:51], v[72:75]
v_mfma_f32_16x16x32_bf16 v[72:75], a[140:143], a[52:55], v[72:75]
v_mfma_f32_16x16x32_bf16 v[76:79], a[136:139], a[56:59], v[76:79]
buffer_load_dwordx4 a[104:107], v230, s[8:11], s47 offen sc1
v_mfma_f32_16x16x32_bf16 v[76:79], a[140:143], a[60:63], v[76:79]
s_waitcnt lgkmcnt(4)
v_mfma_f32_16x16x32_bf16 v[80:83], a[144:147], a[32:35], v[80:83]
ds_read_b64_tr_b16 a[136:137], v233 offset:32992
v_mfma_f32_16x16x32_bf16 v[80:83], a[148:151], a[36:39], v[80:83]
ds_read_b64_tr_b16 a[138:139], v233 offset:38112
v_mfma_f32_16x16x32_bf16 v[84:87], a[144:147], a[40:43], v[84:87]
ds_read_b64_tr_b16 a[140:141], v233 offset:43232
v_mfma_f32_16x16x32_bf16 v[84:87], a[148:151], a[44:47], v[84:87]
ds_read_b64_tr_b16 a[142:143], v233 offset:48352
v_mfma_f32_16x16x32_bf16 v[88:91], a[144:147], a[48:51], v[88:91]
buffer_load_dwordx4 a[108:111], v230, s[8:11], s47 offen offset:1024 sc1
v_mfma_f32_16x16x32_bf16 v[88:91], a[148:151], a[52:55], v[88:91]
v_mfma_f32_16x16x32_bf16 v[92:95], a[144:147], a[56:59], v[92:95]
buffer_load_dwordx4 a[112:115], v231, s[8:11], s47 offen sc1
v_mfma_f32_16x16x32_bf16 v[92:95], a[148:151], a[60:63], v[92:95]
s_waitcnt lgkmcnt(4)
v_mfma_f32_16x16x32_bf16 v[96:99], a[128:131], a[32:35], v[96:99]
ds_read_b64_tr_b16 a[144:145], v233 offset:33024
v_mfma_f32_16x16x32_bf16 v[96:99], a[132:135], a[36:39], v[96:99]
ds_read_b64_tr_b16 a[146:147], v233 offset:38144
v_mfma_f32_16x16x32_bf16 v[100:103], a[128:131], a[40:43], v[100:103]
ds_read_b64_tr_b16 a[148:149], v233 offset:43264
v_mfma_f32_16x16x32_bf16 v[100:103], a[132:135], a[44:47], v[100:103]
ds_read_b64_tr_b16 a[150:151], v233 offset:48384
v_mfma_f32_16x16x32_bf16 v[104:107], a[128:131], a[48:51], v[104:107]
v_mfma_f32_16x16x32_bf16 v[104:107], a[132:135], a[52:55], v[104:107]
v_mfma_f32_16x16x32_bf16 v[108:111], a[128:131], a[56:59], v[108:111]
s_waitcnt vmcnt(10)
v_mfma_f32_16x16x32_bf16 v[108:111], a[132:135], a[60:63], v[108:111]
s_waitcnt lgkmcnt(4)
s_barrier
v_mfma_f32_16x16x32_bf16 v[112:115], a[136:139], a[32:35], v[112:115]
ds_read_b64_tr_b16 a[128:129], v234
v_mfma_f32_16x16x32_bf16 v[112:115], a[140:143], a[36:39], v[112:115]
ds_read_b64_tr_b16 a[130:131], v234 offset:5120
v_mfma_f32_16x16x32_bf16 v[116:119], a[136:139], a[40:43], v[116:119]
ds_read_b64_tr_b16 a[132:133], v234 offset:10240
v_mfma_f32_16x16x32_bf16 v[116:119], a[140:143], a[44:47], v[116:119]
ds_read_b64_tr_b16 a[134:135], v234 offset:15360
v_mfma_f32_16x16x32_bf16 v[120:123], a[136:139], a[48:51], v[120:123]
buffer_load_dwordx4 a[116:119], v231, s[8:11], s47 offen offset:1024 sc1
v_mfma_f32_16x16x32_bf16 v[120:123], a[140:143], a[52:55], v[120:123]
v_mfma_f32_16x16x32_bf16 v[124:127], a[136:139], a[56:59], v[124:127]
buffer_load_dwordx4 a[120:123], v232, s[8:11], s47 offen sc1
v_mfma_f32_16x16x32_bf16 v[124:127], a[140:143], a[60:63], v[124:127]
s_waitcnt lgkmcnt(4)
v_mfma_f32_16x16x32_bf16 v[128:131], a[144:147], a[32:35], v[128:131]
ds_read_b64_tr_b16 a[136:137], v234 offset:32
v_mfma_f32_16x16x32_bf16 v[128:131], a[148:151], a[36:39], v[128:131]
ds_read_b64_tr_b16 a[138:139], v234 offset:5152
v_mfma_f32_16x16x32_bf16 v[132:135], a[144:147], a[40:43], v[132:135]
ds_read_b64_tr_b16 a[140:141], v234 offset:10272
v_mfma_f32_16x16x32_bf16 v[132:135], a[148:151], a[44:47], v[132:135]
ds_read_b64_tr_b16 a[142:143], v234 offset:15392
v_mfma_f32_16x16x32_bf16 v[136:139], a[144:147], a[48:51], v[136:139]
buffer_load_dwordx4 a[124:127], v232, s[8:11], s47 offen offset:1024 sc1
v_mfma_f32_16x16x32_bf16 v[136:139], a[148:151], a[52:55], v[136:139]
s_add_u32 s44, s44, 73728
s_add_u32 s47, s47, 2048
v_mfma_f32_16x16x32_bf16 v[140:143], a[144:147], a[56:59], v[140:143]
v_mfma_f32_16x16x32_bf16 v[140:143], a[148:151], a[60:63], v[140:143]
s_waitcnt lgkmcnt(4)
KD_st2:
s_mov_b32 s58, 0
KD_loop:
v_mfma_f32_16x16x32_bf16 v[0:3], a[128:131], a[64:67], v[0:3]
ds_read_b64_tr_b16 a[144:145], v234 offset:64
v_mfma_f32_16x16x32_bf16 v[0:3], a[132:135], a[68:71], v[0:3]
ds_read_b64_tr_b16 a[146:147], v234 offset:5184
v_mfma_f32_16x16x32_bf16 v[4:7], a[128:131], a[72:75], v[4:7]
ds_read_b64_tr_b16 a[148:149], v234 offset:10304
v_mfma_f32_16x16x32_bf16 v[4:7], a[132:135], a[76:79], v[4:7]
s_add_u32 m0, s48, 0x0
ds_read_b64_tr_b16 a[150:151], v234 offset:15424
v_mfma_f32_16x16x32_bf16 v[8:11], a[128:131], a[80:83], v[8:11]
buffer_load_dwordx4 v224, s[4:7], s44 offen lds
v_mfma_f32_16x16x32_bf16 v[8:11], a[132:135], a[84:87], v[8:11]
v_mfma_f32_16x16x32_bf16 v[12:15], a[128:131], a[88:91], v[12:15]
buffer_load_dwordx4 v225, s[4:7], s44 offen offset:1024 lds
v_mfma_f32_16x16x32_bf16 v[12:15], a[132:135], a[92:95], v[12:15]
s_waitcnt lgkmcnt(4)
v_mfma_f32_16x16x32_bf16 v[16:19], a[136:139], a[64:67], v[16:19]
ds_read_b64_tr_b16 a[128:129], v234 offset:96
v_mfma_f32_16x16x32_bf16 v[16:19], a[140:143], a[68:71], v[16:19]
ds_read_b64_tr_b16 a[130:131], v234 offset:5216
v_mfma_f32_16x16x32_bf16 v[20:23], a[136:139], a[72:75], v[20:23]
ds_read_b64_tr_b16 a[132:133], v234 offset:10336
v_mfma_f32_16x16x32_bf16 v[20:23], a[140:143], a[76:79], v[20:23]
ds_read_b64_tr_b16 a[134:135], v234 offset:15456
v_mfma_f32_16x16x32_bf16 v[24:27], a[136:139], a[80:83], v[24:27]
buffer_load_dwordx4 v226, s[4:7], s44 offen offset:2048 lds
v_mfma_f32_16x16x32_bf16 v[24:27], a[140:143], a[84:87], v[24:27]
v_mfma_f32_16x16x32_bf16 v[28:31], a[136:139], a[88:91], v[28:31]
buffer_load_dwordx4 v227, s[4:7], s44 offen offset:3072 lds
v_mfma_f32_16x16x32_bf16 v[28:31], a[140:143], a[92:95], v[28:31]
s_waitcnt lgkmcnt(4)
v_mfma_f32_16x16x32_bf16 v[32:35], a[144:147], a[64:67], v[32:35]
ds_read_b64_tr_b16 a[136:137], v234 offset:128
v_mfma_f32_16x16x32_bf16 v[32:35], a[148:151], a[68:71], v[32:35]
ds_read_b64_tr_b16 a[138:139], v234 offset:5248
v_mfma_f32_16x16x32_bf16 v[36:39], a[144:147], a[72:75], v[36:39]
ds_read_b64_tr_b16 a[140:141], v234 offset:10368
v_mfma_f32_16x16x32_bf16 v[36:39], a[148:151], a[76:79], v[36:39]
ds_read_b64_tr_b16 a[142:143], v234 offset:15488
v_mfma_f32_16x16x32_bf16 v[40:43], a[144:147], a[80:83], v[40:43]
v_mfma_f32_16x16x32_bf16 v[40:43], a[148:151], a[84:87], v[40:43]
s_add_u32 m0, s48, 0x1000
v_mfma_f32_16x16x32_bf16 v[44:47], a[144:147], a[88:91], v[44:47]
buffer_load_dwordx4 v228, s[4:7], s44 offen lds
v_mfma_f32_16x16x32_bf16 v[44:47], a[148:151], a[92:95], v[44:47]
s_waitcnt lgkmcnt(4)
v_mfma_f32_16x16x32_bf16 v[48:51], a[128:131], a[64:67], v[48:51]
ds_read_b64_tr_b16 a[144:145], v234 offset:160
v_mfma_f32_16x16x32_bf16 v[48:51], a[132:135], a[68:71], v[48:51]
ds_read_b64_tr_b16 a[146:147], v234 offset:5280
v_mfma_f32_16x16x32_bf16 v[52:55], a[128:131], a[72:75], v[52:55]
ds_read_b64_tr_b16 a[148:149], v234 offset:10400
v_mfma_f32_16x16x32_bf16 v[52:55], a[132:135], a[76:79], v[52:55]
ds_read_b64_tr_b16 a[150:151], v234 offset:15520
v_mfma_f32_16x16x32_bf16 v[56:59], a[128:131], a[80:83], v[56:59]
buffer_load_dwordx4 a[0:3], v229, s[8:11], s47 offen sc1
v_mfma_f32_16x16x32_bf16 v[56:59], a[132:135], a[84:87], v[56:59]
v_mfma_f32_16x16x32_bf16 v[60:63], a[128:131], a[88:91], v[60:63]
buffer_load_dwordx4 a[4:7], v229, s[8:11], s47 offen offset:1024 sc1
v_mfma_f32_16x16x32_bf16 v[60:63], a[132:135], a[92:95], v[60:63]
s_waitcnt lgkmcnt(4)
v_mfma_f32_16x16x32_bf16 v[64:67], a[136:139], a[64:67], v[64:67]
ds_read_b64_tr_b16 a[128:129], v234 offset:192
v_mfma_f32_16x16x32_bf16 v[64:67], a[140:143], a[68:71], v[64:67]
ds_read_b64_tr_b16 a[130:131], v234 offset:5312
v_mfma_f32_16x16x32_bf16 v[68:71], a[136:139], a[72:75], v[68:71]
ds_read_b64_tr_b16 a[132:133], v234 offset:10432
v_mfma_f32_16x16x32_bf16 v[68:71], a[140:143], a[76:79], v[68:71]
ds_read_b64_tr_b16 a[134:135], v234 offset:15552
v_mfma_f32_16x16x32_bf16 v[72:75], a[136:139], a[80:83], v[72:75]
v_mfma_f32_16x16x32_bf16 v[72:75], a[140:143], a[84:87], v[72:75]
v_mfma_f32_16x16x32_bf16 v[76:79], a[136:139], a[88:91], v[76:79]
buffer_load_dwordx4 a[8:11], v230, s[8:11], s47 offen sc1
v_mfma_f32_16x16x32_bf16 v[76:79], a[140:143], a[92:95], v[76:79]
s_waitcnt lgkmcnt(4)
v_mfma_f32_16x16x32_bf16 v[80:83], a[144:147], a[64:67], v[80:83]
ds_read_b64_tr_b16 a[136:137], v234 offset:224
v_mfma_f32_16x16x32_bf16 v[80:83], a[148:151], a[68:71], v[80:83]
ds_read_b64_tr_b16 a[138:139], v234 offset:5344
v_mfma_f32_16x16x32_bf16 v[84:87], a[144:147], a[72:75], v[84:87]
ds_read_b64_tr_b16 a[140:141], v234 offset:10464
v_mfma_f32_16x16x32_bf16 v[84:87], a[148:151], a[76:79], v[84:87]
ds_read_b64_tr_b16 a[142:143], v234 offset:15584
v_mfma_f32_16x16x32_bf16 v[88:91], a[144:147], a[80:83], v[88:91]
buffer_load_dwordx4 a[12:15], v230, s[8:11], s47 offen offset:1024 sc1
v_mfma_f32_16x16x32_bf16 v[88:91], a[148:151], a[84:87], v[88:91]
v_mfma_f32_16x16x32_bf16 v[92:95], a[144:147], a[88:91], v[92:95]
buffer_load_dwordx4 a[16:19], v231, s[8:11], s47 offen sc1
v_mfma_f32_16x16x32_bf16 v[92:95], a[148:151], a[92:95], v[92:95]
s_waitcnt lgkmcnt(4)
v_mfma_f32_16x16x32_bf16 v[96:99], a[128:131], a[64:67], v[96:99]
ds_read_b64_tr_b16 a[144:145], v234 offset:256
v_mfma_f32_16x16x32_bf16 v[96:99], a[132:135], a[68:71], v[96:99]
ds_read_b64_tr_b16 a[146:147], v234 offset:5376
v_mfma_f32_16x16x32_bf16 v[100:103], a[128:131], a[72:75], v[100:103]
ds_read_b64_tr_b16 a[148:149], v234 offset:10496
v_mfma_f32_16x16x32_bf16 v[100:103], a[132:135], a[76:79], v[100:103]
ds_read_b64_tr_b16 a[150:151], v234 offset:15616
v_mfma_f32_16x16x32_bf16 v[104:107], a[128:131], a[80:83], v[104:107]
v_mfma_f32_16x16x32_bf16 v[104:107], a[132:135], a[84:87], v[104:107]
v_mfma_f32_16x16x32_bf16 v[108:111], a[128:131], a[88:91], v[108:111]
s_waitcnt vmcnt(10)
v_mfma_f32_16x16x32_bf16 v[108:111], a[132:135], a[92:95], v[108:111]
s_waitcnt lgkmcnt(4)
s_barrier
v_mfma_f32_16x16x32_bf16 v[112:115], a[136:139], a[64:67], v[112:115]
ds_read_b64_tr_b16 a[128:129], v234 offset:32768
v_mfma_f32_16x16x32_bf16 v[112:115], a[140:143], a[68:71], v[112:115]
ds_read_b64_tr_b16 a[130:131], v234 offset:37888
v_mfma_f32_16x16x32_bf16 v[116:119], a[136:139], a[72:75], v[116:119]
ds_read_b64_tr_b16 a[132:133], v234 offset:43008
v_mfma_f32_16x16x32_bf16 v[116:119], a[140:143], a[76:79], v[116:119]
ds_read_b64_tr_b16 a[134:135], v234 offset:48128
v_mfma_f32_16x16x32_bf16 v[120:123], a[136:139], a[80:83], v[120:123]
buffer_load_dwordx4 a[20:23], v231, s[8:11], s47 offen offset:1024 sc1
v_mfma_f32_16x16x32_bf16 v[120:123], a[140:143], a[84:87], v[120:123]
v_mfma_f32_16x16x32_bf16 v[124:127], a[136:139], a[88:91], v[124:127]
buffer_load_dwordx4 a[24:27], v232, s[8:11], s47 offen sc1
v_mfma_f32_16x16x32_bf16 v[124:127], a[140:143], a[92:95], v[124:127]
s_waitcnt lgkmcnt(4)
v_mfma_f32_16x16x32_bf16 v[128:131], a[144:147], a[64:67], v[128:131]
ds_read_b64_tr_b16 a[136:137], v234 offset:32800
v_mfma_f32_16x16x32_bf16 v[128:131], a[148:151], a[68:71], v[128:131]
ds_read_b64_tr_b16 a[138:139], v234 offset:37920
v_mfma_f32_16x16x32_bf16 v[132:135], a[144:147], a[72:75], v[132:135]
ds_read_b64_tr_b16 a[140:141], v234 offset:43040
v_mfma_f32_16x16x32_bf16 v[132:135], a[148:151], a[76:79], v[132:135]
ds_read_b64_tr_b16 a[142:143], v234 offset:48160
v_mfma_f32_16x16x32_bf16 v[136:139], a[144:147], a[80:83], v[136:139]
buffer_load_dwordx4 a[28:31], v232, s[8:11], s47 offen offset:1024 sc1
v_mfma_f32_16x16x32_bf16 v[136:139], a[148:151], a[84:87], v[136:139]
s_add_u32 s44, s44, 73728
s_add_u32 s47, s47, 2048
v_mfma_f32_16x16x32_bf16 v[140:143], a[144:147], a[88:91], v[140:143]
v_mfma_f32_16x16x32_bf16 v[140:143], a[148:151], a[92:95], v[140:143]
s_waitcnt lgkmcnt(4)
v_mfma_f32_16x16x32_bf16 v[0:3], a[128:131], a[96:99], v[0:3]
ds_read_b64_tr_b16 a[144:145], v234 offset:32832
v_mfma_f32_16x16x32_bf16 v[0:3], a[132:135], a[100:103], v[0:3]
ds_read_b64_tr_b16 a[146:147], v234 offset:37952
v_mfma_f32_16x16x32_bf16 v[4:7], a[128:131], a[104:107], v[4:7]
ds_read_b64_tr_b16 a[148:149], v234 offset:43072
v_mfma_f32_16x16x32_bf16 v[4:7], a[132:135], a[108:111], v[4:7]
s_add_u32 m0, s48, 0x8000
ds_read_b64_tr_b16 a[150:151], v234 offset:48192
v_mfma_f32_16x16x32_bf16 v[8:11], a[128:131], a[112:115], v[8:11]
buffer_load_dwordx4 v224, s[4:7], s44 offen lds
v_mfma_f32_16x16x32_bf16 v[8:11], a[132:135], a[116:119], v[8:11]
v_mfma_f32_16x16x32_bf16 v[12:15], a[128:131], a[120:123], v[12:15]
buffer_load_dwordx4 v225, s[4:7], s44 offen offset:1024 lds
v_mfma_f32_16x16x32_bf16 v[12:15], a[132:135], a[124:127], v[12:15]
s_waitcnt lgkmcnt(4)
v_mfma_f32_16x16x32_bf16 v[16:19], a[136:139], a[96:99], v[16:19]
ds_read_b64_tr_b16 a[128:129], v234 offset:32864
v_mfma_f32_16x16x32_bf16 v[16:19], a[140:143], a[100:103], v[16:19]
ds_read_b64_tr_b16 a[130:131], v234 offset:37984
v_mfma_f32_16x16x32_bf16 v[20:23], a[136:139], a[104:107], v[20:23]
ds_read_b64_tr_b16 a[132:133], v234 offset:43104
v_mfma_f32_16x16x32_bf16 v[20:23], a[140:143], a[108:111], v[20:23]
ds_read_b64_tr_b16 a[134:135], v234 offset:48224
v_mfma_f32_16x16x32_bf16 v[24:27], a[136:139], a[112:115], v[24:27]
buffer_load_dwordx4 v226, s[4:7], s44 offen offset:2048 lds
v_mfma_f32_16x16x32_bf16 v[24:27], a[140:143], a[116:119], v[24:27]
v_mfma_f32_16x16x32_bf16 v[28:31], a[136:139], a[120:123], v[28:31]
buffer_load_dwordx4 v227, s[4:7], s44 offen offset:3072 lds
v_mfma_f32_16x16x32_bf16 v[28:31], a[140:143], a[124:127], v[28:31]
s_waitcnt lgkmcnt(4)
v_mfma_f32_16x16x32_bf16 v[32:35], a[144:147], a[96:99], v[32:35]
ds_read_b64_tr_b16 a[136:137], v234 offset:32896
v_mfma_f32_16x16x32_bf16 v[32:35], a[148:151], a[100:103], v[32:35]
ds_read_b64_tr_b16 a[138:139], v234 offset:38016
v_mfma_f32_16x16x32_bf16 v[36:39], a[144:147], a[104:107], v[36:39]
ds_read_b64_tr_b16 a[140:141], v234 offset:43136
v_mfma_f32_16x16x32_bf16 v[36:39], a[148:151], a[108:111], v[36:39]
ds_read_b64_tr_b16 a[142:143], v234 offset:48256
v_mfma_f32_16x16x32_bf16 v[40:43], a[144:147], a[112:115], v[40:43]
v_mfma_f32_16x16x32_bf16 v[40:43], a[148:151], a[116:119], v[40:43]
s_add_u32 m0, s48, 0x9000
v_mfma_f32_16x16x32_bf16 v[44:47], a[144:147], a[120:123], v[44:47]
buffer_load_dwordx4 v228, s[4:7], s44 offen lds
v_mfma_f32_16x16x32_bf16 v[44:47], a[148:151], a[124:127], v[44:47]
s_waitcnt lgkmcnt(4)
v_mfma_f32_16x16x32_bf16 v[48:51], a[128:131], a[96:99], v[48:51]
ds_read_b64_tr_b16 a[144:145], v234 offset:32928
v_mfma_f32_16x16x32_bf16 v[48:51], a[132:135], a[100:103], v[48:51]
ds_read_b64_tr_b16 a[146:147], v234 offset:38048
v_mfma_f32_16x16x32_bf16 v[52:55], a[128:131], a[104:107], v[52:55]
ds_read_b64_tr_b16 a[148:149], v234 offset:43168
v_mfma_f32_16x16x32_bf16 v[52:55], a[132:135], a[108:111], v[52:55]
ds_read_b64_tr_b16 a[150:151], v234 offset:48288
v_mfma_f32_16x16x32_bf16 v[56:59], a[128:131], a[112:115], v[56:59]
buffer_load_dwordx4 a[32:35], v229, s[8:11], s47 offen sc1
v_mfma_f32_16x16x32_bf16 v[56:59], a[132:135], a[116:119], v[56:59]
v_mfma_f32_16x16x32_bf16 v[60:63], a[128:131], a[120:123], v[60:63]
buffer_load_dwordx4 a[36:39], v229, s[8:11], s47 offen offset:1024 sc1
v_mfma_f32_16x16x32_bf16 v[60:63], a[132:135], a[124:127], v[60:63]
s_waitcnt lgkmcnt(4)
v_mfma_f32_16x16x32_bf16 v[64:67], a[136:139], a[96:99], v[64:67]
ds_read_b64_tr_b16 a[128:129], v234 offset:32960
v_mfma_f32_16x16x32_bf16 v[64:67], a[140:143], a[100:103], v[64:67]
ds_read_b64_tr_b16 a[130:131], v234 offset:38080
v_mfma_f32_16x16x32_bf16 v[68:71], a[136:139], a[104:107], v[68:71]
ds_read_b64_tr_b16 a[132:133], v234 offset:43200
v_mfma_f32_16x16x32_bf16 v[68:71], a[140:143], a[108:111], v[68:71]
ds_read_b64_tr_b16 a[134:135], v234 offset:48320
v_mfma_f32_16x16x32_bf16 v[72:75], a[136:139], a[112:115], v[72:75]
v_mfma_f32_16x16x32_bf16 v[72:75], a[140:143], a[116:119], v[72:75]
v_mfma_f32_16x16x32_bf16 v[76:79], a[136:139], a[120:123], v[76:79]
buffer_load_dwordx4 a[40:43], v230, s[8:11], s47 offen sc1
v_mfma_f32_16x16x32_bf16 v[76:79], a[140:143], a[124:127], v[76:79]
s_waitcnt lgkmcnt(4)
v_mfma_f32_16x16x32_bf16 v[80:83], a[144:147], a[96:99], v[80:83]
ds_read_b64_tr_b16 a[136:137], v234 offset:32992
v_mfma_f32_16x16x32_bf16 v[80:83], a[148:151], a[100:103], v[80:83]
ds_read_b64_tr_b16 a[138:139], v234 offset:38112
v_mfma_f32_16x16x32_bf16 v[84:87], a[144:147], a[104:107], v[84:87]
ds_read_b64_tr_b16 a[140:141], v234 offset:43232
v_mfma_f32_16x16x32_bf16 v[84:87], a[148:151], a[108:111], v[84:87]
ds_read_b64_tr_b16 a[142:143], v234 offset:48352
v_mfma_f32_16x16x32_bf16 v[88:91], a[144:147], a[112:115], v[88:91]
buffer_load_dwordx4 a[44:47], v230, s[8:11], s47 offen offset:1024 sc1
v_mfma_f32_16x16x32_bf16 v[88:91], a[148:151], a[116:119], v[88:91]
v_mfma_f32_16x16x32_bf16 v[92:95], a[144:147], a[120:123], v[92:95]
buffer_load_dwordx4 a[48:51], v231, s[8:11], s47 offen sc1
v_mfma_f32_16x16x32_bf16 v[92:95], a[148:151], a[124:127], v[92:95]
s_waitcnt lgkmcnt(4)
v_mfma_f32_16x16x32_bf16 v[96:99], a[128:131], a[96:99], v[96:99]
ds_read_b64_tr_b16 a[144:145], v234 offset:33024
v_mfma_f32_16x16x32_bf16 v[96:99], a[132:135], a[100:103], v[96:99]
ds_read_b64_tr_b16 a[146:147], v234 offset:38144
v_mfma_f32_16x16x32_bf16 v[100:103], a[128:131], a[104:107], v[100:103]
ds_read_b64_tr_b16 a[148:149], v234 offset:43264
v_mfma_f32_16x16x32_bf16 v[100:103], a[132:135], a[108:111], v[100:103]
ds_read_b64_tr_b16 a[150:151], v234 offset:48384
v_mfma_f32_16x16x32_bf16 v[104:107], a[128:131], a[112:115], v[104:107]
v_mfma_f32_16x16x32_bf16 v[104:107], a[132:135], a[116:119], v[104:107]
v_mfma_f32_16x16x32_bf16 v[108:111], a[128:131], a[120:123], v[108:111]
s_waitcnt vmcnt(10)
v_mfma_f32_16x16x32_bf16 v[108:111], a[132:135], a[124:127], v[108:111]
s_waitcnt lgkmcnt(4)
s_barrier
v_mfma_f32_16x16x32_bf16 v[112:115], a[136:139], a[96:99], v[112:115]
ds_read_b64_tr_b16 a[128:129], v233
v_mfma_f32_16x16x32_bf16 v[112:115], a[140:143], a[100:103], v[112:115]
ds_read_b64_tr_b16 a[130:131], v233 offset:5120
v_mfma_f32_16x16x32_bf16 v[116:119], a[136:139], a[104:107], v[116:119]
ds_read_b64_tr_b16 a[132:133], v233 offset:10240
v_mfma_f32_16x16x32_bf16 v[116:119], a[140:143], a[108:111], v[116:119]
ds_read_b64_tr_b16 a[134:135], v233 offset:15360
v_mfma_f32_16x16x32_bf16 v[120:123], a[136:139], a[112:115], v[120:123]
buffer_load_dwordx4 a[52:55], v231, s[8:11], s47 offen offset:1024 sc1
v_mfma_f32_16x16x32_bf16 v[120:123], a[140:143], a[116:119], v[120:123]
v_mfma_f32_16x16x32_bf16 v[124:127], a[136:139], a[120:123], v[124:127]
buffer_load_dwordx4 a[56:59], v232, s[8:11], s47 offen sc1
v_mfma_f32_16x16x32_bf16 v[124:127], a[140:143], a[124:127], v[124:127]
s_waitcnt lgkmcnt(4)
v_mfma_f32_16x16x32_bf16 v[128:131], a[144:147], a[96:99], v[128:131]
ds_read_b64_tr_b16 a[136:137], v233 offset:32
v_mfma_f32_16x16x32_bf16 v[128:131], a[148:151], a[100:103], v[128:131]
ds_read_b64_tr_b16 a[138:139], v233 offset:5152
v_mfma_f32_16x16x32_bf16 v[132:135], a[144:147], a[104:107], v[132:135]
ds_read_b64_tr_b16 a[140:141], v233 offset:10272
v_mfma_f32_16x16x32_bf16 v[132:135], a[148:151], a[108:111], v[132:135]
ds_read_b64_tr_b16 a[142:143], v233 offset:15392
v_mfma_f32_16x16x32_bf16 v[136:139], a[144:147], a[112:115], v[136:139]
buffer_load_dwordx4 a[60:63], v232, s[8:11], s47 offen offset:1024 sc1
v_mfma_f32_16x16x32_bf16 v[136:139], a[148:151], a[116:119], v[136:139]
s_add_u32 s44, s44, 73728
s_add_u32 s47, s47, 2048
v_mfma_f32_16x16x32_bf16 v[140:143], a[144:147], a[120:123], v[140:143]
v_mfma_f32_16x16x32_bf16 v[140:143], a[148:151], a[124:127], v[140:143]
s_waitcnt lgkmcnt(4)
s_cmp_eq_u32 s58, 3
s_cselect_b32 s44, 0x70000000, s44
s_cselect_b32 s47, 0x70000000, s47
v_mfma_f32_16x16x32_bf16 v[0:3], a[128:131], a[0:3], v[0:3]
ds_read_b64_tr_b16 a[144:145], v233 offset:64
v_mfma_f32_16x16x32_bf16 v[0:3], a[132:135], a[4:7], v[0:3]
ds_read_b64_tr_b16 a[146:147], v233 offset:5184
v_mfma_f32_16x16x32_bf16 v[4:7], a[128:131], a[8:11], v[4:7]
ds_read_b64_tr_b16 a[148:149], v233 offset:10304
v_mfma_f32_16x16x32_bf16 v[4:7], a[132:135], a[12:15], v[4:7]
s_add_u32 m0, s48, 0x10000
ds_read_b64_tr_b16 a[150:151], v233 offset:15424
v_mfma_f32_16x16x32_bf16 v[8:11], a[128:131], a[16:19], v[8:11]
buffer_load_dwordx4 v224, s[4:7], s44 offen lds
v_mfma_f32_16x16x32_bf16 v[8:11], a[132:135], a[20:23], v[8:11]
v_mfma_f32_16x16x32_bf16 v[12:15], a[128:131], a[24:27], v[12:15]
buffer_load_dwordx4 v225, s[4:7], s44 offen offset:1024 lds
v_mfma_f32_16x16x32_bf16 v[12:15], a[132:135], a[28:31], v[12:15]
s_waitcnt lgkmcnt(4)
v_mfma_f32_16x16x32_bf16 v[16:19], a[136:139], a[0:3], v[16:19]
ds_read_b64_tr_b16 a[128:129], v233 offset:96
v_mfma_f32_16x16x32_bf16 v[16:19], a[140:143], a[4:7], v[16:19]
ds_read_b64_tr_b16 a[130:131], v233 offset:5216
v_mfma_f32_16x16x32_bf16 v[20:23], a[136:139], a[8:11], v[20:23]
ds_read_b64_tr_b16 a[132:133], v233 offset:10336
v_mfma_f32_16x16x32_bf16 v[20:23], a[140:143], a[12:15], v[20:23]
ds_read_b64_tr_b16 a[134:135], v233 offset:15456
v_mfma_f32_16x16x32_bf16 v[24:27], a[136:139], a[16:19], v[24:27]
buffer_load_dwordx4 v226, s[4:7], s44 offen offset:2048 lds
v_mfma_f32_16x16x32_bf16 v[24:27], a[140:143], a[20:23], v[24:27]
v_mfma_f32_16x16x32_bf16 v[28:31], a[136:139], a[24:27], v[28:31]
buffer_load_dwordx4 v227, s[4:7], s44 offen offset:3072 lds
v_mfma_f32_16x16x32_bf16 v[28:31], a[140:143], a[28:31], v[28:31]
s_waitcnt lgkmcnt(4)
v_mfma_f32_16x16x32_bf16 v[32:35], a[144:147], a[0:3], v[32:35]
ds_read_b64_tr_b16 a[136:137], v233 offset:128
v_mfma_f32_16x16x32_bf16 v[32:35], a[148:151], a[4:7], v[32:35]
ds_read_b64_tr_b16 a[138:139], v233 offset:5248
v_mfma_f32_16x16x32_bf16 v[36:39], a[144:147], a[8:11], v[36:39]
ds_read_b64_tr_b16 a[140:141], v233 offset:10368
v_mfma_f32_16x16x32_bf16 v[36:39], a[148:151], a[12:15], v[36:39]
ds_read_b64_tr_b16 a[142:143], v233 offset:15488
v_mfma_f32_16x16x32_bf16 v[40:43], a[144:147], a[16:19], v[40:43]
v_mfma_f32_16x16x32_bf16 v[40:43], a[148:151], a[20:23], v[40:43]
s_add_u32 m0, s48, 0x11000
v_mfma_f32_16x16x32_bf16 v[44:47], a[144:147], a[24:27], v[44:47]
buffer_load_dwordx4 v228, s[4:7], s44 offen lds
v_mfma_f32_16x16x32_bf16 v[44:47], a[148:151], a[28:31], v[44:47]
s_waitcnt lgkmcnt(4)
v_mfma_f32_16x16x32_bf16 v[48:51], a[128:131], a[0:3], v[48:51]
ds_read_b64_tr_b16 a[144:145], v233 offset:160
v_mfma_f32_16x16x32_bf16 v[48:51], a[132:135], a[4:7], v[48:51]
ds_read_b64_tr_b16 a[146:147], v233 offset:5280
v_mfma_f32_16x16x32_bf16 v[52:55], a[128:131], a[8:11], v[52:55]
ds_read_b64_tr_b16 a[148:149], v233 offset:10400
v_mfma_f32_16x16x32_bf16 v[52:55], a[132:135], a[12:15], v[52:55]
ds_read_b64_tr_b16 a[150:151], v233 offset:15520
v_mfma_f32_16x16x32_bf16 v[56:59], a[128:131], a[16:19], v[56:59]
buffer_load_dwordx4 a[64:67], v229, s[8:11], s47 offen sc1
v_mfma_f32_16x16x32_bf16 v[56:59], a[132:135], a[20:23], v[56:59]
v_mfma_f32_16x16x32_bf16 v[60:63], a[128:131], a[24:27], v[60:63]
buffer_load_dwordx4 a[68:71], v229, s[8:11], s47 offen offset:1024 sc1
v_mfma_f32_16x16x32_bf16 v[60:63], a[132:135], a[28:31], v[60:63]
s_waitcnt lgkmcnt(4)
v_mfma_f32_16x16x32_bf16 v[64:67], a[136:139], a[0:3], v[64:67]
ds_read_b64_tr_b16 a[128:129], v233 offset:192
v_mfma_f32_16x16x32_bf16 v[64:67], a[140:143], a[4:7], v[64:67]
ds_read_b64_tr_b16 a[130:131], v233 offset:5312
v_mfma_f32_16x16x32_bf16 v[68:71], a[136:139], a[8:11], v[68:71]
ds_read_b64_tr_b16 a[132:133], v233 offset:10432
v_mfma_f32_16x16x32_bf16 v[68:71], a[140:143], a[12:15], v[68:71]
ds_read_b64_tr_b16 a[134:135], v233 offset:15552
v_mfma_f32_16x16x32_bf16 v[72:75], a[136:139], a[16:19], v[72:75]
v_mfma_f32_16x16x32_bf16 v[72:75], a[140:143], a[20:23], v[72:75]
v_mfma_f32_16x16x32_bf16 v[76:79], a[136:139], a[24:27], v[76:79]
buffer_load_dwordx4 a[72:75], v230, s[8:11], s47 offen sc1
v_mfma_f32_16x16x32_bf16 v[76:79], a[140:143], a[28:31], v[76:79]
s_waitcnt lgkmcnt(4)
v_mfma_f32_16x16x32_bf16 v[80:83], a[144:147], a[0:3], v[80:83]
ds_read_b64_tr_b16 a[136:137], v233 offset:224
v_mfma_f32_16x16x32_bf16 v[80:83], a[148:151], a[4:7], v[80:83]
ds_read_b64_tr_b16 a[138:139], v233 offset:5344
v_mfma_f32_16x16x32_bf16 v[84:87], a[144:147], a[8:11], v[84:87]
ds_read_b64_tr_b16 a[140:141], v233 offset:10464
v_mfma_f32_16x16x32_bf16 v[84:87], a[148:151], a[12:15], v[84:87]
ds_read_b64_tr_b16 a[142:143], v233 offset:15584
v_mfma_f32_16x16x32_bf16 v[88:91], a[144:147], a[16:19], v[88:91]
buffer_load_dwordx4 a[76:79], v230, s[8:11], s47 offen offset:1024 sc1
v_mfma_f32_16x16x32_bf16 v[88:91], a[148:151], a[20:23], v[88:91]
v_mfma_f32_16x16x32_bf16 v[92:95], a[144:147], a[24:27], v[92:95]
buffer_load_dwordx4 a[80:83], v231, s[8:11], s47 offen sc1
v_mfma_f32_16x16x32_bf16 v[92:95], a[148:151], a[28:31], v[92:95]
s_waitcnt lgkmcnt(4)
v_mfma_f32_16x16x32_bf16 v[96:99], a[128:131], a[0:3], v[96:99]
ds_read_b64_tr_b16 a[144:145], v233 offset:256
v_mfma_f32_16x16x32_bf16 v[96:99], a[132:135], a[4:7], v[96:99]
ds_read_b64_tr_b16 a[146:147], v233 offset:5376
v_mfma_f32_16x16x32_bf16 v[100:103], a[128:131], a[8:11], v[100:103]
ds_read_b64_tr_b16 a[148:149], v233 offset:10496
v_mfma_f32_16x16x32_bf16 v[100:103], a[132:135], a[12:15], v[100:103]
ds_read_b64_tr_b16 a[150:151], v233 offset:15616
v_mfma_f32_16x16x32_bf16 v[104:107], a[128:131], a[16:19], v[104:107]
v_mfma_f32_16x16x32_bf16 v[104:107], a[132:135], a[20:23], v[104:107]
v_mfma_f32_16x16x32_bf16 v[108:111], a[128:131], a[24:27], v[108:111]
s_waitcnt vmcnt(10)
v_mfma_f32_16x16x32_bf16 v[108:111], a[132:135], a[28:31], v[108:111]
s_waitcnt lgkmcnt(4)
s_barrier
v_mfma_f32_16x16x32_bf16 v[112:115], a[136:139], a[0:3], v[112:115]
ds_read_b64_tr_b16 a[128:129], v233 offset:32768
v_mfma_f32_16x16x32_bf16 v[112:115], a[140:143], a[4:7], v[112:115]
ds_read_b64_tr_b16 a[130:131], v233 offset:37888
v_mfma_f32_16x16x32_bf16 v[116:119], a[136:139], a[8:11], v[116:119]
ds_read_b64_tr_b16 a[132:133], v233 offset:43008
v_mfma_f32_16x16x32_bf16 v[116:119], a[140:143], a[12:15], v[116:119]
ds_read_b64_tr_b16 a[134:135], v233 offset:48128
v_mfma_f32_16x16x32_bf16 v[120:123], a[136:139], a[16:19], v[120:123]
buffer_load_dwordx4 a[84:87], v231, s[8:11], s47 offen offset:1024 sc1
v_mfma_f32_16x16x32_bf16 v[120:123], a[140:143], a[20:23], v[120:123]
v_mfma_f32_16x16x32_bf16 v[124:127], a[136:139], a[24:27], v[124:127]
buffer_load_dwordx4 a[88:91], v232, s[8:11], s47 offen sc1
v_mfma_f32_16x16x32_bf16 v[124:127], a[140:143], a[28:31], v[124:127]
s_waitcnt lgkmcnt(4)
v_mfma_f32_16x16x32_bf16 v[128:131], a[144:147], a[0:3], v[128:131]
ds_read_b64_tr_b16 a[136:137], v233 offset:32800
v_mfma_f32_16x16x32_bf16 v[128:131], a[148:151], a[4:7], v[128:131]
ds_read_b64_tr_b16 a[138:139], v233 offset:37920
v_mfma_f32_16x16x32_bf16 v[132:135], a[144:147], a[8:11], v[132:135]
ds_read_b64_tr_b16 a[140:141], v233 offset:43040
v_mfma_f32_16x16x32_bf16 v[132:135], a[148:151], a[12:15], v[132:135]
ds_read_b64_tr_b16 a[142:143], v233 offset:48160
v_mfma_f32_16x16x32_bf16 v[136:139], a[144:147], a[16:19], v[136:139]
buffer_load_dwordx4 a[92:95], v232, s[8:11], s47 offen offset:1024 sc1
v_mfma_f32_16x16x32_bf16 v[136:139], a[148:151], a[20:23], v[136:139]
s_add_u32 s44, s44, 73728
s_add_u32 s47, s47, 2048
v_mfma_f32_16x16x32_bf16 v[140:143], a[144:147], a[24:27], v[140:143]
v_mfma_f32_16x16x32_bf16 v[140:143], a[148:151], a[28:31], v[140:143]
s_waitcnt lgkmcnt(4)
v_mfma_f32_16x16x32_bf16 v[0:3], a[128:131], a[32:35], v[0:3]
ds_read_b64_tr_b16 a[144:145], v233 offset:32832
v_mfma_f32_16x16x32_bf16 v[0:3], a[132:135], a[36:39], v[0:3]
ds_read_b64_tr_b16 a[146:147], v233 offset:37952
v_mfma_f32_16x16x32_bf16 v[4:7], a[128:131], a[40:43], v[4:7]
ds_read_b64_tr_b16 a[148:149], v233 offset:43072
v_mfma_f32_16x16x32_bf16 v[4:7], a[132:135], a[44:47], v[4:7]
s_add_u32 m0, s48, 0x18000
ds_read_b64_tr_b16 a[150:151], v233 offset:48192
v_mfma_f32_16x16x32_bf16 v[8:11], a[128:131], a[48:51], v[8:11]
buffer_load_dwordx4 v224, s[4:7], s44 offen lds
v_mfma_f32_16x16x32_bf16 v[8:11], a[132:135], a[52:55], v[8:11]
v_mfma_f32_16x16x32_bf16 v[12:15], a[128:131], a[56:59], v[12:15]
buffer_load_dwordx4 v225, s[4:7], s44 offen offset:1024 lds
v_mfma_f32_16x16x32_bf16 v[12:15], a[132:135], a[60:63], v[12:15]
s_waitcnt lgkmcnt(4)
v_mfma_f32_16x16x32_bf16 v[16:19], a[136:139], a[32:35], v[16:19]
ds_read_b64_tr_b16 a[128:129], v233 offset:32864
v_mfma_f32_16x16x32_bf16 v[16:19], a[140:143], a[36:39], v[16:19]
ds_read_b64_tr_b16 a[130:131], v233 offset:37984
v_mfma_f32_16x16x32_bf16 v[20:23], a[136:139], a[40:43], v[20:23]
ds_read_b64_tr_b16 a[132:133], v233 offset:43104
v_mfma_f32_16x16x32_bf16 v[20:23], a[140:143], a[44:47], v[20:23]
ds_read_b64_tr_b16 a[134:135], v233 offset:48224
v_mfma_f32_16x16x32_bf16 v[24:27], a[136:139], a[48:51], v[24:27]
buffer_load_dwordx4 v226, s[4:7], s44 offen offset:2048 lds
v_mfma_f32_16x16x32_bf16 v[24:27], a[140:143], a[52:55], v[24:27]
v_mfma_f32_16x16x32_bf16 v[28:31], a[136:139], a[56:59], v[28:31]
buffer_load_dwordx4 v227, s[4:7], s44 offen offset:3072 lds
v_mfma_f32_16x16x32_bf16 v[28:31], a[140:143], a[60:63], v[28:31]
s_waitcnt lgkmcnt(4)
v_mfma_f32_16x16x32_bf16 v[32:35], a[144:147], a[32:35], v[32:35]
ds_read_b64_tr_b16 a[136:137], v233 offset:32896
v_mfma_f32_16x16x32_bf16 v[32:35], a[148:151], a[36:39], v[32:35]
ds_read_b64_tr_b16 a[138:139], v233 offset:38016
v_mfma_f32_16x16x32_bf16 v[36:39], a[144:147], a[40:43], v[36:39]
ds_read_b64_tr_b16 a[140:141], v233 offset:43136
v_mfma_f32_16x16x32_bf16 v[36:39], a[148:151], a[44:47], v[36:39]
ds_read_b64_tr_b16 a[142:143], v233 offset:48256
v_mfma_f32_16x16x32_bf16 v[40:43], a[144:147], a[48:51], v[40:43]
v_mfma_f32_16x16x32_bf16 v[40:43], a[148:151], a[52:55], v[40:43]
s_add_u32 m0, s48, 0x19000
v_mfma_f32_16x16x32_bf16 v[44:47], a[144:147], a[56:59], v[44:47]
buffer_load_dwordx4 v228, s[4:7], s44 offen lds
v_mfma_f32_16x16x32_bf16 v[44:47], a[148:151], a[60:63], v[44:47]
s_waitcnt lgkmcnt(4)
v_mfma_f32_16x16x32_bf16 v[48:51], a[128:131], a[32:35], v[48:51]
ds_read_b64_tr_b16 a[144:145], v233 offset:32928
v_mfma_f32_16x16x32_bf16 v[48:51], a[132:135], a[36:39], v[48:51]
ds_read_b64_tr_b16 a[146:147], v233 offset:38048
v_mfma_f32_16x16x32_bf16 v[52:55], a[128:131], a[40:43], v[52:55]
ds_read_b64_tr_b16 a[148:149], v233 offset:43168
v_mfma_f32_16x16x32_bf16 v[52:55], a[132:135], a[44:47], v[52:55]
ds_read_b64_tr_b16 a[150:151], v233 offset:48288
v_mfma_f32_16x16x32_bf16 v[56:59], a[128:131], a[48:51], v[56:59]
buffer_load_dwordx4 a[96:99], v229, s[8:11], s47 offen sc1
v_mfma_f32_16x16x32_bf16 v[56:59], a[132:135], a[52:55], v[56:59]
v_mfma_f32_16x16x32_bf16 v[60:63], a[128:131], a[56:59], v[60:63]
buffer_load_dwordx4 a[100:103], v229, s[8:11], s47 offen offset:1024 sc1
v_mfma_f32_16x16x32_bf16 v[60:63], a[132:135], a[60:63], v[60:63]
s_waitcnt lgkmcnt(4)
v_mfma_f32_16x16x32_bf16 v[64:67], a[136:139], a[32:35], v[64:67]
ds_read_b64_tr_b16 a[128:129], v233 offset:32960
v_mfma_f32_16x16x32_bf16 v[64:67], a[140:143], a[36:39], v[64:67]
ds_read_b64_tr_b16 a[130:131], v233 offset:38080
v_mfma_f32_16x16x32_bf16 v[68:71], a[136:139], a[40:43], v[68:71]
ds_read_b64_tr_b16 a[132:133], v233 offset:43200
v_mfma_f32_16x16x32_bf16 v[68:71], a[140:143], a[44:47], v[68:71]
ds_read_b64_tr_b16 a[134:135], v233 offset:48320
v_mfma_f32_16x16x32_bf16 v[72:75], a[136:139], a[48:51], v[72:75]
v_mfma_f32_16x16x32_bf16 v[72:75], a[140:143], a[52:55], v[72:75]
v_mfma_f32_16x16x32_bf16 v[76:79], a[136:139], a[56:59], v[76:79]
buffer_load_dwordx4 a[104:107], v230, s[8:11], s47 offen sc1
v_mfma_f32_16x16x32_bf16 v[76:79], a[140:143], a[60:63], v[76:79]
s_waitcnt lgkmcnt(4)
v_mfma_f32_16x16x32_bf16 v[80:83], a[144:147], a[32:35], v[80:83]
ds_read_b64_tr_b16 a[136:137], v233 offset:32992
v_mfma_f32_16x16x32_bf16 v[80:83], a[148:151], a[36:39], v[80:83]
ds_read_b64_tr_b16 a[138:139], v233 offset:38112
v_mfma_f32_16x16x32_bf16 v[84:87], a[144:147], a[40:43], v[84:87]
ds_read_b64_tr_b16 a[140:141], v233 offset:43232
v_mfma_f32_16x16x32_bf16 v[84:87], a[148:151], a[44:47], v[84:87]
ds_read_b64_tr_b16 a[142:143], v233 offset:48352
v_mfma_f32_16x16x32_bf16 v[88:91], a[144:147], a[48:51], v[88:91]
buffer_load_dwordx4 a[108:111], v230, s[8:11], s47 offen offset:1024 sc1
v_mfma_f32_16x16x32_bf16 v[88:91], a[148:151], a[52:55], v[88:91]
v_mfma_f32_16x16x32_bf16 v[92:95], a[144:147], a[56:59], v[92:95]
buffer_load_dwordx4 a[112:115], v231, s[8:11], s47 offen sc1
v_mfma_f32_16x16x32_bf16 v[92:95], a[148:151], a[60:63], v[92:95]
s_waitcnt lgkmcnt(4)
v_mfma_f32_16x16x32_bf16 v[96:99], a[128:131], a[32:35], v[96:99]
ds_read_b64_tr_b16 a[144:145], v233 offset:33024
v_mfma_f32_16x16x32_bf16 v[96:99], a[132:135], a[36:39], v[96:99]
ds_read_b64_tr_b16 a[146:147], v233 offset:38144
v_mfma_f32_16x16x32_bf16 v[100:103], a[128:131], a[40:43], v[100:103]
ds_read_b64_tr_b16 a[148:149], v233 offset:43264
v_mfma_f32_16x16x32_bf16 v[100:103], a[132:135], a[44:47], v[100:103]
ds_read_b64_tr_b16 a[150:151], v233 offset:48384
v_mfma_f32_16x16x32_bf16 v[104:107], a[128:131], a[48:51], v[104:107]
v_mfma_f32_16x16x32_bf16 v[104:107], a[132:135], a[52:55], v[104:107]
v_mfma_f32_16x16x32_bf16 v[108:111], a[128:131], a[56:59], v[108:111]
s_waitcnt vmcnt(10)
v_mfma_f32_16x16x32_bf16 v[108:111], a[132:135], a[60:63], v[108:111]
s_waitcnt lgkmcnt(4)
s_barrier
v_mfma_f32_16x16x32_bf16 v[112:115], a[136:139], a[32:35], v[112:115]
ds_read_b64_tr_b16 a[128:129], v234
v_mfma_f32_16x16x32_bf16 v[112:115], a[140:143], a[36:39], v[112:115]
ds_read_b64_tr_b16 a[130:131], v234 offset:5120
v_mfma_f32_16x16x32_bf16 v[116:119], a[136:139], a[40:43], v[116:119]
ds_read_b64_tr_b16 a[132:133], v234 offset:10240
v_mfma_f32_16x16x32_bf16 v[116:119], a[140:143], a[44:47], v[116:119]
ds_read_b64_tr_b16 a[134:135], v234 offset:15360
v_mfma_f32_16x16x32_bf16 v[120:123], a[136:139], a[48:51], v[120:123]
buffer_load_dwordx4 a[116:119], v231, s[8:11], s47 offen offset:1024 sc1
v_mfma_f32_16x16x32_bf16 v[120:123], a[140:143], a[52:55], v[120:123]
v_mfma_f32_16x16x32_bf16 v[124:127], a[136:139], a[56:59], v[124:127]
buffer_load_dwordx4 a[120:123], v232, s[8:11], s47 offen sc1
v_mfma_f32_16x16x32_bf16 v[124:127], a[140:143], a[60:63], v[124:127]
s_waitcnt lgkmcnt(4)
v_mfma_f32_16x16x32_bf16 v[128:131], a[144:147], a[32:35], v[128:131]
ds_read_b64_tr_b16 a[136:137], v234 offset:32
v_mfma_f32_16x16x32_bf16 v[128:131], a[148:151], a[36:39], v[128:131]
ds_read_b64_tr_b16 a[138:139], v234 offset:5152
v_mfma_f32_16x16x32_bf16 v[132:135], a[144:147], a[40:43], v[132:135]
ds_read_b64_tr_b16 a[140:141], v234 offset:10272
v_mfma_f32_16x16x32_bf16 v[132:135], a[148:151], a[44:47], v[132:135]
ds_read_b64_tr_b16 a[142:143], v234 offset:15392
v_mfma_f32_16x16x32_bf16 v[136:139], a[144:147], a[48:51], v[136:139]
buffer_load_dwordx4 a[124:127], v232, s[8:11], s47 offen offset:1024 sc1
v_mfma_f32_16x16x32_bf16 v[136:139], a[148:151], a[52:55], v[136:139]
s_add_u32 s44, s44, 73728
s_add_u32 s47, s47, 2048
v_mfma_f32_16x16x32_bf16 v[140:143], a[144:147], a[56:59], v[140:143]
v_mfma_f32_16x16x32_bf16 v[140:143], a[148:151], a[60:63], v[140:143]
s_waitcnt lgkmcnt(4)
s_add_u32 s58, s58, 1
s_cmp_lt_u32 s58, 4
s_cbranch_scc1 KD_loop
s_waitcnt vmcnt(0)
s_waitcnt lgkmcnt(0)
s_nop 7
s_mul_i32 s49, s41, 2359296
s_mul_i32 s51, s52, 18432
s_add_u32 s49, s49, s51
s_mul_i32 s51, s42, 4608
s_add_u32 s49, s49, s51
v_lshlrev_b32 v241, 4, v255
v_lshlrev_b32 v242, 3, v255
v_cvt_pk_bf16_f32 v0, v0, v1
v_cvt_pk_bf16_f32 v1, v2, v3
v_cvt_pk_bf16_f32 v2, v16, v17
v_cvt_pk_bf16_f32 v3, v18, v19
buffer_store_dwordx4 v[0:3], v241, s[12:15], s49 offen sc1
v_cvt_pk_bf16_f32 v32, v32, v33
v_cvt_pk_bf16_f32 v33, v34, v35
v_cvt_pk_bf16_f32 v34, v48, v49
v_cvt_pk_bf16_f32 v35, v50, v51
buffer_store_dwordx4 v[32:35], v241, s[12:15], s49 offen offset:1024 sc1
v_cvt_pk_bf16_f32 v64, v64, v65
v_cvt_pk_bf16_f32 v65, v66, v67
v_cvt_pk_bf16_f32 v66, v80, v81
v_cvt_pk_bf16_f32 v67, v82, v83
buffer_store_dwordx4 v[64:67], v241, s[12:15], s49 offen offset:2048 sc1
v_cvt_pk_bf16_f32 v96, v96, v97
v_cvt_pk_bf16_f32 v97, v98, v99
v_cvt_pk_bf16_f32 v98, v112, v113
v_cvt_pk_bf16_f32 v99, v114, v115
buffer_store_dwordx4 v[96:99], v241, s[12:15], s49 offen offset:3072 sc1
v_cvt_pk_bf16_f32 v128, v128, v129
v_cvt_pk_bf16_f32 v129, v130, v131
s_add_u32 s51, s49, 4096
buffer_store_dwordx2 v[128:129], v242, s[12:15], s51 offen sc1
s_add_u32 s49, s49, 18432
v_cvt_pk_bf16_f32 v4, v4, v5
v_cvt_pk_bf16_f32 v5, v6, v7
v_cvt_pk_bf16_f32 v6, v20, v21
v_cvt_pk_bf16_f32 v7, v22, v23
buffer_store_dwordx4 v[4:7], v241, s[12:15], s49 offen sc1
v_cvt_pk_bf16_f32 v36, v36, v37
v_cvt_pk_bf16_f32 v37, v38, v39
v_cvt_pk_bf16_f32 v38, v52, v53
v_cvt_pk_bf16_f32 v39, v54, v55
buffer_store_dwordx4 v[36:39], v241, s[12:15], s49 offen offset:1024 sc1
v_cvt_pk_bf16_f32 v68, v68, v69
v_cvt_pk_bf16_f32 v69, v70, v71
v_cvt_pk_bf16_f32 v70, v84, v85
v_cvt_pk_bf16_f32 v71, v86, v87
buffer_store_dwordx4 v[68:71], v241, s[12:15], s49 offen offset:2048 sc1
v_cvt_pk_bf16_f32 v100, v100, v101
v_cvt_pk_bf16_f32 v101, v102, v103
v_cvt_pk_bf16_f32 v102, v116, v117
v_cvt_pk_bf16_f32 v103, v118, v119
buffer_store_dwordx4 v[100:103], v241, s[12:15], s49 offen offset:3072 sc1
v_cvt_pk_bf16_f32 v132, v132, v133
v_cvt_pk_bf16_f32 v133, v134, v135
s_add_u32 s51, s49, 4096
buffer_store_dwordx2 v[132:133], v242, s[12:15], s51 offen sc1
s_add_u32 s49, s49, 18432
v_cvt_pk_bf16_f32 v8, v8, v9
v_cvt_pk_bf16_f32 v9, v10, v11
v_cvt_pk_bf16_f32 v10, v24, v25
v_cvt_pk_bf16_f32 v11, v26, v27
buffer_store_dwordx4 v[8:11], v241, s[12:15], s49 offen sc1
v_cvt_pk_bf16_f32 v40, v40, v41
v_cvt_pk_bf16_f32 v41, v42, v43
v_cvt_pk_bf16_f32 v42, v56, v57
v_cvt_pk_bf16_f32 v43, v58, v59
buffer_store_dwordx4 v[40:43], v241, s[12:15], s49 offen offset:1024 sc1
v_cvt_pk_bf16_f32 v72, v72, v73
v_cvt_pk_bf16_f32 v73, v74, v75
v_cvt_pk_bf16_f32 v74, v88, v89
v_cvt_pk_bf16_f32 v75, v90, v91
buffer_store_dwordx4 v[72:75], v241, s[12:15], s49 offen offset:2048 sc1
v_cvt_pk_bf16_f32 v104, v104, v105
v_cvt_pk_bf16_f32 v105, v106, v107
v_cvt_pk_bf16_f32 v106, v120, v121
v_cvt_pk_bf16_f32 v107, v122, v123
buffer_store_dwordx4 v[104:107], v241, s[12:15], s49 offen offset:3072 sc1
v_cvt_pk_bf16_f32 v136, v136, v137
v_cvt_pk_bf16_f32 v137, v138, v139
s_add_u32 s51, s49, 4096
buffer_store_dwordx2 v[136:137], v242, s[12:15], s51 offen sc1
s_add_u32 s49, s49, 18432
v_cvt_pk_bf16_f32 v12, v12, v13
v_cvt_pk_bf16_f32 v13, v14, v15
v_cvt_pk_bf16_f32 v14, v28, v29
v_cvt_pk_bf16_f32 v15, v30, v31
buffer_store_dwordx4 v[12:15], v241, s[12:15], s49 offen sc1
v_cvt_pk_bf16_f32 v44, v44, v45
v_cvt_pk_bf16_f32 v45, v46, v47
v_cvt_pk_bf16_f32 v46, v60, v61
v_cvt_pk_bf16_f32 v47, v62, v63
buffer_store_dwordx4 v[44:47], v241, s[12:15], s49 offen offset:1024 sc1
v_cvt_pk_bf16_f32 v76, v76, v77
v_cvt_pk_bf16_f32 v77, v78, v79
v_cvt_pk_bf16_f32 v78, v92, v93
v_cvt_pk_bf16_f32 v79, v94, v95
buffer_store_dwordx4 v[76:79], v241, s[12:15], s49 offen offset:2048 sc1
v_cvt_pk_bf16_f32 v108, v108, v109
v_cvt_pk_bf16_f32 v109, v110, v111
v_cvt_pk_bf16_f32 v110, v124, v125
v_cvt_pk_bf16_f32 v111, v126, v127
buffer_store_dwordx4 v[108:111], v241, s[12:15], s49 offen offset:3072 sc1
v_cvt_pk_bf16_f32 v140, v140, v141
v_cvt_pk_bf16_f32 v141, v142, v143
s_add_u32 s51, s49, 4096
buffer_store_dwordx2 v[140:141], v242, s[12:15], s51 offen sc1
s_add_u32 s16, s70, 0x300000
s_addc_u32 s17, s71, 0
s_mov_b32 s18, 0x240000
s_mov_b32 s19, 0x20000
s_mov_b32 s20, s68
s_mov_b32 s21, s69
s_mov_b32 s22, 0x240000
s_mov_b32 s23, 0x20000
s_mov_b32 s24, s62
s_mov_b32 s25, s63
s_mov_b32 s26, 0x240000
s_mov_b32 s27, 0x20000
s_and_b32 s53, s40, 1
s_lshr_b32 s54, s40, 1
s_lshl_b32 s55, s43, 4
s_lshl_b32 s49, s41, 1
s_add_u32 s55, s55, s49
s_add_u32 s55, s55, s53
s_lshl_b32 s49, s55, 4
v_add_u32 v243, s49, v254
v_mul_u32_u24 v243, 1152, v243
v_lshl_add_u32 v244, v253, 3, v243
s_lshl_b32 s49, s54, 2
s_add_u32 s49, s49, 0
s_mul_i32 s51, s42, 9
s_add_u32 s49, s49, s51
s_lshr_b32 s51, s49, 1
s_lshl_b32 s51, s51, 10
s_and_b32 s60, s49, 1
s_lshl_b32 s60, s60, 3
s_add_u32 s51, s51, s60
s_mul_i32 s60, s55, 18432
s_add_u32 s51, s51, s60
buffer_load_dwordx2 v[160:161], v241, s[16:19], s51 offen sc1
s_lshl_b32 s51, s49, 5
buffer_load_dwordx2 v[170:171], v244, s[20:23], s51 offen
s_lshl_b32 s49, s54, 2
s_add_u32 s49, s49, 1
s_mul_i32 s51, s42, 9
s_add_u32 s49, s49, s51
s_lshr_b32 s51, s49, 1
s_lshl_b32 s51, s51, 10
s_and_b32 s60, s49, 1
s_lshl_b32 s60, s60, 3
s_add_u32 s51, s51, s60
s_mul_i32 s60, s55, 18432
s_add_u32 s51, s51, s60
buffer_load_dwordx2 v[162:163], v241, s[16:19], s51 offen sc1
s_lshl_b32 s51, s49, 5
buffer_load_dwordx2 v[172:173], v244, s[20:23], s51 offen
s_lshl_b32 s49, s54, 2
s_add_u32 s49, s49, 2
s_mul_i32 s51, s42, 9
s_add_u32 s49, s49, s51
s_lshr_b32 s51, s49, 1
s_lshl_b32 s51, s51, 10
s_and_b32 s60, s49, 1
s_lshl_b32 s60, s60, 3
s_add_u32 s51, s51, s60
s_mul_i32 s60, s55, 18432
s_add_u32 s51, s51, s60
buffer_load_dwordx2 v[164:165], v241, s[16:19], s51 offen sc1
s_lshl_b32 s51, s49, 5
buffer_load_dwordx2 v[174:175], v244, s[20:23], s51 offen
s_lshl_b32 s49, s54, 2
s_add_u32 s49, s49, 3
s_mul_i32 s51, s42, 9
s_add_u32 s49, s49, s51
s_lshr_b32 s51, s49, 1
s_lshl_b32 s51, s51, 10
s_and_b32 s60, s49, 1
s_lshl_b32 s60, s60, 3
s_add_u32 s51, s51, s60
s_mul_i32 s60, s55, 18432
s_add_u32 s51, s51, s60
buffer_load_dwordx2 v[166:167], v241, s[16:19], s51 offen sc1
s_lshl_b32 s51, s49, 5
buffer_load_dwordx2 v[176:177], v244, s[20:23], s51 offen
s_mov_b32 s49, 8
s_mul_i32 s51, s42, 9
s_add_u32 s49, s49, s51
s_lshr_b32 s51, s49, 1
s_lshl_b32 s51, s51, 10
s_and_b32 s60, s49, 1
s_lshl_b32 s60, s60, 3
s_add_u32 s51, s51, s60
s_mul_i32 s60, s55, 18432
s_add_u32 s51, s51, s60
buffer_load_dwordx2 v[168:169], v241, s[16:19], s51 offen sc1
s_lshl_b32 s51, s49, 5
buffer_load_dwordx2 v[178:179], v244, s[20:23], s51 offen
s_waitcnt vmcnt(10)
s_barrier
s_cmp_lg_u32 s40, 0
s_cbranch_scc1 L_nosig_sl
s_mov_b64 exec, 1
v_mov_b32 v252, 1
v_mov_b32 v251, 0
s_nop 0
buffer_atomic_add v252, v251, s[72:75], s59 offen
s_mov_b64 exec, -1
L_nosig_sl:
s_cmp_lg_u32 s40, 0
s_cbranch_scc1 L_pd_sl
s_mov_b32 s49, 0
L_pl_sl:
buffer_load_dword v239, v248, s[72:75], s59 offen sc1
s_waitcnt vmcnt(0)
v_readfirstlane_b32 s50, v239
s_nop 3
s_lshr_b32 s50, s50, 0
s_and_b32 s50, s50, 0xffff
s_cmp_ge_u32 s50, 8
s_cbranch_scc1 L_pd_sl
s_add_u32 s49, s49, 1
s_cmp_ge_u32 s49, 65536
s_cbranch_scc1 L_pd_sl
s_sleep 2
s_branch L_pl_sl
L_pd_sl:
s_barrier
s_mul_i32 s49, s55, 18432
s_mul_i32 s51, s42, 4608
s_add_u32 s49, s49, s51
s_lshl_b32 s51, s54, 11
s_add_u32 s60, s49, s51
s_add_u32 s49, s49, 4096
s_add_u32 s60, s60, 0x900000
s_add_u32 s49, s49, 0x900000
buffer_load_dwordx4 v[40:43], v241, s[12:15], s60 offen sc1
buffer_load_dwordx4 v[44:47], v241, s[12:15], s60 offen offset:1024 sc1
buffer_load_dwordx2 v[48:49], v242, s[12:15], s49 offen sc1
s_add_u32 s60, s60, 2359296
s_add_u32 s49, s49, 2359296
buffer_load_dwordx4 v[50:53], v241, s[12:15], s60 offen sc1
buffer_load_dwordx4 v[54:57], v241, s[12:15], s60 offen offset:1024 sc1
buffer_load_dwordx2 v[58:59], v242, s[12:15], s49 offen sc1
s_add_u32 s60, s60, 2359296
s_add_u32 s49, s49, 2359296
buffer_load_dwordx4 v[60:63], v241, s[12:15], s60 offen sc1
buffer_load_dwordx4 v[64:67], v241, s[12:15], s60 offen offset:1024 sc1
buffer_load_dwordx2 v[68:69], v242, s[12:15], s49 offen sc1
s_add_u32 s60, s60, 2359296
s_add_u32 s49, s49, 2359296
buffer_load_dwordx4 v[70:73], v241, s[12:15], s60 offen sc1
buffer_load_dwordx4 v[74:77], v241, s[12:15], s60 offen offset:1024 sc1
buffer_load_dwordx2 v[78:79], v242, s[12:15], s49 offen sc1
s_sub_u32 s60, s60, 0xfc0000
s_sub_u32 s49, s49, 0xfc0000
buffer_load_dwordx4 v[0:3], v241, s[12:15], s60 offen sc1
buffer_load_dwordx4 v[4:7], v241, s[12:15], s60 offen offset:1024 sc1
buffer_load_dwordx2 v[8:9], v242, s[12:15], s49 offen sc1
s_add_u32 s60, s60, 2359296
s_add_u32 s49, s49, 2359296
buffer_load_dwordx4 v[10:13], v241, s[12:15], s60 offen sc1
buffer_load_dwordx4 v[14:17], v241, s[12:15], s60 offen offset:1024 sc1
buffer_load_dwordx2 v[18:19], v242, s[12:15], s49 offen sc1
s_add_u32 s60, s60, 2359296
s_add_u32 s49, s49, 2359296
buffer_load_dwordx4 v[20:23], v241, s[12:15], s60 offen sc1
buffer_load_dwordx4 v[24:27], v241, s[12:15], s60 offen offset:1024 sc1
buffer_load_dwordx2 v[28:29], v242, s[12:15], s49 offen sc1
s_add_u32 s60, s60, 2359296
s_add_u32 s49, s49, 2359296
buffer_load_dwordx4 v[30:33], v241, s[12:15], s60 offen sc1
buffer_load_dwordx4 v[34:37], v241, s[12:15], s60 offen offset:1024 sc1
buffer_load_dwordx2 v[38:39], v242, s[12:15], s49 offen sc1
s_waitcnt vmcnt(12)
v_lshlrev_b32 v116, 16, v40
v_and_b32 v117, 0xffff0000, v40
v_lshlrev_b32 v136, 16, v50
v_and_b32 v137, 0xffff0000, v50
v_pk_add_f32 v[116:117], v[116:117], v[136:137]
v_lshlrev_b32 v136, 16, v60
v_and_b32 v137, 0xffff0000, v60
v_pk_add_f32 v[116:117], v[116:117], v[136:137]
v_lshlrev_b32 v136, 16, v70
v_and_b32 v137, 0xffff0000, v70
v_pk_add_f32 v[116:117], v[116:117], v[136:137]
v_lshlrev_b32 v136, 16, v160
v_and_b32 v137, 0xffff0000, v160
v_pk_add_f32 v[116:117], v[116:117], v[136:137]
v_lshlrev_b32 v118, 16, v41
v_and_b32 v119, 0xffff0000, v41
v_lshlrev_b32 v136, 16, v51
v_and_b32 v137, 0xffff0000, v51
v_pk_add_f32 v[118:119], v[118:119], v[136:137]
v_lshlrev_b32 v136, 16, v61
v_and_b32 v137, 0xffff0000, v61
v_pk_add_f32 v[118:119], v[118:119], v[136:137]
v_lshlrev_b32 v136, 16, v71
v_and_b32 v137, 0xffff0000, v71
v_pk_add_f32 v[118:119], v[118:119], v[136:137]
v_lshlrev_b32 v136, 16, v161
v_and_b32 v137, 0xffff0000, v161
v_pk_add_f32 v[118:119], v[118:119], v[136:137]
v_lshlrev_b32 v120, 16, v42
v_and_b32 v121, 0xffff0000, v42
v_lshlrev_b32 v136, 16, v52
v_and_b32 v137, 0xffff0000, v52
v_pk_add_f32 v[120:121], v[120:121], v[136:137]
v_lshlrev_b32 v136, 16, v62
v_and_b32 v137, 0xffff0000, v62
v_pk_add_f32 v[120:121], v[120:121], v[136:137]
v_lshlrev_b32 v136, 16, v72
v_and_b32 v137, 0xffff0000, v72
v_pk_add_f32 v[120:121], v[120:121], v[136:137]
v_lshlrev_b32 v136, 16, v162
v_and_b32 v137, 0xffff0000, v162
v_pk_add_f32 v[120:121], v[120:121], v[136:137]
v_lshlrev_b32 v122, 16, v43
v_and_b32 v123, 0xffff0000, v43
v_lshlrev_b32 v136, 16, v53
v_and_b32 v137, 0xffff0000, v53
v_pk_add_f32 v[122:123], v[122:123], v[136:137]
v_lshlrev_b32 v136, 16, v63
v_and_b32 v137, 0xffff0000, v63
v_pk_add_f32 v[122:123], v[122:123], v[136:137]
v_lshlrev_b32 v136, 16, v73
v_and_b32 v137, 0xffff0000, v73
v_pk_add_f32 v[122:123], v[122:123], v[136:137]
v_lshlrev_b32 v136, 16, v163
v_and_b32 v137, 0xffff0000, v163
v_pk_add_f32 v[122:123], v[122:123], v[136:137]
v_lshlrev_b32 v124, 16, v44
v_and_b32 v125, 0xffff0000, v44
v_lshlrev_b32 v136, 16, v54
v_and_b32 v137, 0xffff0000, v54
v_pk_add_f32 v[124:125], v[124:125], v[136:137]
v_lshlrev_b32 v136, 16, v64
v_and_b32 v137, 0xffff0000, v64
v_pk_add_f32 v[124:125], v[124:125], v[136:137]
v_lshlrev_b32 v136, 16, v74
v_and_b32 v137, 0xffff0000, v74
v_pk_add_f32 v[124:125], v[124:125], v[136:137]
v_lshlrev_b32 v136, 16, v164
v_and_b32 v137, 0xffff0000, v164
v_pk_add_f32 v[124:125], v[124:125], v[136:137]
v_lshlrev_b32 v126, 16, v45
v_and_b32 v127, 0xffff0000, v45
v_lshlrev_b32 v136, 16, v55
v_and_b32 v137, 0xffff0000, v55
v_pk_add_f32 v[126:127], v[126:127], v[136:137]
v_lshlrev_b32 v136, 16, v65
v_and_b32 v137, 0xffff0000, v65
v_pk_add_f32 v[126:127], v[126:127], v[136:137]
v_lshlrev_b32 v136, 16, v75
v_and_b32 v137, 0xffff0000, v75
v_pk_add_f32 v[126:127], v[126:127], v[136:137]
v_lshlrev_b32 v136, 16, v165
v_and_b32 v137, 0xffff0000, v165
v_pk_add_f32 v[126:127], v[126:127], v[136:137]
v_lshlrev_b32 v128, 16, v46
v_and_b32 v129, 0xffff0000, v46
v_lshlrev_b32 v136, 16, v56
v_and_b32 v137, 0xffff0000, v56
v_pk_add_f32 v[128:129], v[128:129], v[136:137]
v_lshlrev_b32 v136, 16, v66
v_and_b32 v137, 0xffff0000, v66
v_pk_add_f32 v[128:129], v[128:129], v[136:137]
v_lshlrev_b32 v136, 16, v76
v_and_b32 v137, 0xffff0000, v76
v_pk_add_f32 v[128:129], v[128:129], v[136:137]
v_lshlrev_b32 v136, 16, v166
v_and_b32 v137, 0xffff0000, v166
v_pk_add_f32 v[128:129], v[128:129], v[136:137]
v_lshlrev_b32 v130, 16, v47
v_and_b32 v131, 0xffff0000, v47
v_lshlrev_b32 v136, 16, v57
v_and_b32 v137, 0xffff0000, v57
v_pk_add_f32 v[130:131], v[130:131], v[136:137]
v_lshlrev_b32 v136, 16, v67
v_and_b32 v137, 0xffff0000, v67
v_pk_add_f32 v[130:131], v[130:131], v[136:137]
v_lshlrev_b32 v136, 16, v77
v_and_b32 v137, 0xffff0000, v77
v_pk_add_f32 v[130:131], v[130:131], v[136:137]
v_lshlrev_b32 v136, 16, v167
v_and_b32 v137, 0xffff0000, v167
v_pk_add_f32 v[130:131], v[130:131], v[136:137]
v_lshlrev_b32 v132, 16, v48
v_and_b32 v133, 0xffff0000, v48
v_lshlrev_b32 v136, 16, v58
v_and_b32 v137, 0xffff0000, v58
v_pk_add_f32 v[132:133], v[132:133], v[136:137]
v_lshlrev_b32 v136, 16, v68
v_and_b32 v137, 0xffff0000, v68
v_pk_add_f32 v[132:133], v[132:133], v[136:137]
v_lshlrev_b32 v136, 16, v78
v_and_b32 v137, 0xffff0000, v78
v_pk_add_f32 v[132:133], v[132:133], v[136:137]
v_lshlrev_b32 v136, 16, v168
v_and_b32 v137, 0xffff0000, v168
v_pk_add_f32 v[132:133], v[132:133], v[136:137]
v_lshlrev_b32 v134, 16, v49
v_and_b32 v135, 0xffff0000, v49
v_lshlrev_b32 v136, 16, v59
v_and_b32 v137, 0xffff0000, v59
v_pk_add_f32 v[134:135], v[134:135], v[136:137]
v_lshlrev_b32 v136, 16, v69
v_and_b32 v137, 0xffff0000, v69
v_pk_add_f32 v[134:135], v[134:135], v[136:137]
v_lshlrev_b32 v136, 16, v79
v_and_b32 v137, 0xffff0000, v79
v_pk_add_f32 v[134:135], v[134:135], v[136:137]
v_lshlrev_b32 v136, 16, v169
v_and_b32 v137, 0xffff0000, v169
v_pk_add_f32 v[134:135], v[134:135], v[136:137]
v_mul_f32 v140, 0xbfb8aa3b, v116
v_mul_f32 v141, 0xbfb8aa3b, v117
v_mul_f32 v142, 0xbfb8aa3b, v118
v_mul_f32 v143, 0xbfb8aa3b, v119
v_mul_f32 v144, 0xbfb8aa3b, v120
v_mul_f32 v145, 0xbfb8aa3b, v121
v_mul_f32 v146, 0xbfb8aa3b, v122
v_mul_f32 v147, 0xbfb8aa3b, v123
v_mul_f32 v148, 0xbfb8aa3b, v124
v_mul_f32 v149, 0xbfb8aa3b, v125
v_mul_f32 v150, 0xbfb8aa3b, v126
v_mul_f32 v151, 0xbfb8aa3b, v127
v_mul_f32 v152, 0xbfb8aa3b, v128
v_mul_f32 v153, 0xbfb8aa3b, v129
v_mul_f32 v154, 0xbfb8aa3b, v130
v_mul_f32 v155, 0xbfb8aa3b, v131
v_mul_f32 v156, 0xbfb8aa3b, v132
v_mul_f32 v157, 0xbfb8aa3b, v133
v_mul_f32 v158, 0xbfb8aa3b, v134
v_mul_f32 v159, 0xbfb8aa3b, v135
v_exp_f32 v140, v140
v_exp_f32 v141, v141
v_exp_f32 v142, v142
v_exp_f32 v143, v143
v_exp_f32 v144, v144
v_exp_f32 v145, v145
v_exp_f32 v146, v146
v_exp_f32 v147, v147
v_exp_f32 v148, v148
v_exp_f32 v149, v149
v_exp_f32 v150, v150
v_exp_f32 v151, v151
v_exp_f32 v152, v152
v_exp_f32 v153, v153
v_exp_f32 v154, v154
v_exp_f32 v155, v155
v_exp_f32 v156, v156
v_exp_f32 v157, v157
v_exp_f32 v158, v158
v_exp_f32 v159, v159
v_add_f32 v140, 1.0, v140
v_add_f32 v141, 1.0, v141
v_add_f32 v142, 1.0, v142
v_add_f32 v143, 1.0, v143
v_add_f32 v144, 1.0, v144
v_add_f32 v145, 1.0, v145
v_add_f32 v146, 1.0, v146
v_add_f32 v147, 1.0, v147
v_add_f32 v148, 1.0, v148
v_add_f32 v149, 1.0, v149
v_add_f32 v150, 1.0, v150
v_add_f32 v151, 1.0, v151
v_add_f32 v152, 1.0, v152
v_add_f32 v153, 1.0, v153
v_add_f32 v154, 1.0, v154
v_add_f32 v155, 1.0, v155
v_add_f32 v156, 1.0, v156
v_add_f32 v157, 1.0, v157
v_add_f32 v158, 1.0, v158
v_add_f32 v159, 1.0, v159
v_rcp_f32 v140, v140
v_rcp_f32 v141, v141
v_rcp_f32 v142, v142
v_rcp_f32 v143, v143
v_rcp_f32 v144, v144
v_rcp_f32 v145, v145
v_rcp_f32 v146, v146
v_rcp_f32 v147, v147
v_rcp_f32 v148, v148
v_rcp_f32 v149, v149
v_rcp_f32 v150, v150
v_rcp_f32 v151, v151
v_rcp_f32 v152, v152
v_rcp_f32 v153, v153
v_rcp_f32 v154, v154
v_rcp_f32 v155, v155
v_rcp_f32 v156, v156
v_rcp_f32 v157, v157
v_rcp_f32 v158, v158
v_rcp_f32 v159, v159
v_mul_f32 v116, v116, v140
v_mul_f32 v117, v117, v141
v_mul_f32 v118, v118, v142
v_mul_f32 v119, v119, v143
v_mul_f32 v120, v120, v144
v_mul_f32 v121, v121, v145
v_mul_f32 v122, v122, v146
v_mul_f32 v123, v123, v147
v_mul_f32 v124, v124, v148
v_mul_f32 v125, v125, v149
v_mul_f32 v126, v126, v150
v_mul_f32 v127, v127, v151
v_mul_f32 v128, v128, v152
v_mul_f32 v129, v129, v153
v_mul_f32 v130, v130, v154
v_mul_f32 v131, v131, v155
v_mul_f32 v132, v132, v156
v_mul_f32 v133, v133, v157
v_mul_f32 v134, v134, v158
v_mul_f32 v135, v135, v159
s_waitcnt vmcnt(0)
v_lshlrev_b32 v96, 16, v0
v_and_b32 v97, 0xffff0000, v0
v_lshlrev_b32 v136, 16, v10
v_and_b32 v137, 0xffff0000, v10
v_pk_add_f32 v[96:97], v[96:97], v[136:137]
v_lshlrev_b32 v136, 16, v20
v_and_b32 v137, 0xffff0000, v20
v_pk_add_f32 v[96:97], v[96:97], v[136:137]
v_lshlrev_b32 v136, 16, v30
v_and_b32 v137, 0xffff0000, v30
v_pk_add_f32 v[96:97], v[96:97], v[136:137]
v_lshlrev_b32 v98, 16, v1
v_and_b32 v99, 0xffff0000, v1
v_lshlrev_b32 v136, 16, v11
v_and_b32 v137, 0xffff0000, v11
v_pk_add_f32 v[98:99], v[98:99], v[136:137]
v_lshlrev_b32 v136, 16, v21
v_and_b32 v137, 0xffff0000, v21
v_pk_add_f32 v[98:99], v[98:99], v[136:137]
v_lshlrev_b32 v136, 16, v31
v_and_b32 v137, 0xffff0000, v31
v_pk_add_f32 v[98:99], v[98:99], v[136:137]
v_lshlrev_b32 v100, 16, v2
v_and_b32 v101, 0xffff0000, v2
v_lshlrev_b32 v136, 16, v12
v_and_b32 v137, 0xffff0000, v12
v_pk_add_f32 v[100:101], v[100:101], v[136:137]
v_lshlrev_b32 v136, 16, v22
v_and_b32 v137, 0xffff0000, v22
v_pk_add_f32 v[100:101], v[100:101], v[136:137]
v_lshlrev_b32 v136, 16, v32
v_and_b32 v137, 0xffff0000, v32
v_pk_add_f32 v[100:101], v[100:101], v[136:137]
v_lshlrev_b32 v102, 16, v3
v_and_b32 v103, 0xffff0000, v3
v_lshlrev_b32 v136, 16, v13
v_and_b32 v137, 0xffff0000, v13
v_pk_add_f32 v[102:103], v[102:103], v[136:137]
v_lshlrev_b32 v136, 16, v23
v_and_b32 v137, 0xffff0000, v23
v_pk_add_f32 v[102:103], v[102:103], v[136:137]
v_lshlrev_b32 v136, 16, v33
v_and_b32 v137, 0xffff0000, v33
v_pk_add_f32 v[102:103], v[102:103], v[136:137]
v_lshlrev_b32 v104, 16, v4
v_and_b32 v105, 0xffff0000, v4
v_lshlrev_b32 v136, 16, v14
v_and_b32 v137, 0xffff0000, v14
v_pk_add_f32 v[104:105], v[104:105], v[136:137]
v_lshlrev_b32 v136, 16, v24
v_and_b32 v137, 0xffff0000, v24
v_pk_add_f32 v[104:105], v[104:105], v[136:137]
v_lshlrev_b32 v136, 16, v34
v_and_b32 v137, 0xffff0000, v34
v_pk_add_f32 v[104:105], v[104:105], v[136:137]
v_lshlrev_b32 v106, 16, v5
v_and_b32 v107, 0xffff0000, v5
v_lshlrev_b32 v136, 16, v15
v_and_b32 v137, 0xffff0000, v15
v_pk_add_f32 v[106:107], v[106:107], v[136:137]
v_lshlrev_b32 v136, 16, v25
v_and_b32 v137, 0xffff0000, v25
v_pk_add_f32 v[106:107], v[106:107], v[136:137]
v_lshlrev_b32 v136, 16, v35
v_and_b32 v137, 0xffff0000, v35
v_pk_add_f32 v[106:107], v[106:107], v[136:137]
v_lshlrev_b32 v108, 16, v6
v_and_b32 v109, 0xffff0000, v6
v_lshlrev_b32 v136, 16, v16
v_and_b32 v137, 0xffff0000, v16
v_pk_add_f32 v[108:109], v[108:109], v[136:137]
v_lshlrev_b32 v136, 16, v26
v_and_b32 v137, 0xffff0000, v26
v_pk_add_f32 v[108:109], v[108:109], v[136:137]
v_lshlrev_b32 v136, 16, v36
v_and_b32 v137, 0xffff0000, v36
v_pk_add_f32 v[108:109], v[108:109], v[136:137]
v_lshlrev_b32 v110, 16, v7
v_and_b32 v111, 0xffff0000, v7
v_lshlrev_b32 v136, 16, v17
v_and_b32 v137, 0xffff0000, v17
v_pk_add_f32 v[110:111], v[110:111], v[136:137]
v_lshlrev_b32 v136, 16, v27
v_and_b32 v137, 0xffff0000, v27
v_pk_add_f32 v[110:111], v[110:111], v[136:137]
v_lshlrev_b32 v136, 16, v37
v_and_b32 v137, 0xffff0000, v37
v_pk_add_f32 v[110:111], v[110:111], v[136:137]
v_lshlrev_b32 v112, 16, v8
v_and_b32 v113, 0xffff0000, v8
v_lshlrev_b32 v136, 16, v18
v_and_b32 v137, 0xffff0000, v18
v_pk_add_f32 v[112:113], v[112:113], v[136:137]
v_lshlrev_b32 v136, 16, v28
v_and_b32 v137, 0xffff0000, v28
v_pk_add_f32 v[112:113], v[112:113], v[136:137]
v_lshlrev_b32 v136, 16, v38
v_and_b32 v137, 0xffff0000, v38
v_pk_add_f32 v[112:113], v[112:113], v[136:137]
v_lshlrev_b32 v114, 16, v9
v_and_b32 v115, 0xffff0000, v9
v_lshlrev_b32 v136, 16, v19
v_and_b32 v137, 0xffff0000, v19
v_pk_add_f32 v[114:115], v[114:115], v[136:137]
v_lshlrev_b32 v136, 16, v29
v_and_b32 v137, 0xffff0000, v29
v_pk_add_f32 v[114:115], v[114:115], v[136:137]
v_lshlrev_b32 v136, 16, v39
v_and_b32 v137, 0xffff0000, v39
v_pk_add_f32 v[114:115], v[114:115], v[136:137]
v_lshlrev_b32 v0, 16, v170
v_and_b32 v1, 0xffff0000, v170
v_lshlrev_b32 v2, 16, v171
v_and_b32 v3, 0xffff0000, v171
v_lshlrev_b32 v4, 16, v172
v_and_b32 v5, 0xffff0000, v172
v_lshlrev_b32 v6, 16, v173
v_and_b32 v7, 0xffff0000, v173
v_lshlrev_b32 v8, 16, v174
v_and_b32 v9, 0xffff0000, v174
v_lshlrev_b32 v10, 16, v175
v_and_b32 v11, 0xffff0000, v175
v_lshlrev_b32 v12, 16, v176
v_and_b32 v13, 0xffff0000, v176
v_lshlrev_b32 v14, 16, v177
v_and_b32 v15, 0xffff0000, v177
v_lshlrev_b32 v16, 16, v178
v_and_b32 v17, 0xffff0000, v178
v_lshlrev_b32 v18, 16, v179
v_and_b32 v19, 0xffff0000, v179
v_fmac_f32 v0, v96, v116
v_fmac_f32 v1, v97, v117
v_fmac_f32 v2, v98, v118
v_fmac_f32 v3, v99, v119
v_fmac_f32 v4, v100, v120
v_fmac_f32 v5, v101, v121
v_fmac_f32 v6, v102, v122
v_fmac_f32 v7, v103, v123
v_fmac_f32 v8, v104, v124
v_fmac_f32 v9, v105, v125
v_fmac_f32 v10, v106, v126
v_fmac_f32 v11, v107, v127
v_fmac_f32 v12, v108, v128
v_fmac_f32 v13, v109, v129
v_fmac_f32 v14, v110, v130
v_fmac_f32 v15, v111, v131
v_fmac_f32 v16, v112, v132
v_fmac_f32 v17, v113, v133
v_fmac_f32 v18, v114, v134
v_fmac_f32 v19, v115, v135
v_and_b32 v245, 1, v253
v_lshlrev_b32 v245, 5, v245
v_lshrrev_b32 v246, 1, v253
v_lshl_add_u32 v245, v246, 4, v245
v_add_u32 v245, v245, v243
s_mul_i32 s49, s42, 288
s_lshl_b32 s51, s54, 7
s_add_u32 s51, s51, s49
v_cvt_pk_bf16_f32 v40, v0, v1
v_cvt_pk_bf16_f32 v41, v2, v3
v_cvt_pk_bf16_f32 v42, v4, v5
v_cvt_pk_bf16_f32 v43, v6, v7
s_nop 1
v_permlane16_swap_b32 v40, v42
v_permlane16_swap_b32 v41, v43
buffer_store_dwordx4 v[40:43], v245, s[24:27], s51 offen
s_nop 1
v_cvt_pk_bf16_f32 v40, v8, v9
v_cvt_pk_bf16_f32 v41, v10, v11
v_cvt_pk_bf16_f32 v42, v12, v13
v_cvt_pk_bf16_f32 v43, v14, v15
s_nop 1
v_permlane16_swap_b32 v40, v42
v_permlane16_swap_b32 v41, v43
buffer_store_dwordx4 v[40:43], v245, s[24:27], s51 offen offset:64
s_nop 1
s_cmp_lg_u32 s54, 0
s_cbranch_scc1 KE_done
v_cvt_pk_bf16_f32 v44, v16, v17
v_cvt_pk_bf16_f32 v45, v18, v19
buffer_store_dwordx2 v[44:45], v244, s[24:27], s49 offen offset:256
KE_done:
K3_end:
s_endpgm
.section .rodata,"a"
.p2align 6
.amdhsa_kernel recurrent_scan__gqa_block_cached__mixer_s_mlp__prompt_kernel
  .amdhsa_next_free_vgpr 512
  .amdhsa_next_free_sgpr 102
  .amdhsa_accum_offset 256
  .amdhsa_group_segment_fixed_size 0
  .amdhsa_kernarg_size 104
  .amdhsa_user_sgpr_count 2
  .amdhsa_user_sgpr_kernarg_segment_ptr 1
  .amdhsa_system_sgpr_workgroup_id_x 1
  .amdhsa_float_denorm_mode_32 3
.end_amdhsa_kernel
```
